```python
import torch

def _softmax(x, axis=-1):
    return torch.softmax(x, dim=axis)
def _gelu(x):
    return torch.nn.functional.gelu(x, approximate="tanh")
def _silu(x):
    return torch.nn.functional.silu(x)
def _sigmoid(x):
    return torch.sigmoid(x)
def _layernorm(x, axis=-1, eps=1e-5):
    m = x.mean(dim=axis, keepdim=True)
    v = x.var(dim=axis, keepdim=True, unbiased=False)
    return (x - m) / torch.sqrt(v + eps)
def _scatter_add(tgt, idx, src, axis=0):
    return tgt.clone().index_add_(axis, idx, src)
def _segment_sum(src, seg, n):
    out = torch.zeros((n,) + src.shape[1:], dtype=src.dtype)
    return out.index_add_(0, seg, src)
def _pad(x, pw):
    flat = tuple(v for pair in reversed(pw) for v in pair)
    return torch.nn.functional.pad(x, flat)

kernel_name = 'standalone__gqa_softmax__near_ridge'

def setup_inputs():

    _w = (lambda a: (lambda t: t.to(torch.bfloat16) if t.is_floating_point() else t)(torch.as_tensor(a)))
    B, Hq, Hkv, Sq, Sk, D = 32, 32, 32, 256, 512, 128
    return {
        "q": _w((lambda *s: torch.randn(*s, dtype=torch.bfloat16) * 0.8)(B, Hq, Sq, D)),
        "k": _w((lambda *s: torch.randn(*s, dtype=torch.bfloat16) * 0.8)(B, Hkv, Sk, D)),
        "v": _w((lambda *s: torch.randn(*s, dtype=torch.bfloat16) * 0.05)(B, Hkv, Sk, D)),
    }

def reference(q, k, v):
    B, Hq, Sq, D = q.shape
    Hkv = k.shape[1]
    rep = Hq // Hkv
    k = (lambda x, n, axis: torch.repeat_interleave(x, n, dim=axis))(k, rep, axis=1)
    v = (lambda x, n, axis: torch.repeat_interleave(x, n, dim=axis))(v, rep, axis=1)
    scale = D ** -0.5
    scores = torch.einsum("bhqd,bhkd->bhqk", q, k) * scale
    p = _softmax(scores, axis=-1)
    return torch.einsum("bhqk,bhkd->bhqd", p, v)
```

```asm
; @launch grid=(256,1,1) block=(256,1,1) lds=163840
.amdgcn_target "amdgcn-amd-amdhsa--gfx950"
.text
.globl standalone__gqa_softmax__near_ridge_kernel
.p2align 12
.p2align 8
.type standalone__gqa_softmax__near_ridge_kernel,@function
standalone__gqa_softmax__near_ridge_kernel:
  s_load_dwordx4 s[4:7], s[0:1], 0
  s_load_dwordx4 s[8:11], s[0:1], 16
  s_load_dwordx2 s[38:39], s[0:1], 32
  s_cmp_ge_u32 s2, 256
  s_cbranch_scc1 L_done
  v_lshrrev_b32 v2, 6, v0
  v_bfe_u32 v3, v0, 4, 2
  v_readfirstlane_b32 s45, v2
  v_and_b32 v4, 15, v0
  v_lshlrev_b32 v5, 1, v3
  v_xor_b32 v4, v4, v5
  v_lshlrev_b32 v4, 4, v4
  v_lshl_add_u32 v4, v3, 8, v4
  s_getpc_b64 s[56:57]
L_pc:
  s_sub_u32 s56, s56, L_pc-standalone__gqa_softmax__near_ridge_kernel
  s_subb_u32 s57, s57, 0
  s_and_b32 s57, s57, 0xffff
  s_mov_b32 s58, L_done-standalone__gqa_softmax__near_ridge_kernel
  s_mov_b32 s59, 0x20000
  s_lshr_b32 s55, s2, 3
  s_and_b32 s55, s55, 3
  s_lshl_b32 s55, s55, 15
  v_lshlrev_b32 v126, 7, v0
  buffer_load_dword v127, v126, s[56:59], s55 offen
  v_xor_b32 v22, 0, v4
  v_xor_b32 v23, 128, v4
  v_xor_b32 v24, 144, v4
  v_xor_b32 v25, 16, v4
  s_lshl_b32 s30, s45, 12
  s_lshl_b32 s31, s45, 13
  s_add_u32 s31, s31, 131072
  s_lshl_b32 s32, s2, 17
  s_lshl_b32 s35, s2, 16
  s_lshl2_add_u32 s40, s2, s45
  s_bitcmp1_b32 s40, 0
  s_cselect_b32 s41, 0x7800, 0
  s_cselect_b32 s42, 0x2000, 0
  s_xor_b32 s32, s32, s41
  s_xor_b32 s35, s35, s42
  s_bitcmp1_b32 s40, 1
  s_cselect_b32 s41, 0x8000, 0
  s_cselect_b32 s42, 0x8000, 0
  s_xor_b32 s32, s32, s41
  s_xor_b32 s35, s35, s42
  s_bitcmp1_b32 s40, 2
  s_cselect_b32 s41, 0x4a1000, 0
  s_cselect_b32 s42, 0x25c000, 0
  s_xor_b32 s32, s32, s41
  s_xor_b32 s35, s35, s42
  s_bitcmp1_b32 s40, 3
  s_cselect_b32 s41, 0xb000, 0
  s_cselect_b32 s42, 0x5c00, 0
  s_xor_b32 s32, s32, s41
  s_xor_b32 s35, s35, s42
  s_bitcmp1_b32 s40, 4
  s_cselect_b32 s41, 0x5b4000, 0
  s_cselect_b32 s42, 0x2d2000, 0
  s_xor_b32 s32, s32, s41
  s_xor_b32 s35, s35, s42
  s_bitcmp1_b32 s40, 5
  s_cselect_b32 s41, 0x1f000, 0
  s_cselect_b32 s42, 0xa000, 0
  s_xor_b32 s32, s32, s41
  s_xor_b32 s35, s35, s42
  s_bitcmp1_b32 s40, 6
  s_cselect_b32 s41, 0x2400, 0
  s_cselect_b32 s42, 0x2c00, 0
  s_xor_b32 s32, s32, s41
  s_xor_b32 s35, s35, s42
  s_bitcmp1_b32 s40, 7
  s_cselect_b32 s41, 0x103000, 0
  s_cselect_b32 s42, 0x82000, 0
  s_xor_b32 s32, s32, s41
  s_xor_b32 s35, s35, s42
  s_bitcmp1_b32 s40, 8
  s_cselect_b32 s41, 0x11d800, 0
  s_cselect_b32 s42, 0x80c00, 0
  s_xor_b32 s32, s32, s41
  s_xor_b32 s35, s35, s42
  s_bitcmp1_b32 s40, 9
  s_cselect_b32 s41, 0x200800, 0
  s_cselect_b32 s42, 0x100800, 0
  s_xor_b32 s32, s32, s41
  s_xor_b32 s35, s35, s42
  s_mov_b32 s47, s35
  s_mov_b32 s46, s32
  s_mov_b32 s14, 0x4000000
  s_mov_b32 s15, 0x20000
  s_mov_b32 s18, 0x8000000
  s_mov_b32 s19, 0x20000
  s_mov_b32 s22, 0x8000000
  s_mov_b32 s23, 0x20000
  s_mov_b32 s26, 0x4000000
  s_mov_b32 s27, 0x20000
  s_waitcnt lgkmcnt(0)
  s_mov_b32 s16, s6
  s_and_b32 s17, s7, 0xffff
  s_mov_b32 s12, s4
  s_and_b32 s13, s5, 0xffff
  s_mov_b32 s20, s8
  s_and_b32 s21, s9, 0xffff
  s_mov_b32 s24, s10
  s_and_b32 s25, s11, 0xffff
  s_add_u32 m0, s30, 0
  s_xor_b32 s40, s32, 0x0
  buffer_load_dwordx4 v22, s[16:19], s40 offen nt lds
  s_add_u32 m0, s30, 1024
  s_xor_b32 s40, s32, 0xc00
  buffer_load_dwordx4 v23, s[16:19], s40 offen nt lds
  s_add_u32 m0, s30, 2048
  s_xor_b32 s40, s32, 0x10400
  buffer_load_dwordx4 v24, s[16:19], s40 offen nt lds
  s_add_u32 m0, s30, 3072
  s_xor_b32 s40, s32, 0x10800
  buffer_load_dwordx4 v25, s[16:19], s40 offen nt lds
  s_add_u32 m0, s31, 0
  s_xor_b32 s42, s47, 0x0
  buffer_load_dwordx4 v22, s[12:15], s42 offen nt lds
  s_add_u32 m0, s31, 1024
  s_xor_b32 s42, s47, 0x6000
  buffer_load_dwordx4 v23, s[12:15], s42 offen nt lds
  s_add_u32 m0, s31, 2048
  s_xor_b32 s42, s47, 0x400
  buffer_load_dwordx4 v24, s[12:15], s42 offen nt lds
  s_add_u32 m0, s31, 3072
  s_xor_b32 s42, s47, 0x6400
  buffer_load_dwordx4 v25, s[12:15], s42 offen nt lds
  s_add_u32 m0, s31, 4096
  s_xor_b32 s42, s47, 0x5000
  buffer_load_dwordx4 v22, s[12:15], s42 offen nt lds
  s_add_u32 m0, s31, 5120
  s_xor_b32 s42, s47, 0x3000
  buffer_load_dwordx4 v23, s[12:15], s42 offen nt lds
  s_add_u32 m0, s31, 6144
  s_xor_b32 s42, s47, 0x5400
  buffer_load_dwordx4 v24, s[12:15], s42 offen nt lds
  s_add_u32 m0, s31, 7168
  s_xor_b32 s42, s47, 0x3400
  buffer_load_dwordx4 v25, s[12:15], s42 offen nt lds
  s_mov_b64 exec, 0
  s_cmp_eq_u32 s45, 0
  s_cbranch_scc1 L_pg1
  s_cmp_eq_u32 s45, 1
  s_cbranch_scc1 L_pg2
  s_cmp_eq_u32 s45, 2
  s_cbranch_scc1 L_pg3
  s_branch L_pg4
L_rt0:
  s_mov_b64 exec, -1
  s_add_u32 m0, s30, 98304
  s_xor_b32 s42, s47, 0xe800
  buffer_load_dwordx4 v22, s[12:15], s42 offen nt lds
  s_add_u32 m0, s30, 99328
  s_xor_b32 s42, s47, 0x8800
  buffer_load_dwordx4 v23, s[12:15], s42 offen nt lds
  s_add_u32 m0, s30, 100352
  s_xor_b32 s42, s47, 0xec00
  buffer_load_dwordx4 v24, s[12:15], s42 offen nt lds
  s_add_u32 m0, s30, 101376
  s_xor_b32 s42, s47, 0x8c00
  buffer_load_dwordx4 v25, s[12:15], s42 offen nt lds
  s_add_u32 m0, s30, 114688
  s_xor_b32 s42, s47, 0xb800
  buffer_load_dwordx4 v22, s[12:15], s42 offen nt lds
  s_add_u32 m0, s30, 115712
  s_xor_b32 s42, s47, 0xd800
  buffer_load_dwordx4 v23, s[12:15], s42 offen nt lds
  s_add_u32 m0, s30, 116736
  s_xor_b32 s42, s47, 0xbc00
  buffer_load_dwordx4 v24, s[12:15], s42 offen nt lds
  s_add_u32 m0, s30, 117760
  s_xor_b32 s42, s47, 0xdc00
  buffer_load_dwordx4 v25, s[12:15], s42 offen nt lds
  s_add_u32 m0, s30, 16384
  s_xor_b32 s40, s32, 0x400
  buffer_load_dwordx4 v22, s[16:19], s40 offen nt lds
  s_add_u32 m0, s30, 17408
  s_xor_b32 s40, s32, 0x800
  buffer_load_dwordx4 v23, s[16:19], s40 offen nt lds
  s_add_u32 m0, s30, 18432
  s_xor_b32 s40, s32, 0x10000
  buffer_load_dwordx4 v24, s[16:19], s40 offen nt lds
  s_add_u32 m0, s30, 19456
  s_xor_b32 s40, s32, 0x10c00
  buffer_load_dwordx4 v25, s[16:19], s40 offen nt lds
  s_add_u32 m0, s30, 65536
  s_xor_b32 s40, s32, 0x0
  buffer_load_dwordx4 v22, s[20:23], s40 offen nt lds
  s_add_u32 m0, s30, 66560
  s_xor_b32 s40, s32, 0xc00
  buffer_load_dwordx4 v23, s[20:23], s40 offen nt lds
  s_add_u32 m0, s30, 67584
  s_xor_b32 s40, s32, 0x10400
  buffer_load_dwordx4 v24, s[20:23], s40 offen nt lds
  s_add_u32 m0, s30, 68608
  s_xor_b32 s40, s32, 0x10800
  buffer_load_dwordx4 v25, s[20:23], s40 offen nt lds
  s_xor_b32 s33, s32, 0x6068c00
  s_xor_b32 s34, s47, 0x3038400
  s_mov_b32 s28, 0x3e0293ee
  s_mov_b32 s3, 0
  s_mov_b32 s36, 0
  s_mov_b32 s37, 1
  s_lshr_b32 s41, s2, 4
  s_and_b32 s41, s41, 3
  s_lshl_b32 s41, s41, 6
  s_add_u32 s4, s38, s41
  s_addc_u32 s5, s39, 0
  s_and_b32 s5, s5, 0xffff
  s_mov_b32 s6, 4
  s_mov_b32 s7, 0x20000
  s_cmp_eq_u32 s45, 0
  s_cselect_b32 s49, 0, 0xe0000000
  s_cselect_b32 s44, 32, 0x20000000
  s_cselect_b32 s6, 4, 0
  s_lshr_b32 s40, s2, 6
  s_add_u32 s41, s40, 0
  s_and_b32 s41, s41, 3
  s_lshl_b32 s41, s41, 3
  s_lshr_b32 s98, 0x331a260d, s41
  s_and_b32 s98, s98, 0xff
  s_add_u32 s41, s40, 1
  s_and_b32 s41, s41, 3
  s_lshl_b32 s41, s41, 3
  s_lshr_b32 s99, 0x331a260d, s41
  s_and_b32 s99, s99, 0xff
  s_add_u32 s41, s40, 2
  s_and_b32 s41, s41, 3
  s_lshl_b32 s41, s41, 3
  s_lshr_b32 s100, 0x331a260d, s41
  s_and_b32 s100, s100, 0xff
  s_add_u32 s41, s40, 3
  s_and_b32 s41, s41, 3
  s_lshl_b32 s41, s41, 3
  s_lshr_b32 s101, 0x331a260d, s41
  s_and_b32 s101, s101, 0xff
  s_sub_i32 s8, s44, s98
  s_sub_i32 s9, s44, s99
  s_sub_i32 s10, s44, s100
  s_sub_i32 s11, s44, s101
  v_and_b32 v1, 63, v0
  v_and_b32 v5, 15, v0
  v_bfe_u32 v6, v0, 4, 2
  v_and_b32 v7, 3, v5
  v_lshlrev_b32 v7, 1, v7
  v_lshrrev_b32 v8, 3, v5
  v_bfe_u32 v9, v5, 2, 1
  v_xor_b32 v9, v9, v8
  v_lshl_or_b32 v7, v9, 3, v7
  v_or_b32 v7, v7, v8
  v_xor_b32 v8, v7, v6
  v_lshlrev_b32 v8, 4, v8
  v_lshl_add_u32 v10, v5, 8, v8
  v_xor_b32 v11, 64, v10
  v_xor_b32 v12, 128, v10
  v_xor_b32 v13, 192, v10
  v_lshrrev_b32 v8, 1, v6
  v_xor_b32 v8, v8, v7
  v_lshlrev_b32 v8, 4, v8
  v_lshl_add_u32 v8, v5, 8, v8
  v_and_b32 v9, 1, v6
  v_lshl_add_u32 v8, v9, 3, v8
  s_sub_u32 s41, s31, s30
  v_lshlrev_b32 v8, 4, v1
  v_lshrrev_b32 v3, 2, v1
  v_and_b32 v7, 3, v3
  v_lshlrev_b32 v7, 1, v7
  v_lshrrev_b32 v8, 3, v3
  v_bfe_u32 v9, v3, 2, 1
  v_xor_b32 v9, v9, v8
  v_lshl_or_b32 v7, v9, 3, v7
  v_or_b32 v7, v7, v8
  v_bfe_u32 v8, v1, 1, 1
  v_xor_b32 v8, v8, v7
  v_lshlrev_b32 v8, 4, v8
  v_lshl_add_u32 v8, v3, 8, v8
  v_and_b32 v9, 1, v1
  v_lshl_add_u32 v8, v9, 3, v8
  v_and_b32 v8, 3, v5
  v_cmp_eq_u32 vcc, 0, v8
  v_mov_b32 v9, 0x3f803f80
  s_nop 1
  v_cndmask_b32 v44, 0, v9, vcc
  v_mov_b32 v45, v44
  v_mov_b32 v46, v44
  v_mov_b32 v47, v44
  v_bfe_u32 v8, v1, 1, 1
  v_mul_u32_u24 v41, 2080, v8
  v_mul_u32_u24 v8, 5, v8
  v_xor_b32 v8, v8, v7
  v_lshlrev_b32 v8, 4, v8
  v_lshl_add_u32 v8, v3, 8, v8
  v_and_b32 v9, 1, v1
  v_lshl_add_u32 v8, v9, 3, v8
  v_add_u32 v14, 65536, v8
  v_xor_b32 v15, 16, v14
  v_xor_b32 v16, 32, v14
  v_xor_b32 v17, 48, v14
  v_xor_b32 v18, 128, v14
  v_xor_b32 v19, 144, v14
  v_xor_b32 v20, 160, v14
  v_xor_b32 v21, 176, v14
  v_lshl_add_u32 v41, v9, 6, v41
  v_lshl_add_u32 v41, v6, 7, v41
  v_and_b32 v9, 3, v3
  v_lshl_add_u32 v41, v9, 3, v41
  v_add_u32 v41, s31, v41
  v_lshl_add_u32 v40, v1, 3, s31
  v_and_b32 v8, 1, v3
  v_xor_b32 v8, v8, v1
  v_lshlrev_b32 v26, 4, v8
  v_and_b32 v8, 3, v1
  v_lshl_add_u32 v3, v8, 2, v9
  v_and_b32 v7, 3, v3
  v_lshlrev_b32 v7, 1, v7
  v_lshrrev_b32 v8, 3, v3
  v_bfe_u32 v9, v3, 2, 1
  v_xor_b32 v9, v9, v8
  v_lshl_or_b32 v7, v9, 3, v7
  v_or_b32 v7, v7, v8
  v_xor_b32 v8, v7, v6
  v_lshlrev_b32 v8, 4, v8
  v_lshl_add_u32 v8, v3, 8, v8
  v_add_u32 v28, s31, v8
  v_xor_b32 v29, 64, v28
  v_xor_b32 v30, 128, v28
  v_xor_b32 v31, 192, v28
  v_lshrrev_b32 v8, 2, v5
  v_and_b32 v9, 1, v5
  v_lshlrev_b32 v9, 4, v9
  v_cmp_eq_u32 vcc, v8, v6
  v_lshlrev_b32 v9, v9, 1
  v_bfe_u32 v8, v5, 1, 1
  v_cndmask_b32 v9, 0, v9, vcc
  v_mul_u32_u24 v0, v8, v9
  v_sub_u32 v27, v9, v0
  s_add_u32 s41, s30, 98304
  s_sub_u32 s41, s41, s31
  v_add_u32 v96, s41, v28
  v_add_u32 v97, s41, v29
  v_add_u32 v98, s41, v30
  v_add_u32 v99, s41, v31
  v_add_u32 v100, 0x1000, v28
  v_add_u32 v104, 0x4000, v96
  v_add_u32 v101, 0x1000, v29
  v_add_u32 v105, 0x4000, v97
  v_add_u32 v102, 0x1000, v30
  v_add_u32 v106, 0x4000, v98
  v_add_u32 v103, 0x1000, v31
  v_add_u32 v107, 0x4000, v99
  v_mul_u32_u24 v32, 0x3e03, v27
  v_mul_u32_u24 v33, 0x3e03, v0
  v_mul_u32_u24 v34, 0xb9d8, v27
  v_mul_u32_u24 v35, 0xb9d8, v0
  v_mov_b32 v27, v40
  v_mov_b32 v0, v41
  s_waitcnt vmcnt(24)
  s_barrier
  ds_read_b128 a[192:195], v10
  ds_read_b128 a[196:199], v11
  ds_read_b128 a[200:203], v12
  ds_read_b128 a[204:207], v13
  ds_read_b128 a[208:211], v10 offset:4096
  ds_read_b128 a[212:215], v11 offset:4096
  ds_read_b128 a[216:219], v12 offset:4096
  ds_read_b128 a[220:223], v13 offset:4096
  ds_read_b128 a[224:227], v10 offset:8192
  ds_read_b128 a[228:231], v11 offset:8192
  ds_read_b128 a[232:235], v12 offset:8192
  ds_read_b128 a[236:239], v13 offset:8192
  ds_read_b128 a[240:243], v10 offset:12288
  ds_read_b128 a[244:247], v11 offset:12288
  ds_read_b128 a[248:251], v12 offset:12288
  ds_read_b128 a[252:255], v13 offset:12288
  s_waitcnt vmcnt(20)
  ds_read2_b64 v[192:195], v28 offset0:0 offset1:0
  ds_read2_b64 v[196:199], v28 offset0:1 offset1:1
  ds_read2_b64 v[200:203], v29 offset0:0 offset1:0
  ds_read2_b64 v[204:207], v29 offset0:1 offset1:1
  ds_read2_b64 v[208:211], v30 offset0:0 offset1:0
  ds_read2_b64 v[212:215], v30 offset0:1 offset1:1
  ds_read2_b64 v[216:219], v31 offset0:0 offset1:0
  ds_read2_b64 v[220:223], v31 offset0:1 offset1:1
  s_add_u32 m0, s30, 32768
  s_xor_b32 s40, s32, 0x3800
  buffer_load_dwordx4 v22, s[16:19], s40 offen nt lds
  s_waitcnt lgkmcnt(7)
  v_mfma_f32_16x16x32_bf16 v[192:195], v[32:35], v[192:195], 0
  s_waitcnt lgkmcnt(6)
  v_mfma_f32_16x16x32_bf16 v[196:199], v[32:35], v[196:199], 0
  s_waitcnt lgkmcnt(5)
  v_mfma_f32_16x16x32_bf16 v[200:203], v[32:35], v[200:203], 0
  s_waitcnt lgkmcnt(4)
  v_mfma_f32_16x16x32_bf16 v[204:207], v[32:35], v[204:207], 0
  s_nop 1
  v_cvt_pk_bf16_f32 v192, v192, v193
  v_cvt_pk_bf16_f32 v193, v194, v195
  s_waitcnt lgkmcnt(3)
  v_mfma_f32_16x16x32_bf16 v[208:211], v[32:35], v[208:211], 0
  v_accvgpr_write_b32 a128, v192
  v_accvgpr_write_b32 a129, v193
  v_cvt_pk_bf16_f32 v196, v196, v197
  v_cvt_pk_bf16_f32 v197, v198, v199
  s_waitcnt lgkmcnt(2)
  v_mfma_f32_16x16x32_bf16 v[212:215], v[32:35], v[212:215], 0
  v_accvgpr_write_b32 a130, v196
  v_accvgpr_write_b32 a131, v197
  v_cvt_pk_bf16_f32 v200, v200, v201
  v_cvt_pk_bf16_f32 v201, v202, v203
  s_waitcnt lgkmcnt(1)
  v_mfma_f32_16x16x32_bf16 v[216:219], v[32:35], v[216:219], 0
  v_accvgpr_write_b32 a132, v200
  v_accvgpr_write_b32 a133, v201
  v_cvt_pk_bf16_f32 v204, v204, v205
  v_cvt_pk_bf16_f32 v205, v206, v207
  s_waitcnt lgkmcnt(0)
  v_mfma_f32_16x16x32_bf16 v[220:223], v[32:35], v[220:223], 0
  v_accvgpr_write_b32 a134, v204
  v_accvgpr_write_b32 a135, v205
  v_cvt_pk_bf16_f32 v208, v208, v209
  v_cvt_pk_bf16_f32 v209, v210, v211
  v_accvgpr_write_b32 a136, v208
  v_accvgpr_write_b32 a137, v209
  v_cvt_pk_bf16_f32 v212, v212, v213
  v_cvt_pk_bf16_f32 v213, v214, v215
  v_accvgpr_write_b32 a138, v212
  v_accvgpr_write_b32 a139, v213
  v_cvt_pk_bf16_f32 v216, v216, v217
  v_cvt_pk_bf16_f32 v217, v218, v219
  v_accvgpr_write_b32 a140, v216
  v_accvgpr_write_b32 a141, v217
  v_cvt_pk_bf16_f32 v220, v220, v221
  v_cvt_pk_bf16_f32 v221, v222, v223
  v_accvgpr_write_b32 a142, v220
  v_accvgpr_write_b32 a143, v221
  v_mfma_f32_16x16x32_bf16 v[128:131], a[192:195], a[128:131], 0
  v_mfma_f32_16x16x32_bf16 v[128:131], a[196:199], a[132:135], v[128:131]
  v_mfma_f32_16x16x32_bf16 v[128:131], a[200:203], a[136:139], v[128:131]
  v_mfma_f32_16x16x32_bf16 v[128:131], a[204:207], a[140:143], v[128:131]
  v_mfma_f32_16x16x32_bf16 v[132:135], a[220:223], a[140:143], 0
  v_mfma_f32_16x16x32_bf16 v[132:135], a[216:219], a[136:139], v[132:135]
  v_mfma_f32_16x16x32_bf16 v[132:135], a[212:215], a[132:135], v[132:135]
  v_mfma_f32_16x16x32_bf16 v[132:135], a[208:211], a[128:131], v[132:135]
  v_mfma_f32_16x16x32_bf16 v[136:139], a[224:227], a[128:131], 0
  v_mfma_f32_16x16x32_bf16 v[136:139], a[228:231], a[132:135], v[136:139]
  v_mfma_f32_16x16x32_bf16 v[136:139], a[232:235], a[136:139], v[136:139]
  v_mfma_f32_16x16x32_bf16 v[136:139], a[236:239], a[140:143], v[136:139]
  v_mfma_f32_16x16x32_bf16 v[140:143], a[252:255], a[140:143], 0
  v_exp_f32 v128, v128
  v_mfma_f32_16x16x32_bf16 v[140:143], a[248:251], a[136:139], v[140:143]
  v_exp_f32 v129, v129
  v_mfma_f32_16x16x32_bf16 v[140:143], a[244:247], a[132:135], v[140:143]
  v_exp_f32 v130, v130
  v_cvt_pk_bf16_f32 v128, v128, v129
  v_mfma_f32_16x16x32_bf16 v[140:143], a[240:243], a[128:131], v[140:143]
  v_exp_f32 v131, v131
  v_exp_f32 v132, v132
  v_cvt_pk_bf16_f32 v129, v130, v131
  v_exp_f32 v133, v133
  v_exp_f32 v134, v134
  v_cvt_pk_bf16_f32 v130, v132, v133
  v_exp_f32 v135, v135
  s_nop 0
  v_cvt_pk_bf16_f32 v131, v134, v135
  v_exp_f32 v136, v136
  v_exp_f32 v137, v137
  v_exp_f32 v138, v138
  v_cvt_pk_bf16_f32 v136, v136, v137
  v_exp_f32 v139, v139
  v_exp_f32 v140, v140
  v_cvt_pk_bf16_f32 v137, v138, v139
  v_exp_f32 v141, v141
  v_exp_f32 v142, v142
  v_cvt_pk_bf16_f32 v138, v140, v141
  v_exp_f32 v143, v143
  s_nop 0
  v_cvt_pk_bf16_f32 v139, v142, v143
  s_waitcnt vmcnt(17)
  ds_read2_b64 v[192:195], v100 offset0:0 offset1:0
  ds_read2_b64 v[196:199], v100 offset0:1 offset1:1
  ds_read2_b64 v[200:203], v101 offset0:0 offset1:0
  ds_read2_b64 v[204:207], v101 offset0:1 offset1:1
  ds_read2_b64 v[208:211], v102 offset0:0 offset1:0
  ds_read2_b64 v[212:215], v102 offset0:1 offset1:1
  ds_read2_b64 v[216:219], v103 offset0:0 offset1:0
  ds_read2_b64 v[220:223], v103 offset0:1 offset1:1
  s_add_u32 m0, s30, 33792
  s_xor_b32 s40, s32, 0x3400
  buffer_load_dwordx4 v23, s[16:19], s40 offen nt lds
  s_waitcnt lgkmcnt(7)
  v_mfma_f32_16x16x32_bf16 v[192:195], v[32:35], v[192:195], 0
  s_waitcnt lgkmcnt(6)
  v_mfma_f32_16x16x32_bf16 v[196:199], v[32:35], v[196:199], 0
  s_waitcnt lgkmcnt(5)
  v_mfma_f32_16x16x32_bf16 v[200:203], v[32:35], v[200:203], 0
  s_waitcnt lgkmcnt(4)
  v_mfma_f32_16x16x32_bf16 v[204:207], v[32:35], v[204:207], 0
  s_nop 1
  v_cvt_pk_bf16_f32 v192, v192, v193
  v_cvt_pk_bf16_f32 v193, v194, v195
  s_waitcnt lgkmcnt(3)
  v_mfma_f32_16x16x32_bf16 v[208:211], v[32:35], v[208:211], 0
  v_accvgpr_write_b32 a144, v192
  v_accvgpr_write_b32 a145, v193
  v_cvt_pk_bf16_f32 v196, v196, v197
  v_cvt_pk_bf16_f32 v197, v198, v199
  s_waitcnt lgkmcnt(2)
  v_mfma_f32_16x16x32_bf16 v[212:215], v[32:35], v[212:215], 0
  v_accvgpr_write_b32 a146, v196
  v_accvgpr_write_b32 a147, v197
  v_cvt_pk_bf16_f32 v200, v200, v201
  v_cvt_pk_bf16_f32 v201, v202, v203
  s_waitcnt lgkmcnt(1)
  v_mfma_f32_16x16x32_bf16 v[216:219], v[32:35], v[216:219], 0
  v_accvgpr_write_b32 a148, v200
  v_accvgpr_write_b32 a149, v201
  v_cvt_pk_bf16_f32 v204, v204, v205
  v_cvt_pk_bf16_f32 v205, v206, v207
  s_waitcnt lgkmcnt(0)
  v_mfma_f32_16x16x32_bf16 v[220:223], v[32:35], v[220:223], 0
  v_accvgpr_write_b32 a150, v204
  v_accvgpr_write_b32 a151, v205
  v_cvt_pk_bf16_f32 v208, v208, v209
  v_cvt_pk_bf16_f32 v209, v210, v211
  v_accvgpr_write_b32 a152, v208
  v_accvgpr_write_b32 a153, v209
  v_cvt_pk_bf16_f32 v212, v212, v213
  v_cvt_pk_bf16_f32 v213, v214, v215
  v_accvgpr_write_b32 a154, v212
  v_accvgpr_write_b32 a155, v213
  v_cvt_pk_bf16_f32 v216, v216, v217
  v_cvt_pk_bf16_f32 v217, v218, v219
  v_accvgpr_write_b32 a156, v216
  v_accvgpr_write_b32 a157, v217
  v_cvt_pk_bf16_f32 v220, v220, v221
  v_cvt_pk_bf16_f32 v221, v222, v223
  v_accvgpr_write_b32 a158, v220
  v_accvgpr_write_b32 a159, v221
  v_mfma_f32_16x16x32_bf16 v[144:147], a[192:195], a[144:147], 0
  v_mfma_f32_16x16x32_bf16 v[144:147], a[196:199], a[148:151], v[144:147]
  v_mfma_f32_16x16x32_bf16 v[144:147], a[200:203], a[152:155], v[144:147]
  v_mfma_f32_16x16x32_bf16 v[144:147], a[204:207], a[156:159], v[144:147]
  v_mfma_f32_16x16x32_bf16 v[148:151], a[220:223], a[156:159], 0
  v_mfma_f32_16x16x32_bf16 v[148:151], a[216:219], a[152:155], v[148:151]
  v_mfma_f32_16x16x32_bf16 v[148:151], a[212:215], a[148:151], v[148:151]
  v_mfma_f32_16x16x32_bf16 v[148:151], a[208:211], a[144:147], v[148:151]
  v_mfma_f32_16x16x32_bf16 v[152:155], a[224:227], a[144:147], 0
  v_mfma_f32_16x16x32_bf16 v[152:155], a[228:231], a[148:151], v[152:155]
  v_mfma_f32_16x16x32_bf16 v[152:155], a[232:235], a[152:155], v[152:155]
  v_mfma_f32_16x16x32_bf16 v[152:155], a[236:239], a[156:159], v[152:155]
  v_mfma_f32_16x16x32_bf16 v[156:159], a[252:255], a[156:159], 0
  v_exp_f32 v144, v144
  v_mfma_f32_16x16x32_bf16 v[156:159], a[248:251], a[152:155], v[156:159]
  v_exp_f32 v145, v145
  v_mfma_f32_16x16x32_bf16 v[156:159], a[244:247], a[148:151], v[156:159]
  v_exp_f32 v146, v146
  v_cvt_pk_bf16_f32 v144, v144, v145
  v_mfma_f32_16x16x32_bf16 v[156:159], a[240:243], a[144:147], v[156:159]
  v_exp_f32 v147, v147
  v_exp_f32 v148, v148
  v_cvt_pk_bf16_f32 v145, v146, v147
  v_exp_f32 v149, v149
  v_exp_f32 v150, v150
  v_cvt_pk_bf16_f32 v146, v148, v149
  v_exp_f32 v151, v151
  s_nop 0
  v_cvt_pk_bf16_f32 v147, v150, v151
  v_exp_f32 v152, v152
  v_exp_f32 v153, v153
  v_exp_f32 v154, v154
  v_cvt_pk_bf16_f32 v152, v152, v153
  v_exp_f32 v155, v155
  v_exp_f32 v156, v156
  v_cvt_pk_bf16_f32 v153, v154, v155
  v_exp_f32 v157, v157
  v_exp_f32 v158, v158
  v_cvt_pk_bf16_f32 v154, v156, v157
  v_exp_f32 v159, v159
  s_nop 0
  v_cvt_pk_bf16_f32 v155, v158, v159
  s_waitcnt vmcnt(14)
  ds_read2_b64 v[192:195], v96 offset0:0 offset1:0
  ds_read2_b64 v[196:199], v96 offset0:1 offset1:1
  ds_read2_b64 v[200:203], v97 offset0:0 offset1:0
  ds_read2_b64 v[204:207], v97 offset0:1 offset1:1
  ds_read2_b64 v[208:211], v98 offset0:0 offset1:0
  ds_read2_b64 v[212:215], v98 offset0:1 offset1:1
  ds_read2_b64 v[216:219], v99 offset0:0 offset1:0
  ds_read2_b64 v[220:223], v99 offset0:1 offset1:1
  s_add_u32 m0, s30, 34816
  s_xor_b32 s40, s32, 0x13c00
  buffer_load_dwordx4 v24, s[16:19], s40 offen nt lds
  s_waitcnt lgkmcnt(7)
  v_mfma_f32_16x16x32_bf16 v[192:195], v[32:35], v[192:195], 0
  s_waitcnt lgkmcnt(6)
  v_mfma_f32_16x16x32_bf16 v[196:199], v[32:35], v[196:199], 0
  s_waitcnt lgkmcnt(5)
  v_mfma_f32_16x16x32_bf16 v[200:203], v[32:35], v[200:203], 0
  s_waitcnt lgkmcnt(4)
  v_mfma_f32_16x16x32_bf16 v[204:207], v[32:35], v[204:207], 0
  s_nop 1
  v_cvt_pk_bf16_f32 v192, v192, v193
  v_cvt_pk_bf16_f32 v193, v194, v195
  s_waitcnt lgkmcnt(3)
  v_mfma_f32_16x16x32_bf16 v[208:211], v[32:35], v[208:211], 0
  v_accvgpr_write_b32 a160, v192
  v_accvgpr_write_b32 a161, v193
  v_cvt_pk_bf16_f32 v196, v196, v197
  v_cvt_pk_bf16_f32 v197, v198, v199
  s_waitcnt lgkmcnt(2)
  v_mfma_f32_16x16x32_bf16 v[212:215], v[32:35], v[212:215], 0
  v_accvgpr_write_b32 a162, v196
  v_accvgpr_write_b32 a163, v197
  v_cvt_pk_bf16_f32 v200, v200, v201
  v_cvt_pk_bf16_f32 v201, v202, v203
  s_waitcnt lgkmcnt(1)
  v_mfma_f32_16x16x32_bf16 v[216:219], v[32:35], v[216:219], 0
  v_accvgpr_write_b32 a164, v200
  v_accvgpr_write_b32 a165, v201
  v_cvt_pk_bf16_f32 v204, v204, v205
  v_cvt_pk_bf16_f32 v205, v206, v207
  s_waitcnt lgkmcnt(0)
  v_mfma_f32_16x16x32_bf16 v[220:223], v[32:35], v[220:223], 0
  v_accvgpr_write_b32 a166, v204
  v_accvgpr_write_b32 a167, v205
  v_cvt_pk_bf16_f32 v208, v208, v209
  v_cvt_pk_bf16_f32 v209, v210, v211
  v_accvgpr_write_b32 a168, v208
  v_accvgpr_write_b32 a169, v209
  v_cvt_pk_bf16_f32 v212, v212, v213
  v_cvt_pk_bf16_f32 v213, v214, v215
L_pg1:
  s_cbranch_execz L_pg5
  v_accvgpr_write_b32 a170, v212
  v_accvgpr_write_b32 a171, v213
  v_cvt_pk_bf16_f32 v216, v216, v217
  v_cvt_pk_bf16_f32 v217, v218, v219
  v_accvgpr_write_b32 a172, v216
  v_accvgpr_write_b32 a173, v217
  v_cvt_pk_bf16_f32 v220, v220, v221
  v_cvt_pk_bf16_f32 v221, v222, v223
  v_accvgpr_write_b32 a174, v220
  v_accvgpr_write_b32 a175, v221
  v_mfma_f32_16x16x32_bf16 v[160:163], a[192:195], a[160:163], 0
  v_mfma_f32_16x16x32_bf16 v[160:163], a[196:199], a[164:167], v[160:163]
  v_mfma_f32_16x16x32_bf16 v[160:163], a[200:203], a[168:171], v[160:163]
  v_mfma_f32_16x16x32_bf16 v[160:163], a[204:207], a[172:175], v[160:163]
  v_mfma_f32_16x16x32_bf16 v[164:167], a[220:223], a[172:175], 0
  v_mfma_f32_16x16x32_bf16 v[164:167], a[216:219], a[168:171], v[164:167]
  v_mfma_f32_16x16x32_bf16 v[164:167], a[212:215], a[164:167], v[164:167]
  v_mfma_f32_16x16x32_bf16 v[164:167], a[208:211], a[160:163], v[164:167]
  v_mfma_f32_16x16x32_bf16 v[168:171], a[224:227], a[160:163], 0
  v_mfma_f32_16x16x32_bf16 v[168:171], a[228:231], a[164:167], v[168:171]
  v_mfma_f32_16x16x32_bf16 v[168:171], a[232:235], a[168:171], v[168:171]
  v_mfma_f32_16x16x32_bf16 v[168:171], a[236:239], a[172:175], v[168:171]
  v_mfma_f32_16x16x32_bf16 v[172:175], a[252:255], a[172:175], 0
  v_exp_f32 v160, v160
  v_mfma_f32_16x16x32_bf16 v[172:175], a[248:251], a[168:171], v[172:175]
  v_exp_f32 v161, v161
  v_mfma_f32_16x16x32_bf16 v[172:175], a[244:247], a[164:167], v[172:175]
  v_exp_f32 v162, v162
  v_cvt_pk_bf16_f32 v160, v160, v161
  v_mfma_f32_16x16x32_bf16 v[172:175], a[240:243], a[160:163], v[172:175]
  v_exp_f32 v163, v163
  v_exp_f32 v164, v164
  v_cvt_pk_bf16_f32 v161, v162, v163
  v_exp_f32 v165, v165
  v_exp_f32 v166, v166
  v_cvt_pk_bf16_f32 v162, v164, v165
  v_exp_f32 v167, v167
  s_nop 0
  v_cvt_pk_bf16_f32 v163, v166, v167
  s_waitcnt vmcnt(11)
  ds_read2_b64 v[192:195], v104 offset0:0 offset1:0
  ds_read2_b64 v[196:199], v104 offset0:1 offset1:1
  ds_read2_b64 v[200:203], v105 offset0:0 offset1:0
  ds_read2_b64 v[204:207], v105 offset0:1 offset1:1
  ds_read2_b64 v[208:211], v106 offset0:0 offset1:0
  ds_read2_b64 v[212:215], v106 offset0:1 offset1:1
  ds_read2_b64 v[216:219], v107 offset0:0 offset1:0
  ds_read2_b64 v[220:223], v107 offset0:1 offset1:1
  s_add_u32 m0, s30, 35840
  s_xor_b32 s40, s32, 0x13000
  buffer_load_dwordx4 v25, s[16:19], s40 offen nt lds
  s_waitcnt lgkmcnt(7)
  v_mfma_f32_16x16x32_bf16 v[192:195], v[32:35], v[192:195], 0
  s_waitcnt lgkmcnt(6)
  v_mfma_f32_16x16x32_bf16 v[196:199], v[32:35], v[196:199], 0
  s_waitcnt lgkmcnt(5)
  v_mfma_f32_16x16x32_bf16 v[200:203], v[32:35], v[200:203], 0
  s_waitcnt lgkmcnt(4)
  v_mfma_f32_16x16x32_bf16 v[204:207], v[32:35], v[204:207], 0
  s_nop 1
  v_cvt_pk_bf16_f32 v192, v192, v193
  v_cvt_pk_bf16_f32 v193, v194, v195
  s_waitcnt lgkmcnt(3)
  v_mfma_f32_16x16x32_bf16 v[208:211], v[32:35], v[208:211], 0
  v_accvgpr_write_b32 a176, v192
  v_accvgpr_write_b32 a177, v193
  v_cvt_pk_bf16_f32 v196, v196, v197
  v_cvt_pk_bf16_f32 v197, v198, v199
  s_waitcnt lgkmcnt(2)
  v_mfma_f32_16x16x32_bf16 v[212:215], v[32:35], v[212:215], 0
  v_accvgpr_write_b32 a178, v196
  v_accvgpr_write_b32 a179, v197
  v_cvt_pk_bf16_f32 v200, v200, v201
  v_cvt_pk_bf16_f32 v201, v202, v203
  s_waitcnt lgkmcnt(1)
  v_mfma_f32_16x16x32_bf16 v[216:219], v[32:35], v[216:219], 0
  v_accvgpr_write_b32 a180, v200
  v_accvgpr_write_b32 a181, v201
  v_cvt_pk_bf16_f32 v204, v204, v205
  v_cvt_pk_bf16_f32 v205, v206, v207
  s_waitcnt lgkmcnt(0)
  v_mfma_f32_16x16x32_bf16 v[220:223], v[32:35], v[220:223], 0
  v_accvgpr_write_b32 a182, v204
  v_accvgpr_write_b32 a183, v205
  v_cvt_pk_bf16_f32 v208, v208, v209
  v_cvt_pk_bf16_f32 v209, v210, v211
  v_accvgpr_write_b32 a184, v208
  v_accvgpr_write_b32 a185, v209
  v_cvt_pk_bf16_f32 v212, v212, v213
  v_cvt_pk_bf16_f32 v213, v214, v215
  v_accvgpr_write_b32 a186, v212
  v_accvgpr_write_b32 a187, v213
  v_cvt_pk_bf16_f32 v216, v216, v217
  v_cvt_pk_bf16_f32 v217, v218, v219
  v_accvgpr_write_b32 a188, v216
  v_accvgpr_write_b32 a189, v217
  v_cvt_pk_bf16_f32 v220, v220, v221
  v_cvt_pk_bf16_f32 v221, v222, v223
  v_accvgpr_write_b32 a190, v220
  v_accvgpr_write_b32 a191, v221
  v_mfma_f32_16x16x32_bf16 v[176:179], a[192:195], a[176:179], 0
  v_mfma_f32_16x16x32_bf16 v[176:179], a[196:199], a[180:183], v[176:179]
  v_mfma_f32_16x16x32_bf16 v[176:179], a[200:203], a[184:187], v[176:179]
  v_mfma_f32_16x16x32_bf16 v[176:179], a[204:207], a[188:191], v[176:179]
  v_mfma_f32_16x16x32_bf16 v[180:183], a[220:223], a[188:191], 0
  v_mfma_f32_16x16x32_bf16 v[180:183], a[216:219], a[184:187], v[180:183]
  v_mfma_f32_16x16x32_bf16 v[180:183], a[212:215], a[180:183], v[180:183]
  v_mfma_f32_16x16x32_bf16 v[180:183], a[208:211], a[176:179], v[180:183]
  v_mfma_f32_16x16x32_bf16 v[184:187], a[224:227], a[176:179], 0
  s_waitcnt vmcnt(8) lgkmcnt(0)
  s_barrier
  ds_read_b128 a[192:195], v10 offset:16384
  v_mfma_f32_16x16x32_bf16 v[184:187], a[228:231], a[180:183], v[184:187]
  ds_read_b128 a[196:199], v11 offset:16384
  v_mfma_f32_16x16x32_bf16 v[184:187], a[232:235], a[184:187], v[184:187]
  ds_read_b128 a[200:203], v12 offset:16384
  v_mfma_f32_16x16x32_bf16 v[184:187], a[236:239], a[188:191], v[184:187]
  ds_read_b128 a[204:207], v13 offset:16384
  v_mfma_f32_16x16x32_bf16 v[188:191], a[252:255], a[188:191], 0
  ds_read_b128 a[208:211], v10 offset:20480
  v_exp_f32 v176, v176
  v_mfma_f32_16x16x32_bf16 v[188:191], a[248:251], a[184:187], v[188:191]
  ds_read_b128 a[212:215], v11 offset:20480
  v_mfma_f32_16x16x32_bf16 v[188:191], a[244:247], a[180:183], v[188:191]
  ds_read_b128 a[216:219], v12 offset:20480
  v_exp_f32 v177, v177
  v_mfma_f32_16x16x32_bf16 v[188:191], a[240:243], a[176:179], v[188:191]
  ds_read_b128 a[220:223], v13 offset:20480
  v_cvt_pk_bf16_f32 v176, v176, v177
  v_exp_f32 v178, v178
  v_exp_f32 v179, v179
  v_exp_f32 v180, v180
  v_cvt_pk_bf16_f32 v177, v178, v179
  v_exp_f32 v181, v181
  v_exp_f32 v182, v182
  v_cvt_pk_bf16_f32 v178, v180, v181
  v_exp_f32 v183, v183
  s_nop 0
  v_cvt_pk_bf16_f32 v179, v182, v183
  s_waitcnt lgkmcnt(0)
  v_mfma_f32_16x16x32_bf16 v[240:243], a[192:195], a[176:179], 0
  v_exp_f32 v168, v168
  v_mfma_f32_16x16x32_bf16 v[240:243], a[196:199], a[180:183], v[240:243]
  ds_read_b128 a[224:227], v10 offset:24576
  v_mfma_f32_16x16x32_bf16 v[240:243], a[200:203], a[184:187], v[240:243]
  s_add_u32 m0, s30, 81920
  s_xor_b32 s40, s32, 0x400
  v_exp_f32 v169, v169
  v_mfma_f32_16x16x32_bf16 v[240:243], a[204:207], a[188:191], v[240:243]
  s_waitcnt vmcnt(4)
  buffer_load_dwordx4 v22, s[20:23], s40 offen nt lds
  v_mfma_f32_16x16x32_bf16 v[224:227], a[204:207], a[172:175], 0
  ds_read_b128 a[228:231], v11 offset:24576
  v_cvt_pk_bf16_f32 v168, v168, v169
  v_mfma_f32_16x16x32_bf16 v[224:227], a[200:203], a[168:171], v[224:227]
  v_exp_f32 v170, v170
  v_mfma_f32_16x16x32_bf16 v[224:227], a[196:199], a[164:167], v[224:227]
  v_exp_f32 v171, v171
  v_mfma_f32_16x16x32_bf16 v[224:227], a[192:195], a[160:163], v[224:227]
  ds_read_b128 a[232:235], v12 offset:24576
  v_cvt_pk_bf16_f32 v169, v170, v171
  v_mfma_f32_16x16x32_bf16 v[208:211], a[192:195], a[144:147], 0
  v_exp_f32 v172, v172
  v_mfma_f32_16x16x32_bf16 v[208:211], a[196:199], a[148:151], v[208:211]
  v_exp_f32 v173, v173
  v_mfma_f32_16x16x32_bf16 v[208:211], a[200:203], a[152:155], v[208:211]
  ds_read_b128 a[236:239], v13 offset:24576
  v_cvt_pk_bf16_f32 v170, v172, v173
  v_mfma_f32_16x16x32_bf16 v[208:211], a[204:207], a[156:159], v[208:211]
  v_exp_f32 v174, v174
  v_mfma_f32_16x16x32_bf16 v[192:195], a[204:207], a[140:143], 0
  v_exp_f32 v175, v175
  v_mfma_f32_16x16x32_bf16 v[192:195], a[200:203], a[136:139], v[192:195]
  s_add_u32 m0, s30, 82944
  s_xor_b32 s40, s32, 0x800
  ds_read_b128 a[240:243], v10 offset:28672
  v_cvt_pk_bf16_f32 v171, v174, v175
  v_mfma_f32_16x16x32_bf16 v[192:195], a[196:199], a[132:135], v[192:195]
  s_waitcnt vmcnt(4)
  buffer_load_dwordx4 v23, s[20:23], s40 offen nt lds
  v_mfma_f32_16x16x32_bf16 v[192:195], a[192:195], a[128:131], v[192:195]
  v_exp_f32 v184, v184
  v_mfma_f32_16x16x32_bf16 v[196:199], a[208:211], a[128:131], 0
  ds_read_b128 a[244:247], v11 offset:28672
  v_mfma_f32_16x16x32_bf16 v[196:199], a[212:215], a[132:135], v[196:199]
  v_exp_f32 v185, v185
  v_mfma_f32_16x16x32_bf16 v[196:199], a[216:219], a[136:139], v[196:199]
  v_exp_f32 v186, v186
  v_mfma_f32_16x16x32_bf16 v[196:199], a[220:223], a[140:143], v[196:199]
  ds_read_b128 a[248:251], v12 offset:28672
  v_cvt_pk_bf16_f32 v184, v184, v185
  v_mfma_f32_16x16x32_bf16 v[212:215], a[220:223], a[156:159], 0
  v_exp_f32 v187, v187
  v_mfma_f32_16x16x32_bf16 v[212:215], a[216:219], a[152:155], v[212:215]
  v_exp_f32 v188, v188
  v_mfma_f32_16x16x32_bf16 v[212:215], a[212:215], a[148:151], v[212:215]
  s_add_u32 m0, s30, 83968
  s_xor_b32 s40, s32, 0x10000
  ds_read_b128 a[252:255], v13 offset:28672
  v_cvt_pk_bf16_f32 v185, v186, v187
  v_mfma_f32_16x16x32_bf16 v[212:215], a[208:211], a[144:147], v[212:215]
  s_waitcnt vmcnt(4)
  buffer_load_dwordx4 v24, s[20:23], s40 offen nt lds
  v_mfma_f32_16x16x32_bf16 v[228:231], a[208:211], a[160:163], 0
  v_exp_f32 v189, v189
  v_mfma_f32_16x16x32_bf16 v[228:231], a[212:215], a[164:167], v[228:231]
  v_exp_f32 v190, v190
  v_mfma_f32_16x16x32_bf16 v[228:231], a[216:219], a[168:171], v[228:231]
  v_exp_f32 v191, v191
  v_mfma_f32_16x16x32_bf16 v[228:231], a[220:223], a[172:175], v[228:231]
  v_exp_f32 v192, v192
  v_mfma_f32_16x16x32_bf16 v[244:247], a[220:223], a[188:191], 0
  v_exp_f32 v193, v193
  v_mfma_f32_16x16x32_bf16 v[244:247], a[216:219], a[184:187], v[244:247]
  v_exp_f32 v194, v194
  v_mfma_f32_16x16x32_bf16 v[244:247], a[212:215], a[180:183], v[244:247]
  v_exp_f32 v195, v195
  v_mfma_f32_16x16x32_bf16 v[244:247], a[208:211], a[176:179], v[244:247]
  s_waitcnt vmcnt(7) lgkmcnt(0)
  s_barrier
  v_cvt_pk_bf16_f32 v186, v188, v189
  v_mfma_f32_16x16x32_bf16 v[248:251], a[224:227], a[176:179], 0
  s_add_u32 m0, s30, 84992
  s_xor_b32 s40, s32, 0x10c00
  ds_read_b64_tr_b16 a[192:193], v14
  v_cvt_pk_bf16_f32 v187, v190, v191
  v_mfma_f32_16x16x32_bf16 v[248:251], a[228:231], a[180:183], v[248:251]
  s_waitcnt vmcnt(4)
  buffer_load_dwordx4 v25, s[20:23], s40 offen nt lds
  v_mfma_f32_16x16x32_bf16 v[248:251], a[232:235], a[184:187], v[248:251]
  ds_read_b64_tr_b16 a[194:195], v14 offset:4096
  v_cvt_pk_bf16_f32 v192, v192, v193
  v_mfma_f32_16x16x32_bf16 v[248:251], a[236:239], a[188:191], v[248:251]
  v_exp_f32 v196, v196
  v_mfma_f32_16x16x32_bf16 v[232:235], a[236:239], a[172:175], 0
  ds_read_b64_tr_b16 a[196:197], v14 offset:8192
  v_cvt_pk_bf16_f32 v193, v194, v195
  v_mfma_f32_16x16x32_bf16 v[232:235], a[232:235], a[168:171], v[232:235]
  v_exp_f32 v197, v197
  v_mfma_f32_16x16x32_bf16 v[232:235], a[228:231], a[164:167], v[232:235]
  ds_read_b64_tr_b16 a[198:199], v14 offset:12288
  v_cvt_pk_bf16_f32 v194, v196, v197
  v_mfma_f32_16x16x32_bf16 v[232:235], a[224:227], a[160:163], v[232:235]
  v_exp_f32 v198, v198
  v_mfma_f32_16x16x32_bf16 v[216:219], a[224:227], a[144:147], 0
  ds_read_b64_tr_b16 a[200:201], v15
  v_mfma_f32_16x16x32_bf16 v[216:219], a[228:231], a[148:151], v[216:219]
  v_exp_f32 v199, v199
  v_mfma_f32_16x16x32_bf16 v[216:219], a[232:235], a[152:155], v[216:219]
  ds_read_b64_tr_b16 a[202:203], v15 offset:4096
  v_cvt_pk_bf16_f32 v195, v198, v199
  v_mfma_f32_16x16x32_bf16 v[216:219], a[236:239], a[156:159], v[216:219]
  v_exp_f32 v208, v208
  v_mfma_f32_16x16x32_bf16 v[200:203], a[236:239], a[140:143], 0
  s_add_u32 m0, s30, 49152
  s_xor_b32 s40, s32, 0x3c00
  ds_read_b64_tr_b16 a[204:205], v15 offset:8192
  v_mfma_f32_16x16x32_bf16 v[200:203], a[232:235], a[136:139], v[200:203]
  s_waitcnt vmcnt(4)
  buffer_load_dwordx4 v22, s[16:19], s40 offen nt lds
  v_mfma_f32_16x16x32_bf16 v[200:203], a[228:231], a[132:135], v[200:203]
  ds_read_b64_tr_b16 a[206:207], v15 offset:12288
  v_mfma_f32_16x16x32_bf16 v[200:203], a[224:227], a[128:131], v[200:203]
  v_exp_f32 v209, v209
  v_mfma_f32_16x16x32_bf16 v[204:207], a[240:243], a[128:131], 0
  ds_read_b64_tr_b16 a[208:209], v16
  v_cvt_pk_bf16_f32 v208, v208, v209
  v_mfma_f32_16x16x32_bf16 v[204:207], a[244:247], a[132:135], v[204:207]
  v_exp_f32 v210, v210
  v_mfma_f32_16x16x32_bf16 v[204:207], a[248:251], a[136:139], v[204:207]
  ds_read_b64_tr_b16 a[210:211], v16 offset:4096
  v_mfma_f32_16x16x32_bf16 v[204:207], a[252:255], a[140:143], v[204:207]
  v_exp_f32 v211, v211
  v_mfma_f32_16x16x32_bf16 v[220:223], a[252:255], a[156:159], 0
  ds_read_b64_tr_b16 a[212:213], v16 offset:8192
  v_cvt_pk_bf16_f32 v209, v210, v211
  v_mfma_f32_16x16x32_bf16 v[220:223], a[248:251], a[152:155], v[220:223]
  v_exp_f32 v212, v212
  v_mfma_f32_16x16x32_bf16 v[220:223], a[244:247], a[148:151], v[220:223]
  s_add_u32 m0, s31, 0
  s_xor_b32 s42, s34, 0x0
  ds_read_b64_tr_b16 a[214:215], v16 offset:12288
  v_mfma_f32_16x16x32_bf16 v[220:223], a[240:243], a[144:147], v[220:223]
  s_waitcnt vmcnt(4)
  buffer_load_dwordx4 v22, s[12:15], s42 offen nt lds
  v_mfma_f32_16x16x32_bf16 v[236:239], a[240:243], a[160:163], 0
  ds_read_b64_tr_b16 a[216:217], v17
  v_mfma_f32_16x16x32_bf16 v[236:239], a[244:247], a[164:167], v[236:239]
  v_exp_f32 v213, v213
  v_mfma_f32_16x16x32_bf16 v[236:239], a[248:251], a[168:171], v[236:239]
  ds_read_b64_tr_b16 a[218:219], v17 offset:4096
  v_cvt_pk_bf16_f32 v210, v212, v213
  v_mfma_f32_16x16x32_bf16 v[236:239], a[252:255], a[172:175], v[236:239]
  v_exp_f32 v214, v214
  v_mfma_f32_16x16x32_bf16 v[252:255], a[252:255], a[188:191], 0
  ds_read_b64_tr_b16 a[220:221], v17 offset:8192
  v_mfma_f32_16x16x32_bf16 v[252:255], a[248:251], a[184:187], v[252:255]
  v_exp_f32 v215, v215
  v_mfma_f32_16x16x32_bf16 v[252:255], a[244:247], a[180:183], v[252:255]
  ds_read_b64_tr_b16 a[222:223], v17 offset:12288
  v_cvt_pk_bf16_f32 v211, v214, v215
  v_mfma_f32_16x16x32_bf16 v[252:255], a[240:243], a[176:179], v[252:255]
  v_exp_f32 v224, v224
  v_mfma_f32_16x16x32_bf16 v[48:51], v[44:47], v[128:131], 0
  s_add_u32 m0, s30, 50176
  s_xor_b32 s40, s32, 0x3000
  ds_read_b64_tr_b16 a[224:225], v18
  v_mfma_f32_16x16x32_bf16 v[48:51], v[44:47], v[136:139], v[48:51]
  s_waitcnt vmcnt(4)
  buffer_load_dwordx4 v23, s[16:19], s40 offen nt lds
  v_mfma_f32_16x16x32_bf16 v[52:55], v[44:47], v[144:147], 0
  ds_read_b64_tr_b16 a[226:227], v18 offset:4096
  v_mfma_f32_16x16x32_bf16 v[52:55], v[44:47], v[152:155], v[52:55]
  v_exp_f32 v225, v225
  v_mfma_f32_16x16x32_bf16 v[56:59], v[44:47], v[160:163], 0
  ds_read_b64_tr_b16 a[228:229], v18 offset:8192
  v_cvt_pk_bf16_f32 v224, v224, v225
  v_mfma_f32_16x16x32_bf16 v[56:59], v[44:47], v[168:171], v[56:59]
  v_exp_f32 v226, v226
  v_mfma_f32_16x16x32_bf16 v[60:63], v[44:47], v[176:179], 0
  ds_read_b64_tr_b16 a[230:231], v18 offset:12288
  v_mfma_f32_16x16x32_bf16 v[60:63], v[44:47], v[184:187], v[60:63]
  s_waitcnt lgkmcnt(4)
  v_exp_f32 v227, v227
  v_mfma_f32_16x16x32_bf16 a[12:15], v[136:139], a[220:223], 0
  ds_read_b64_tr_b16 a[232:233], v19
  v_cvt_pk_bf16_f32 v225, v226, v227
  v_mfma_f32_16x16x32_bf16 a[12:15], v[128:131], a[216:219], a[12:15]
  v_exp_f32 v228, v228
  v_mfma_f32_16x16x32_bf16 a[8:11], v[128:131], a[208:211], 0
  s_add_u32 m0, s31, 1024
  s_xor_b32 s42, s34, 0x6000
  ds_read_b64_tr_b16 a[234:235], v19 offset:4096
  v_mfma_f32_16x16x32_bf16 a[8:11], v[136:139], a[212:215], a[8:11]
  s_waitcnt vmcnt(4)
  buffer_load_dwordx4 v23, s[12:15], s42 offen nt lds
  v_mfma_f32_16x16x32_bf16 a[4:7], v[136:139], a[204:207], 0
  ds_read_b64_tr_b16 a[236:237], v19 offset:8192
  v_mfma_f32_16x16x32_bf16 a[4:7], v[128:131], a[200:203], a[4:7]
  v_exp_f32 v229, v229
  v_mfma_f32_16x16x32_bf16 a[0:3], v[128:131], a[192:195], 0
  ds_read_b64_tr_b16 a[238:239], v19 offset:12288
  v_cvt_pk_bf16_f32 v226, v228, v229
  v_mfma_f32_16x16x32_bf16 a[0:3], v[136:139], a[196:199], a[0:3]
  v_exp_f32 v230, v230
  v_mfma_f32_16x16x32_bf16 a[32:35], v[152:155], a[196:199], 0
  ds_read_b64_tr_b16 a[240:241], v20
  v_mfma_f32_16x16x32_bf16 a[32:35], v[144:147], a[192:195], a[32:35]
  v_exp_f32 v231, v231
  v_mfma_f32_16x16x32_bf16 a[36:39], v[144:147], a[200:203], 0
  ds_read_b64_tr_b16 a[242:243], v20 offset:4096
  v_cvt_pk_bf16_f32 v227, v230, v231
  v_mfma_f32_16x16x32_bf16 a[36:39], v[152:155], a[204:207], a[36:39]
  v_exp_f32 v240, v240
  v_mfma_f32_16x16x32_bf16 a[40:43], v[152:155], a[212:215], 0
  s_add_u32 m0, s30, 51200
  s_xor_b32 s40, s32, 0x13800
  ds_read_b64_tr_b16 a[244:245], v20 offset:8192
  v_mfma_f32_16x16x32_bf16 a[40:43], v[144:147], a[208:211], a[40:43]
  s_waitcnt vmcnt(4)
  buffer_load_dwordx4 v24, s[16:19], s40 offen nt lds
  v_mfma_f32_16x16x32_bf16 a[44:47], v[144:147], a[216:219], 0
  ds_read_b64_tr_b16 a[246:247], v20 offset:12288
  v_mfma_f32_16x16x32_bf16 a[44:47], v[152:155], a[220:223], a[44:47]
  v_exp_f32 v241, v241
  v_mfma_f32_16x16x32_bf16 a[76:79], v[168:171], a[220:223], 0
  ds_read_b64_tr_b16 a[248:249], v21
  v_cvt_pk_bf16_f32 v240, v240, v241
  v_mfma_f32_16x16x32_bf16 a[76:79], v[160:163], a[216:219], a[76:79]
  v_exp_f32 v242, v242
  v_mfma_f32_16x16x32_bf16 a[72:75], v[160:163], a[208:211], 0
  ds_read_b64_tr_b16 a[250:251], v21 offset:4096
  v_mfma_f32_16x16x32_bf16 a[72:75], v[168:171], a[212:215], a[72:75]
  v_exp_f32 v243, v243
  v_mfma_f32_16x16x32_bf16 a[68:71], v[168:171], a[204:207], 0
  ds_read_b64_tr_b16 a[252:253], v21 offset:8192
  v_cvt_pk_bf16_f32 v241, v242, v243
  v_mfma_f32_16x16x32_bf16 a[68:71], v[160:163], a[200:203], a[68:71]
  v_exp_f32 v244, v244
  v_mfma_f32_16x16x32_bf16 a[64:67], v[160:163], a[192:195], 0
  ds_read_b64_tr_b16 a[254:255], v21 offset:12288
  v_mfma_f32_16x16x32_bf16 a[64:67], v[168:171], a[196:199], a[64:67]
  s_add_u32 m0, s31, 2048
  s_xor_b32 s42, s34, 0x400
  v_exp_f32 v245, v245
  v_mfma_f32_16x16x32_bf16 a[96:99], v[184:187], a[196:199], 0
  s_waitcnt vmcnt(4)
  buffer_load_dwordx4 v24, s[12:15], s42 offen nt lds
  v_mfma_f32_16x16x32_bf16 a[96:99], v[176:179], a[192:195], a[96:99]
  v_exp_f32 v246, v246
  v_mfma_f32_16x16x32_bf16 a[100:103], v[176:179], a[200:203], 0
  v_exp_f32 v247, v247
  v_mfma_f32_16x16x32_bf16 a[100:103], v[184:187], a[204:207], a[100:103]
  s_waitcnt vmcnt(10) lgkmcnt(0)
  s_barrier
  v_cvt_pk_bf16_f32 v242, v244, v245
  v_mfma_f32_16x16x32_bf16 a[104:107], v[184:187], a[212:215], 0
  ds_read_b128 a[192:195], v10 offset:32768
  v_cvt_pk_bf16_f32 v243, v246, v247
  v_mfma_f32_16x16x32_bf16 a[104:107], v[176:179], a[208:211], a[104:107]
  v_exp_f32 v200, v200
  v_mfma_f32_16x16x32_bf16 a[108:111], v[176:179], a[216:219], 0
  v_exp_f32 v201, v201
  v_mfma_f32_16x16x32_bf16 a[108:111], v[184:187], a[220:223], a[108:111]
  v_exp_f32 v202, v202
  v_mfma_f32_16x16x32_bf16 a[28:31], v[136:139], a[252:255], 0
  ds_read_b128 a[196:199], v11 offset:32768
  v_cvt_pk_bf16_f32 v200, v200, v201
  v_mfma_f32_16x16x32_bf16 a[28:31], v[128:131], a[248:251], a[28:31]
  v_exp_f32 v203, v203
  v_mfma_f32_16x16x32_bf16 a[24:27], v[128:131], a[240:243], 0
  s_add_u32 m0, s30, 52224
  s_xor_b32 s40, s32, 0x13400
  v_exp_f32 v204, v204
  v_mfma_f32_16x16x32_bf16 a[24:27], v[136:139], a[244:247], a[24:27]
  s_waitcnt vmcnt(4)
  buffer_load_dwordx4 v25, s[16:19], s40 offen nt lds
  v_mfma_f32_16x16x32_bf16 a[20:23], v[136:139], a[236:239], 0
  ds_read_b128 a[200:203], v12 offset:32768
  v_cvt_pk_bf16_f32 v201, v202, v203
  v_mfma_f32_16x16x32_bf16 a[20:23], v[128:131], a[232:235], a[20:23]
  v_exp_f32 v205, v205
  v_mfma_f32_16x16x32_bf16 a[16:19], v[128:131], a[224:227], 0
  v_exp_f32 v206, v206
  v_mfma_f32_16x16x32_bf16 a[16:19], v[136:139], a[228:231], a[16:19]
  v_exp_f32 v207, v207
  v_mfma_f32_16x16x32_bf16 a[48:51], v[152:155], a[228:231], 0
  ds_read_b128 a[204:207], v13 offset:32768
  v_cvt_pk_bf16_f32 v202, v204, v205
  v_mfma_f32_16x16x32_bf16 a[48:51], v[144:147], a[224:227], a[48:51]
  v_exp_f32 v216, v216
  v_mfma_f32_16x16x32_bf16 a[52:55], v[144:147], a[232:235], 0
  v_exp_f32 v217, v217
  v_mfma_f32_16x16x32_bf16 a[52:55], v[152:155], a[236:239], a[52:55]
  v_exp_f32 v218, v218
  v_mfma_f32_16x16x32_bf16 a[56:59], v[152:155], a[244:247], 0
  s_add_u32 m0, s31, 3072
  s_xor_b32 s42, s34, 0x6400
  ds_read_b128 a[208:211], v10 offset:36864
  v_cvt_pk_bf16_f32 v203, v206, v207
  v_mfma_f32_16x16x32_bf16 a[56:59], v[144:147], a[240:243], a[56:59]
  s_waitcnt vmcnt(4)
  buffer_load_dwordx4 v25, s[12:15], s42 offen nt lds
  v_mfma_f32_16x16x32_bf16 a[60:63], v[144:147], a[248:251], 0
  v_exp_f32 v219, v219
  v_mfma_f32_16x16x32_bf16 a[60:63], v[152:155], a[252:255], a[60:63]
  v_exp_f32 v220, v220
  v_mfma_f32_16x16x32_bf16 a[92:95], v[168:171], a[252:255], 0
  ds_read_b128 a[212:215], v11 offset:36864
  v_cvt_pk_bf16_f32 v216, v216, v217
  v_mfma_f32_16x16x32_bf16 a[92:95], v[160:163], a[248:251], a[92:95]
  v_exp_f32 v221, v221
  v_mfma_f32_16x16x32_bf16 a[88:91], v[160:163], a[240:243], 0
  v_exp_f32 v222, v222
  v_mfma_f32_16x16x32_bf16 a[88:91], v[168:171], a[244:247], a[88:91]
  v_exp_f32 v223, v223
  v_mfma_f32_16x16x32_bf16 a[84:87], v[168:171], a[236:239], 0
  ds_read_b128 a[216:219], v12 offset:36864
  v_cvt_pk_bf16_f32 v217, v218, v219
  v_mfma_f32_16x16x32_bf16 a[84:87], v[160:163], a[232:235], a[84:87]
  v_exp_f32 v232, v232
  v_mfma_f32_16x16x32_bf16 a[80:83], v[160:163], a[224:227], 0
  v_exp_f32 v233, v233
  v_mfma_f32_16x16x32_bf16 a[80:83], v[168:171], a[228:231], a[80:83]
  v_exp_f32 v234, v234
  v_mfma_f32_16x16x32_bf16 a[112:115], v[184:187], a[228:231], 0
  s_add_u32 m0, s30, 98304
  s_xor_b32 s40, s32, 0x3800
  ds_read_b128 a[220:223], v13 offset:36864
  v_cvt_pk_bf16_f32 v218, v220, v221
  v_mfma_f32_16x16x32_bf16 a[112:115], v[176:179], a[224:227], a[112:115]
  s_waitcnt vmcnt(4)
  buffer_load_dwordx4 v22, s[20:23], s40 offen nt lds
  v_mfma_f32_16x16x32_bf16 a[116:119], v[176:179], a[232:235], 0
  v_exp_f32 v235, v235
  v_mfma_f32_16x16x32_bf16 a[116:119], v[184:187], a[236:239], a[116:119]
  v_exp_f32 v236, v236
  v_mfma_f32_16x16x32_bf16 a[120:123], v[184:187], a[244:247], 0
  v_exp_f32 v237, v237
  v_mfma_f32_16x16x32_bf16 a[120:123], v[176:179], a[240:243], a[120:123]
  v_exp_f32 v238, v238
  v_mfma_f32_16x16x32_bf16 a[124:127], v[176:179], a[248:251], 0
  v_exp_f32 v239, v239
  v_mfma_f32_16x16x32_bf16 a[124:127], v[184:187], a[252:255], a[124:127]
  s_waitcnt lgkmcnt(0)
  v_exp_f32 v248, v248
  v_mfma_f32_16x16x32_bf16 v[176:179], a[192:195], a[176:179], 0
  v_exp_f32 v249, v249
  v_mfma_f32_16x16x32_bf16 v[176:179], a[196:199], a[180:183], v[176:179]
  ds_read_b128 a[224:227], v10 offset:40960
  v_cvt_pk_bf16_f32 v219, v222, v223
  v_mfma_f32_16x16x32_bf16 v[176:179], a[200:203], a[184:187], v[176:179]
  s_add_u32 m0, s30, 99328
  s_xor_b32 s40, s32, 0x3400
  v_exp_f32 v250, v250
  v_mfma_f32_16x16x32_bf16 v[176:179], a[204:207], a[188:191], v[176:179]
  s_waitcnt vmcnt(5)
  buffer_load_dwordx4 v23, s[20:23], s40 offen nt lds
  v_mfma_f32_16x16x32_bf16 v[160:163], a[204:207], a[172:175], 0
  ds_read_b128 a[228:231], v11 offset:40960
  v_cvt_pk_bf16_f32 v232, v232, v233
  v_mfma_f32_16x16x32_bf16 v[160:163], a[200:203], a[168:171], v[160:163]
  v_exp_f32 v251, v251
  v_mfma_f32_16x16x32_bf16 v[160:163], a[196:199], a[164:167], v[160:163]
  v_exp_f32 v252, v252
  v_mfma_f32_16x16x32_bf16 v[160:163], a[192:195], a[160:163], v[160:163]
  ds_read_b128 a[232:235], v12 offset:40960
  v_cvt_pk_bf16_f32 v233, v234, v235
  v_mfma_f32_16x16x32_bf16 v[144:147], a[192:195], a[144:147], 0
  v_exp_f32 v253, v253
  v_mfma_f32_16x16x32_bf16 v[144:147], a[196:199], a[148:151], v[144:147]
  v_exp_f32 v254, v254
  v_mfma_f32_16x16x32_bf16 v[144:147], a[200:203], a[152:155], v[144:147]
  ds_read_b128 a[236:239], v13 offset:40960
  v_cvt_pk_bf16_f32 v234, v236, v237
  v_mfma_f32_16x16x32_bf16 v[144:147], a[204:207], a[156:159], v[144:147]
  v_exp_f32 v255, v255
  v_mfma_f32_16x16x32_bf16 v[128:131], a[204:207], a[140:143], 0
  v_cvt_pk_bf16_f32 v235, v238, v239
  v_cvt_pk_bf16_f32 v248, v248, v249
  v_mfma_f32_16x16x32_bf16 v[128:131], a[200:203], a[136:139], v[128:131]
  s_add_u32 m0, s30, 100352
  s_xor_b32 s40, s32, 0x13c00
  ds_read_b128 a[240:243], v10 offset:45056
  v_cvt_pk_bf16_f32 v249, v250, v251
  v_mfma_f32_16x16x32_bf16 v[128:131], a[196:199], a[132:135], v[128:131]
  s_waitcnt vmcnt(5)
  buffer_load_dwordx4 v24, s[20:23], s40 offen nt lds
  v_mfma_f32_16x16x32_bf16 v[128:131], a[192:195], a[128:131], v[128:131]
  v_cvt_pk_bf16_f32 v250, v252, v253
  v_cvt_pk_bf16_f32 v251, v254, v255
  v_mfma_f32_16x16x32_bf16 v[132:135], a[208:211], a[128:131], 0
  ds_read_b128 a[244:247], v11 offset:45056
  v_mfma_f32_16x16x32_bf16 v[132:135], a[212:215], a[132:135], v[132:135]
  v_mfma_f32_16x16x32_bf16 v[132:135], a[216:219], a[136:139], v[132:135]
  v_mfma_f32_16x16x32_bf16 v[132:135], a[220:223], a[140:143], v[132:135]
  ds_read_b128 a[248:251], v12 offset:45056
  v_mfma_f32_16x16x32_bf16 v[148:151], a[220:223], a[156:159], 0
  v_mfma_f32_16x16x32_bf16 v[148:151], a[216:219], a[152:155], v[148:151]
  v_mfma_f32_16x16x32_bf16 v[148:151], a[212:215], a[148:151], v[148:151]
  ds_read_b128 a[252:255], v13 offset:45056
  v_mfma_f32_16x16x32_bf16 v[148:151], a[208:211], a[144:147], v[148:151]
  v_mfma_f32_16x16x32_bf16 v[164:167], a[208:211], a[160:163], 0
  s_add_u32 m0, s30, 101376
  s_xor_b32 s40, s32, 0x13000
  v_exp_f32 v128, v128
  v_mfma_f32_16x16x32_bf16 v[164:167], a[212:215], a[164:167], v[164:167]
  s_waitcnt vmcnt(5)
  buffer_load_dwordx4 v25, s[20:23], s40 offen nt lds
  v_mfma_f32_16x16x32_bf16 v[164:167], a[216:219], a[168:171], v[164:167]
  v_exp_f32 v129, v129
  v_mfma_f32_16x16x32_bf16 v[164:167], a[220:223], a[172:175], v[164:167]
  v_exp_f32 v130, v130
  v_mfma_f32_16x16x32_bf16 v[180:183], a[220:223], a[188:191], 0
  v_exp_f32 v131, v131
  v_mfma_f32_16x16x32_bf16 v[180:183], a[216:219], a[184:187], v[180:183]
  v_exp_f32 v132, v132
  v_mfma_f32_16x16x32_bf16 v[180:183], a[212:215], a[180:183], v[180:183]
  v_exp_f32 v133, v133
  v_mfma_f32_16x16x32_bf16 v[180:183], a[208:211], a[176:179], v[180:183]
  s_waitcnt vmcnt(7) lgkmcnt(0)
  s_cmpk_lt_i32 s10, 0x0
  s_cbranch_scc0 L_fb0_2
  s_waitcnt vmcnt(4)
L_fb0_2:
  s_barrier
  v_mfma_f32_16x16x32_bf16 v[184:187], a[224:227], a[176:179], 0
  ds_read_b64_tr_b16 a[192:193], v14 offset:16384
  v_cvt_pk_bf16_f32 v128, v128, v129
  v_mfma_f32_16x16x32_bf16 v[184:187], a[228:231], a[180:183], v[184:187]
  v_exp_f32 v134, v134
  v_mfma_f32_16x16x32_bf16 v[184:187], a[232:235], a[184:187], v[184:187]
  ds_read_b64_tr_b16 a[194:195], v14 offset:20480
  v_cvt_pk_bf16_f32 v129, v130, v131
  v_mfma_f32_16x16x32_bf16 v[184:187], a[236:239], a[188:191], v[184:187]
  v_exp_f32 v135, v135
  v_mfma_f32_16x16x32_bf16 v[168:171], a[236:239], a[172:175], 0
  s_add_u32 m0, s30, 0
  s_xor_b32 s40, s32, 0x12000
  ds_read_b64_tr_b16 a[196:197], v14 offset:24576
  v_cvt_pk_bf16_f32 v130, v132, v133
  v_mfma_f32_16x16x32_bf16 v[168:171], a[232:235], a[168:171], v[168:171]
  s_waitcnt vmcnt(5)
  buffer_load_dwordx4 v22, s[16:19], s40 offen nt lds
  v_mfma_f32_16x16x32_bf16 v[168:171], a[228:231], a[164:167], v[168:171]
  ds_read_b64_tr_b16 a[198:199], v14 offset:28672
  v_cvt_pk_bf16_f32 v131, v134, v135
L_pg2:
  s_cbranch_execz L_pg6
  v_mfma_f32_16x16x32_bf16 v[168:171], a[224:227], a[160:163], v[168:171]
  v_exp_f32 v144, v144
  v_mfma_f32_16x16x32_bf16 v[152:155], a[224:227], a[144:147], 0
  ds_read_b64_tr_b16 a[200:201], v15 offset:16384
  v_mfma_f32_16x16x32_bf16 v[152:155], a[228:231], a[148:151], v[152:155]
  v_exp_f32 v145, v145
  v_mfma_f32_16x16x32_bf16 v[152:155], a[232:235], a[152:155], v[152:155]
  ds_read_b64_tr_b16 a[202:203], v15 offset:20480
  v_cvt_pk_bf16_f32 v144, v144, v145
  v_mfma_f32_16x16x32_bf16 v[152:155], a[236:239], a[156:159], v[152:155]
  v_exp_f32 v146, v146
  v_mfma_f32_16x16x32_bf16 v[136:139], a[236:239], a[140:143], 0
  ds_read_b64_tr_b16 a[204:205], v15 offset:24576
  v_mfma_f32_16x16x32_bf16 v[136:139], a[232:235], a[136:139], v[136:139]
  v_exp_f32 v147, v147
  v_mfma_f32_16x16x32_bf16 v[136:139], a[228:231], a[132:135], v[136:139]
  s_add_u32 m0, s30, 1024
  s_xor_b32 s40, s32, 0x12c00
  ds_read_b64_tr_b16 a[206:207], v15 offset:28672
  v_cvt_pk_bf16_f32 v145, v146, v147
  v_mfma_f32_16x16x32_bf16 v[136:139], a[224:227], a[128:131], v[136:139]
  s_waitcnt vmcnt(5)
  buffer_load_dwordx4 v23, s[16:19], s40 offen nt lds
  v_mfma_f32_16x16x32_bf16 v[140:143], a[240:243], a[128:131], 0
  ds_read_b64_tr_b16 a[208:209], v16 offset:16384
  v_mfma_f32_16x16x32_bf16 v[140:143], a[244:247], a[132:135], v[140:143]
  v_exp_f32 v148, v148
  v_mfma_f32_16x16x32_bf16 v[140:143], a[248:251], a[136:139], v[140:143]
  ds_read_b64_tr_b16 a[210:211], v16 offset:20480
  v_mfma_f32_16x16x32_bf16 v[140:143], a[252:255], a[140:143], v[140:143]
  v_exp_f32 v149, v149
  v_mfma_f32_16x16x32_bf16 v[156:159], a[252:255], a[156:159], 0
  ds_read_b64_tr_b16 a[212:213], v16 offset:24576
  v_cvt_pk_bf16_f32 v146, v148, v149
  v_mfma_f32_16x16x32_bf16 v[156:159], a[248:251], a[152:155], v[156:159]
  v_exp_f32 v150, v150
  v_mfma_f32_16x16x32_bf16 v[156:159], a[244:247], a[148:151], v[156:159]
  ds_read_b64_tr_b16 a[214:215], v16 offset:28672
  v_mfma_f32_16x16x32_bf16 v[156:159], a[240:243], a[144:147], v[156:159]
  v_exp_f32 v151, v151
  v_mfma_f32_16x16x32_bf16 v[172:175], a[240:243], a[160:163], 0
  ds_read_b64_tr_b16 a[216:217], v17 offset:16384
  v_cvt_pk_bf16_f32 v147, v150, v151
  v_mfma_f32_16x16x32_bf16 v[172:175], a[244:247], a[164:167], v[172:175]
  v_exp_f32 v160, v160
  v_mfma_f32_16x16x32_bf16 v[172:175], a[248:251], a[168:171], v[172:175]
  s_add_u32 m0, s30, 2048
  s_xor_b32 s40, s32, 0x2400
  ds_read_b64_tr_b16 a[218:219], v17 offset:20480
  v_mfma_f32_16x16x32_bf16 v[172:175], a[252:255], a[172:175], v[172:175]
  s_waitcnt vmcnt(5)
  buffer_load_dwordx4 v24, s[16:19], s40 offen nt lds
  v_mfma_f32_16x16x32_bf16 v[188:191], a[252:255], a[188:191], 0
  ds_read_b64_tr_b16 a[220:221], v17 offset:24576
  v_mfma_f32_16x16x32_bf16 v[188:191], a[248:251], a[184:187], v[188:191]
  v_exp_f32 v161, v161
  v_mfma_f32_16x16x32_bf16 v[188:191], a[244:247], a[180:183], v[188:191]
  ds_read_b64_tr_b16 a[222:223], v17 offset:28672
  v_cvt_pk_bf16_f32 v160, v160, v161
  v_mfma_f32_16x16x32_bf16 v[188:191], a[240:243], a[176:179], v[188:191]
  v_exp_f32 v162, v162
  v_mfma_f32_16x16x32_bf16 v[48:51], v[44:47], v[192:195], v[48:51]
  ds_read_b64_tr_b16 a[224:225], v18 offset:16384
  v_mfma_f32_16x16x32_bf16 v[48:51], v[44:47], v[200:203], v[48:51]
  v_exp_f32 v163, v163
  v_mfma_f32_16x16x32_bf16 v[52:55], v[44:47], v[208:211], v[52:55]
  ds_read_b64_tr_b16 a[226:227], v18 offset:20480
  v_cvt_pk_bf16_f32 v161, v162, v163
  v_mfma_f32_16x16x32_bf16 v[52:55], v[44:47], v[216:219], v[52:55]
  v_mov_b32 v252, 1
  v_mfma_f32_16x16x32_bf16 v[56:59], v[44:47], v[224:227], v[56:59]
  ds_read_b64_tr_b16 a[228:229], v18 offset:24576
  v_mfma_f32_16x16x32_bf16 v[56:59], v[44:47], v[232:235], v[56:59]
  s_waitcnt vmcnt(6)
  buffer_atomic_add v252, v26, s[4:7], 0 offen sc0 sc1
  v_mfma_f32_16x16x32_bf16 v[60:63], v[44:47], v[240:243], v[60:63]
  ds_read_b64_tr_b16 a[230:231], v18 offset:28672
  v_mfma_f32_16x16x32_bf16 v[60:63], v[44:47], v[248:251], v[60:63]
  s_waitcnt lgkmcnt(4)
  v_exp_f32 v164, v164
  v_mfma_f32_16x16x32_bf16 a[96:99], v[248:251], a[196:199], a[96:99]
  s_add_u32 m0, s31, 4096
  s_xor_b32 s42, s34, 0x5000
  ds_read_b64_tr_b16 a[232:233], v19 offset:16384
  v_mfma_f32_16x16x32_bf16 a[96:99], v[240:243], a[192:195], a[96:99]
  s_waitcnt vmcnt(6)
  buffer_load_dwordx4 v22, s[12:15], s42 offen nt lds
  v_mfma_f32_16x16x32_bf16 a[64:67], v[224:227], a[192:195], a[64:67]
  ds_read_b64_tr_b16 a[234:235], v19 offset:20480
  v_mfma_f32_16x16x32_bf16 a[64:67], v[232:235], a[196:199], a[64:67]
  v_exp_f32 v165, v165
  v_mfma_f32_16x16x32_bf16 a[32:35], v[216:219], a[196:199], a[32:35]
  ds_read_b64_tr_b16 a[236:237], v19 offset:24576
  v_cvt_pk_bf16_f32 v162, v164, v165
  v_mfma_f32_16x16x32_bf16 a[32:35], v[208:211], a[192:195], a[32:35]
  v_exp_f32 v166, v166
  v_mfma_f32_16x16x32_bf16 a[0:3], v[192:195], a[192:195], a[0:3]
  ds_read_b64_tr_b16 a[238:239], v19 offset:28672
  v_mfma_f32_16x16x32_bf16 a[0:3], v[200:203], a[196:199], a[0:3]
  v_exp_f32 v167, v167
  v_mfma_f32_16x16x32_bf16 a[4:7], v[200:203], a[204:207], a[4:7]
  s_add_u32 m0, s30, 3072
  s_xor_b32 s40, s32, 0x2800
  ds_read_b64_tr_b16 a[240:241], v20 offset:16384
  v_cvt_pk_bf16_f32 v163, v166, v167
  v_mfma_f32_16x16x32_bf16 a[4:7], v[192:195], a[200:203], a[4:7]
  s_waitcnt vmcnt(6)
  buffer_load_dwordx4 v25, s[16:19], s40 offen nt lds
  v_mfma_f32_16x16x32_bf16 a[36:39], v[208:211], a[200:203], a[36:39]
  ds_read_b64_tr_b16 a[242:243], v20 offset:20480
  v_mfma_f32_16x16x32_bf16 a[36:39], v[216:219], a[204:207], a[36:39]
  v_exp_f32 v176, v176
  v_mfma_f32_16x16x32_bf16 a[68:71], v[232:235], a[204:207], a[68:71]
  ds_read_b64_tr_b16 a[244:245], v20 offset:24576
  v_mfma_f32_16x16x32_bf16 a[68:71], v[224:227], a[200:203], a[68:71]
  v_exp_f32 v177, v177
  v_mfma_f32_16x16x32_bf16 a[100:103], v[240:243], a[200:203], a[100:103]
  ds_read_b64_tr_b16 a[246:247], v20 offset:28672
  v_cvt_pk_bf16_f32 v176, v176, v177
  v_mfma_f32_16x16x32_bf16 a[100:103], v[248:251], a[204:207], a[100:103]
  v_exp_f32 v178, v178
  v_mfma_f32_16x16x32_bf16 a[104:107], v[248:251], a[212:215], a[104:107]
  ds_read_b64_tr_b16 a[248:249], v21 offset:16384
  v_mfma_f32_16x16x32_bf16 a[104:107], v[240:243], a[208:211], a[104:107]
  v_exp_f32 v179, v179
  v_mfma_f32_16x16x32_bf16 a[72:75], v[224:227], a[208:211], a[72:75]
  ds_read_b64_tr_b16 a[250:251], v21 offset:20480
  v_cvt_pk_bf16_f32 v177, v178, v179
  v_mfma_f32_16x16x32_bf16 a[72:75], v[232:235], a[212:215], a[72:75]
  v_exp_f32 v180, v180
  v_mfma_f32_16x16x32_bf16 a[40:43], v[216:219], a[212:215], a[40:43]
  s_add_u32 m0, s31, 5120
  s_xor_b32 s42, s34, 0x3000
  ds_read_b64_tr_b16 a[252:253], v21 offset:24576
  v_mfma_f32_16x16x32_bf16 a[40:43], v[208:211], a[208:211], a[40:43]
  s_waitcnt vmcnt(6)
  buffer_load_dwordx4 v23, s[12:15], s42 offen nt lds
  v_mfma_f32_16x16x32_bf16 a[8:11], v[192:195], a[208:211], a[8:11]
  ds_read_b64_tr_b16 a[254:255], v21 offset:28672
  v_mfma_f32_16x16x32_bf16 a[8:11], v[200:203], a[212:215], a[8:11]
  v_exp_f32 v181, v181
  v_mfma_f32_16x16x32_bf16 a[12:15], v[200:203], a[220:223], a[12:15]
  v_exp_f32 v182, v182
  v_mfma_f32_16x16x32_bf16 a[12:15], v[192:195], a[216:219], a[12:15]
  v_exp_f32 v183, v183
  v_mfma_f32_16x16x32_bf16 a[44:47], v[208:211], a[216:219], a[44:47]
  v_exp_f32 v136, v136
  v_mfma_f32_16x16x32_bf16 a[44:47], v[216:219], a[220:223], a[44:47]
  s_waitcnt vmcnt(7) lgkmcnt(0)
  s_cmpk_lt_i32 s11, 0x0
  s_cbranch_scc0 L_fb0_3
  s_waitcnt vmcnt(4)
L_fb0_3:
  s_barrier
  v_mfma_f32_16x16x32_bf16 a[76:79], v[232:235], a[220:223], a[76:79]
  ds_read_b128 a[192:195], v10 offset:49152
  v_cvt_pk_bf16_f32 v178, v180, v181
  v_mfma_f32_16x16x32_bf16 a[76:79], v[224:227], a[216:219], a[76:79]
  v_exp_f32 v137, v137
  v_mfma_f32_16x16x32_bf16 a[108:111], v[240:243], a[216:219], a[108:111]
  v_exp_f32 v138, v138
  v_mfma_f32_16x16x32_bf16 a[108:111], v[248:251], a[220:223], a[108:111]
  v_exp_f32 v139, v139
  v_mfma_f32_16x16x32_bf16 a[112:115], v[248:251], a[228:231], a[112:115]
  s_add_u32 m0, s31, 6144
  s_xor_b32 s42, s34, 0x5400
  ds_read_b128 a[196:199], v11 offset:49152
  v_cvt_pk_bf16_f32 v179, v182, v183
  v_mfma_f32_16x16x32_bf16 a[112:115], v[240:243], a[224:227], a[112:115]
  s_waitcnt vmcnt(6)
  buffer_load_dwordx4 v24, s[12:15], s42 offen nt lds
  v_mfma_f32_16x16x32_bf16 a[80:83], v[224:227], a[224:227], a[80:83]
  v_exp_f32 v140, v140
  v_mfma_f32_16x16x32_bf16 a[80:83], v[232:235], a[228:231], a[80:83]
  v_exp_f32 v141, v141
  v_mfma_f32_16x16x32_bf16 a[48:51], v[216:219], a[228:231], a[48:51]
  ds_read_b128 a[200:203], v12 offset:49152
  v_cvt_pk_bf16_f32 v136, v136, v137
  v_mfma_f32_16x16x32_bf16 a[48:51], v[208:211], a[224:227], a[48:51]
  v_exp_f32 v142, v142
  v_mfma_f32_16x16x32_bf16 a[16:19], v[192:195], a[224:227], a[16:19]
  v_exp_f32 v143, v143
  v_mfma_f32_16x16x32_bf16 a[16:19], v[200:203], a[228:231], a[16:19]
  v_exp_f32 v152, v152
  v_mfma_f32_16x16x32_bf16 a[20:23], v[200:203], a[236:239], a[20:23]
  ds_read_b128 a[204:207], v13 offset:49152
  v_cvt_pk_bf16_f32 v137, v138, v139
  v_mfma_f32_16x16x32_bf16 a[20:23], v[192:195], a[232:235], a[20:23]
  v_exp_f32 v153, v153
  v_mfma_f32_16x16x32_bf16 a[52:55], v[208:211], a[232:235], a[52:55]
  s_waitcnt vmcnt(12)
  ds_read2_b64 v[2:5], v28 offset0:0 offset1:0
  v_cvt_pk_bf16_f32 v138, v140, v141
  v_mfma_f32_16x16x32_bf16 a[52:55], v[216:219], a[236:239], a[52:55]
  v_exp_f32 v154, v154
  v_mfma_f32_16x16x32_bf16 a[84:87], v[232:235], a[236:239], a[84:87]
  s_add_u32 m0, s30, 114688
  s_xor_b32 s40, s32, 0x3c00
  ds_read_b128 a[208:211], v10 offset:53248
  v_cvt_pk_bf16_f32 v139, v142, v143
  v_mfma_f32_16x16x32_bf16 a[84:87], v[224:227], a[232:235], a[84:87]
  s_waitcnt vmcnt(6)
  buffer_load_dwordx4 v22, s[20:23], s40 offen nt lds
  v_mfma_f32_16x16x32_bf16 a[116:119], v[240:243], a[232:235], a[116:119]
  v_exp_f32 v155, v155
  v_mfma_f32_16x16x32_bf16 a[116:119], v[248:251], a[236:239], a[116:119]
  v_exp_f32 v156, v156
  v_mfma_f32_16x16x32_bf16 a[120:123], v[248:251], a[244:247], a[120:123]
  ds_read_b128 a[212:215], v11 offset:53248
  v_cvt_pk_bf16_f32 v152, v152, v153
  v_mfma_f32_16x16x32_bf16 a[120:123], v[240:243], a[240:243], a[120:123]
  v_exp_f32 v157, v157
  v_mfma_f32_16x16x32_bf16 a[88:91], v[224:227], a[240:243], a[88:91]
  v_exp_f32 v158, v158
  v_mfma_f32_16x16x32_bf16 a[88:91], v[232:235], a[244:247], a[88:91]
  v_exp_f32 v159, v159
  s_waitcnt lgkmcnt(2)
  v_mfma_f32_16x16x32_bf16 v[2:5], v[32:35], v[2:5], 0
  v_exp_f32 v168, v168
  v_mfma_f32_16x16x32_bf16 a[56:59], v[216:219], a[244:247], a[56:59]
  ds_read_b128 a[216:219], v12 offset:53248
  v_cvt_pk_bf16_f32 v153, v154, v155
  v_mfma_f32_16x16x32_bf16 a[56:59], v[208:211], a[240:243], a[56:59]
  v_exp_f32 v169, v169
  v_mfma_f32_16x16x32_bf16 a[24:27], v[192:195], a[240:243], a[24:27]
  v_exp_f32 v170, v170
  v_mfma_f32_16x16x32_bf16 a[24:27], v[200:203], a[244:247], a[24:27]
  v_cvt_pk_bf16_f32 v64, v2, v3
  v_cvt_pk_bf16_f32 v154, v156, v157
  v_mfma_f32_16x16x32_bf16 a[28:31], v[200:203], a[252:255], a[28:31]
  s_add_u32 m0, s31, 7168
  s_xor_b32 s42, s34, 0x3400
  ds_read_b128 a[220:223], v13 offset:53248
  v_cvt_pk_bf16_f32 v65, v4, v5
  v_mfma_f32_16x16x32_bf16 a[28:31], v[192:195], a[248:251], a[28:31]
  s_waitcnt vmcnt(6)
  buffer_load_dwordx4 v25, s[12:15], s42 offen nt lds
  v_mfma_f32_16x16x32_bf16 a[60:63], v[208:211], a[248:251], a[60:63]
  v_exp_f32 v171, v171
  v_mfma_f32_16x16x32_bf16 a[60:63], v[216:219], a[252:255], a[60:63]
  v_exp_f32 v172, v172
  v_mfma_f32_16x16x32_bf16 a[92:95], v[232:235], a[252:255], a[92:95]
  v_exp_f32 v173, v173
  v_mfma_f32_16x16x32_bf16 a[92:95], v[224:227], a[248:251], a[92:95]
  ds_read2_b64 v[6:9], v28 offset0:1 offset1:1
  v_cvt_pk_bf16_f32 v155, v158, v159
  v_mfma_f32_16x16x32_bf16 a[124:127], v[240:243], a[248:251], a[124:127]
  v_xor_b32 v28, 0x1000, v28
  v_cvt_pk_bf16_f32 v168, v168, v169
  v_mfma_f32_16x16x32_bf16 a[124:127], v[248:251], a[252:255], a[124:127]
  s_waitcnt lgkmcnt(1)
  v_exp_f32 v174, v174
  v_mfma_f32_16x16x32_bf16 v[240:243], a[192:195], a[176:179], 0
  v_exp_f32 v175, v175
  v_mfma_f32_16x16x32_bf16 v[240:243], a[196:199], a[180:183], v[240:243]
  s_add_u32 m0, s30, 115712
  s_xor_b32 s40, s32, 0x3000
  ds_read_b128 a[224:227], v10 offset:57344
  v_cvt_pk_bf16_f32 v169, v170, v171
  v_mfma_f32_16x16x32_bf16 v[240:243], a[200:203], a[184:187], v[240:243]
  s_waitcnt vmcnt(6)
  buffer_load_dwordx4 v23, s[20:23], s40 offen nt lds
  v_mfma_f32_16x16x32_bf16 v[240:243], a[204:207], a[188:191], v[240:243]
  v_exp_f32 v184, v184
  v_mfma_f32_16x16x32_bf16 v[224:227], a[204:207], a[172:175], 0
  ds_read_b128 a[228:231], v11 offset:57344
  v_cvt_pk_bf16_f32 v170, v172, v173
  v_mfma_f32_16x16x32_bf16 v[224:227], a[200:203], a[168:171], v[224:227]
  v_exp_f32 v185, v185
  v_mfma_f32_16x16x32_bf16 v[224:227], a[196:199], a[164:167], v[224:227]
  v_exp_f32 v186, v186
  v_mfma_f32_16x16x32_bf16 v[224:227], a[192:195], a[160:163], v[224:227]
  ds_read_b128 a[232:235], v12 offset:57344
  v_cvt_pk_bf16_f32 v171, v174, v175
  s_waitcnt lgkmcnt(3)
  v_mfma_f32_16x16x32_bf16 v[6:9], v[32:35], v[6:9], 0
  v_exp_f32 v187, v187
  v_mfma_f32_16x16x32_bf16 v[208:211], a[192:195], a[144:147], 0
  v_exp_f32 v188, v188
  v_mfma_f32_16x16x32_bf16 v[208:211], a[196:199], a[148:151], v[208:211]
  v_exp_f32 v189, v189
  v_mfma_f32_16x16x32_bf16 v[208:211], a[200:203], a[152:155], v[208:211]
  ds_read_b128 a[236:239], v13 offset:57344
  v_cvt_pk_bf16_f32 v184, v184, v185
  v_mfma_f32_16x16x32_bf16 v[208:211], a[204:207], a[156:159], v[208:211]
  v_cvt_pk_bf16_f32 v66, v6, v7
  v_cvt_pk_bf16_f32 v185, v186, v187
  v_mfma_f32_16x16x32_bf16 v[192:195], a[204:207], a[140:143], 0
  v_cvt_pk_bf16_f32 v67, v8, v9
  v_cvt_pk_bf16_f32 v186, v188, v189
  v_mfma_f32_16x16x32_bf16 v[192:195], a[200:203], a[136:139], v[192:195]
  s_add_u32 m0, s30, 116736
  s_xor_b32 s40, s32, 0x13800
  ds_read_b128 a[240:243], v10 offset:61440
  v_mfma_f32_16x16x32_bf16 v[192:195], a[196:199], a[132:135], v[192:195]
  s_waitcnt vmcnt(6)
  buffer_load_dwordx4 v24, s[20:23], s40 offen nt lds
  v_mfma_f32_16x16x32_bf16 v[192:195], a[192:195], a[128:131], v[192:195]
  v_exp_f32 v190, v190
  v_mfma_f32_16x16x32_bf16 v[196:199], a[208:211], a[128:131], 0
  ds_read_b128 a[244:247], v11 offset:61440
  v_mfma_f32_16x16x32_bf16 v[196:199], a[212:215], a[132:135], v[196:199]
  ds_read2_b64 v[2:5], v29 offset0:0 offset1:0
  v_mfma_f32_16x16x32_bf16 v[196:199], a[216:219], a[136:139], v[196:199]
  v_exp_f32 v191, v191
  v_mfma_f32_16x16x32_bf16 v[196:199], a[220:223], a[140:143], v[196:199]
  ds_read_b128 a[248:251], v12 offset:61440
  v_cvt_pk_bf16_f32 v187, v190, v191
  v_mfma_f32_16x16x32_bf16 v[212:215], a[220:223], a[156:159], 0
  v_mfma_f32_16x16x32_bf16 v[212:215], a[216:219], a[152:155], v[212:215]
  v_mfma_f32_16x16x32_bf16 v[212:215], a[212:215], a[148:151], v[212:215]
  ds_read_b128 a[252:255], v13 offset:61440
  v_mfma_f32_16x16x32_bf16 v[212:215], a[208:211], a[144:147], v[212:215]
  v_mfma_f32_16x16x32_bf16 v[228:231], a[208:211], a[160:163], 0
  v_exp_f32 v192, v192
  v_mfma_f32_16x16x32_bf16 v[228:231], a[212:215], a[164:167], v[228:231]
  s_add_u32 m0, s30, 117760
  s_xor_b32 s40, s32, 0x13400
  v_exp_f32 v193, v193
  v_mfma_f32_16x16x32_bf16 v[228:231], a[216:219], a[168:171], v[228:231]
  s_waitcnt vmcnt(6)
  buffer_load_dwordx4 v25, s[20:23], s40 offen nt lds
  v_mfma_f32_16x16x32_bf16 v[228:231], a[220:223], a[172:175], v[228:231]
  v_exp_f32 v194, v194
  s_waitcnt lgkmcnt(2)
  v_mfma_f32_16x16x32_bf16 v[2:5], v[32:35], v[2:5], 0
  v_exp_f32 v195, v195
  v_mfma_f32_16x16x32_bf16 v[244:247], a[220:223], a[188:191], 0
  v_exp_f32 v196, v196
  v_mfma_f32_16x16x32_bf16 v[244:247], a[216:219], a[184:187], v[244:247]
  v_exp_f32 v197, v197
  v_mfma_f32_16x16x32_bf16 v[244:247], a[212:215], a[180:183], v[244:247]
  v_exp_f32 v198, v198
  v_mfma_f32_16x16x32_bf16 v[244:247], a[208:211], a[176:179], v[244:247]
  s_waitcnt vmcnt(7) lgkmcnt(0)
  s_cmpk_lt_i32 s8, 0x0
  s_cbranch_scc0 L_fb0_4
  s_waitcnt vmcnt(4)
L_fb0_4:
  s_barrier
  v_mfma_f32_16x16x32_bf16 v[248:251], a[224:227], a[176:179], 0
  ds_read_b64_tr_b16 a[192:193], v14 offset:32768
  v_cvt_pk_bf16_f32 v68, v2, v3
  v_mfma_f32_16x16x32_bf16 v[248:251], a[228:231], a[180:183], v[248:251]
  v_cvt_pk_bf16_f32 v69, v4, v5
  v_cvt_pk_bf16_f32 v192, v192, v193
  v_mfma_f32_16x16x32_bf16 v[248:251], a[232:235], a[184:187], v[248:251]
  ds_read_b64_tr_b16 a[194:195], v14 offset:36864
  v_cvt_pk_bf16_f32 v193, v194, v195
  v_mfma_f32_16x16x32_bf16 v[248:251], a[236:239], a[188:191], v[248:251]
  ds_read2_b64 v[6:9], v29 offset0:1 offset1:1
  v_cvt_pk_bf16_f32 v194, v196, v197
  v_mfma_f32_16x16x32_bf16 v[232:235], a[236:239], a[172:175], 0
  s_add_u32 m0, s30, 16384
  s_xor_b32 s40, s32, 0x12400
  ds_read_b64_tr_b16 a[196:197], v14 offset:40960
  v_xor_b32 v29, 0x1000, v29
  v_mfma_f32_16x16x32_bf16 v[232:235], a[232:235], a[168:171], v[232:235]
  s_waitcnt vmcnt(6)
  buffer_load_dwordx4 v22, s[16:19], s40 offen nt lds
  v_mfma_f32_16x16x32_bf16 v[232:235], a[228:231], a[164:167], v[232:235]
  ds_read_b64_tr_b16 a[198:199], v14 offset:45056
  v_mfma_f32_16x16x32_bf16 v[232:235], a[224:227], a[160:163], v[232:235]
  v_exp_f32 v199, v199
  v_mfma_f32_16x16x32_bf16 v[216:219], a[224:227], a[144:147], 0
  ds_read_b64_tr_b16 a[200:201], v15 offset:32768
  v_cvt_pk_bf16_f32 v195, v198, v199
  v_mfma_f32_16x16x32_bf16 v[216:219], a[228:231], a[148:151], v[216:219]
  v_exp_f32 v208, v208
  v_mfma_f32_16x16x32_bf16 v[216:219], a[232:235], a[152:155], v[216:219]
  ds_read_b64_tr_b16 a[202:203], v15 offset:36864
  v_mfma_f32_16x16x32_bf16 v[216:219], a[236:239], a[156:159], v[216:219]
  v_exp_f32 v209, v209
  s_waitcnt lgkmcnt(4)
  v_mfma_f32_16x16x32_bf16 v[6:9], v[32:35], v[6:9], 0
  v_exp_f32 v210, v210
  v_mfma_f32_16x16x32_bf16 v[200:203], a[236:239], a[140:143], 0
  ds_read_b64_tr_b16 a[204:205], v15 offset:40960
  v_cvt_pk_bf16_f32 v208, v208, v209
  v_mfma_f32_16x16x32_bf16 v[200:203], a[232:235], a[136:139], v[200:203]
  v_exp_f32 v211, v211
  v_mfma_f32_16x16x32_bf16 v[200:203], a[228:231], a[132:135], v[200:203]
  ds_read_b64_tr_b16 a[206:207], v15 offset:45056
  v_cvt_pk_bf16_f32 v209, v210, v211
  v_mfma_f32_16x16x32_bf16 v[200:203], a[224:227], a[128:131], v[200:203]
  v_cvt_pk_bf16_f32 v70, v6, v7
  v_mfma_f32_16x16x32_bf16 v[204:207], a[240:243], a[128:131], 0
  s_add_u32 m0, s30, 17408
  s_xor_b32 s40, s32, 0x12800
  ds_read_b64_tr_b16 a[208:209], v16 offset:32768
  v_cvt_pk_bf16_f32 v71, v8, v9
  v_mfma_f32_16x16x32_bf16 v[204:207], a[244:247], a[132:135], v[204:207]
  s_waitcnt vmcnt(6)
  buffer_load_dwordx4 v23, s[16:19], s40 offen nt lds
  v_mfma_f32_16x16x32_bf16 v[204:207], a[248:251], a[136:139], v[204:207]
  ds_read_b64_tr_b16 a[210:211], v16 offset:36864
  v_mfma_f32_16x16x32_bf16 v[204:207], a[252:255], a[140:143], v[204:207]
  s_waitcnt vmcnt(11)
  v_readfirstlane_b32 s44, v252
  v_mfma_f32_16x16x32_bf16 v[220:223], a[252:255], a[156:159], 0
  ds_read_b64_tr_b16 a[212:213], v16 offset:40960
  v_mfma_f32_16x16x32_bf16 v[220:223], a[248:251], a[152:155], v[220:223]
  s_sub_u32 s44, s44, s49
  s_add_u32 s49, s49, 64
  s_sub_i32 s8, s44, s98
  s_sub_i32 s9, s44, s99
  s_sub_i32 s10, s44, s100
  s_sub_i32 s11, s44, s101
  v_exp_f32 v212, v212
  v_mfma_f32_16x16x32_bf16 v[220:223], a[244:247], a[148:151], v[220:223]
  ds_read_b64_tr_b16 a[214:215], v16 offset:45056
  v_mfma_f32_16x16x32_bf16 v[220:223], a[240:243], a[144:147], v[220:223]
  ds_read2_b64 v[2:5], v30 offset0:0 offset1:0
  v_mfma_f32_16x16x32_bf16 v[236:239], a[240:243], a[160:163], 0
  ds_read_b64_tr_b16 a[216:217], v17 offset:32768
  v_mfma_f32_16x16x32_bf16 v[236:239], a[244:247], a[164:167], v[236:239]
  v_exp_f32 v213, v213
  v_mfma_f32_16x16x32_bf16 v[236:239], a[248:251], a[168:171], v[236:239]
  ds_read_b64_tr_b16 a[218:219], v17 offset:36864
  v_cvt_pk_bf16_f32 v210, v212, v213
  v_mfma_f32_16x16x32_bf16 v[236:239], a[252:255], a[172:175], v[236:239]
  v_exp_f32 v214, v214
  v_mfma_f32_16x16x32_bf16 v[252:255], a[252:255], a[188:191], 0
  s_add_u32 m0, s30, 18432
  s_xor_b32 s40, s32, 0x2000
  ds_read_b64_tr_b16 a[220:221], v17 offset:40960
  v_mfma_f32_16x16x32_bf16 v[252:255], a[248:251], a[184:187], v[252:255]
  s_waitcnt vmcnt(6)
  buffer_load_dwordx4 v24, s[16:19], s40 offen nt lds
  v_mfma_f32_16x16x32_bf16 v[252:255], a[244:247], a[180:183], v[252:255]
  ds_read_b64_tr_b16 a[222:223], v17 offset:45056
  v_mfma_f32_16x16x32_bf16 v[252:255], a[240:243], a[176:179], v[252:255]
  v_exp_f32 v215, v215
  s_waitcnt lgkmcnt(4)
  v_mfma_f32_16x16x32_bf16 v[2:5], v[32:35], v[2:5], 0
  v_exp_f32 v224, v224
  v_mfma_f32_16x16x32_bf16 v[48:51], v[44:47], v[128:131], v[48:51]
  ds_read_b64_tr_b16 a[224:225], v18 offset:32768
  v_cvt_pk_bf16_f32 v211, v214, v215
  v_mfma_f32_16x16x32_bf16 v[48:51], v[44:47], v[136:139], v[48:51]
  v_exp_f32 v225, v225
  v_mfma_f32_16x16x32_bf16 v[52:55], v[44:47], v[144:147], v[52:55]
  ds_read_b64_tr_b16 a[226:227], v18 offset:36864
  v_cvt_pk_bf16_f32 v224, v224, v225
  v_mfma_f32_16x16x32_bf16 v[52:55], v[44:47], v[152:155], v[52:55]
  v_cvt_pk_bf16_f32 v72, v2, v3
  v_mfma_f32_16x16x32_bf16 v[56:59], v[44:47], v[160:163], v[56:59]
  ds_read_b64_tr_b16 a[228:229], v18 offset:40960
  v_cvt_pk_bf16_f32 v73, v4, v5
  v_mfma_f32_16x16x32_bf16 v[56:59], v[44:47], v[168:171], v[56:59]
  v_exp_f32 v226, v226
  v_mfma_f32_16x16x32_bf16 v[60:63], v[44:47], v[176:179], v[60:63]
  s_add_u32 m0, s30, 19456
  s_xor_b32 s40, s32, 0x2c00
  ds_read_b64_tr_b16 a[230:231], v18 offset:45056
  v_mfma_f32_16x16x32_bf16 v[60:63], v[44:47], v[184:187], v[60:63]
  s_waitcnt lgkmcnt(4)
  s_waitcnt vmcnt(6)
  buffer_load_dwordx4 v25, s[16:19], s40 offen nt lds
  v_mfma_f32_16x16x32_bf16 a[96:99], v[184:187], a[196:199], a[96:99]
  ds_read_b64_tr_b16 a[232:233], v19 offset:32768
  v_mfma_f32_16x16x32_bf16 a[96:99], v[176:179], a[192:195], a[96:99]
  v_exp_f32 v227, v227
  v_mfma_f32_16x16x32_bf16 a[64:67], v[160:163], a[192:195], a[64:67]
  ds_read_b64_tr_b16 a[234:235], v19 offset:36864
  v_cvt_pk_bf16_f32 v225, v226, v227
  v_mfma_f32_16x16x32_bf16 a[64:67], v[168:171], a[196:199], a[64:67]
  ds_read2_b64 v[6:9], v30 offset0:1 offset1:1
  v_mfma_f32_16x16x32_bf16 a[32:35], v[152:155], a[196:199], a[32:35]
  ds_read_b64_tr_b16 a[236:237], v19 offset:40960
  v_xor_b32 v30, 0x1000, v30
  v_mfma_f32_16x16x32_bf16 a[32:35], v[144:147], a[192:195], a[32:35]
  v_exp_f32 v228, v228
  v_mfma_f32_16x16x32_bf16 a[0:3], v[128:131], a[192:195], a[0:3]
  ds_read_b64_tr_b16 a[238:239], v19 offset:45056
  v_mfma_f32_16x16x32_bf16 a[0:3], v[136:139], a[196:199], a[0:3]
  v_exp_f32 v229, v229
  v_mfma_f32_16x16x32_bf16 a[4:7], v[136:139], a[204:207], a[4:7]
  ds_read_b64_tr_b16 a[240:241], v20 offset:32768
  v_cvt_pk_bf16_f32 v226, v228, v229
  v_mfma_f32_16x16x32_bf16 a[4:7], v[128:131], a[200:203], a[4:7]
  v_exp_f32 v230, v230
  v_mfma_f32_16x16x32_bf16 a[36:39], v[144:147], a[200:203], a[36:39]
  s_add_u32 m0, s30, 65536
  s_xor_b32 s40, s32, 0x12000
  ds_read_b64_tr_b16 a[242:243], v20 offset:36864
  v_mfma_f32_16x16x32_bf16 a[36:39], v[152:155], a[204:207], a[36:39]
  s_waitcnt vmcnt(6)
  buffer_load_dwordx4 v22, s[20:23], s40 offen nt lds
  s_waitcnt lgkmcnt(4)
  v_mfma_f32_16x16x32_bf16 v[6:9], v[32:35], v[6:9], 0
  v_exp_f32 v231, v231
  v_mfma_f32_16x16x32_bf16 a[68:71], v[168:171], a[204:207], a[68:71]
  ds_read_b64_tr_b16 a[244:245], v20 offset:40960
  v_cvt_pk_bf16_f32 v227, v230, v231
  v_mfma_f32_16x16x32_bf16 a[68:71], v[160:163], a[200:203], a[68:71]
  v_exp_f32 v240, v240
  v_mfma_f32_16x16x32_bf16 a[100:103], v[176:179], a[200:203], a[100:103]
  ds_read_b64_tr_b16 a[246:247], v20 offset:45056
  v_mfma_f32_16x16x32_bf16 a[100:103], v[184:187], a[204:207], a[100:103]
  v_cvt_pk_bf16_f32 v74, v6, v7
  v_mfma_f32_16x16x32_bf16 a[104:107], v[184:187], a[212:215], a[104:107]
  ds_read_b64_tr_b16 a[248:249], v21 offset:32768
  v_cvt_pk_bf16_f32 v75, v8, v9
  v_mfma_f32_16x16x32_bf16 a[104:107], v[176:179], a[208:211], a[104:107]
  v_exp_f32 v241, v241
  v_mfma_f32_16x16x32_bf16 a[72:75], v[160:163], a[208:211], a[72:75]
  ds_read_b64_tr_b16 a[250:251], v21 offset:36864
  v_cvt_pk_bf16_f32 v240, v240, v241
  v_mfma_f32_16x16x32_bf16 a[72:75], v[168:171], a[212:215], a[72:75]
  v_exp_f32 v242, v242
  v_mfma_f32_16x16x32_bf16 a[40:43], v[152:155], a[212:215], a[40:43]
  ds_read_b64_tr_b16 a[252:253], v21 offset:40960
  v_mfma_f32_16x16x32_bf16 a[40:43], v[144:147], a[208:211], a[40:43]
  ds_read2_b64 v[2:5], v31 offset0:0 offset1:0
  v_mfma_f32_16x16x32_bf16 a[8:11], v[128:131], a[208:211], a[8:11]
  ds_read_b64_tr_b16 a[254:255], v21 offset:45056
  v_mfma_f32_16x16x32_bf16 a[8:11], v[136:139], a[212:215], a[8:11]
  s_add_u32 m0, s30, 66560
  s_xor_b32 s40, s32, 0x12c00
  v_exp_f32 v243, v243
  v_mfma_f32_16x16x32_bf16 a[12:15], v[136:139], a[220:223], a[12:15]
  s_waitcnt vmcnt(6)
  buffer_load_dwordx4 v23, s[20:23], s40 offen nt lds
  v_mfma_f32_16x16x32_bf16 a[12:15], v[128:131], a[216:219], a[12:15]
  v_exp_f32 v244, v244
  v_mfma_f32_16x16x32_bf16 a[44:47], v[144:147], a[216:219], a[44:47]
  v_exp_f32 v245, v245
  v_mfma_f32_16x16x32_bf16 a[44:47], v[152:155], a[220:223], a[44:47]
  s_waitcnt vmcnt(7) lgkmcnt(0)
  s_cmpk_lt_i32 s9, 0x0
  s_cbranch_scc0 L_fb0_5
  s_waitcnt vmcnt(4)
L_fb0_5:
  s_barrier
  v_mfma_f32_16x16x32_bf16 a[76:79], v[168:171], a[220:223], a[76:79]
  ds_read_b128 a[192:195], v10
  v_cvt_pk_bf16_f32 v241, v242, v243
  v_mfma_f32_16x16x32_bf16 a[76:79], v[160:163], a[216:219], a[76:79]
  v_exp_f32 v246, v246
  v_mfma_f32_16x16x32_bf16 a[108:111], v[176:179], a[216:219], a[108:111]
  v_exp_f32 v247, v247
  v_mfma_f32_16x16x32_bf16 a[108:111], v[184:187], a[220:223], a[108:111]
  v_exp_f32 v200, v200
  v_mfma_f32_16x16x32_bf16 v[2:5], v[32:35], v[2:5], 0
  v_exp_f32 v201, v201
  v_mfma_f32_16x16x32_bf16 a[112:115], v[184:187], a[228:231], a[112:115]
  ds_read_b128 a[196:199], v11
  v_cvt_pk_bf16_f32 v242, v244, v245
  v_mfma_f32_16x16x32_bf16 a[112:115], v[176:179], a[224:227], a[112:115]
  v_exp_f32 v202, v202
  v_mfma_f32_16x16x32_bf16 a[80:83], v[160:163], a[224:227], a[80:83]
  v_exp_f32 v203, v203
  v_mfma_f32_16x16x32_bf16 a[80:83], v[168:171], a[228:231], a[80:83]
  v_cvt_pk_bf16_f32 v76, v2, v3
  v_cvt_pk_bf16_f32 v243, v246, v247
  v_mfma_f32_16x16x32_bf16 a[48:51], v[152:155], a[228:231], a[48:51]
  s_add_u32 m0, s30, 67584
  s_xor_b32 s40, s32, 0x2400
  ds_read_b128 a[200:203], v12
  v_cvt_pk_bf16_f32 v77, v4, v5
  v_mfma_f32_16x16x32_bf16 a[48:51], v[144:147], a[224:227], a[48:51]
  s_waitcnt vmcnt(6)
  buffer_load_dwordx4 v24, s[20:23], s40 offen nt lds
  v_mfma_f32_16x16x32_bf16 a[16:19], v[128:131], a[224:227], a[16:19]
  v_exp_f32 v204, v204
  v_mfma_f32_16x16x32_bf16 a[16:19], v[136:139], a[228:231], a[16:19]
  v_exp_f32 v205, v205
  v_mfma_f32_16x16x32_bf16 a[20:23], v[136:139], a[236:239], a[20:23]
  ds_read_b128 a[204:207], v13
  v_cvt_pk_bf16_f32 v200, v200, v201
  v_mfma_f32_16x16x32_bf16 a[20:23], v[128:131], a[232:235], a[20:23]
  ds_read2_b64 v[6:9], v31 offset0:1 offset1:1
  v_cvt_pk_bf16_f32 v201, v202, v203
  v_mfma_f32_16x16x32_bf16 a[52:55], v[144:147], a[232:235], a[52:55]
  v_xor_b32 v31, 0x1000, v31
  v_cvt_pk_bf16_f32 v202, v204, v205
  v_mfma_f32_16x16x32_bf16 a[52:55], v[152:155], a[236:239], a[52:55]
  v_exp_f32 v206, v206
  v_mfma_f32_16x16x32_bf16 a[84:87], v[168:171], a[236:239], a[84:87]
  ds_read_b128 a[208:211], v10 offset:4096
  v_mfma_f32_16x16x32_bf16 a[84:87], v[160:163], a[232:235], a[84:87]
  v_exp_f32 v207, v207
  v_mfma_f32_16x16x32_bf16 a[116:119], v[176:179], a[232:235], a[116:119]
  v_exp_f32 v216, v216
  v_mfma_f32_16x16x32_bf16 a[116:119], v[184:187], a[236:239], a[116:119]
  v_exp_f32 v217, v217
  v_mfma_f32_16x16x32_bf16 a[120:123], v[184:187], a[244:247], a[120:123]
  s_add_u32 m0, s30, 68608
  s_xor_b32 s40, s32, 0x2800
L_pg3:
  s_cbranch_execz L_pg7
  ds_read_b128 a[212:215], v11 offset:4096
  v_cvt_pk_bf16_f32 v203, v206, v207
  v_mfma_f32_16x16x32_bf16 a[120:123], v[176:179], a[240:243], a[120:123]
  s_waitcnt vmcnt(6)
  buffer_load_dwordx4 v25, s[20:23], s40 offen nt lds
  v_mfma_f32_16x16x32_bf16 a[88:91], v[160:163], a[240:243], a[88:91]
  v_exp_f32 v218, v218
  v_mfma_f32_16x16x32_bf16 a[88:91], v[168:171], a[244:247], a[88:91]
  v_exp_f32 v219, v219
  s_waitcnt lgkmcnt(2)
  v_mfma_f32_16x16x32_bf16 v[6:9], v[32:35], v[6:9], 0
  v_exp_f32 v220, v220
  v_mfma_f32_16x16x32_bf16 a[56:59], v[152:155], a[244:247], a[56:59]
  ds_read_b128 a[216:219], v12 offset:4096
  v_cvt_pk_bf16_f32 v216, v216, v217
  v_mfma_f32_16x16x32_bf16 a[56:59], v[144:147], a[240:243], a[56:59]
  v_exp_f32 v221, v221
  v_mfma_f32_16x16x32_bf16 a[24:27], v[128:131], a[240:243], a[24:27]
  v_exp_f32 v222, v222
  v_mfma_f32_16x16x32_bf16 a[24:27], v[136:139], a[244:247], a[24:27]
  v_cvt_pk_bf16_f32 v78, v6, v7
  v_cvt_pk_bf16_f32 v217, v218, v219
  v_mfma_f32_16x16x32_bf16 a[28:31], v[136:139], a[252:255], a[28:31]
  ds_read_b128 a[220:223], v13 offset:4096
  v_cvt_pk_bf16_f32 v79, v8, v9
  v_mfma_f32_16x16x32_bf16 a[28:31], v[128:131], a[248:251], a[28:31]
  v_exp_f32 v223, v223
  v_mfma_f32_16x16x32_bf16 a[60:63], v[144:147], a[248:251], a[60:63]
  v_exp_f32 v232, v232
  v_mfma_f32_16x16x32_bf16 a[60:63], v[152:155], a[252:255], a[60:63]
  v_exp_f32 v233, v233
  v_mfma_f32_16x16x32_bf16 a[92:95], v[168:171], a[252:255], a[92:95]
  s_waitcnt vmcnt(11)
  s_add_u32 m0, s31, 0
  s_xor_b32 s42, s34, 0xe800
  ds_read2_b64 v[2:5], v28 offset0:0 offset1:0
  v_cvt_pk_bf16_f32 v218, v220, v221
  v_mfma_f32_16x16x32_bf16 a[92:95], v[160:163], a[248:251], a[92:95]
  s_waitcnt vmcnt(6)
  buffer_load_dwordx4 v22, s[12:15], s42 offen nt lds
  v_mfma_f32_16x16x32_bf16 a[124:127], v[176:179], a[248:251], a[124:127]
  v_exp_f32 v234, v234
  v_mfma_f32_16x16x32_bf16 a[124:127], v[184:187], a[252:255], a[124:127]
  s_waitcnt lgkmcnt(1)
  v_exp_f32 v235, v235
  v_mfma_f32_16x16x32_bf16 v[176:179], a[192:195], a[176:179], 0
  v_exp_f32 v236, v236
  v_mfma_f32_16x16x32_bf16 v[176:179], a[196:199], a[180:183], v[176:179]
  ds_read_b128 a[224:227], v10 offset:8192
  v_cvt_pk_bf16_f32 v219, v222, v223
  v_mfma_f32_16x16x32_bf16 v[176:179], a[200:203], a[184:187], v[176:179]
  v_exp_f32 v237, v237
  v_mfma_f32_16x16x32_bf16 v[176:179], a[204:207], a[188:191], v[176:179]
  v_exp_f32 v238, v238
  v_mfma_f32_16x16x32_bf16 v[160:163], a[204:207], a[172:175], 0
  ds_read_b128 a[228:231], v11 offset:8192
  v_cvt_pk_bf16_f32 v232, v232, v233
  v_mfma_f32_16x16x32_bf16 v[160:163], a[200:203], a[168:171], v[160:163]
  v_exp_f32 v239, v239
  v_mfma_f32_16x16x32_bf16 v[160:163], a[196:199], a[164:167], v[160:163]
  v_exp_f32 v248, v248
  v_mfma_f32_16x16x32_bf16 v[160:163], a[192:195], a[160:163], v[160:163]
  s_add_u32 m0, s31, 1024
  s_xor_b32 s42, s34, 0x8800
  ds_read_b128 a[232:235], v12 offset:8192
  v_cvt_pk_bf16_f32 v233, v234, v235
  s_waitcnt lgkmcnt(3)
  v_mfma_f32_16x16x32_bf16 v[2:5], v[32:35], v[2:5], 0
  v_exp_f32 v249, v249
  v_mfma_f32_16x16x32_bf16 v[144:147], a[192:195], a[144:147], 0
  s_waitcnt vmcnt(6)
  buffer_load_dwordx4 v23, s[12:15], s42 offen nt lds
  v_mfma_f32_16x16x32_bf16 v[144:147], a[196:199], a[148:151], v[144:147]
  v_exp_f32 v250, v250
  v_mfma_f32_16x16x32_bf16 v[144:147], a[200:203], a[152:155], v[144:147]
  ds_read_b128 a[236:239], v13 offset:8192
  v_cvt_pk_bf16_f32 v234, v236, v237
  v_mfma_f32_16x16x32_bf16 v[144:147], a[204:207], a[156:159], v[144:147]
  v_cvt_pk_bf16_f32 v80, v2, v3
  v_cvt_pk_bf16_f32 v235, v238, v239
  v_mfma_f32_16x16x32_bf16 v[128:131], a[204:207], a[140:143], 0
  v_cvt_pk_bf16_f32 v81, v4, v5
  v_cvt_pk_bf16_f32 v248, v248, v249
  v_mfma_f32_16x16x32_bf16 v[128:131], a[200:203], a[136:139], v[128:131]
  ds_read_b128 a[240:243], v10 offset:12288
  v_mfma_f32_16x16x32_bf16 v[128:131], a[196:199], a[132:135], v[128:131]
  v_exp_f32 v251, v251
  v_mfma_f32_16x16x32_bf16 v[128:131], a[192:195], a[128:131], v[128:131]
  ds_read2_b64 v[6:9], v28 offset0:1 offset1:1
  v_cvt_pk_bf16_f32 v249, v250, v251
  v_mfma_f32_16x16x32_bf16 v[132:135], a[208:211], a[128:131], 0
  ds_read_b128 a[244:247], v11 offset:12288
  v_xor_b32 v28, 0x1000, v28
  v_mfma_f32_16x16x32_bf16 v[132:135], a[212:215], a[132:135], v[132:135]
  v_exp_f32 v252, v252
  v_mfma_f32_16x16x32_bf16 v[132:135], a[216:219], a[136:139], v[132:135]
  v_exp_f32 v253, v253
  v_mfma_f32_16x16x32_bf16 v[132:135], a[220:223], a[140:143], v[132:135]
  ds_read_b128 a[248:251], v12 offset:12288
  v_cvt_pk_bf16_f32 v250, v252, v253
  v_mfma_f32_16x16x32_bf16 v[148:151], a[220:223], a[156:159], 0
  s_add_u32 m0, s31, 2048
  s_xor_b32 s42, s34, 0xec00
  v_exp_f32 v254, v254
  v_mfma_f32_16x16x32_bf16 v[148:151], a[216:219], a[152:155], v[148:151]
  s_waitcnt vmcnt(6)
  buffer_load_dwordx4 v24, s[12:15], s42 offen nt lds
  v_mfma_f32_16x16x32_bf16 v[148:151], a[212:215], a[148:151], v[148:151]
  ds_read_b128 a[252:255], v13 offset:12288
  v_mfma_f32_16x16x32_bf16 v[148:151], a[208:211], a[144:147], v[148:151]
  v_exp_f32 v255, v255
  s_waitcnt lgkmcnt(3)
  v_mfma_f32_16x16x32_bf16 v[6:9], v[32:35], v[6:9], 0
  v_cvt_pk_bf16_f32 v251, v254, v255
  v_mfma_f32_16x16x32_bf16 v[164:167], a[208:211], a[160:163], 0
  v_exp_f32 v128, v128
  v_mfma_f32_16x16x32_bf16 v[164:167], a[212:215], a[164:167], v[164:167]
  v_exp_f32 v129, v129
  v_mfma_f32_16x16x32_bf16 v[164:167], a[216:219], a[168:171], v[164:167]
  v_exp_f32 v130, v130
  v_mfma_f32_16x16x32_bf16 v[164:167], a[220:223], a[172:175], v[164:167]
  v_cvt_pk_bf16_f32 v82, v6, v7
  v_cvt_pk_bf16_f32 v128, v128, v129
  v_mfma_f32_16x16x32_bf16 v[180:183], a[220:223], a[188:191], 0
  v_cvt_pk_bf16_f32 v83, v8, v9
  v_mfma_f32_16x16x32_bf16 v[180:183], a[216:219], a[184:187], v[180:183]
  v_exp_f32 v131, v131
  v_mfma_f32_16x16x32_bf16 v[180:183], a[212:215], a[180:183], v[180:183]
  v_exp_f32 v132, v132
  v_mfma_f32_16x16x32_bf16 v[180:183], a[208:211], a[176:179], v[180:183]
  s_waitcnt vmcnt(7) lgkmcnt(0)
  s_cmpk_lt_i32 s10, 0x0
  s_cbranch_scc0 L_fb0_6
  s_waitcnt vmcnt(4)
L_fb0_6:
  s_barrier
  v_mfma_f32_16x16x32_bf16 v[184:187], a[224:227], a[176:179], 0
  ds_read_b64_tr_b16 a[192:193], v14 offset:49152
  v_cvt_pk_bf16_f32 v129, v130, v131
  v_mfma_f32_16x16x32_bf16 v[184:187], a[228:231], a[180:183], v[184:187]
  v_exp_f32 v133, v133
  v_mfma_f32_16x16x32_bf16 v[184:187], a[232:235], a[184:187], v[184:187]
  ds_read_b64_tr_b16 a[194:195], v14 offset:53248
  v_cvt_pk_bf16_f32 v130, v132, v133
  v_mfma_f32_16x16x32_bf16 v[184:187], a[236:239], a[188:191], v[184:187]
  ds_read2_b64 v[2:5], v29 offset0:0 offset1:0
  v_mfma_f32_16x16x32_bf16 v[168:171], a[236:239], a[172:175], 0
  s_add_u32 m0, s31, 3072
  s_xor_b32 s42, s34, 0x8c00
  ds_read_b64_tr_b16 a[196:197], v14 offset:57344
  v_mfma_f32_16x16x32_bf16 v[168:171], a[232:235], a[168:171], v[168:171]
  s_waitcnt vmcnt(6)
  buffer_load_dwordx4 v25, s[12:15], s42 offen nt lds
  v_mfma_f32_16x16x32_bf16 v[168:171], a[228:231], a[164:167], v[168:171]
  ds_read_b64_tr_b16 a[198:199], v14 offset:61440
  v_mfma_f32_16x16x32_bf16 v[168:171], a[224:227], a[160:163], v[168:171]
  v_exp_f32 v134, v134
  v_mfma_f32_16x16x32_bf16 v[152:155], a[224:227], a[144:147], 0
  ds_read_b64_tr_b16 a[200:201], v15 offset:49152
  v_mfma_f32_16x16x32_bf16 v[152:155], a[228:231], a[148:151], v[152:155]
  v_exp_f32 v135, v135
  v_mfma_f32_16x16x32_bf16 v[152:155], a[232:235], a[152:155], v[152:155]
  ds_read_b64_tr_b16 a[202:203], v15 offset:53248
  v_cvt_pk_bf16_f32 v131, v134, v135
  v_mfma_f32_16x16x32_bf16 v[152:155], a[236:239], a[156:159], v[152:155]
  v_exp_f32 v144, v144
  s_waitcnt lgkmcnt(4)
  v_mfma_f32_16x16x32_bf16 v[2:5], v[32:35], v[2:5], 0
  v_exp_f32 v145, v145
  v_mfma_f32_16x16x32_bf16 v[136:139], a[236:239], a[140:143], 0
  ds_read_b64_tr_b16 a[204:205], v15 offset:57344
  v_cvt_pk_bf16_f32 v144, v144, v145
  v_mfma_f32_16x16x32_bf16 v[136:139], a[232:235], a[136:139], v[136:139]
  v_exp_f32 v146, v146
  v_mfma_f32_16x16x32_bf16 v[136:139], a[228:231], a[132:135], v[136:139]
  ds_read_b64_tr_b16 a[206:207], v15 offset:61440
  v_mfma_f32_16x16x32_bf16 v[136:139], a[224:227], a[128:131], v[136:139]
  v_cvt_pk_bf16_f32 v84, v2, v3
  v_mfma_f32_16x16x32_bf16 v[140:143], a[240:243], a[128:131], 0
  s_add_u32 m0, s30, 32768
  s_xor_b32 s40, s32, 0x11800
  ds_read_b64_tr_b16 a[208:209], v16 offset:49152
  v_cvt_pk_bf16_f32 v85, v4, v5
  v_mfma_f32_16x16x32_bf16 v[140:143], a[244:247], a[132:135], v[140:143]
  s_waitcnt vmcnt(6)
  buffer_load_dwordx4 v22, s[16:19], s40 offen nt lds
  v_mfma_f32_16x16x32_bf16 v[140:143], a[248:251], a[136:139], v[140:143]
  ds_read_b64_tr_b16 a[210:211], v16 offset:53248
  v_mfma_f32_16x16x32_bf16 v[140:143], a[252:255], a[140:143], v[140:143]
  v_exp_f32 v147, v147
  v_mfma_f32_16x16x32_bf16 v[156:159], a[252:255], a[156:159], 0
  ds_read_b64_tr_b16 a[212:213], v16 offset:57344
  v_cvt_pk_bf16_f32 v145, v146, v147
  v_mfma_f32_16x16x32_bf16 v[156:159], a[248:251], a[152:155], v[156:159]
  ds_read2_b64 v[6:9], v29 offset0:1 offset1:1
  v_mfma_f32_16x16x32_bf16 v[156:159], a[244:247], a[148:151], v[156:159]
  ds_read_b64_tr_b16 a[214:215], v16 offset:61440
  v_xor_b32 v29, 0x1000, v29
  v_mfma_f32_16x16x32_bf16 v[156:159], a[240:243], a[144:147], v[156:159]
  v_exp_f32 v148, v148
  v_mfma_f32_16x16x32_bf16 v[172:175], a[240:243], a[160:163], 0
  ds_read_b64_tr_b16 a[216:217], v17 offset:49152
  v_mfma_f32_16x16x32_bf16 v[172:175], a[244:247], a[164:167], v[172:175]
  v_exp_f32 v149, v149
  v_mfma_f32_16x16x32_bf16 v[172:175], a[248:251], a[168:171], v[172:175]
  s_add_u32 m0, s30, 33792
  s_xor_b32 s40, s32, 0x11400
  ds_read_b64_tr_b16 a[218:219], v17 offset:53248
  v_cvt_pk_bf16_f32 v146, v148, v149
  v_mfma_f32_16x16x32_bf16 v[172:175], a[252:255], a[172:175], v[172:175]
  s_waitcnt vmcnt(6)
  buffer_load_dwordx4 v23, s[16:19], s40 offen nt lds
  v_mfma_f32_16x16x32_bf16 v[188:191], a[252:255], a[188:191], 0
  ds_read_b64_tr_b16 a[220:221], v17 offset:57344
  v_mfma_f32_16x16x32_bf16 v[188:191], a[248:251], a[184:187], v[188:191]
  v_exp_f32 v150, v150
  v_mfma_f32_16x16x32_bf16 v[188:191], a[244:247], a[180:183], v[188:191]
  ds_read_b64_tr_b16 a[222:223], v17 offset:61440
  v_mfma_f32_16x16x32_bf16 v[188:191], a[240:243], a[176:179], v[188:191]
  v_exp_f32 v151, v151
  s_waitcnt lgkmcnt(5)
  v_mfma_f32_16x16x32_bf16 v[6:9], v[32:35], v[6:9], 0
  v_exp_f32 v160, v160
  v_mfma_f32_16x16x32_bf16 v[48:51], v[44:47], v[192:195], v[48:51]
  ds_read_b64_tr_b16 a[224:225], v18 offset:49152
  v_cvt_pk_bf16_f32 v147, v150, v151
  v_mfma_f32_16x16x32_bf16 v[48:51], v[44:47], v[200:203], v[48:51]
  v_exp_f32 v161, v161
  v_mfma_f32_16x16x32_bf16 v[52:55], v[44:47], v[208:211], v[52:55]
  ds_read_b64_tr_b16 a[226:227], v18 offset:53248
  v_cvt_pk_bf16_f32 v160, v160, v161
  v_mfma_f32_16x16x32_bf16 v[52:55], v[44:47], v[216:219], v[52:55]
  v_cvt_pk_bf16_f32 v86, v6, v7
  v_mfma_f32_16x16x32_bf16 v[56:59], v[44:47], v[224:227], v[56:59]
  ds_read_b64_tr_b16 a[228:229], v18 offset:57344
  v_cvt_pk_bf16_f32 v87, v8, v9
  v_mfma_f32_16x16x32_bf16 v[56:59], v[44:47], v[232:235], v[56:59]
  v_mov_b32 v252, 1
  v_mfma_f32_16x16x32_bf16 v[60:63], v[44:47], v[240:243], v[60:63]
  ds_read_b64_tr_b16 a[230:231], v18 offset:61440
  v_mfma_f32_16x16x32_bf16 v[60:63], v[44:47], v[248:251], v[60:63]
  s_waitcnt lgkmcnt(4)
  s_waitcnt vmcnt(6)
  buffer_atomic_add v252, v26, s[4:7], 0 offen sc0 sc1
  v_mfma_f32_16x16x32_bf16 a[96:99], v[248:251], a[196:199], a[96:99]
  ds_read_b64_tr_b16 a[232:233], v19 offset:49152
  v_mfma_f32_16x16x32_bf16 a[96:99], v[240:243], a[192:195], a[96:99]
  ds_read2_b64 v[2:5], v30 offset0:0 offset1:0
  v_mfma_f32_16x16x32_bf16 a[64:67], v[224:227], a[192:195], a[64:67]
  s_add_u32 m0, s30, 34816
  s_xor_b32 s40, s32, 0x1c00
  ds_read_b64_tr_b16 a[234:235], v19 offset:53248
  v_mfma_f32_16x16x32_bf16 a[64:67], v[232:235], a[196:199], a[64:67]
  s_waitcnt vmcnt(6)
  buffer_load_dwordx4 v24, s[16:19], s40 offen nt lds
  v_mfma_f32_16x16x32_bf16 a[32:35], v[216:219], a[196:199], a[32:35]
  ds_read_b64_tr_b16 a[236:237], v19 offset:57344
  v_mfma_f32_16x16x32_bf16 a[32:35], v[208:211], a[192:195], a[32:35]
  v_exp_f32 v162, v162
  v_mfma_f32_16x16x32_bf16 a[0:3], v[192:195], a[192:195], a[0:3]
  ds_read_b64_tr_b16 a[238:239], v19 offset:61440
  v_mfma_f32_16x16x32_bf16 a[0:3], v[200:203], a[196:199], a[0:3]
  v_exp_f32 v163, v163
  v_mfma_f32_16x16x32_bf16 a[4:7], v[200:203], a[204:207], a[4:7]
  ds_read_b64_tr_b16 a[240:241], v20 offset:49152
  v_cvt_pk_bf16_f32 v161, v162, v163
  v_mfma_f32_16x16x32_bf16 a[4:7], v[192:195], a[200:203], a[4:7]
  v_exp_f32 v164, v164
  v_mfma_f32_16x16x32_bf16 a[36:39], v[208:211], a[200:203], a[36:39]
  ds_read_b64_tr_b16 a[242:243], v20 offset:53248
  v_mfma_f32_16x16x32_bf16 a[36:39], v[216:219], a[204:207], a[36:39]
  v_exp_f32 v165, v165
  s_waitcnt lgkmcnt(5)
  v_mfma_f32_16x16x32_bf16 v[2:5], v[32:35], v[2:5], 0
  v_exp_f32 v166, v166
  v_mfma_f32_16x16x32_bf16 a[68:71], v[232:235], a[204:207], a[68:71]
  s_add_u32 m0, s30, 35840
  s_xor_b32 s40, s32, 0x1000
  ds_read_b64_tr_b16 a[244:245], v20 offset:57344
  v_cvt_pk_bf16_f32 v162, v164, v165
  v_mfma_f32_16x16x32_bf16 a[68:71], v[224:227], a[200:203], a[68:71]
  s_waitcnt vmcnt(6)
  buffer_load_dwordx4 v25, s[16:19], s40 offen nt lds
  v_mfma_f32_16x16x32_bf16 a[100:103], v[240:243], a[200:203], a[100:103]
  ds_read_b64_tr_b16 a[246:247], v20 offset:61440
  v_mfma_f32_16x16x32_bf16 a[100:103], v[248:251], a[204:207], a[100:103]
  v_cvt_pk_bf16_f32 v88, v2, v3
  v_mfma_f32_16x16x32_bf16 a[104:107], v[248:251], a[212:215], a[104:107]
  ds_read_b64_tr_b16 a[248:249], v21 offset:49152
  v_cvt_pk_bf16_f32 v89, v4, v5
  v_mfma_f32_16x16x32_bf16 a[104:107], v[240:243], a[208:211], a[104:107]
  v_exp_f32 v167, v167
  v_mfma_f32_16x16x32_bf16 a[72:75], v[224:227], a[208:211], a[72:75]
  ds_read_b64_tr_b16 a[250:251], v21 offset:53248
  v_cvt_pk_bf16_f32 v163, v166, v167
  v_mfma_f32_16x16x32_bf16 a[72:75], v[232:235], a[212:215], a[72:75]
  v_exp_f32 v176, v176
  v_mfma_f32_16x16x32_bf16 a[40:43], v[216:219], a[212:215], a[40:43]
  ds_read_b64_tr_b16 a[252:253], v21 offset:57344
  v_mfma_f32_16x16x32_bf16 a[40:43], v[208:211], a[208:211], a[40:43]
  ds_read2_b64 v[6:9], v30 offset0:1 offset1:1
  v_mfma_f32_16x16x32_bf16 a[8:11], v[192:195], a[208:211], a[8:11]
  ds_read_b64_tr_b16 a[254:255], v21 offset:61440
  v_xor_b32 v30, 0x1000, v30
  v_mfma_f32_16x16x32_bf16 a[8:11], v[200:203], a[212:215], a[8:11]
  v_exp_f32 v177, v177
  v_mfma_f32_16x16x32_bf16 a[12:15], v[200:203], a[220:223], a[12:15]
  s_add_u32 m0, s30, 81920
  s_xor_b32 s40, s32, 0x12400
  v_exp_f32 v178, v178
  v_mfma_f32_16x16x32_bf16 a[12:15], v[192:195], a[216:219], a[12:15]
  s_waitcnt vmcnt(6)
  buffer_load_dwordx4 v22, s[20:23], s40 offen nt lds
  v_mfma_f32_16x16x32_bf16 a[44:47], v[208:211], a[216:219], a[44:47]
  v_exp_f32 v179, v179
  v_mfma_f32_16x16x32_bf16 a[44:47], v[216:219], a[220:223], a[44:47]
  s_waitcnt vmcnt(7) lgkmcnt(0)
  s_cmpk_lt_i32 s11, 0x0
  s_cbranch_scc0 L_fb0_7
  s_waitcnt vmcnt(4)
L_fb0_7:
  s_barrier
  v_mfma_f32_16x16x32_bf16 a[76:79], v[232:235], a[220:223], a[76:79]
  ds_read_b128 a[192:195], v10 offset:16384
  v_cvt_pk_bf16_f32 v176, v176, v177
  v_mfma_f32_16x16x32_bf16 a[76:79], v[224:227], a[216:219], a[76:79]
  v_exp_f32 v180, v180
  v_mfma_f32_16x16x32_bf16 a[108:111], v[240:243], a[216:219], a[108:111]
  v_exp_f32 v181, v181
  v_mfma_f32_16x16x32_bf16 a[108:111], v[248:251], a[220:223], a[108:111]
  v_exp_f32 v182, v182
  v_mfma_f32_16x16x32_bf16 v[6:9], v[32:35], v[6:9], 0
  v_exp_f32 v183, v183
  v_mfma_f32_16x16x32_bf16 a[112:115], v[248:251], a[228:231], a[112:115]
  ds_read_b128 a[196:199], v11 offset:16384
  v_cvt_pk_bf16_f32 v177, v178, v179
  v_mfma_f32_16x16x32_bf16 a[112:115], v[240:243], a[224:227], a[112:115]
  v_exp_f32 v136, v136
  v_mfma_f32_16x16x32_bf16 a[80:83], v[224:227], a[224:227], a[80:83]
  v_exp_f32 v137, v137
  v_mfma_f32_16x16x32_bf16 a[80:83], v[232:235], a[228:231], a[80:83]
  v_cvt_pk_bf16_f32 v90, v6, v7
  v_cvt_pk_bf16_f32 v178, v180, v181
  v_mfma_f32_16x16x32_bf16 a[48:51], v[216:219], a[228:231], a[48:51]
  ds_read_b128 a[200:203], v12 offset:16384
  v_cvt_pk_bf16_f32 v91, v8, v9
  v_mfma_f32_16x16x32_bf16 a[48:51], v[208:211], a[224:227], a[48:51]
  s_add_u32 m0, s30, 82944
  s_xor_b32 s40, s32, 0x12800
  v_exp_f32 v138, v138
  v_mfma_f32_16x16x32_bf16 a[16:19], v[192:195], a[224:227], a[16:19]
  s_waitcnt vmcnt(6)
  buffer_load_dwordx4 v23, s[20:23], s40 offen nt lds
  v_mfma_f32_16x16x32_bf16 a[16:19], v[200:203], a[228:231], a[16:19]
  ds_read2_b64 v[2:5], v31 offset0:0 offset1:0
  v_cvt_pk_bf16_f32 v179, v182, v183
  v_mfma_f32_16x16x32_bf16 a[20:23], v[200:203], a[236:239], a[20:23]
  ds_read_b128 a[204:207], v13 offset:16384
  v_cvt_pk_bf16_f32 v136, v136, v137
  v_mfma_f32_16x16x32_bf16 a[20:23], v[192:195], a[232:235], a[20:23]
  v_exp_f32 v139, v139
  v_mfma_f32_16x16x32_bf16 a[52:55], v[208:211], a[232:235], a[52:55]
  v_exp_f32 v140, v140
  v_mfma_f32_16x16x32_bf16 a[52:55], v[216:219], a[236:239], a[52:55]
  v_exp_f32 v141, v141
  v_mfma_f32_16x16x32_bf16 a[84:87], v[232:235], a[236:239], a[84:87]
  ds_read_b128 a[208:211], v10 offset:20480
  v_cvt_pk_bf16_f32 v137, v138, v139
  v_mfma_f32_16x16x32_bf16 a[84:87], v[224:227], a[232:235], a[84:87]
  v_exp_f32 v142, v142
  v_mfma_f32_16x16x32_bf16 a[116:119], v[240:243], a[232:235], a[116:119]
  v_exp_f32 v143, v143
  v_mfma_f32_16x16x32_bf16 a[116:119], v[248:251], a[236:239], a[116:119]
  v_exp_f32 v152, v152
  s_waitcnt lgkmcnt(2)
  v_mfma_f32_16x16x32_bf16 v[2:5], v[32:35], v[2:5], 0
  v_exp_f32 v153, v153
  v_mfma_f32_16x16x32_bf16 a[120:123], v[248:251], a[244:247], a[120:123]
  ds_read_b128 a[212:215], v11 offset:20480
  v_cvt_pk_bf16_f32 v138, v140, v141
  v_mfma_f32_16x16x32_bf16 a[120:123], v[240:243], a[240:243], a[120:123]
  s_add_u32 m0, s30, 83968
  s_xor_b32 s40, s32, 0x2000
  v_exp_f32 v154, v154
  v_mfma_f32_16x16x32_bf16 a[88:91], v[224:227], a[240:243], a[88:91]
  s_waitcnt vmcnt(6)
  buffer_load_dwordx4 v24, s[20:23], s40 offen nt lds
  v_mfma_f32_16x16x32_bf16 a[88:91], v[232:235], a[244:247], a[88:91]
  v_cvt_pk_bf16_f32 v92, v2, v3
  v_cvt_pk_bf16_f32 v139, v142, v143
  v_mfma_f32_16x16x32_bf16 a[56:59], v[216:219], a[244:247], a[56:59]
  ds_read_b128 a[216:219], v12 offset:20480
  v_cvt_pk_bf16_f32 v93, v4, v5
  v_mfma_f32_16x16x32_bf16 a[56:59], v[208:211], a[240:243], a[56:59]
  v_exp_f32 v155, v155
  v_mfma_f32_16x16x32_bf16 a[24:27], v[192:195], a[240:243], a[24:27]
  v_exp_f32 v156, v156
  v_mfma_f32_16x16x32_bf16 a[24:27], v[200:203], a[244:247], a[24:27]
  v_exp_f32 v157, v157
  v_mfma_f32_16x16x32_bf16 a[28:31], v[200:203], a[252:255], a[28:31]
  ds_read_b128 a[220:223], v13 offset:20480
  v_cvt_pk_bf16_f32 v152, v152, v153
  v_mfma_f32_16x16x32_bf16 a[28:31], v[192:195], a[248:251], a[28:31]
  v_exp_f32 v158, v158
  v_mfma_f32_16x16x32_bf16 a[60:63], v[208:211], a[248:251], a[60:63]
  ds_read2_b64 v[6:9], v31 offset0:1 offset1:1
  v_cvt_pk_bf16_f32 v153, v154, v155
  v_mfma_f32_16x16x32_bf16 a[60:63], v[216:219], a[252:255], a[60:63]
  v_xor_b32 v31, 0x1000, v31
  v_cvt_pk_bf16_f32 v154, v156, v157
  v_mfma_f32_16x16x32_bf16 a[92:95], v[232:235], a[252:255], a[92:95]
  v_exp_f32 v159, v159
  v_mfma_f32_16x16x32_bf16 a[92:95], v[224:227], a[248:251], a[92:95]
  v_exp_f32 v168, v168
  v_mfma_f32_16x16x32_bf16 a[124:127], v[240:243], a[248:251], a[124:127]
  s_add_u32 m0, s30, 84992
  s_xor_b32 s40, s32, 0x2c00
  v_exp_f32 v169, v169
  v_mfma_f32_16x16x32_bf16 a[124:127], v[248:251], a[252:255], a[124:127]
  s_waitcnt lgkmcnt(1)
  s_waitcnt vmcnt(6)
  buffer_load_dwordx4 v25, s[20:23], s40 offen nt lds
  v_mfma_f32_16x16x32_bf16 v[240:243], a[192:195], a[176:179], 0
  v_exp_f32 v170, v170
  v_mfma_f32_16x16x32_bf16 v[240:243], a[196:199], a[180:183], v[240:243]
  ds_read_b128 a[224:227], v10 offset:24576
  v_cvt_pk_bf16_f32 v155, v158, v159
  v_mfma_f32_16x16x32_bf16 v[240:243], a[200:203], a[184:187], v[240:243]
  v_exp_f32 v171, v171
  v_mfma_f32_16x16x32_bf16 v[240:243], a[204:207], a[188:191], v[240:243]
  v_exp_f32 v172, v172
  s_waitcnt lgkmcnt(1)
  v_mfma_f32_16x16x32_bf16 v[6:9], v[32:35], v[6:9], 0
  v_exp_f32 v173, v173
  v_mfma_f32_16x16x32_bf16 v[224:227], a[204:207], a[172:175], 0
  ds_read_b128 a[228:231], v11 offset:24576
  v_cvt_pk_bf16_f32 v168, v168, v169
  v_mfma_f32_16x16x32_bf16 v[224:227], a[200:203], a[168:171], v[224:227]
  v_exp_f32 v174, v174
  v_mfma_f32_16x16x32_bf16 v[224:227], a[196:199], a[164:167], v[224:227]
  v_exp_f32 v175, v175
  v_mfma_f32_16x16x32_bf16 v[224:227], a[192:195], a[160:163], v[224:227]
  ds_read_b128 a[232:235], v12 offset:24576
  v_cvt_pk_bf16_f32 v94, v6, v7
  v_mfma_f32_16x16x32_bf16 v[208:211], a[192:195], a[144:147], 0
  v_cvt_pk_bf16_f32 v95, v8, v9
  v_cvt_pk_bf16_f32 v169, v170, v171
  v_mfma_f32_16x16x32_bf16 v[208:211], a[196:199], a[148:151], v[208:211]
  v_exp_f32 v184, v184
  v_mfma_f32_16x16x32_bf16 v[208:211], a[200:203], a[152:155], v[208:211]
  ds_read_b128 a[236:239], v13 offset:24576
  v_cvt_pk_bf16_f32 v170, v172, v173
  v_mfma_f32_16x16x32_bf16 v[208:211], a[204:207], a[156:159], v[208:211]
  s_add_u32 m0, s31, 4096
  s_xor_b32 s42, s34, 0xb800
  v_exp_f32 v185, v185
  v_mfma_f32_16x16x32_bf16 v[192:195], a[204:207], a[140:143], 0
  s_waitcnt vmcnt(6)
  buffer_load_dwordx4 v22, s[12:15], s42 offen nt lds
  v_mfma_f32_16x16x32_bf16 v[192:195], a[200:203], a[136:139], v[192:195]
  ds_read_b128 a[240:243], v10 offset:28672
  v_cvt_pk_bf16_f32 v171, v174, v175
  v_mfma_f32_16x16x32_bf16 v[192:195], a[196:199], a[132:135], v[192:195]
  s_waitcnt vmcnt(10)
  ds_read2_b64 v[2:5], v28 offset0:0 offset1:0
  v_cvt_pk_bf16_f32 v184, v184, v185
  v_mfma_f32_16x16x32_bf16 v[192:195], a[192:195], a[128:131], v[192:195]
  v_exp_f32 v186, v186
  v_mfma_f32_16x16x32_bf16 v[196:199], a[208:211], a[128:131], 0
  ds_read_b128 a[244:247], v11 offset:28672
  v_mfma_f32_16x16x32_bf16 v[196:199], a[212:215], a[132:135], v[196:199]
  v_exp_f32 v187, v187
  v_mfma_f32_16x16x32_bf16 v[196:199], a[216:219], a[136:139], v[196:199]
  v_exp_f32 v188, v188
  v_mfma_f32_16x16x32_bf16 v[196:199], a[220:223], a[140:143], v[196:199]
  ds_read_b128 a[248:251], v12 offset:28672
  v_cvt_pk_bf16_f32 v185, v186, v187
  v_mfma_f32_16x16x32_bf16 v[212:215], a[220:223], a[156:159], 0
  v_exp_f32 v189, v189
  v_mfma_f32_16x16x32_bf16 v[212:215], a[216:219], a[152:155], v[212:215]
  v_exp_f32 v190, v190
  v_mfma_f32_16x16x32_bf16 v[212:215], a[212:215], a[148:151], v[212:215]
  ds_read_b128 a[252:255], v13 offset:28672
  v_cvt_pk_bf16_f32 v186, v188, v189
  v_mfma_f32_16x16x32_bf16 v[212:215], a[208:211], a[144:147], v[212:215]
  s_add_u32 m0, s31, 5120
  s_xor_b32 s42, s34, 0xd800
  v_exp_f32 v191, v191
  s_waitcnt lgkmcnt(3)
  v_mfma_f32_16x16x32_bf16 v[2:5], v[32:35], v[2:5], 0
  v_cvt_pk_bf16_f32 v187, v190, v191
  v_mfma_f32_16x16x32_bf16 v[228:231], a[208:211], a[160:163], 0
  s_waitcnt vmcnt(6)
  buffer_load_dwordx4 v23, s[12:15], s42 offen nt lds
  v_mfma_f32_16x16x32_bf16 v[228:231], a[212:215], a[164:167], v[228:231]
  v_exp_f32 v192, v192
  v_mfma_f32_16x16x32_bf16 v[228:231], a[216:219], a[168:171], v[228:231]
  v_exp_f32 v193, v193
  v_mfma_f32_16x16x32_bf16 v[228:231], a[220:223], a[172:175], v[228:231]
  v_cvt_pk_bf16_f32 v96, v2, v3
  v_cvt_pk_bf16_f32 v192, v192, v193
  v_mfma_f32_16x16x32_bf16 v[244:247], a[220:223], a[188:191], 0
  v_cvt_pk_bf16_f32 v97, v4, v5
  v_mfma_f32_16x16x32_bf16 v[244:247], a[216:219], a[184:187], v[244:247]
  v_exp_f32 v194, v194
  v_mfma_f32_16x16x32_bf16 v[244:247], a[212:215], a[180:183], v[244:247]
  v_exp_f32 v195, v195
  v_mfma_f32_16x16x32_bf16 v[244:247], a[208:211], a[176:179], v[244:247]
  s_waitcnt vmcnt(7) lgkmcnt(0)
  s_cmpk_lt_i32 s8, 0x0
  s_cbranch_scc0 L_fb0_8
  s_waitcnt vmcnt(3)
L_fb0_8:
  s_barrier
  v_mfma_f32_16x16x32_bf16 v[248:251], a[224:227], a[176:179], 0
  ds_read_b64_tr_b16 a[192:193], v14
  v_cvt_pk_bf16_f32 v193, v194, v195
  v_mfma_f32_16x16x32_bf16 v[248:251], a[228:231], a[180:183], v[248:251]
  ds_read2_b64 v[6:9], v28 offset0:1 offset1:1
  v_mfma_f32_16x16x32_bf16 v[248:251], a[232:235], a[184:187], v[248:251]
  ds_read_b64_tr_b16 a[194:195], v14 offset:4096
  v_xor_b32 v28, 0x1000, v28
  v_mfma_f32_16x16x32_bf16 v[248:251], a[236:239], a[188:191], v[248:251]
  v_exp_f32 v196, v196
  v_mfma_f32_16x16x32_bf16 v[232:235], a[236:239], a[172:175], 0
  s_add_u32 m0, s31, 6144
  s_xor_b32 s42, s34, 0xbc00
  ds_read_b64_tr_b16 a[196:197], v14 offset:8192
  v_mfma_f32_16x16x32_bf16 v[232:235], a[232:235], a[168:171], v[232:235]
  s_waitcnt vmcnt(6)
  buffer_load_dwordx4 v24, s[12:15], s42 offen nt lds
  v_mfma_f32_16x16x32_bf16 v[232:235], a[228:231], a[164:167], v[232:235]
  ds_read_b64_tr_b16 a[198:199], v14 offset:12288
  v_mfma_f32_16x16x32_bf16 v[232:235], a[224:227], a[160:163], v[232:235]
  v_exp_f32 v197, v197
  v_mfma_f32_16x16x32_bf16 v[216:219], a[224:227], a[144:147], 0
  ds_read_b64_tr_b16 a[200:201], v15
  v_cvt_pk_bf16_f32 v194, v196, v197
  v_mfma_f32_16x16x32_bf16 v[216:219], a[228:231], a[148:151], v[216:219]
  v_exp_f32 v198, v198
  v_mfma_f32_16x16x32_bf16 v[216:219], a[232:235], a[152:155], v[216:219]
  ds_read_b64_tr_b16 a[202:203], v15 offset:4096
  v_mfma_f32_16x16x32_bf16 v[216:219], a[236:239], a[156:159], v[216:219]
  v_exp_f32 v199, v199
  s_waitcnt lgkmcnt(5)
  v_mfma_f32_16x16x32_bf16 v[6:9], v[32:35], v[6:9], 0
  v_exp_f32 v208, v208
  v_mfma_f32_16x16x32_bf16 v[200:203], a[236:239], a[140:143], 0
  ds_read_b64_tr_b16 a[204:205], v15 offset:8192
  v_cvt_pk_bf16_f32 v195, v198, v199
  v_mfma_f32_16x16x32_bf16 v[200:203], a[232:235], a[136:139], v[200:203]
  v_exp_f32 v209, v209
  v_mfma_f32_16x16x32_bf16 v[200:203], a[228:231], a[132:135], v[200:203]
  ds_read_b64_tr_b16 a[206:207], v15 offset:12288
  v_cvt_pk_bf16_f32 v208, v208, v209
  v_mfma_f32_16x16x32_bf16 v[200:203], a[224:227], a[128:131], v[200:203]
  v_cvt_pk_bf16_f32 v98, v6, v7
  v_mfma_f32_16x16x32_bf16 v[204:207], a[240:243], a[128:131], 0
  ds_read_b64_tr_b16 a[208:209], v16
  v_cvt_pk_bf16_f32 v99, v8, v9
  v_mfma_f32_16x16x32_bf16 v[204:207], a[244:247], a[132:135], v[204:207]
  v_exp_f32 v210, v210
  v_mfma_f32_16x16x32_bf16 v[204:207], a[248:251], a[136:139], v[204:207]
  ds_read_b64_tr_b16 a[210:211], v16 offset:4096
  v_mfma_f32_16x16x32_bf16 v[204:207], a[252:255], a[140:143], v[204:207]
  s_waitcnt vmcnt(9)
  v_readfirstlane_b32 s44, v252
  v_mfma_f32_16x16x32_bf16 v[220:223], a[252:255], a[156:159], 0
  ds_read_b64_tr_b16 a[212:213], v16 offset:8192
  v_mfma_f32_16x16x32_bf16 v[220:223], a[248:251], a[152:155], v[220:223]
  s_sub_u32 s44, s44, s49
  s_add_u32 s49, s49, 64
  s_sub_i32 s8, s44, s98
  s_sub_i32 s9, s44, s99
  s_sub_i32 s10, s44, s100
  s_sub_i32 s11, s44, s101
  ds_read2_b64 v[2:5], v29 offset0:0 offset1:0
  v_mfma_f32_16x16x32_bf16 v[220:223], a[244:247], a[148:151], v[220:223]
  s_add_u32 m0, s31, 7168
  s_xor_b32 s42, s34, 0xdc00
  ds_read_b64_tr_b16 a[214:215], v16 offset:12288
  v_mfma_f32_16x16x32_bf16 v[220:223], a[240:243], a[144:147], v[220:223]
  s_waitcnt vmcnt(6)
  buffer_load_dwordx4 v25, s[12:15], s42 offen nt lds
  v_mfma_f32_16x16x32_bf16 v[236:239], a[240:243], a[160:163], 0
  ds_read_b64_tr_b16 a[216:217], v17
  v_mfma_f32_16x16x32_bf16 v[236:239], a[244:247], a[164:167], v[236:239]
  v_exp_f32 v211, v211
  v_mfma_f32_16x16x32_bf16 v[236:239], a[248:251], a[168:171], v[236:239]
  ds_read_b64_tr_b16 a[218:219], v17 offset:4096
  v_cvt_pk_bf16_f32 v209, v210, v211
  v_mfma_f32_16x16x32_bf16 v[236:239], a[252:255], a[172:175], v[236:239]
  v_exp_f32 v212, v212
L_pg4:
  s_cbranch_execz L_rt0
  v_mfma_f32_16x16x32_bf16 v[252:255], a[252:255], a[188:191], 0
  ds_read_b64_tr_b16 a[220:221], v17 offset:8192
  v_mfma_f32_16x16x32_bf16 v[252:255], a[248:251], a[184:187], v[252:255]
  v_exp_f32 v213, v213
  v_mfma_f32_16x16x32_bf16 v[252:255], a[244:247], a[180:183], v[252:255]
  s_add_u32 m0, s30, 49152
  s_xor_b32 s40, s32, 0x11c00
  ds_read_b64_tr_b16 a[222:223], v17 offset:12288
  v_cvt_pk_bf16_f32 v210, v212, v213
  v_mfma_f32_16x16x32_bf16 v[252:255], a[240:243], a[176:179], v[252:255]
  s_waitcnt vmcnt(6)
  buffer_load_dwordx4 v22, s[16:19], s40 offen nt lds
  s_waitcnt lgkmcnt(5)
  v_mfma_f32_16x16x32_bf16 v[2:5], v[32:35], v[2:5], 0
  v_exp_f32 v214, v214
  v_mfma_f32_16x16x32_bf16 v[48:51], v[44:47], v[128:131], v[48:51]
  ds_read_b64_tr_b16 a[224:225], v18
  v_mfma_f32_16x16x32_bf16 v[48:51], v[44:47], v[136:139], v[48:51]
  v_exp_f32 v215, v215
  v_mfma_f32_16x16x32_bf16 v[52:55], v[44:47], v[144:147], v[52:55]
  ds_read_b64_tr_b16 a[226:227], v18 offset:4096
  v_cvt_pk_bf16_f32 v211, v214, v215
  v_mfma_f32_16x16x32_bf16 v[52:55], v[44:47], v[152:155], v[52:55]
  v_cvt_pk_bf16_f32 v100, v2, v3
  v_mfma_f32_16x16x32_bf16 v[56:59], v[44:47], v[160:163], v[56:59]
  ds_read_b64_tr_b16 a[228:229], v18 offset:8192
  v_cvt_pk_bf16_f32 v101, v4, v5
  v_mfma_f32_16x16x32_bf16 v[56:59], v[44:47], v[168:171], v[56:59]
  v_exp_f32 v224, v224
  v_mfma_f32_16x16x32_bf16 v[60:63], v[44:47], v[176:179], v[60:63]
  ds_read_b64_tr_b16 a[230:231], v18 offset:12288
  v_mfma_f32_16x16x32_bf16 v[60:63], v[44:47], v[184:187], v[60:63]
  s_waitcnt lgkmcnt(4)
  ds_read2_b64 v[6:9], v29 offset0:1 offset1:1
  v_mfma_f32_16x16x32_bf16 a[96:99], v[184:187], a[196:199], a[96:99]
  ds_read_b64_tr_b16 a[232:233], v19
  v_xor_b32 v29, 0x1000, v29
  v_mfma_f32_16x16x32_bf16 a[96:99], v[176:179], a[192:195], a[96:99]
  v_exp_f32 v225, v225
  v_mfma_f32_16x16x32_bf16 a[64:67], v[160:163], a[192:195], a[64:67]
  s_add_u32 m0, s30, 50176
  s_xor_b32 s40, s32, 0x11000
  ds_read_b64_tr_b16 a[234:235], v19 offset:4096
  v_cvt_pk_bf16_f32 v224, v224, v225
  v_mfma_f32_16x16x32_bf16 a[64:67], v[168:171], a[196:199], a[64:67]
  s_waitcnt vmcnt(6)
  buffer_load_dwordx4 v23, s[16:19], s40 offen nt lds
  v_mfma_f32_16x16x32_bf16 a[32:35], v[152:155], a[196:199], a[32:35]
  ds_read_b64_tr_b16 a[236:237], v19 offset:8192
  v_mfma_f32_16x16x32_bf16 a[32:35], v[144:147], a[192:195], a[32:35]
  v_exp_f32 v226, v226
  v_mfma_f32_16x16x32_bf16 a[0:3], v[128:131], a[192:195], a[0:3]
  ds_read_b64_tr_b16 a[238:239], v19 offset:12288
  v_mfma_f32_16x16x32_bf16 a[0:3], v[136:139], a[196:199], a[0:3]
  v_exp_f32 v227, v227
  s_waitcnt lgkmcnt(4)
  v_mfma_f32_16x16x32_bf16 v[6:9], v[32:35], v[6:9], 0
  v_exp_f32 v228, v228
  v_mfma_f32_16x16x32_bf16 a[4:7], v[136:139], a[204:207], a[4:7]
  ds_read_b64_tr_b16 a[240:241], v20
  v_cvt_pk_bf16_f32 v225, v226, v227
  v_mfma_f32_16x16x32_bf16 a[4:7], v[128:131], a[200:203], a[4:7]
  v_exp_f32 v229, v229
  v_mfma_f32_16x16x32_bf16 a[36:39], v[144:147], a[200:203], a[36:39]
  ds_read_b64_tr_b16 a[242:243], v20 offset:4096
  v_cvt_pk_bf16_f32 v226, v228, v229
  v_mfma_f32_16x16x32_bf16 a[36:39], v[152:155], a[204:207], a[36:39]
  v_cvt_pk_bf16_f32 v102, v6, v7
  v_mfma_f32_16x16x32_bf16 a[68:71], v[168:171], a[204:207], a[68:71]
  ds_read_b64_tr_b16 a[244:245], v20 offset:8192
  v_cvt_pk_bf16_f32 v103, v8, v9
  v_mfma_f32_16x16x32_bf16 a[68:71], v[160:163], a[200:203], a[68:71]
  v_exp_f32 v230, v230
  v_mfma_f32_16x16x32_bf16 a[100:103], v[176:179], a[200:203], a[100:103]
  ds_read_b64_tr_b16 a[246:247], v20 offset:12288
  v_mfma_f32_16x16x32_bf16 a[100:103], v[184:187], a[204:207], a[100:103]
  v_exp_f32 v231, v231
  v_mfma_f32_16x16x32_bf16 a[104:107], v[184:187], a[212:215], a[104:107]
  s_add_u32 m0, s30, 51200
  s_xor_b32 s40, s32, 0x1800
  ds_read_b64_tr_b16 a[248:249], v21
  v_cvt_pk_bf16_f32 v227, v230, v231
  v_mfma_f32_16x16x32_bf16 a[104:107], v[176:179], a[208:211], a[104:107]
  s_waitcnt vmcnt(6)
  buffer_load_dwordx4 v24, s[16:19], s40 offen nt lds
  v_mfma_f32_16x16x32_bf16 a[72:75], v[160:163], a[208:211], a[72:75]
  ds_read_b64_tr_b16 a[250:251], v21 offset:4096
  v_mfma_f32_16x16x32_bf16 a[72:75], v[168:171], a[212:215], a[72:75]
  ds_read2_b64 v[2:5], v30 offset0:0 offset1:0
  v_mfma_f32_16x16x32_bf16 a[40:43], v[152:155], a[212:215], a[40:43]
  ds_read_b64_tr_b16 a[252:253], v21 offset:8192
  v_mfma_f32_16x16x32_bf16 a[40:43], v[144:147], a[208:211], a[40:43]
  v_exp_f32 v240, v240
  v_mfma_f32_16x16x32_bf16 a[8:11], v[128:131], a[208:211], a[8:11]
  ds_read_b64_tr_b16 a[254:255], v21 offset:12288
  v_mfma_f32_16x16x32_bf16 a[8:11], v[136:139], a[212:215], a[8:11]
  v_exp_f32 v241, v241
  v_mfma_f32_16x16x32_bf16 a[12:15], v[136:139], a[220:223], a[12:15]
  v_exp_f32 v242, v242
  v_mfma_f32_16x16x32_bf16 a[12:15], v[128:131], a[216:219], a[12:15]
  v_exp_f32 v243, v243
  v_mfma_f32_16x16x32_bf16 a[44:47], v[144:147], a[216:219], a[44:47]
  v_exp_f32 v244, v244
  v_mfma_f32_16x16x32_bf16 a[44:47], v[152:155], a[220:223], a[44:47]
  s_waitcnt vmcnt(7) lgkmcnt(0)
  s_cmpk_lt_i32 s9, 0x0
  s_cbranch_scc0 L_fb0_9
  s_waitcnt vmcnt(3)
L_fb0_9:
  s_barrier
  v_mfma_f32_16x16x32_bf16 a[76:79], v[168:171], a[220:223], a[76:79]
  s_add_u32 m0, s30, 52224
  s_xor_b32 s40, s32, 0x1400
  ds_read_b128 a[192:195], v10 offset:32768
  v_cvt_pk_bf16_f32 v240, v240, v241
  v_mfma_f32_16x16x32_bf16 a[76:79], v[160:163], a[216:219], a[76:79]
  s_waitcnt vmcnt(6)
  buffer_load_dwordx4 v25, s[16:19], s40 offen nt lds
  v_mfma_f32_16x16x32_bf16 a[108:111], v[176:179], a[216:219], a[108:111]
  v_exp_f32 v245, v245
  v_mfma_f32_16x16x32_bf16 a[108:111], v[184:187], a[220:223], a[108:111]
  v_exp_f32 v246, v246
  v_mfma_f32_16x16x32_bf16 v[2:5], v[32:35], v[2:5], 0
  v_exp_f32 v247, v247
  v_mfma_f32_16x16x32_bf16 a[112:115], v[184:187], a[228:231], a[112:115]
  ds_read_b128 a[196:199], v11 offset:32768
  v_cvt_pk_bf16_f32 v241, v242, v243
  v_mfma_f32_16x16x32_bf16 a[112:115], v[176:179], a[224:227], a[112:115]
  v_exp_f32 v200, v200
  v_mfma_f32_16x16x32_bf16 a[80:83], v[160:163], a[224:227], a[80:83]
  v_exp_f32 v201, v201
  v_mfma_f32_16x16x32_bf16 a[80:83], v[168:171], a[228:231], a[80:83]
  v_cvt_pk_bf16_f32 v104, v2, v3
  v_cvt_pk_bf16_f32 v242, v244, v245
  v_mfma_f32_16x16x32_bf16 a[48:51], v[152:155], a[228:231], a[48:51]
  ds_read_b128 a[200:203], v12 offset:32768
  v_cvt_pk_bf16_f32 v105, v4, v5
  v_mfma_f32_16x16x32_bf16 a[48:51], v[144:147], a[224:227], a[48:51]
  v_exp_f32 v202, v202
  v_mfma_f32_16x16x32_bf16 a[16:19], v[128:131], a[224:227], a[16:19]
  ds_read2_b64 v[6:9], v30 offset0:1 offset1:1
  v_cvt_pk_bf16_f32 v243, v246, v247
  v_mfma_f32_16x16x32_bf16 a[16:19], v[136:139], a[228:231], a[16:19]
  v_xor_b32 v30, 0x1000, v30
  v_cvt_pk_bf16_f32 v200, v200, v201
  v_mfma_f32_16x16x32_bf16 a[20:23], v[136:139], a[236:239], a[20:23]
  s_add_u32 m0, s30, 98304
  s_xor_b32 s40, s32, 0x11800
  ds_read_b128 a[204:207], v13 offset:32768
  v_mfma_f32_16x16x32_bf16 a[20:23], v[128:131], a[232:235], a[20:23]
  s_waitcnt vmcnt(6)
  buffer_load_dwordx4 v22, s[20:23], s40 offen nt lds
  v_mfma_f32_16x16x32_bf16 a[52:55], v[144:147], a[232:235], a[52:55]
  v_exp_f32 v203, v203
  v_mfma_f32_16x16x32_bf16 a[52:55], v[152:155], a[236:239], a[52:55]
  v_exp_f32 v204, v204
  v_mfma_f32_16x16x32_bf16 a[84:87], v[168:171], a[236:239], a[84:87]
  ds_read_b128 a[208:211], v10 offset:36864
  v_cvt_pk_bf16_f32 v201, v202, v203
  v_mfma_f32_16x16x32_bf16 a[84:87], v[160:163], a[232:235], a[84:87]
  v_exp_f32 v205, v205
  v_mfma_f32_16x16x32_bf16 a[116:119], v[176:179], a[232:235], a[116:119]
  v_exp_f32 v206, v206
  v_mfma_f32_16x16x32_bf16 a[116:119], v[184:187], a[236:239], a[116:119]
  v_exp_f32 v207, v207
  s_waitcnt lgkmcnt(2)
  v_mfma_f32_16x16x32_bf16 v[6:9], v[32:35], v[6:9], 0
  v_exp_f32 v216, v216
  v_mfma_f32_16x16x32_bf16 a[120:123], v[184:187], a[244:247], a[120:123]
  ds_read_b128 a[212:215], v11 offset:36864
  v_cvt_pk_bf16_f32 v202, v204, v205
  v_mfma_f32_16x16x32_bf16 a[120:123], v[176:179], a[240:243], a[120:123]
  v_exp_f32 v217, v217
  v_mfma_f32_16x16x32_bf16 a[88:91], v[160:163], a[240:243], a[88:91]
  v_exp_f32 v218, v218
  v_mfma_f32_16x16x32_bf16 a[88:91], v[168:171], a[244:247], a[88:91]
  v_cvt_pk_bf16_f32 v106, v6, v7
  v_cvt_pk_bf16_f32 v203, v206, v207
  v_mfma_f32_16x16x32_bf16 a[56:59], v[152:155], a[244:247], a[56:59]
  ds_read_b128 a[216:219], v12 offset:36864
  v_cvt_pk_bf16_f32 v107, v8, v9
  v_mfma_f32_16x16x32_bf16 a[56:59], v[144:147], a[240:243], a[56:59]
  s_add_u32 m0, s30, 99328
  s_xor_b32 s40, s32, 0x11400
  v_exp_f32 v219, v219
  v_mfma_f32_16x16x32_bf16 a[24:27], v[128:131], a[240:243], a[24:27]
  s_waitcnt vmcnt(6)
  buffer_load_dwordx4 v23, s[20:23], s40 offen nt lds
  v_mfma_f32_16x16x32_bf16 a[24:27], v[136:139], a[244:247], a[24:27]
  v_exp_f32 v220, v220
  v_mfma_f32_16x16x32_bf16 a[28:31], v[136:139], a[252:255], a[28:31]
  ds_read_b128 a[220:223], v13 offset:36864
  v_cvt_pk_bf16_f32 v216, v216, v217
  v_mfma_f32_16x16x32_bf16 a[28:31], v[128:131], a[248:251], a[28:31]
  ds_read2_b64 v[2:5], v31 offset0:0 offset1:0
  v_cvt_pk_bf16_f32 v217, v218, v219
  v_mfma_f32_16x16x32_bf16 a[60:63], v[144:147], a[248:251], a[60:63]
  v_exp_f32 v221, v221
  v_mfma_f32_16x16x32_bf16 a[60:63], v[152:155], a[252:255], a[60:63]
  v_exp_f32 v222, v222
  v_mfma_f32_16x16x32_bf16 a[92:95], v[168:171], a[252:255], a[92:95]
  v_exp_f32 v223, v223
  v_mfma_f32_16x16x32_bf16 a[92:95], v[160:163], a[248:251], a[92:95]
  v_exp_f32 v232, v232
  v_mfma_f32_16x16x32_bf16 a[124:127], v[176:179], a[248:251], a[124:127]
  v_exp_f32 v233, v233
  v_mfma_f32_16x16x32_bf16 a[124:127], v[184:187], a[252:255], a[124:127]
  s_waitcnt lgkmcnt(1)
  v_exp_f32 v234, v234
  v_mfma_f32_16x16x32_bf16 v[176:179], a[192:195], a[176:179], 0
  v_exp_f32 v235, v235
  v_mfma_f32_16x16x32_bf16 v[176:179], a[196:199], a[180:183], v[176:179]
  ds_read_b128 a[224:227], v10 offset:40960
  v_cvt_pk_bf16_f32 v218, v220, v221
  v_mfma_f32_16x16x32_bf16 v[176:179], a[200:203], a[184:187], v[176:179]
  s_add_u32 m0, s30, 100352
  s_xor_b32 s40, s32, 0x1c00
  v_exp_f32 v236, v236
  v_mfma_f32_16x16x32_bf16 v[176:179], a[204:207], a[188:191], v[176:179]
  s_waitcnt vmcnt(6)
  buffer_load_dwordx4 v24, s[20:23], s40 offen nt lds
  s_waitcnt lgkmcnt(1)
  v_mfma_f32_16x16x32_bf16 v[2:5], v[32:35], v[2:5], 0
  v_exp_f32 v237, v237
  v_mfma_f32_16x16x32_bf16 v[160:163], a[204:207], a[172:175], 0
  ds_read_b128 a[228:231], v11 offset:40960
  v_cvt_pk_bf16_f32 v219, v222, v223
  v_mfma_f32_16x16x32_bf16 v[160:163], a[200:203], a[168:171], v[160:163]
  v_exp_f32 v238, v238
  v_mfma_f32_16x16x32_bf16 v[160:163], a[196:199], a[164:167], v[160:163]
  v_exp_f32 v239, v239
  v_mfma_f32_16x16x32_bf16 v[160:163], a[192:195], a[160:163], v[160:163]
  ds_read_b128 a[232:235], v12 offset:40960
  v_cvt_pk_bf16_f32 v108, v2, v3
  v_mfma_f32_16x16x32_bf16 v[144:147], a[192:195], a[144:147], 0
  v_cvt_pk_bf16_f32 v109, v4, v5
  v_cvt_pk_bf16_f32 v232, v232, v233
  v_mfma_f32_16x16x32_bf16 v[144:147], a[196:199], a[148:151], v[144:147]
  v_exp_f32 v248, v248
  v_mfma_f32_16x16x32_bf16 v[144:147], a[200:203], a[152:155], v[144:147]
  ds_read_b128 a[236:239], v13 offset:40960
  v_cvt_pk_bf16_f32 v233, v234, v235
  v_mfma_f32_16x16x32_bf16 v[144:147], a[204:207], a[156:159], v[144:147]
  v_exp_f32 v249, v249
  v_mfma_f32_16x16x32_bf16 v[128:131], a[204:207], a[140:143], 0
  ds_read2_b64 v[6:9], v31 offset0:1 offset1:1
  v_cvt_pk_bf16_f32 v234, v236, v237
  v_mfma_f32_16x16x32_bf16 v[128:131], a[200:203], a[136:139], v[128:131]
  ds_read_b128 a[240:243], v10 offset:45056
  v_xor_b32 v31, 0x1000, v31
  v_mfma_f32_16x16x32_bf16 v[128:131], a[196:199], a[132:135], v[128:131]
  s_add_u32 m0, s30, 101376
  s_xor_b32 s40, s32, 0x1000
  v_exp_f32 v250, v250
  v_mfma_f32_16x16x32_bf16 v[128:131], a[192:195], a[128:131], v[128:131]
  s_waitcnt vmcnt(6)
  buffer_load_dwordx4 v25, s[20:23], s40 offen nt lds
  v_mfma_f32_16x16x32_bf16 v[132:135], a[208:211], a[128:131], 0
  ds_read_b128 a[244:247], v11 offset:45056
  v_cvt_pk_bf16_f32 v235, v238, v239
  v_mfma_f32_16x16x32_bf16 v[132:135], a[212:215], a[132:135], v[132:135]
  v_exp_f32 v251, v251
  v_mfma_f32_16x16x32_bf16 v[132:135], a[216:219], a[136:139], v[132:135]
  v_exp_f32 v252, v252
  v_mfma_f32_16x16x32_bf16 v[132:135], a[220:223], a[140:143], v[132:135]
  ds_read_b128 a[248:251], v12 offset:45056
  v_cvt_pk_bf16_f32 v248, v248, v249
  v_mfma_f32_16x16x32_bf16 v[148:151], a[220:223], a[156:159], 0
  v_exp_f32 v253, v253
  v_mfma_f32_16x16x32_bf16 v[148:151], a[216:219], a[152:155], v[148:151]
  v_exp_f32 v254, v254
  v_mfma_f32_16x16x32_bf16 v[148:151], a[212:215], a[148:151], v[148:151]
  ds_read_b128 a[252:255], v13 offset:45056
  v_cvt_pk_bf16_f32 v249, v250, v251
  v_mfma_f32_16x16x32_bf16 v[148:151], a[208:211], a[144:147], v[148:151]
  v_exp_f32 v255, v255
  s_waitcnt lgkmcnt(4)
  v_mfma_f32_16x16x32_bf16 v[6:9], v[32:35], v[6:9], 0
  v_cvt_pk_bf16_f32 v250, v252, v253
  v_cvt_pk_bf16_f32 v251, v254, v255
  v_mfma_f32_16x16x32_bf16 v[164:167], a[208:211], a[160:163], 0
  v_exp_f32 v128, v128
  v_mfma_f32_16x16x32_bf16 v[164:167], a[212:215], a[164:167], v[164:167]
  v_exp_f32 v129, v129
  v_mfma_f32_16x16x32_bf16 v[164:167], a[216:219], a[168:171], v[164:167]
  v_exp_f32 v130, v130
  v_mfma_f32_16x16x32_bf16 v[164:167], a[220:223], a[172:175], v[164:167]
  v_cvt_pk_bf16_f32 v110, v6, v7
  v_cvt_pk_bf16_f32 v128, v128, v129
  v_mfma_f32_16x16x32_bf16 v[180:183], a[220:223], a[188:191], 0
  s_add_u32 m0, s30, 0
  s_xor_b32 s40, s33, 0x0
  v_cvt_pk_bf16_f32 v111, v8, v9
  v_mfma_f32_16x16x32_bf16 v[180:183], a[216:219], a[184:187], v[180:183]
  s_waitcnt vmcnt(6)
  buffer_load_dwordx4 v22, s[16:19], s40 offen nt lds
  v_mfma_f32_16x16x32_bf16 v[180:183], a[212:215], a[180:183], v[180:183]
  v_exp_f32 v131, v131
  v_mfma_f32_16x16x32_bf16 v[180:183], a[208:211], a[176:179], v[180:183]
  s_waitcnt vmcnt(7) lgkmcnt(0)
  s_cmpk_lt_i32 s10, 0x0
  s_cbranch_scc0 L_fb0_10
  s_waitcnt vmcnt(4)
L_fb0_10:
  s_barrier
  v_mfma_f32_16x16x32_bf16 v[184:187], a[224:227], a[176:179], 0
  ds_read_b64_tr_b16 a[192:193], v14 offset:16384
  v_cvt_pk_bf16_f32 v129, v130, v131
  v_mfma_f32_16x16x32_bf16 v[184:187], a[228:231], a[180:183], v[184:187]
  s_waitcnt vmcnt(9)
  ds_read2_b64 v[2:5], v28 offset0:0 offset1:0
  v_mfma_f32_16x16x32_bf16 v[184:187], a[232:235], a[184:187], v[184:187]
  ds_read_b64_tr_b16 a[194:195], v14 offset:20480
  v_mfma_f32_16x16x32_bf16 v[184:187], a[236:239], a[188:191], v[184:187]
  v_exp_f32 v132, v132
  v_mfma_f32_16x16x32_bf16 v[168:171], a[236:239], a[172:175], 0
  ds_read_b64_tr_b16 a[196:197], v14 offset:24576
  v_mfma_f32_16x16x32_bf16 v[168:171], a[232:235], a[168:171], v[168:171]
  v_exp_f32 v133, v133
  v_mfma_f32_16x16x32_bf16 v[168:171], a[228:231], a[164:167], v[168:171]
  ds_read_b64_tr_b16 a[198:199], v14 offset:28672
  v_cvt_pk_bf16_f32 v130, v132, v133
  v_mfma_f32_16x16x32_bf16 v[168:171], a[224:227], a[160:163], v[168:171]
  v_exp_f32 v134, v134
  v_mfma_f32_16x16x32_bf16 v[152:155], a[224:227], a[144:147], 0
  s_add_u32 m0, s30, 1024
  s_xor_b32 s40, s33, 0xc00
  ds_read_b64_tr_b16 a[200:201], v15 offset:16384
  v_mfma_f32_16x16x32_bf16 v[152:155], a[228:231], a[148:151], v[152:155]
  s_waitcnt vmcnt(6)
  buffer_load_dwordx4 v23, s[16:19], s40 offen nt lds
  v_mfma_f32_16x16x32_bf16 v[152:155], a[232:235], a[152:155], v[152:155]
  ds_read_b64_tr_b16 a[202:203], v15 offset:20480
  v_mfma_f32_16x16x32_bf16 v[152:155], a[236:239], a[156:159], v[152:155]
  v_exp_f32 v135, v135
  s_waitcnt lgkmcnt(5)
  v_mfma_f32_16x16x32_bf16 v[2:5], v[32:35], v[2:5], 0
  v_exp_f32 v144, v144
  v_mfma_f32_16x16x32_bf16 v[136:139], a[236:239], a[140:143], 0
  ds_read_b64_tr_b16 a[204:205], v15 offset:24576
  v_cvt_pk_bf16_f32 v131, v134, v135
  v_mfma_f32_16x16x32_bf16 v[136:139], a[232:235], a[136:139], v[136:139]
  v_exp_f32 v145, v145
  v_mfma_f32_16x16x32_bf16 v[136:139], a[228:231], a[132:135], v[136:139]
  ds_read_b64_tr_b16 a[206:207], v15 offset:28672
  v_cvt_pk_bf16_f32 v144, v144, v145
  v_mfma_f32_16x16x32_bf16 v[136:139], a[224:227], a[128:131], v[136:139]
  v_cvt_pk_bf16_f32 v112, v2, v3
  v_mfma_f32_16x16x32_bf16 v[140:143], a[240:243], a[128:131], 0
  ds_read_b64_tr_b16 a[208:209], v16 offset:16384
  v_cvt_pk_bf16_f32 v113, v4, v5
  v_mfma_f32_16x16x32_bf16 v[140:143], a[244:247], a[132:135], v[140:143]
  v_exp_f32 v146, v146
  v_mfma_f32_16x16x32_bf16 v[140:143], a[248:251], a[136:139], v[140:143]
  ds_read_b64_tr_b16 a[210:211], v16 offset:20480
  v_mfma_f32_16x16x32_bf16 v[140:143], a[252:255], a[140:143], v[140:143]
  ds_read2_b64 v[6:9], v28 offset0:1 offset1:1
  v_mfma_f32_16x16x32_bf16 v[156:159], a[252:255], a[156:159], 0
  s_add_u32 m0, s30, 2048
  s_xor_b32 s40, s33, 0x10400
  ds_read_b64_tr_b16 a[212:213], v16 offset:24576
  v_xor_b32 v28, 0x1000, v28
  v_mfma_f32_16x16x32_bf16 v[156:159], a[248:251], a[152:155], v[156:159]
  s_waitcnt vmcnt(6)
  buffer_load_dwordx4 v24, s[16:19], s40 offen nt lds
  v_mfma_f32_16x16x32_bf16 v[156:159], a[244:247], a[148:151], v[156:159]
  ds_read_b64_tr_b16 a[214:215], v16 offset:28672
  v_mfma_f32_16x16x32_bf16 v[156:159], a[240:243], a[144:147], v[156:159]
  v_exp_f32 v147, v147
  v_mfma_f32_16x16x32_bf16 v[172:175], a[240:243], a[160:163], 0
  ds_read_b64_tr_b16 a[216:217], v17 offset:16384
  v_cvt_pk_bf16_f32 v145, v146, v147
  v_mfma_f32_16x16x32_bf16 v[172:175], a[244:247], a[164:167], v[172:175]
  v_exp_f32 v148, v148
  v_mfma_f32_16x16x32_bf16 v[172:175], a[248:251], a[168:171], v[172:175]
  ds_read_b64_tr_b16 a[218:219], v17 offset:20480
  v_mfma_f32_16x16x32_bf16 v[172:175], a[252:255], a[172:175], v[172:175]
  v_exp_f32 v149, v149
  s_waitcnt lgkmcnt(4)
  v_mfma_f32_16x16x32_bf16 v[6:9], v[32:35], v[6:9], 0
  v_exp_f32 v150, v150
  v_mfma_f32_16x16x32_bf16 v[188:191], a[252:255], a[188:191], 0
  ds_read_b64_tr_b16 a[220:221], v17 offset:24576
  v_cvt_pk_bf16_f32 v146, v148, v149
  v_mfma_f32_16x16x32_bf16 v[188:191], a[248:251], a[184:187], v[188:191]
  v_exp_f32 v151, v151
  v_mfma_f32_16x16x32_bf16 v[188:191], a[244:247], a[180:183], v[188:191]
  ds_read_b64_tr_b16 a[222:223], v17 offset:28672
  v_cvt_pk_bf16_f32 v147, v150, v151
  v_mfma_f32_16x16x32_bf16 v[188:191], a[240:243], a[176:179], v[188:191]
  v_cvt_pk_bf16_f32 v114, v6, v7
  v_mfma_f32_16x16x32_bf16 v[48:51], v[44:47], v[192:195], v[48:51]
  s_add_u32 m0, s30, 3072
  s_xor_b32 s40, s33, 0x10800
  ds_read_b64_tr_b16 a[224:225], v18 offset:16384
  v_cvt_pk_bf16_f32 v115, v8, v9
  v_mfma_f32_16x16x32_bf16 v[48:51], v[44:47], v[200:203], v[48:51]
  s_waitcnt vmcnt(6)
  buffer_load_dwordx4 v25, s[16:19], s40 offen nt lds
  v_mfma_f32_16x16x32_bf16 v[52:55], v[44:47], v[208:211], v[52:55]
  ds_read_b64_tr_b16 a[226:227], v18 offset:20480
  v_mfma_f32_16x16x32_bf16 v[52:55], v[44:47], v[216:219], v[52:55]
  v_mov_b32 v252, 1
  v_mfma_f32_16x16x32_bf16 v[56:59], v[44:47], v[224:227], v[56:59]
  ds_read_b64_tr_b16 a[228:229], v18 offset:24576
  v_mfma_f32_16x16x32_bf16 v[56:59], v[44:47], v[232:235], v[56:59]
  s_waitcnt vmcnt(6)
  buffer_atomic_add v252, v26, s[4:7], 0 offen sc0 sc1
  v_mfma_f32_16x16x32_bf16 v[60:63], v[44:47], v[240:243], v[60:63]
  ds_read_b64_tr_b16 a[230:231], v18 offset:28672
  v_mfma_f32_16x16x32_bf16 v[60:63], v[44:47], v[248:251], v[60:63]
  s_waitcnt lgkmcnt(4)
  ds_read2_b64 v[2:5], v29 offset0:0 offset1:0
  v_mfma_f32_16x16x32_bf16 a[96:99], v[248:251], a[196:199], a[96:99]
  ds_read_b64_tr_b16 a[232:233], v19 offset:16384
  v_mfma_f32_16x16x32_bf16 a[96:99], v[240:243], a[192:195], a[96:99]
  v_exp_f32 v160, v160
  v_mfma_f32_16x16x32_bf16 a[64:67], v[224:227], a[192:195], a[64:67]
  ds_read_b64_tr_b16 a[234:235], v19 offset:20480
  v_mfma_f32_16x16x32_bf16 a[64:67], v[232:235], a[196:199], a[64:67]
  v_exp_f32 v161, v161
  v_mfma_f32_16x16x32_bf16 a[32:35], v[216:219], a[196:199], a[32:35]
  ds_read_b64_tr_b16 a[236:237], v19 offset:24576
  v_cvt_pk_bf16_f32 v160, v160, v161
  v_mfma_f32_16x16x32_bf16 a[32:35], v[208:211], a[192:195], a[32:35]
  v_exp_f32 v162, v162
  v_mfma_f32_16x16x32_bf16 a[0:3], v[192:195], a[192:195], a[0:3]
  s_add_u32 m0, s30, 114688
  s_xor_b32 s40, s32, 0x11c00
  ds_read_b64_tr_b16 a[238:239], v19 offset:28672
  v_mfma_f32_16x16x32_bf16 a[0:3], v[200:203], a[196:199], a[0:3]
  s_waitcnt vmcnt(6)
  buffer_load_dwordx4 v22, s[20:23], s40 offen nt lds
  s_waitcnt lgkmcnt(4)
  v_mfma_f32_16x16x32_bf16 v[2:5], v[32:35], v[2:5], 0
  v_exp_f32 v163, v163
  v_mfma_f32_16x16x32_bf16 a[4:7], v[200:203], a[204:207], a[4:7]
  ds_read_b64_tr_b16 a[240:241], v20 offset:16384
  v_cvt_pk_bf16_f32 v161, v162, v163
  v_mfma_f32_16x16x32_bf16 a[4:7], v[192:195], a[200:203], a[4:7]
  v_exp_f32 v164, v164
  v_mfma_f32_16x16x32_bf16 a[36:39], v[208:211], a[200:203], a[36:39]
  ds_read_b64_tr_b16 a[242:243], v20 offset:20480
  v_mfma_f32_16x16x32_bf16 a[36:39], v[216:219], a[204:207], a[36:39]
  v_cvt_pk_bf16_f32 v116, v2, v3
  v_mfma_f32_16x16x32_bf16 a[68:71], v[232:235], a[204:207], a[68:71]
  ds_read_b64_tr_b16 a[244:245], v20 offset:24576
  v_cvt_pk_bf16_f32 v117, v4, v5
  v_mfma_f32_16x16x32_bf16 a[68:71], v[224:227], a[200:203], a[68:71]
  v_exp_f32 v165, v165
  v_mfma_f32_16x16x32_bf16 a[100:103], v[240:243], a[200:203], a[100:103]
  ds_read_b64_tr_b16 a[246:247], v20 offset:28672
  v_cvt_pk_bf16_f32 v162, v164, v165
  v_mfma_f32_16x16x32_bf16 a[100:103], v[248:251], a[204:207], a[100:103]
  v_exp_f32 v166, v166
  v_mfma_f32_16x16x32_bf16 a[104:107], v[248:251], a[212:215], a[104:107]
  ds_read_b64_tr_b16 a[248:249], v21 offset:16384
  v_mfma_f32_16x16x32_bf16 a[104:107], v[240:243], a[208:211], a[104:107]
  ds_read2_b64 v[6:9], v29 offset0:1 offset1:1
  v_mfma_f32_16x16x32_bf16 a[72:75], v[224:227], a[208:211], a[72:75]
  s_add_u32 m0, s30, 115712
  s_xor_b32 s40, s32, 0x11000
  ds_read_b64_tr_b16 a[250:251], v21 offset:20480
  v_xor_b32 v29, 0x1000, v29
  v_mfma_f32_16x16x32_bf16 a[72:75], v[232:235], a[212:215], a[72:75]
  s_waitcnt vmcnt(6)
  buffer_load_dwordx4 v23, s[20:23], s40 offen nt lds
  v_mfma_f32_16x16x32_bf16 a[40:43], v[216:219], a[212:215], a[40:43]
  ds_read_b64_tr_b16 a[252:253], v21 offset:24576
  v_mfma_f32_16x16x32_bf16 a[40:43], v[208:211], a[208:211], a[40:43]
  v_exp_f32 v167, v167
  v_mfma_f32_16x16x32_bf16 a[8:11], v[192:195], a[208:211], a[8:11]
  ds_read_b64_tr_b16 a[254:255], v21 offset:28672
  v_cvt_pk_bf16_f32 v163, v166, v167
  v_mfma_f32_16x16x32_bf16 a[8:11], v[200:203], a[212:215], a[8:11]
  v_exp_f32 v176, v176
  v_mfma_f32_16x16x32_bf16 a[12:15], v[200:203], a[220:223], a[12:15]
  v_exp_f32 v177, v177
  v_mfma_f32_16x16x32_bf16 a[12:15], v[192:195], a[216:219], a[12:15]
  v_exp_f32 v178, v178
  v_mfma_f32_16x16x32_bf16 a[44:47], v[208:211], a[216:219], a[44:47]
  v_exp_f32 v179, v179
  v_mfma_f32_16x16x32_bf16 a[44:47], v[216:219], a[220:223], a[44:47]
  s_waitcnt vmcnt(7) lgkmcnt(0)
  s_cmpk_lt_i32 s11, 0x0
  s_cbranch_scc0 L_fb0_11
  s_waitcnt vmcnt(4)
L_fb0_11:
  s_barrier
  v_mfma_f32_16x16x32_bf16 a[76:79], v[232:235], a[220:223], a[76:79]
  ds_read_b128 a[192:195], v10 offset:49152
  v_cvt_pk_bf16_f32 v176, v176, v177
  v_mfma_f32_16x16x32_bf16 a[76:79], v[224:227], a[216:219], a[76:79]
  v_exp_f32 v180, v180
  v_mfma_f32_16x16x32_bf16 a[108:111], v[240:243], a[216:219], a[108:111]
  s_add_u32 m0, s30, 116736
  s_xor_b32 s40, s32, 0x1800
  v_exp_f32 v181, v181
  v_mfma_f32_16x16x32_bf16 a[108:111], v[248:251], a[220:223], a[108:111]
  s_waitcnt vmcnt(6)
  buffer_load_dwordx4 v24, s[20:23], s40 offen nt lds
  v_mfma_f32_16x16x32_bf16 v[6:9], v[32:35], v[6:9], 0
  v_exp_f32 v182, v182
  v_mfma_f32_16x16x32_bf16 a[112:115], v[248:251], a[228:231], a[112:115]
  ds_read_b128 a[196:199], v11 offset:49152
  v_cvt_pk_bf16_f32 v177, v178, v179
  v_mfma_f32_16x16x32_bf16 a[112:115], v[240:243], a[224:227], a[112:115]
  v_exp_f32 v183, v183
  v_mfma_f32_16x16x32_bf16 a[80:83], v[224:227], a[224:227], a[80:83]
  v_exp_f32 v136, v136
  v_mfma_f32_16x16x32_bf16 a[80:83], v[232:235], a[228:231], a[80:83]
  v_cvt_pk_bf16_f32 v118, v6, v7
  v_cvt_pk_bf16_f32 v178, v180, v181
  v_mfma_f32_16x16x32_bf16 a[48:51], v[216:219], a[228:231], a[48:51]
  ds_read_b128 a[200:203], v12 offset:49152
  v_cvt_pk_bf16_f32 v119, v8, v9
  v_mfma_f32_16x16x32_bf16 a[48:51], v[208:211], a[224:227], a[48:51]
  ds_read2_b64 v[2:5], v30 offset0:0 offset1:0
  v_cvt_pk_bf16_f32 v179, v182, v183
  v_mfma_f32_16x16x32_bf16 a[16:19], v[192:195], a[224:227], a[16:19]
  v_exp_f32 v137, v137
  v_mfma_f32_16x16x32_bf16 a[16:19], v[200:203], a[228:231], a[16:19]
  v_exp_f32 v138, v138
  v_mfma_f32_16x16x32_bf16 a[20:23], v[200:203], a[236:239], a[20:23]
  ds_read_b128 a[204:207], v13 offset:49152
  v_cvt_pk_bf16_f32 v136, v136, v137
  v_mfma_f32_16x16x32_bf16 a[20:23], v[192:195], a[232:235], a[20:23]
  v_exp_f32 v139, v139
  v_mfma_f32_16x16x32_bf16 a[52:55], v[208:211], a[232:235], a[52:55]
  v_exp_f32 v140, v140
  v_mfma_f32_16x16x32_bf16 a[52:55], v[216:219], a[236:239], a[52:55]
  v_exp_f32 v141, v141
  v_mfma_f32_16x16x32_bf16 a[84:87], v[232:235], a[236:239], a[84:87]
  s_add_u32 m0, s30, 117760
  s_xor_b32 s40, s32, 0x1400
  ds_read_b128 a[208:211], v10 offset:53248
  v_cvt_pk_bf16_f32 v137, v138, v139
  v_mfma_f32_16x16x32_bf16 a[84:87], v[224:227], a[232:235], a[84:87]
  s_waitcnt vmcnt(6)
  buffer_load_dwordx4 v25, s[20:23], s40 offen nt lds
  v_mfma_f32_16x16x32_bf16 a[116:119], v[240:243], a[232:235], a[116:119]
  v_exp_f32 v142, v142
  v_mfma_f32_16x16x32_bf16 a[116:119], v[248:251], a[236:239], a[116:119]
  v_exp_f32 v143, v143
  s_waitcnt lgkmcnt(2)
  v_mfma_f32_16x16x32_bf16 v[2:5], v[32:35], v[2:5], 0
  v_exp_f32 v152, v152
  v_mfma_f32_16x16x32_bf16 a[120:123], v[248:251], a[244:247], a[120:123]
  ds_read_b128 a[212:215], v11 offset:53248
  v_cvt_pk_bf16_f32 v138, v140, v141
  v_mfma_f32_16x16x32_bf16 a[120:123], v[240:243], a[240:243], a[120:123]
  v_exp_f32 v153, v153
  v_mfma_f32_16x16x32_bf16 a[88:91], v[224:227], a[240:243], a[88:91]
  v_exp_f32 v154, v154
  v_mfma_f32_16x16x32_bf16 a[88:91], v[232:235], a[244:247], a[88:91]
  v_cvt_pk_bf16_f32 v120, v2, v3
  v_cvt_pk_bf16_f32 v139, v142, v143
  v_mfma_f32_16x16x32_bf16 a[56:59], v[216:219], a[244:247], a[56:59]
  ds_read_b128 a[216:219], v12 offset:53248
  v_cvt_pk_bf16_f32 v121, v4, v5
  v_mfma_f32_16x16x32_bf16 a[56:59], v[208:211], a[240:243], a[56:59]
  v_exp_f32 v155, v155
  v_mfma_f32_16x16x32_bf16 a[24:27], v[192:195], a[240:243], a[24:27]
  v_exp_f32 v156, v156
  v_mfma_f32_16x16x32_bf16 a[24:27], v[200:203], a[244:247], a[24:27]
  v_exp_f32 v157, v157
  v_mfma_f32_16x16x32_bf16 a[28:31], v[200:203], a[252:255], a[28:31]
  ds_read_b128 a[220:223], v13 offset:53248
  v_cvt_pk_bf16_f32 v152, v152, v153
  v_mfma_f32_16x16x32_bf16 a[28:31], v[192:195], a[248:251], a[28:31]
  ds_read2_b64 v[6:9], v30 offset0:1 offset1:1
  v_cvt_pk_bf16_f32 v153, v154, v155
  v_mfma_f32_16x16x32_bf16 a[60:63], v[208:211], a[248:251], a[60:63]
  s_add_u32 m0, s30, 16384
  s_xor_b32 s40, s33, 0x400
  v_xor_b32 v30, 0x1000, v30
  v_cvt_pk_bf16_f32 v154, v156, v157
  v_mfma_f32_16x16x32_bf16 a[60:63], v[216:219], a[252:255], a[60:63]
  s_waitcnt vmcnt(6)
  buffer_load_dwordx4 v22, s[16:19], s40 offen nt lds
  v_mfma_f32_16x16x32_bf16 a[92:95], v[232:235], a[252:255], a[92:95]
  v_exp_f32 v158, v158
  v_mfma_f32_16x16x32_bf16 a[92:95], v[224:227], a[248:251], a[92:95]
  v_exp_f32 v159, v159
  v_mfma_f32_16x16x32_bf16 a[124:127], v[240:243], a[248:251], a[124:127]
  v_exp_f32 v168, v168
  v_mfma_f32_16x16x32_bf16 a[124:127], v[248:251], a[252:255], a[124:127]
  s_waitcnt lgkmcnt(1)
  v_exp_f32 v169, v169
  v_mfma_f32_16x16x32_bf16 v[240:243], a[192:195], a[176:179], 0
L_pg5:
  s_cbranch_execz L_rt0
  v_exp_f32 v170, v170
  v_mfma_f32_16x16x32_bf16 v[240:243], a[196:199], a[180:183], v[240:243]
  ds_read_b128 a[224:227], v10 offset:57344
  v_cvt_pk_bf16_f32 v155, v158, v159
  v_mfma_f32_16x16x32_bf16 v[240:243], a[200:203], a[184:187], v[240:243]
  v_exp_f32 v171, v171
  v_mfma_f32_16x16x32_bf16 v[240:243], a[204:207], a[188:191], v[240:243]
  v_exp_f32 v172, v172
  s_waitcnt lgkmcnt(1)
  v_mfma_f32_16x16x32_bf16 v[6:9], v[32:35], v[6:9], 0
  v_exp_f32 v173, v173
  v_mfma_f32_16x16x32_bf16 v[224:227], a[204:207], a[172:175], 0
  s_add_u32 m0, s30, 17408
  s_xor_b32 s40, s33, 0x800
  ds_read_b128 a[228:231], v11 offset:57344
  v_cvt_pk_bf16_f32 v168, v168, v169
  v_mfma_f32_16x16x32_bf16 v[224:227], a[200:203], a[168:171], v[224:227]
  s_waitcnt vmcnt(6)
  buffer_load_dwordx4 v23, s[16:19], s40 offen nt lds
  v_mfma_f32_16x16x32_bf16 v[224:227], a[196:199], a[164:167], v[224:227]
  v_exp_f32 v174, v174
  v_mfma_f32_16x16x32_bf16 v[224:227], a[192:195], a[160:163], v[224:227]
  ds_read_b128 a[232:235], v12 offset:57344
  v_cvt_pk_bf16_f32 v122, v6, v7
  v_mfma_f32_16x16x32_bf16 v[208:211], a[192:195], a[144:147], 0
  v_cvt_pk_bf16_f32 v123, v8, v9
  v_cvt_pk_bf16_f32 v169, v170, v171
  v_mfma_f32_16x16x32_bf16 v[208:211], a[196:199], a[148:151], v[208:211]
  v_exp_f32 v175, v175
  v_mfma_f32_16x16x32_bf16 v[208:211], a[200:203], a[152:155], v[208:211]
  ds_read_b128 a[236:239], v13 offset:57344
  v_cvt_pk_bf16_f32 v170, v172, v173
  v_mfma_f32_16x16x32_bf16 v[208:211], a[204:207], a[156:159], v[208:211]
  ds_read2_b64 v[2:5], v31 offset0:0 offset1:0
  v_cvt_pk_bf16_f32 v171, v174, v175
  v_mfma_f32_16x16x32_bf16 v[192:195], a[204:207], a[140:143], 0
  v_exp_f32 v184, v184
  v_mfma_f32_16x16x32_bf16 v[192:195], a[200:203], a[136:139], v[192:195]
  ds_read_b128 a[240:243], v10 offset:61440
  v_mfma_f32_16x16x32_bf16 v[192:195], a[196:199], a[132:135], v[192:195]
  v_exp_f32 v185, v185
  v_mfma_f32_16x16x32_bf16 v[192:195], a[192:195], a[128:131], v[192:195]
  v_exp_f32 v186, v186
  v_mfma_f32_16x16x32_bf16 v[196:199], a[208:211], a[128:131], 0
  ds_read_b128 a[244:247], v11 offset:61440
  v_cvt_pk_bf16_f32 v184, v184, v185
  v_mfma_f32_16x16x32_bf16 v[196:199], a[212:215], a[132:135], v[196:199]
  v_exp_f32 v187, v187
  v_mfma_f32_16x16x32_bf16 v[196:199], a[216:219], a[136:139], v[196:199]
  v_exp_f32 v188, v188
  v_mfma_f32_16x16x32_bf16 v[196:199], a[220:223], a[140:143], v[196:199]
  s_add_u32 m0, s30, 18432
  s_xor_b32 s40, s33, 0x10000
  ds_read_b128 a[248:251], v12 offset:61440
  v_cvt_pk_bf16_f32 v185, v186, v187
  s_waitcnt lgkmcnt(3)
  v_mfma_f32_16x16x32_bf16 v[2:5], v[32:35], v[2:5], 0
  v_exp_f32 v189, v189
  v_mfma_f32_16x16x32_bf16 v[212:215], a[220:223], a[156:159], 0
  s_waitcnt vmcnt(6)
  buffer_load_dwordx4 v24, s[16:19], s40 offen nt lds
  v_mfma_f32_16x16x32_bf16 v[212:215], a[216:219], a[152:155], v[212:215]
  v_exp_f32 v190, v190
  v_mfma_f32_16x16x32_bf16 v[212:215], a[212:215], a[148:151], v[212:215]
  ds_read_b128 a[252:255], v13 offset:61440
  v_cvt_pk_bf16_f32 v186, v188, v189
  v_mfma_f32_16x16x32_bf16 v[212:215], a[208:211], a[144:147], v[212:215]
  v_cvt_pk_bf16_f32 v124, v2, v3
  v_mfma_f32_16x16x32_bf16 v[228:231], a[208:211], a[160:163], 0
  v_cvt_pk_bf16_f32 v125, v4, v5
  v_mfma_f32_16x16x32_bf16 v[228:231], a[212:215], a[164:167], v[228:231]
  v_exp_f32 v191, v191
  v_mfma_f32_16x16x32_bf16 v[228:231], a[216:219], a[168:171], v[228:231]
  v_exp_f32 v192, v192
  v_mfma_f32_16x16x32_bf16 v[228:231], a[220:223], a[172:175], v[228:231]
  v_exp_f32 v193, v193
  v_mfma_f32_16x16x32_bf16 v[244:247], a[220:223], a[188:191], 0
  v_exp_f32 v194, v194
  v_mfma_f32_16x16x32_bf16 v[244:247], a[216:219], a[184:187], v[244:247]
  v_exp_f32 v195, v195
  v_mfma_f32_16x16x32_bf16 v[244:247], a[212:215], a[180:183], v[244:247]
  ds_read2_b64 v[6:9], v31 offset0:1 offset1:1
  v_cvt_pk_bf16_f32 v187, v190, v191
  v_mfma_f32_16x16x32_bf16 v[244:247], a[208:211], a[176:179], v[244:247]
  s_waitcnt vmcnt(7) lgkmcnt(0)
  s_cmpk_lt_i32 s8, 0x0
  s_cbranch_scc0 L_fb0_12
  s_waitcnt vmcnt(4)
L_fb0_12:
  s_barrier
  v_mfma_f32_16x16x32_bf16 v[248:251], a[224:227], a[176:179], 0
  s_add_u32 m0, s30, 19456
  s_xor_b32 s40, s33, 0x10c00
  ds_read_b64_tr_b16 a[192:193], v14 offset:32768
  v_xor_b32 v31, 0x1000, v31
  v_mfma_f32_16x16x32_bf16 v[248:251], a[228:231], a[180:183], v[248:251]
  s_waitcnt vmcnt(6)
  buffer_load_dwordx4 v25, s[16:19], s40 offen nt lds
  v_mfma_f32_16x16x32_bf16 v[248:251], a[232:235], a[184:187], v[248:251]
  ds_read_b64_tr_b16 a[194:195], v14 offset:36864
  v_cvt_pk_bf16_f32 v192, v192, v193
  v_mfma_f32_16x16x32_bf16 v[248:251], a[236:239], a[188:191], v[248:251]
  v_exp_f32 v196, v196
  v_mfma_f32_16x16x32_bf16 v[232:235], a[236:239], a[172:175], 0
  ds_read_b64_tr_b16 a[196:197], v14 offset:40960
  v_cvt_pk_bf16_f32 v193, v194, v195
  v_mfma_f32_16x16x32_bf16 v[232:235], a[232:235], a[168:171], v[232:235]
  v_exp_f32 v197, v197
  v_mfma_f32_16x16x32_bf16 v[232:235], a[228:231], a[164:167], v[232:235]
  ds_read_b64_tr_b16 a[198:199], v14 offset:45056
  v_cvt_pk_bf16_f32 v194, v196, v197
  v_mfma_f32_16x16x32_bf16 v[232:235], a[224:227], a[160:163], v[232:235]
  v_exp_f32 v198, v198
  v_mfma_f32_16x16x32_bf16 v[6:9], v[32:35], v[6:9], 0
  v_exp_f32 v199, v199
  v_mfma_f32_16x16x32_bf16 v[216:219], a[224:227], a[144:147], 0
  ds_read_b64_tr_b16 a[200:201], v15 offset:32768
  v_cvt_pk_bf16_f32 v195, v198, v199
  v_mfma_f32_16x16x32_bf16 v[216:219], a[228:231], a[148:151], v[216:219]
  v_exp_f32 v208, v208
  v_mfma_f32_16x16x32_bf16 v[216:219], a[232:235], a[152:155], v[216:219]
  ds_read_b64_tr_b16 a[202:203], v15 offset:36864
  v_mfma_f32_16x16x32_bf16 v[216:219], a[236:239], a[156:159], v[216:219]
  v_cvt_pk_bf16_f32 v126, v6, v7
  v_mfma_f32_16x16x32_bf16 v[200:203], a[236:239], a[140:143], 0
  s_add_u32 m0, s30, 65536
  s_xor_b32 s40, s33, 0x0
  ds_read_b64_tr_b16 a[204:205], v15 offset:40960
  v_cvt_pk_bf16_f32 v127, v8, v9
  v_mfma_f32_16x16x32_bf16 v[200:203], a[232:235], a[136:139], v[200:203]
  s_waitcnt vmcnt(6)
  buffer_load_dwordx4 v22, s[20:23], s40 offen nt lds
  v_mfma_f32_16x16x32_bf16 v[200:203], a[228:231], a[132:135], v[200:203]
  ds_read_b64_tr_b16 a[206:207], v15 offset:45056
  v_mfma_f32_16x16x32_bf16 v[200:203], a[224:227], a[128:131], v[200:203]
  v_exp_f32 v209, v209
  v_mfma_f32_16x16x32_bf16 v[204:207], a[240:243], a[128:131], 0
  ds_read_b64_tr_b16 a[208:209], v16 offset:32768
  v_cvt_pk_bf16_f32 v208, v208, v209
  v_mfma_f32_16x16x32_bf16 v[204:207], a[244:247], a[132:135], v[204:207]
  v_exp_f32 v210, v210
  v_mfma_f32_16x16x32_bf16 v[204:207], a[248:251], a[136:139], v[204:207]
  ds_read_b64_tr_b16 a[210:211], v16 offset:36864
  v_mfma_f32_16x16x32_bf16 v[204:207], a[252:255], a[140:143], v[204:207]
  s_waitcnt vmcnt(9)
  v_readfirstlane_b32 s44, v252
  v_mfma_f32_16x16x32_bf16 v[220:223], a[252:255], a[156:159], 0
  ds_read_b64_tr_b16 a[212:213], v16 offset:40960
  v_mfma_f32_16x16x32_bf16 v[220:223], a[248:251], a[152:155], v[220:223]
  s_sub_u32 s44, s44, s49
  s_add_u32 s49, s49, 64
  s_sub_i32 s8, s44, s98
  s_sub_i32 s9, s44, s99
  s_sub_i32 s10, s44, s100
  s_sub_i32 s11, s44, s101
  v_exp_f32 v211, v211
  v_mfma_f32_16x16x32_bf16 v[220:223], a[244:247], a[148:151], v[220:223]
  ds_read_b64_tr_b16 a[214:215], v16 offset:45056
  v_cvt_pk_bf16_f32 v209, v210, v211
  v_mfma_f32_16x16x32_bf16 v[220:223], a[240:243], a[144:147], v[220:223]
  v_exp_f32 v212, v212
  v_mfma_f32_16x16x32_bf16 v[236:239], a[240:243], a[160:163], 0
  s_add_u32 m0, s30, 66560
  s_xor_b32 s40, s33, 0xc00
  ds_read_b64_tr_b16 a[216:217], v17 offset:32768
  v_mfma_f32_16x16x32_bf16 v[236:239], a[244:247], a[164:167], v[236:239]
  s_waitcnt vmcnt(6)
  buffer_load_dwordx4 v23, s[20:23], s40 offen nt lds
  v_mfma_f32_16x16x32_bf16 v[236:239], a[248:251], a[168:171], v[236:239]
  ds_read_b64_tr_b16 a[218:219], v17 offset:36864
  v_mfma_f32_16x16x32_bf16 v[236:239], a[252:255], a[172:175], v[236:239]
  v_exp_f32 v213, v213
  v_mfma_f32_16x16x32_bf16 v[252:255], a[252:255], a[188:191], 0
  ds_read_b64_tr_b16 a[220:221], v17 offset:40960
  v_cvt_pk_bf16_f32 v210, v212, v213
  v_mfma_f32_16x16x32_bf16 v[252:255], a[248:251], a[184:187], v[252:255]
  v_exp_f32 v214, v214
  v_mfma_f32_16x16x32_bf16 v[252:255], a[244:247], a[180:183], v[252:255]
  ds_read_b64_tr_b16 a[222:223], v17 offset:45056
  v_mfma_f32_16x16x32_bf16 v[252:255], a[240:243], a[176:179], v[252:255]
  v_exp_f32 v215, v215
  v_mfma_f32_16x16x32_bf16 v[48:51], v[44:47], v[128:131], v[48:51]
  ds_read_b64_tr_b16 a[224:225], v18 offset:32768
  v_accvgpr_write_b32 a128, v64
  v_mfma_f32_16x16x32_bf16 v[48:51], v[44:47], v[136:139], v[48:51]
  v_accvgpr_write_b32 a129, v65
  v_accvgpr_write_b32 a130, v66
  v_mfma_f32_16x16x32_bf16 v[52:55], v[44:47], v[144:147], v[52:55]
  ds_read_b64_tr_b16 a[226:227], v18 offset:36864
  v_accvgpr_write_b32 a131, v67
  v_cvt_pk_bf16_f32 v211, v214, v215
  v_mfma_f32_16x16x32_bf16 v[52:55], v[44:47], v[152:155], v[52:55]
  v_accvgpr_write_b32 a132, v68
  v_mfma_f32_16x16x32_bf16 v[56:59], v[44:47], v[160:163], v[56:59]
  s_add_u32 m0, s30, 67584
  s_xor_b32 s40, s33, 0x10400
  ds_read_b64_tr_b16 a[228:229], v18 offset:40960
  v_accvgpr_write_b32 a133, v69
  v_mfma_f32_16x16x32_bf16 v[56:59], v[44:47], v[168:171], v[56:59]
  s_waitcnt vmcnt(6)
  buffer_load_dwordx4 v24, s[20:23], s40 offen nt lds
  v_mfma_f32_16x16x32_bf16 v[60:63], v[44:47], v[176:179], v[60:63]
  ds_read_b64_tr_b16 a[230:231], v18 offset:45056
  v_accvgpr_write_b32 a134, v70
  v_mfma_f32_16x16x32_bf16 v[60:63], v[44:47], v[184:187], v[60:63]
  s_waitcnt lgkmcnt(4)
  v_accvgpr_write_b32 a135, v71
  v_exp_f32 v224, v224
  v_mfma_f32_16x16x32_bf16 a[96:99], v[184:187], a[196:199], a[96:99]
  ds_read_b64_tr_b16 a[232:233], v19 offset:32768
  v_accvgpr_write_b32 a136, v72
  v_mfma_f32_16x16x32_bf16 a[96:99], v[176:179], a[192:195], a[96:99]
  v_accvgpr_write_b32 a137, v73
  v_exp_f32 v225, v225
  v_mfma_f32_16x16x32_bf16 a[64:67], v[160:163], a[192:195], a[64:67]
  ds_read_b64_tr_b16 a[234:235], v19 offset:36864
  v_accvgpr_write_b32 a138, v74
  v_mfma_f32_16x16x32_bf16 a[64:67], v[168:171], a[196:199], a[64:67]
  v_accvgpr_write_b32 a139, v75
  v_exp_f32 v226, v226
  v_mfma_f32_16x16x32_bf16 a[32:35], v[152:155], a[196:199], a[32:35]
  ds_read_b64_tr_b16 a[236:237], v19 offset:40960
  v_accvgpr_write_b32 a140, v76
  v_mfma_f32_16x16x32_bf16 a[32:35], v[144:147], a[192:195], a[32:35]
  v_accvgpr_write_b32 a141, v77
  v_exp_f32 v227, v227
  v_mfma_f32_16x16x32_bf16 a[0:3], v[128:131], a[192:195], a[0:3]
  ds_read_b64_tr_b16 a[238:239], v19 offset:45056
  v_accvgpr_write_b32 a142, v78
  v_mfma_f32_16x16x32_bf16 a[0:3], v[136:139], a[196:199], a[0:3]
  v_accvgpr_write_b32 a143, v79
  v_exp_f32 v228, v228
  v_mfma_f32_16x16x32_bf16 a[4:7], v[136:139], a[204:207], a[4:7]
  s_add_u32 m0, s30, 68608
  s_xor_b32 s40, s33, 0x10800
  ds_read_b64_tr_b16 a[240:241], v20 offset:32768
  v_accvgpr_write_b32 a144, v80
  v_mfma_f32_16x16x32_bf16 a[4:7], v[128:131], a[200:203], a[4:7]
  s_waitcnt vmcnt(6)
  buffer_load_dwordx4 v25, s[20:23], s40 offen nt lds
  v_mfma_f32_16x16x32_bf16 a[36:39], v[144:147], a[200:203], a[36:39]
  ds_read_b64_tr_b16 a[242:243], v20 offset:36864
  v_accvgpr_write_b32 a145, v81
  v_mfma_f32_16x16x32_bf16 a[36:39], v[152:155], a[204:207], a[36:39]
  v_accvgpr_write_b32 a146, v82
  v_exp_f32 v229, v229
  v_mfma_f32_16x16x32_bf16 a[68:71], v[168:171], a[204:207], a[68:71]
  ds_read_b64_tr_b16 a[244:245], v20 offset:40960
  v_accvgpr_write_b32 a147, v83
  v_mfma_f32_16x16x32_bf16 a[68:71], v[160:163], a[200:203], a[68:71]
  v_accvgpr_write_b32 a148, v84
  v_cvt_pk_bf16_f32 v224, v224, v225
  v_mfma_f32_16x16x32_bf16 a[100:103], v[176:179], a[200:203], a[100:103]
  ds_read_b64_tr_b16 a[246:247], v20 offset:45056
  v_accvgpr_write_b32 a149, v85
  v_cvt_pk_bf16_f32 v225, v226, v227
  v_mfma_f32_16x16x32_bf16 a[100:103], v[184:187], a[204:207], a[100:103]
  v_accvgpr_write_b32 a150, v86
  v_cvt_pk_bf16_f32 v226, v228, v229
  v_mfma_f32_16x16x32_bf16 a[104:107], v[184:187], a[212:215], a[104:107]
  ds_read_b64_tr_b16 a[248:249], v21 offset:32768
  v_accvgpr_write_b32 a151, v87
  v_mfma_f32_16x16x32_bf16 a[104:107], v[176:179], a[208:211], a[104:107]
  v_accvgpr_write_b32 a152, v88
  v_exp_f32 v230, v230
  v_mfma_f32_16x16x32_bf16 a[72:75], v[160:163], a[208:211], a[72:75]
  ds_read_b64_tr_b16 a[250:251], v21 offset:36864
  v_accvgpr_write_b32 a153, v89
  v_mfma_f32_16x16x32_bf16 a[72:75], v[168:171], a[212:215], a[72:75]
  v_accvgpr_write_b32 a154, v90
  v_exp_f32 v231, v231
  v_mfma_f32_16x16x32_bf16 a[40:43], v[152:155], a[212:215], a[40:43]
  s_add_u32 m0, s30, 32768
  s_xor_b32 s40, s33, 0x3800
  ds_read_b64_tr_b16 a[252:253], v21 offset:40960
  v_accvgpr_write_b32 a155, v91
  v_mfma_f32_16x16x32_bf16 a[40:43], v[144:147], a[208:211], a[40:43]
  s_waitcnt vmcnt(6)
  buffer_load_dwordx4 v22, s[16:19], s40 offen nt lds
  v_mfma_f32_16x16x32_bf16 a[8:11], v[128:131], a[208:211], a[8:11]
  ds_read_b64_tr_b16 a[254:255], v21 offset:45056
  v_accvgpr_write_b32 a156, v92
  v_mfma_f32_16x16x32_bf16 a[8:11], v[136:139], a[212:215], a[8:11]
  v_accvgpr_write_b32 a157, v93
  v_exp_f32 v240, v240
  v_mfma_f32_16x16x32_bf16 a[12:15], v[136:139], a[220:223], a[12:15]
  v_accvgpr_write_b32 a158, v94
  v_cvt_pk_bf16_f32 v227, v230, v231
  v_mfma_f32_16x16x32_bf16 a[12:15], v[128:131], a[216:219], a[12:15]
  v_accvgpr_write_b32 a159, v95
  v_exp_f32 v241, v241
  v_mfma_f32_16x16x32_bf16 a[44:47], v[144:147], a[216:219], a[44:47]
  v_accvgpr_write_b32 a160, v96
  v_cvt_pk_bf16_f32 v240, v240, v241
  v_mfma_f32_16x16x32_bf16 a[44:47], v[152:155], a[220:223], a[44:47]
  s_waitcnt vmcnt(7) lgkmcnt(0)
  s_cmpk_lt_i32 s9, 0x0
  s_cbranch_scc0 L_fb0_13
  s_waitcnt vmcnt(4)
L_fb0_13:
  s_barrier
  v_mfma_f32_16x16x32_bf16 a[76:79], v[168:171], a[220:223], a[76:79]
  ds_read_b128 a[192:195], v10
  v_accvgpr_write_b32 a161, v97
  v_mfma_f32_16x16x32_bf16 a[76:79], v[160:163], a[216:219], a[76:79]
  v_accvgpr_write_b32 a162, v98
  v_exp_f32 v242, v242
  v_mfma_f32_16x16x32_bf16 a[108:111], v[176:179], a[216:219], a[108:111]
  s_add_u32 m0, s30, 33792
  s_xor_b32 s40, s33, 0x3400
  v_accvgpr_write_b32 a163, v99
  v_mfma_f32_16x16x32_bf16 a[108:111], v[184:187], a[220:223], a[108:111]
  s_waitcnt vmcnt(6)
  buffer_load_dwordx4 v23, s[16:19], s40 offen nt lds
  v_mfma_f32_16x16x32_bf16 a[112:115], v[184:187], a[228:231], a[112:115]
  ds_read_b128 a[196:199], v11
  v_accvgpr_write_b32 a164, v100
  v_mfma_f32_16x16x32_bf16 a[112:115], v[176:179], a[224:227], a[112:115]
  v_accvgpr_write_b32 a165, v101
  v_exp_f32 v243, v243
  v_mfma_f32_16x16x32_bf16 a[80:83], v[160:163], a[224:227], a[80:83]
  v_accvgpr_write_b32 a166, v102
  v_cvt_pk_bf16_f32 v241, v242, v243
  v_mfma_f32_16x16x32_bf16 a[80:83], v[168:171], a[228:231], a[80:83]
  v_accvgpr_write_b32 a167, v103
  v_exp_f32 v244, v244
  v_mfma_f32_16x16x32_bf16 a[48:51], v[152:155], a[228:231], a[48:51]
  ds_read_b128 a[200:203], v12
  v_accvgpr_write_b32 a168, v104
  v_mfma_f32_16x16x32_bf16 a[48:51], v[144:147], a[224:227], a[48:51]
  v_accvgpr_write_b32 a169, v105
  v_exp_f32 v245, v245
  v_mfma_f32_16x16x32_bf16 a[16:19], v[128:131], a[224:227], a[16:19]
  v_accvgpr_write_b32 a170, v106
  v_cvt_pk_bf16_f32 v242, v244, v245
  v_mfma_f32_16x16x32_bf16 a[16:19], v[136:139], a[228:231], a[16:19]
  v_accvgpr_write_b32 a171, v107
  v_exp_f32 v246, v246
  v_mfma_f32_16x16x32_bf16 a[20:23], v[136:139], a[236:239], a[20:23]
  ds_read_b128 a[204:207], v13
  v_accvgpr_write_b32 a172, v108
  v_mfma_f32_16x16x32_bf16 a[20:23], v[128:131], a[232:235], a[20:23]
  s_add_u32 m0, s30, 34816
  s_xor_b32 s40, s33, 0x13c00
  v_accvgpr_write_b32 a173, v109
  v_exp_f32 v247, v247
  v_mfma_f32_16x16x32_bf16 a[52:55], v[144:147], a[232:235], a[52:55]
  s_waitcnt vmcnt(6)
  buffer_load_dwordx4 v24, s[16:19], s40 offen nt lds
  v_mfma_f32_16x16x32_bf16 a[52:55], v[152:155], a[236:239], a[52:55]
  v_accvgpr_write_b32 a174, v110
  v_cvt_pk_bf16_f32 v243, v246, v247
  v_mfma_f32_16x16x32_bf16 a[84:87], v[168:171], a[236:239], a[84:87]
  ds_read_b128 a[208:211], v10 offset:4096
  v_accvgpr_write_b32 a175, v111
  v_mfma_f32_16x16x32_bf16 a[84:87], v[160:163], a[232:235], a[84:87]
  v_accvgpr_write_b32 a176, v112
  v_exp_f32 v200, v200
  v_mfma_f32_16x16x32_bf16 a[116:119], v[176:179], a[232:235], a[116:119]
  v_accvgpr_write_b32 a177, v113
  v_mfma_f32_16x16x32_bf16 a[116:119], v[184:187], a[236:239], a[116:119]
  v_accvgpr_write_b32 a178, v114
  v_exp_f32 v201, v201
  v_mfma_f32_16x16x32_bf16 a[120:123], v[184:187], a[244:247], a[120:123]
  ds_read_b128 a[212:215], v11 offset:4096
  v_accvgpr_write_b32 a179, v115
  v_mfma_f32_16x16x32_bf16 a[120:123], v[176:179], a[240:243], a[120:123]
  v_accvgpr_write_b32 a180, v116
  v_exp_f32 v202, v202
  v_mfma_f32_16x16x32_bf16 a[88:91], v[160:163], a[240:243], a[88:91]
  v_accvgpr_write_b32 a181, v117
  v_cvt_pk_bf16_f32 v200, v200, v201
  v_mfma_f32_16x16x32_bf16 a[88:91], v[168:171], a[244:247], a[88:91]
  v_accvgpr_write_b32 a182, v118
  v_exp_f32 v203, v203
  v_mfma_f32_16x16x32_bf16 a[56:59], v[152:155], a[244:247], a[56:59]
  s_add_u32 m0, s30, 35840
  s_xor_b32 s40, s33, 0x13000
  ds_read_b128 a[216:219], v12 offset:4096
  v_accvgpr_write_b32 a183, v119
  v_mfma_f32_16x16x32_bf16 a[56:59], v[144:147], a[240:243], a[56:59]
  s_waitcnt vmcnt(6)
  buffer_load_dwordx4 v25, s[16:19], s40 offen nt lds
  v_mfma_f32_16x16x32_bf16 a[24:27], v[128:131], a[240:243], a[24:27]
  v_accvgpr_write_b32 a184, v120
  v_cvt_pk_bf16_f32 v201, v202, v203
  v_mfma_f32_16x16x32_bf16 a[24:27], v[136:139], a[244:247], a[24:27]
  v_accvgpr_write_b32 a185, v121
  v_exp_f32 v204, v204
  v_mfma_f32_16x16x32_bf16 a[28:31], v[136:139], a[252:255], a[28:31]
  ds_read_b128 a[220:223], v13 offset:4096
  v_accvgpr_write_b32 a186, v122
  v_mfma_f32_16x16x32_bf16 a[28:31], v[128:131], a[248:251], a[28:31]
  v_accvgpr_write_b32 a187, v123
  v_exp_f32 v205, v205
  v_mfma_f32_16x16x32_bf16 a[60:63], v[144:147], a[248:251], a[60:63]
  v_accvgpr_write_b32 a188, v124
  v_cvt_pk_bf16_f32 v202, v204, v205
  v_mfma_f32_16x16x32_bf16 a[60:63], v[152:155], a[252:255], a[60:63]
  v_accvgpr_write_b32 a189, v125
  v_exp_f32 v206, v206
  v_mfma_f32_16x16x32_bf16 a[92:95], v[168:171], a[252:255], a[92:95]
  v_accvgpr_write_b32 a190, v126
  v_mfma_f32_16x16x32_bf16 a[92:95], v[160:163], a[248:251], a[92:95]
  v_accvgpr_write_b32 a191, v127
  v_exp_f32 v207, v207
  v_mfma_f32_16x16x32_bf16 a[124:127], v[176:179], a[248:251], a[124:127]
  v_exp_f32 v216, v216
  v_mfma_f32_16x16x32_bf16 a[124:127], v[184:187], a[252:255], a[124:127]
  s_waitcnt lgkmcnt(0)
  v_exp_f32 v217, v217
  v_cvt_pk_bf16_f32 v203, v206, v207
  v_mfma_f32_16x16x32_bf16 v[176:179], a[192:195], a[176:179], 0
  v_exp_f32 v218, v218
  v_mfma_f32_16x16x32_bf16 v[176:179], a[196:199], a[180:183], v[176:179]
  s_add_u32 m0, s30, 81920
  s_xor_b32 s40, s33, 0x400
  ds_read_b128 a[224:227], v10 offset:8192
  v_exp_f32 v219, v219
  v_mfma_f32_16x16x32_bf16 v[176:179], a[200:203], a[184:187], v[176:179]
  s_waitcnt vmcnt(6)
  buffer_load_dwordx4 v22, s[20:23], s40 offen nt lds
  v_mfma_f32_16x16x32_bf16 v[176:179], a[204:207], a[188:191], v[176:179]
  v_exp_f32 v220, v220
  v_mfma_f32_16x16x32_bf16 v[160:163], a[204:207], a[172:175], 0
  ds_read_b128 a[228:231], v11 offset:8192
  v_cvt_pk_bf16_f32 v216, v216, v217
  v_mfma_f32_16x16x32_bf16 v[160:163], a[200:203], a[168:171], v[160:163]
  v_exp_f32 v221, v221
  v_cvt_pk_bf16_f32 v217, v218, v219
  v_mfma_f32_16x16x32_bf16 v[160:163], a[196:199], a[164:167], v[160:163]
  v_exp_f32 v222, v222
  v_mfma_f32_16x16x32_bf16 v[160:163], a[192:195], a[160:163], v[160:163]
  ds_read_b128 a[232:235], v12 offset:8192
  v_exp_f32 v223, v223
  v_mfma_f32_16x16x32_bf16 v[144:147], a[192:195], a[144:147], 0
  v_exp_f32 v232, v232
  v_mfma_f32_16x16x32_bf16 v[144:147], a[196:199], a[148:151], v[144:147]
  v_exp_f32 v233, v233
  v_cvt_pk_bf16_f32 v218, v220, v221
  v_mfma_f32_16x16x32_bf16 v[144:147], a[200:203], a[152:155], v[144:147]
  ds_read_b128 a[236:239], v13 offset:8192
  v_cvt_pk_bf16_f32 v219, v222, v223
  v_mfma_f32_16x16x32_bf16 v[144:147], a[204:207], a[156:159], v[144:147]
  v_exp_f32 v234, v234
  v_cvt_pk_bf16_f32 v232, v232, v233
  v_mfma_f32_16x16x32_bf16 v[128:131], a[204:207], a[140:143], 0
  v_exp_f32 v235, v235
  v_mfma_f32_16x16x32_bf16 v[128:131], a[200:203], a[136:139], v[128:131]
  s_add_u32 m0, s30, 82944
  s_xor_b32 s40, s33, 0x800
  ds_read_b128 a[240:243], v10 offset:12288
  v_cvt_pk_bf16_f32 v233, v234, v235
  v_mfma_f32_16x16x32_bf16 v[128:131], a[196:199], a[132:135], v[128:131]
  s_waitcnt vmcnt(6)
  buffer_load_dwordx4 v23, s[20:23], s40 offen nt lds
  v_mfma_f32_16x16x32_bf16 v[128:131], a[192:195], a[128:131], v[128:131]
  v_exp_f32 v236, v236
  v_mfma_f32_16x16x32_bf16 v[132:135], a[208:211], a[128:131], 0
  ds_read_b128 a[244:247], v11 offset:12288
  v_exp_f32 v237, v237
  v_mfma_f32_16x16x32_bf16 v[132:135], a[212:215], a[132:135], v[132:135]
  v_exp_f32 v238, v238
  v_mfma_f32_16x16x32_bf16 v[132:135], a[216:219], a[136:139], v[132:135]
  v_exp_f32 v239, v239
  v_cvt_pk_bf16_f32 v234, v236, v237
  v_mfma_f32_16x16x32_bf16 v[132:135], a[220:223], a[140:143], v[132:135]
  ds_read_b128 a[248:251], v12 offset:12288
  v_cvt_pk_bf16_f32 v235, v238, v239
  v_mfma_f32_16x16x32_bf16 v[148:151], a[220:223], a[156:159], 0
  v_exp_f32 v248, v248
  v_mfma_f32_16x16x32_bf16 v[148:151], a[216:219], a[152:155], v[148:151]
  v_exp_f32 v249, v249
  v_mfma_f32_16x16x32_bf16 v[148:151], a[212:215], a[148:151], v[148:151]
  ds_read_b128 a[252:255], v13 offset:12288
  v_exp_f32 v250, v250
  v_mfma_f32_16x16x32_bf16 v[148:151], a[208:211], a[144:147], v[148:151]
  v_exp_f32 v251, v251
  v_mfma_f32_16x16x32_bf16 v[164:167], a[208:211], a[160:163], 0
  v_exp_f32 v252, v252
  v_cvt_pk_bf16_f32 v248, v248, v249
  v_mfma_f32_16x16x32_bf16 v[164:167], a[212:215], a[164:167], v[164:167]
  v_exp_f32 v253, v253
  v_mfma_f32_16x16x32_bf16 v[164:167], a[216:219], a[168:171], v[164:167]
  v_exp_f32 v254, v254
  v_cvt_pk_bf16_f32 v249, v250, v251
  v_mfma_f32_16x16x32_bf16 v[164:167], a[220:223], a[172:175], v[164:167]
  s_add_u32 m0, s30, 83968
  s_xor_b32 s40, s33, 0x10000
  v_exp_f32 v255, v255
  v_mfma_f32_16x16x32_bf16 v[180:183], a[220:223], a[188:191], 0
  s_waitcnt vmcnt(6)
  buffer_load_dwordx4 v24, s[20:23], s40 offen nt lds
  v_mfma_f32_16x16x32_bf16 v[180:183], a[216:219], a[184:187], v[180:183]
  v_exp_f32 v128, v128
  v_mfma_f32_16x16x32_bf16 v[180:183], a[212:215], a[180:183], v[180:183]
  v_exp_f32 v129, v129
  v_cvt_pk_bf16_f32 v250, v252, v253
  v_mfma_f32_16x16x32_bf16 v[180:183], a[208:211], a[176:179], v[180:183]
  s_waitcnt vmcnt(7) lgkmcnt(0)
  s_cmpk_lt_i32 s10, 0x0
  s_cbranch_scc0 L_fb0_14
  s_waitcnt vmcnt(5)
L_fb0_14:
  s_barrier
  v_mfma_f32_16x16x32_bf16 v[184:187], a[224:227], a[176:179], 0
  ds_read_b64_tr_b16 a[192:193], v14 offset:49152
  v_exp_f32 v130, v130
  v_mfma_f32_16x16x32_bf16 v[184:187], a[228:231], a[180:183], v[184:187]
  v_exp_f32 v131, v131
  v_mfma_f32_16x16x32_bf16 v[184:187], a[232:235], a[184:187], v[184:187]
  ds_read_b64_tr_b16 a[194:195], v14 offset:53248
  v_exp_f32 v132, v132
  v_mfma_f32_16x16x32_bf16 v[184:187], a[236:239], a[188:191], v[184:187]
  v_exp_f32 v133, v133
  v_mfma_f32_16x16x32_bf16 v[168:171], a[236:239], a[172:175], 0
  ds_read_b64_tr_b16 a[196:197], v14 offset:57344
  v_exp_f32 v134, v134
  v_mfma_f32_16x16x32_bf16 v[168:171], a[232:235], a[168:171], v[168:171]
  v_exp_f32 v135, v135
  v_mfma_f32_16x16x32_bf16 v[168:171], a[228:231], a[164:167], v[168:171]
  ds_read_b64_tr_b16 a[198:199], v14 offset:61440
  v_cvt_pk_bf16_f32 v251, v254, v255
  v_mfma_f32_16x16x32_bf16 v[168:171], a[224:227], a[160:163], v[168:171]
  v_exp_f32 v144, v144
  v_cvt_pk_bf16_f32 v128, v128, v129
  v_mfma_f32_16x16x32_bf16 v[152:155], a[224:227], a[144:147], 0
  s_add_u32 m0, s30, 84992
  s_xor_b32 s40, s33, 0x10c00
  ds_read_b64_tr_b16 a[200:201], v15 offset:49152
  v_cvt_pk_bf16_f32 v129, v130, v131
  v_mfma_f32_16x16x32_bf16 v[152:155], a[228:231], a[148:151], v[152:155]
  s_waitcnt vmcnt(6)
  buffer_load_dwordx4 v25, s[20:23], s40 offen nt lds
  v_mfma_f32_16x16x32_bf16 v[152:155], a[232:235], a[152:155], v[152:155]
  ds_read_b64_tr_b16 a[202:203], v15 offset:53248
  v_cvt_pk_bf16_f32 v130, v132, v133
  v_mfma_f32_16x16x32_bf16 v[152:155], a[236:239], a[156:159], v[152:155]
  v_exp_f32 v145, v145
  v_cvt_pk_bf16_f32 v131, v134, v135
  v_mfma_f32_16x16x32_bf16 v[136:139], a[236:239], a[140:143], 0
  ds_read_b64_tr_b16 a[204:205], v15 offset:57344
  v_cvt_pk_bf16_f32 v144, v144, v145
  v_mfma_f32_16x16x32_bf16 v[136:139], a[232:235], a[136:139], v[136:139]
  v_exp_f32 v146, v146
  v_mfma_f32_16x16x32_bf16 v[136:139], a[228:231], a[132:135], v[136:139]
  ds_read_b64_tr_b16 a[206:207], v15 offset:61440
  v_exp_f32 v147, v147
  v_mfma_f32_16x16x32_bf16 v[136:139], a[224:227], a[128:131], v[136:139]
  v_exp_f32 v148, v148
  v_mfma_f32_16x16x32_bf16 v[140:143], a[240:243], a[128:131], 0
  ds_read_b64_tr_b16 a[208:209], v16 offset:49152
  v_exp_f32 v149, v149
  v_mfma_f32_16x16x32_bf16 v[140:143], a[244:247], a[132:135], v[140:143]
  v_exp_f32 v150, v150
  v_mfma_f32_16x16x32_bf16 v[140:143], a[248:251], a[136:139], v[140:143]
  ds_read_b64_tr_b16 a[210:211], v16 offset:53248
  v_exp_f32 v151, v151
  v_mfma_f32_16x16x32_bf16 v[140:143], a[252:255], a[140:143], v[140:143]
  v_exp_f32 v160, v160
  v_mfma_f32_16x16x32_bf16 v[156:159], a[252:255], a[156:159], 0
  ds_read_b64_tr_b16 a[212:213], v16 offset:57344
  v_exp_f32 v161, v161
  v_mfma_f32_16x16x32_bf16 v[156:159], a[248:251], a[152:155], v[156:159]
  v_exp_f32 v162, v162
  v_mfma_f32_16x16x32_bf16 v[156:159], a[244:247], a[148:151], v[156:159]
  s_add_u32 m0, s30, 49152
  s_xor_b32 s40, s33, 0x3c00
  ds_read_b64_tr_b16 a[214:215], v16 offset:61440
  v_exp_f32 v163, v163
  v_mfma_f32_16x16x32_bf16 v[156:159], a[240:243], a[144:147], v[156:159]
  s_waitcnt vmcnt(6)
  buffer_load_dwordx4 v22, s[16:19], s40 offen nt lds
  v_mfma_f32_16x16x32_bf16 v[172:175], a[240:243], a[160:163], 0
  ds_read_b64_tr_b16 a[216:217], v17 offset:49152
  v_cvt_pk_bf16_f32 v145, v146, v147
  v_mfma_f32_16x16x32_bf16 v[172:175], a[244:247], a[164:167], v[172:175]
  v_exp_f32 v164, v164
  v_mfma_f32_16x16x32_bf16 v[172:175], a[248:251], a[168:171], v[172:175]
  ds_read_b64_tr_b16 a[218:219], v17 offset:53248
  v_exp_f32 v165, v165
  v_mfma_f32_16x16x32_bf16 v[172:175], a[252:255], a[172:175], v[172:175]
  v_exp_f32 v166, v166
  v_mfma_f32_16x16x32_bf16 v[188:191], a[252:255], a[188:191], 0
  ds_read_b64_tr_b16 a[220:221], v17 offset:57344
  v_exp_f32 v167, v167
  v_mfma_f32_16x16x32_bf16 v[188:191], a[248:251], a[184:187], v[188:191]
  v_exp_f32 v176, v176
L_pg6:
  s_cbranch_execz L_rt0
  v_mfma_f32_16x16x32_bf16 v[188:191], a[244:247], a[180:183], v[188:191]
  ds_read_b64_tr_b16 a[222:223], v17 offset:61440
  v_cvt_pk_bf16_f32 v146, v148, v149
  v_mfma_f32_16x16x32_bf16 v[188:191], a[240:243], a[176:179], v[188:191]
  v_exp_f32 v177, v177
  v_cvt_pk_bf16_f32 v147, v150, v151
  v_mfma_f32_16x16x32_bf16 v[48:51], v[44:47], v[192:195], v[48:51]
  ds_read_b64_tr_b16 a[224:225], v18 offset:49152
  v_cvt_pk_bf16_f32 v160, v160, v161
  v_mfma_f32_16x16x32_bf16 v[48:51], v[44:47], v[200:203], v[48:51]
  v_lshrrev_b32 v120, 8, v26
  v_exp_f32 v178, v178
  v_mfma_f32_16x16x32_bf16 v[52:55], v[44:47], v[208:211], v[52:55]
  ds_read_b64_tr_b16 a[226:227], v18 offset:53248
  v_lshl_add_u32 v120, v120, 5, s31
  v_mfma_f32_16x16x32_bf16 v[52:55], v[44:47], v[216:219], v[52:55]
  v_exp_f32 v179, v179
  v_cvt_pk_bf16_f32 v161, v162, v163
  v_mfma_f32_16x16x32_bf16 v[56:59], v[44:47], v[224:227], v[56:59]
  s_add_u32 m0, s30, 50176
  s_xor_b32 s40, s33, 0x3000
  ds_read_b64_tr_b16 a[228:229], v18 offset:57344
  v_cvt_pk_bf16_f32 v162, v164, v165
  v_mfma_f32_16x16x32_bf16 v[56:59], v[44:47], v[232:235], v[56:59]
  s_waitcnt vmcnt(6)
  buffer_load_dwordx4 v23, s[16:19], s40 offen nt lds
  v_mfma_f32_16x16x32_bf16 v[60:63], v[44:47], v[240:243], v[60:63]
  ds_read_b64_tr_b16 a[230:231], v18 offset:61440
  v_cvt_pk_bf16_f32 v163, v166, v167
  v_mfma_f32_16x16x32_bf16 v[60:63], v[44:47], v[248:251], v[60:63]
  s_waitcnt lgkmcnt(4)
  v_exp_f32 v180, v180
  v_cvt_pk_bf16_f32 v176, v176, v177
  v_mfma_f32_16x16x32_bf16 a[12:15], v[200:203], a[220:223], a[12:15]
  ds_read_b64_tr_b16 a[232:233], v19 offset:49152
  v_rcp_f32 v112, v48
  v_mfma_f32_16x16x32_bf16 a[12:15], v[192:195], a[216:219], a[12:15]
  v_exp_f32 v181, v181
  v_mfma_f32_16x16x32_bf16 a[8:11], v[192:195], a[208:211], a[8:11]
  ds_read_b64_tr_b16 a[234:235], v19 offset:53248
  v_rcp_f32 v113, v52
  v_mfma_f32_16x16x32_bf16 a[8:11], v[200:203], a[212:215], a[8:11]
  s_nop 0
  ds_write_b64 v27, v[112:113] offset:6208
  v_mfma_f32_16x16x32_bf16 a[4:7], v[200:203], a[204:207], a[4:7]
  ds_read_b64_tr_b16 a[236:237], v19 offset:57344
  ds_read_b128 v[112:115], v120 offset:6208
  v_mfma_f32_16x16x32_bf16 a[4:7], v[192:195], a[200:203], a[4:7]
  v_exp_f32 v182, v182
  v_mfma_f32_16x16x32_bf16 a[0:3], v[192:195], a[192:195], a[0:3]
  ds_read_b64_tr_b16 a[238:239], v19 offset:61440
  ds_read_b128 v[116:119], v120 offset:6224
  v_mfma_f32_16x16x32_bf16 a[0:3], v[200:203], a[196:199], a[0:3]
  v_exp_f32 v183, v183
  v_mfma_f32_16x16x32_bf16 a[32:35], v[216:219], a[196:199], a[32:35]
  s_add_u32 m0, s30, 51200
  s_xor_b32 s40, s33, 0x13800
  ds_read_b64_tr_b16 a[240:241], v20 offset:49152
  v_cvt_pk_bf16_f32 v177, v178, v179
  v_cvt_pk_bf16_f32 v178, v180, v181
  v_mfma_f32_16x16x32_bf16 a[32:35], v[208:211], a[192:195], a[32:35]
  s_waitcnt vmcnt(6)
  buffer_load_dwordx4 v24, s[16:19], s40 offen nt lds
  v_mfma_f32_16x16x32_bf16 a[36:39], v[208:211], a[200:203], a[36:39]
  ds_read_b64_tr_b16 a[242:243], v20 offset:53248
  v_cvt_pk_bf16_f32 v179, v182, v183
  v_mfma_f32_16x16x32_bf16 a[36:39], v[216:219], a[204:207], a[36:39]
  v_accvgpr_read_b32 v36, a0
  v_accvgpr_read_b32 v37, a4
  v_accvgpr_read_b32 v38, a8
  v_accvgpr_read_b32 v39, a12
  v_mfma_f32_16x16x32_bf16 a[40:43], v[216:219], a[212:215], a[40:43]
  ds_read_b64_tr_b16 a[244:245], v20 offset:57344
  v_subrev_u32 v50, 0x37800000, v48
  v_mfma_f32_16x16x32_bf16 a[40:43], v[208:211], a[208:211], a[40:43]
  v_exp_f32 v136, v136
  v_subrev_u32 v54, 0x37800000, v52
  v_mfma_f32_16x16x32_bf16 a[44:47], v[208:211], a[216:219], a[44:47]
  ds_read_b64_tr_b16 a[246:247], v20 offset:61440
  v_subrev_u32 v58, 0x37800000, v56
  v_mfma_f32_16x16x32_bf16 a[44:47], v[216:219], a[220:223], a[44:47]
  v_accvgpr_read_b32 v40, a1
  v_accvgpr_read_b32 v41, a5
  v_accvgpr_read_b32 v42, a9
  s_waitcnt lgkmcnt(6)
  v_pk_mul_f32 v[36:37], v[36:37], v[112:113] op_sel:[0,0] op_sel_hi:[1,0]
  v_pk_mul_f32 v[38:39], v[38:39], v[112:113] op_sel:[0,0] op_sel_hi:[1,0]
  v_accvgpr_read_b32 v43, a13
  v_mfma_f32_16x16x32_bf16 a[76:79], v[232:235], a[220:223], a[76:79]
  ds_read_b64_tr_b16 a[248:249], v21 offset:49152
  v_exp_f32 v137, v137
  v_mfma_f32_16x16x32_bf16 a[76:79], v[224:227], a[216:219], a[76:79]
  v_exp_f32 v138, v138
  v_mfma_f32_16x16x32_bf16 a[72:75], v[224:227], a[208:211], a[72:75]
  ds_read_b64_tr_b16 a[250:251], v21 offset:53248
  v_exp_f32 v139, v139
  v_mfma_f32_16x16x32_bf16 a[72:75], v[232:235], a[212:215], a[72:75]
  v_accvgpr_read_b32 v124, a2
  v_accvgpr_read_b32 v125, a6
  v_accvgpr_read_b32 v126, a10
  v_accvgpr_read_b32 v127, a14
  v_cvt_pk_bf16_f32 v64, v36, v37
  v_pk_mul_f32 v[40:41], v[40:41], v[114:115] op_sel:[0,0] op_sel_hi:[1,0]
  v_pk_mul_f32 v[42:43], v[42:43], v[114:115] op_sel:[0,0] op_sel_hi:[1,0]
  v_cvt_pk_bf16_f32 v65, v38, v39
  v_mfma_f32_16x16x32_bf16 a[68:71], v[232:235], a[204:207], a[68:71]
  s_add_u32 m0, s30, 52224
  s_xor_b32 s40, s33, 0x13400
  ds_read_b64_tr_b16 a[252:253], v21 offset:57344
  v_subrev_u32 v62, 0x37800000, v60
  v_mfma_f32_16x16x32_bf16 a[68:71], v[224:227], a[200:203], a[68:71]
  s_waitcnt vmcnt(6)
  buffer_load_dwordx4 v25, s[16:19], s40 offen nt lds
  v_mfma_f32_16x16x32_bf16 a[64:67], v[224:227], a[192:195], a[64:67]
  ds_read_b64_tr_b16 a[254:255], v21 offset:61440
  v_max3_u32 v51, v50, v54, v58
  v_mfma_f32_16x16x32_bf16 a[64:67], v[232:235], a[196:199], a[64:67]
  ds_write_b64 v27, v[64:65] offset:2080
  v_accvgpr_read_b32 v36, a3
  v_accvgpr_read_b32 v37, a7
  v_accvgpr_read_b32 v38, a11
  v_accvgpr_read_b32 v39, a15
  v_cvt_pk_bf16_f32 v68, v40, v41
  s_waitcnt lgkmcnt(9)
  v_pk_mul_f32 v[124:125], v[124:125], v[116:117] op_sel:[0,0] op_sel_hi:[1,0]
  v_pk_mul_f32 v[126:127], v[126:127], v[116:117] op_sel:[0,0] op_sel_hi:[1,0]
  v_cvt_pk_bf16_f32 v69, v42, v43
  v_mfma_f32_16x16x32_bf16 a[96:99], v[248:251], a[196:199], a[96:99]
  v_exp_f32 v140, v140
  v_max_u32 v51, v51, v62
  v_mfma_f32_16x16x32_bf16 a[96:99], v[240:243], a[192:195], a[96:99]
  v_exp_f32 v141, v141
  v_mfma_f32_16x16x32_bf16 a[100:103], v[240:243], a[200:203], a[100:103]
  ds_write_b64 v27, v[68:69] offset:2592
  v_accvgpr_read_b32 v40, a32
  v_accvgpr_read_b32 v41, a36
  v_accvgpr_read_b32 v42, a40
  v_accvgpr_read_b32 v43, a44
  v_cvt_pk_bf16_f32 v72, v124, v125
  v_pk_mul_f32 v[36:37], v[36:37], v[118:119] op_sel:[0,0] op_sel_hi:[1,0]
  v_pk_mul_f32 v[38:39], v[38:39], v[118:119] op_sel:[0,0] op_sel_hi:[1,0]
  v_cvt_pk_bf16_f32 v73, v126, v127
  v_mfma_f32_16x16x32_bf16 a[100:103], v[248:251], a[204:207], a[100:103]
  s_waitcnt vmcnt(16) lgkmcnt(0)
  s_barrier
  v_cmp_gt_u32 vcc, 0x18000000, v51
  v_mfma_f32_16x16x32_bf16 a[104:107], v[248:251], a[212:215], a[104:107]
  s_add_u32 m0, s30, 98304
  s_xor_b32 s40, s33, 0x3800
  ds_read_b128 a[192:195], v10 offset:16384
  v_exp_f32 v142, v142
  v_mfma_f32_16x16x32_bf16 a[104:107], v[240:243], a[208:211], a[104:107]
  s_waitcnt vmcnt(6)
  buffer_load_dwordx4 v22, s[20:23], s40 offen nt lds
  v_mfma_f32_16x16x32_bf16 a[108:111], v[240:243], a[216:219], a[108:111]
  ds_write_b64 v27, v[72:73] offset:3104
  v_accvgpr_read_b32 v124, a33
  v_accvgpr_read_b32 v125, a37
  v_accvgpr_read_b32 v126, a41
  v_accvgpr_read_b32 v127, a45
  v_cvt_pk_bf16_f32 v76, v36, v37
  v_pk_mul_f32 v[40:41], v[40:41], v[112:113] op_sel:[0,1] op_sel_hi:[1,1]
  v_pk_mul_f32 v[42:43], v[42:43], v[112:113] op_sel:[0,1] op_sel_hi:[1,1]
  v_cvt_pk_bf16_f32 v77, v38, v39
  v_mfma_f32_16x16x32_bf16 a[108:111], v[248:251], a[220:223], a[108:111]
  v_exp_f32 v143, v143
  v_mfma_f32_16x16x32_bf16 a[28:31], v[200:203], a[252:255], a[28:31]
  ds_read_b128 a[196:199], v11 offset:16384
  v_rcp_f32 v2, v56
  v_mfma_f32_16x16x32_bf16 a[28:31], v[192:195], a[248:251], a[28:31]
  v_exp_f32 v152, v152
  v_mfma_f32_16x16x32_bf16 a[24:27], v[192:195], a[240:243], a[24:27]
  ds_write_b64 v27, v[76:77] offset:3616
  v_accvgpr_read_b32 v36, a34
  v_accvgpr_read_b32 v37, a38
  v_accvgpr_read_b32 v38, a42
  v_accvgpr_read_b32 v39, a46
  v_cvt_pk_bf16_f32 v80, v40, v41
  v_pk_mul_f32 v[124:125], v[124:125], v[114:115] op_sel:[0,1] op_sel_hi:[1,1]
  v_pk_mul_f32 v[126:127], v[126:127], v[114:115] op_sel:[0,1] op_sel_hi:[1,1]
  v_cvt_pk_bf16_f32 v81, v42, v43
  v_mfma_f32_16x16x32_bf16 a[24:27], v[200:203], a[244:247], a[24:27]
  v_exp_f32 v153, v153
  v_mfma_f32_16x16x32_bf16 a[20:23], v[200:203], a[236:239], a[20:23]
  ds_read_b128 a[200:203], v12 offset:16384
  v_rcp_f32 v3, v60
  v_mfma_f32_16x16x32_bf16 a[20:23], v[192:195], a[232:235], a[20:23]
  s_nop 0
  ds_write_b64 v27, v[2:3] offset:6720
  v_mfma_f32_16x16x32_bf16 a[16:19], v[192:195], a[224:227], a[16:19]
  s_add_u32 m0, s30, 99328
  s_xor_b32 s40, s33, 0x3400
  ds_write_b64 v27, v[80:81]
  v_accvgpr_read_b32 v40, a35
  v_accvgpr_read_b32 v41, a39
  v_accvgpr_read_b32 v42, a43
  v_accvgpr_read_b32 v43, a47
  v_cvt_pk_bf16_f32 v84, v124, v125
  v_pk_mul_f32 v[36:37], v[36:37], v[116:117] op_sel:[0,1] op_sel_hi:[1,1]
  v_pk_mul_f32 v[38:39], v[38:39], v[116:117] op_sel:[0,1] op_sel_hi:[1,1]
  v_cvt_pk_bf16_f32 v85, v126, v127
  v_mfma_f32_16x16x32_bf16 a[16:19], v[200:203], a[228:231], a[16:19]
  s_waitcnt vmcnt(6)
  buffer_load_dwordx4 v23, s[20:23], s40 offen nt lds
  v_mfma_f32_16x16x32_bf16 a[48:51], v[216:219], a[228:231], a[48:51]
  ds_read_b128 a[204:207], v13 offset:16384
  ds_read_b128 v[2:5], v120 offset:6720
  v_mfma_f32_16x16x32_bf16 a[48:51], v[208:211], a[224:227], a[48:51]
  v_exp_f32 v154, v154
  v_mfma_f32_16x16x32_bf16 a[52:55], v[208:211], a[232:235], a[52:55]
  ds_write_b64 v27, v[84:85] offset:512
  v_accvgpr_read_b32 v124, a16
  v_accvgpr_read_b32 v125, a20
  v_accvgpr_read_b32 v126, a24
  v_accvgpr_read_b32 v127, a28
  v_cvt_pk_bf16_f32 v88, v36, v37
  v_pk_mul_f32 v[40:41], v[40:41], v[118:119] op_sel:[0,1] op_sel_hi:[1,1]
  v_pk_mul_f32 v[42:43], v[42:43], v[118:119] op_sel:[0,1] op_sel_hi:[1,1]
  v_cvt_pk_bf16_f32 v89, v38, v39
  v_mfma_f32_16x16x32_bf16 a[52:55], v[216:219], a[236:239], a[52:55]
  v_exp_f32 v155, v155
  v_mfma_f32_16x16x32_bf16 a[56:59], v[216:219], a[244:247], a[56:59]
  ds_read_b128 a[208:211], v10 offset:20480
  ds_read_b128 v[6:9], v120 offset:6736
  v_cvt_pk_bf16_f32 v136, v136, v137
  v_mfma_f32_16x16x32_bf16 a[56:59], v[208:211], a[240:243], a[56:59]
  v_exp_f32 v156, v156
  v_mfma_f32_16x16x32_bf16 a[60:63], v[208:211], a[248:251], a[60:63]
  s_add_u32 m0, s30, 100352
  s_xor_b32 s40, s33, 0x13c00
  ds_write_b64 v27, v[88:89] offset:1024
  v_accvgpr_read_b32 v36, a17
  v_accvgpr_read_b32 v37, a21
  v_accvgpr_read_b32 v38, a25
  v_accvgpr_read_b32 v39, a29
  v_cvt_pk_bf16_f32 v92, v40, v41
  v_pk_mul_f32 v[124:125], v[124:125], v[112:113] op_sel:[0,0] op_sel_hi:[1,0]
  v_pk_mul_f32 v[126:127], v[126:127], v[112:113] op_sel:[0,0] op_sel_hi:[1,0]
  v_cvt_pk_bf16_f32 v93, v42, v43
  v_mfma_f32_16x16x32_bf16 a[60:63], v[216:219], a[252:255], a[60:63]
  s_waitcnt vmcnt(6)
  buffer_load_dwordx4 v24, s[20:23], s40 offen nt lds
  v_mfma_f32_16x16x32_bf16 a[92:95], v[232:235], a[252:255], a[92:95]
  ds_read_b128 a[212:215], v11 offset:20480
  v_cvt_pk_bf16_f32 v137, v138, v139
  v_mfma_f32_16x16x32_bf16 a[92:95], v[224:227], a[248:251], a[92:95]
  v_exp_f32 v157, v157
  v_mfma_f32_16x16x32_bf16 a[88:91], v[224:227], a[240:243], a[88:91]
  ds_write_b64 v27, v[92:93] offset:1536
  v_accvgpr_read_b32 v40, a18
  v_accvgpr_read_b32 v41, a22
  v_accvgpr_read_b32 v42, a26
  v_accvgpr_read_b32 v43, a30
  v_cvt_pk_bf16_f32 v66, v124, v125
  v_pk_mul_f32 v[36:37], v[36:37], v[114:115] op_sel:[0,0] op_sel_hi:[1,0]
  v_pk_mul_f32 v[38:39], v[38:39], v[114:115] op_sel:[0,0] op_sel_hi:[1,0]
  v_cvt_pk_bf16_f32 v67, v126, v127
  v_mfma_f32_16x16x32_bf16 a[88:91], v[232:235], a[244:247], a[88:91]
  v_exp_f32 v158, v158
  v_cvt_pk_bf16_f32 v138, v140, v141
  v_mfma_f32_16x16x32_bf16 a[84:87], v[232:235], a[236:239], a[84:87]
  ds_read_b128 a[216:219], v12 offset:20480
  v_cvt_pk_bf16_f32 v139, v142, v143
  v_mfma_f32_16x16x32_bf16 a[84:87], v[224:227], a[232:235], a[84:87]
  v_exp_f32 v159, v159
  v_cvt_pk_bf16_f32 v152, v152, v153
  v_mfma_f32_16x16x32_bf16 a[80:83], v[224:227], a[224:227], a[80:83]
  ds_write_b64 v27, v[66:67] offset:4160
  v_accvgpr_read_b32 v124, a19
  v_accvgpr_read_b32 v125, a23
  v_accvgpr_read_b32 v126, a27
  v_accvgpr_read_b32 v127, a31
  v_cvt_pk_bf16_f32 v70, v36, v37
  v_pk_mul_f32 v[40:41], v[40:41], v[116:117] op_sel:[0,0] op_sel_hi:[1,0]
  v_pk_mul_f32 v[42:43], v[42:43], v[116:117] op_sel:[0,0] op_sel_hi:[1,0]
  v_cvt_pk_bf16_f32 v71, v38, v39
  v_mfma_f32_16x16x32_bf16 a[80:83], v[232:235], a[228:231], a[80:83]
  ds_read_b64_tr_b16 v[64:65], v0 offset:2080
  ds_read_b64_tr_b16 v[66:67], v0 offset:2112
  v_mfma_f32_16x16x32_bf16 a[112:115], v[248:251], a[228:231], a[112:115]
  s_add_u32 m0, s30, 101376
  s_xor_b32 s40, s33, 0x13000
  ds_read_b128 a[220:223], v13 offset:20480
  s_nop 4
  s_cmp_eq_u64 vcc, -1
  s_cselect_b32 s41, 0, s37
  s_or_b32 s36, s36, s41
  v_mfma_f32_16x16x32_bf16 a[112:115], v[240:243], a[224:227], a[112:115]
  s_waitcnt vmcnt(6)
  buffer_load_dwordx4 v25, s[20:23], s40 offen nt lds
  v_mfma_f32_16x16x32_bf16 a[116:119], v[240:243], a[232:235], a[116:119]
  ds_write_b64 v27, v[70:71] offset:4672
  v_accvgpr_read_b32 v36, a48
  v_accvgpr_read_b32 v37, a52
  v_accvgpr_read_b32 v38, a56
  v_accvgpr_read_b32 v39, a60
  v_cvt_pk_bf16_f32 v74, v40, v41
  v_pk_mul_f32 v[124:125], v[124:125], v[118:119] op_sel:[0,0] op_sel_hi:[1,0]
  v_pk_mul_f32 v[126:127], v[126:127], v[118:119] op_sel:[0,0] op_sel_hi:[1,0]
  v_cvt_pk_bf16_f32 v75, v42, v43
  v_mfma_f32_16x16x32_bf16 a[116:119], v[248:251], a[236:239], a[116:119]
  ds_read_b64_tr_b16 v[68:69], v0 offset:2592
  ds_read_b64_tr_b16 v[70:71], v0 offset:2624
  v_mfma_f32_16x16x32_bf16 a[120:123], v[248:251], a[244:247], a[120:123]
  v_cvt_pk_bf16_f32 v153, v154, v155
  v_cvt_pk_bf16_f32 v154, v156, v157
  v_mfma_f32_16x16x32_bf16 a[120:123], v[240:243], a[240:243], a[120:123]
  v_cvt_pk_bf16_f32 v155, v158, v159
  v_mfma_f32_16x16x32_bf16 a[124:127], v[240:243], a[248:251], a[124:127]
  ds_write_b64 v27, v[74:75] offset:5184
  v_accvgpr_read_b32 v40, a49
  v_accvgpr_read_b32 v41, a53
  v_accvgpr_read_b32 v42, a57
  v_accvgpr_read_b32 v43, a61
  v_cvt_pk_bf16_f32 v78, v124, v125
  v_pk_mul_f32 v[36:37], v[36:37], v[112:113] op_sel:[0,1] op_sel_hi:[1,1]
  v_pk_mul_f32 v[38:39], v[38:39], v[112:113] op_sel:[0,1] op_sel_hi:[1,1]
  v_cvt_pk_bf16_f32 v79, v126, v127
  v_mfma_f32_16x16x32_bf16 a[124:127], v[248:251], a[252:255], a[124:127]
  s_waitcnt lgkmcnt(4)
  s_mov_b32 s48, s35
  s_lshl_b32 s37, s37, 1
  s_mov_b32 s32, s33
  s_mov_b32 s35, s34
  s_xor_b32 s33, s46, 0x502e000
  s_xor_b32 s34, s47, 0x2811400
L_blk1:
  v_mfma_f32_16x16x32_bf16 v[240:243], a[192:195], a[176:179], 0
  ds_read_b64_tr_b16 v[72:73], v0 offset:3104
  ds_read_b64_tr_b16 v[74:75], v0 offset:3136
  v_mfma_f32_16x16x32_bf16 v[240:243], a[196:199], a[180:183], v[240:243]
  ds_read_b128 a[224:227], v10 offset:24576
  v_mfma_f32_16x16x32_bf16 v[240:243], a[200:203], a[184:187], v[240:243]
  ds_write_b64 v27, v[78:79] offset:5696
  v_accvgpr_read_b32 v124, a50
  v_accvgpr_read_b32 v125, a54
  v_accvgpr_read_b32 v126, a58
  v_accvgpr_read_b32 v127, a62
  v_cvt_pk_bf16_f32 v82, v36, v37
  v_pk_mul_f32 v[40:41], v[40:41], v[114:115] op_sel:[0,1] op_sel_hi:[1,1]
  v_pk_mul_f32 v[42:43], v[42:43], v[114:115] op_sel:[0,1] op_sel_hi:[1,1]
  v_cvt_pk_bf16_f32 v83, v38, v39
  v_mfma_f32_16x16x32_bf16 v[240:243], a[204:207], a[188:191], v[240:243]
  ds_read_b64_tr_b16 v[76:77], v0 offset:3616
  ds_read_b64_tr_b16 v[78:79], v0 offset:3648
  v_mfma_f32_16x16x32_bf16 v[224:227], a[204:207], a[172:175], 0
  s_add_u32 m0, s30, 0
  s_xor_b32 s40, s32, 0x12000
  ds_read_b128 a[228:231], v11 offset:24576
  v_exp_f32 v168, v168
  v_mfma_f32_16x16x32_bf16 v[224:227], a[200:203], a[168:171], v[224:227]
  s_waitcnt vmcnt(12)
  buffer_load_dwordx4 v22, s[16:19], s40 offen nt lds
  v_mfma_f32_16x16x32_bf16 v[224:227], a[196:199], a[164:167], v[224:227]
  ds_write_b64 v27, v[82:83] offset:2080
  v_accvgpr_read_b32 v36, a51
  v_accvgpr_read_b32 v37, a55
  v_accvgpr_read_b32 v38, a59
  v_accvgpr_read_b32 v39, a63
  v_cvt_pk_bf16_f32 v86, v40, v41
  v_pk_mul_f32 v[124:125], v[124:125], v[116:117] op_sel:[0,1] op_sel_hi:[1,1]
  v_pk_mul_f32 v[126:127], v[126:127], v[116:117] op_sel:[0,1] op_sel_hi:[1,1]
  v_cvt_pk_bf16_f32 v87, v42, v43
  v_mfma_f32_16x16x32_bf16 v[224:227], a[192:195], a[160:163], v[224:227]
  ds_read_b128 a[232:235], v12 offset:24576
  ds_read_b64_tr_b16 v[80:81], v0
  v_mfma_f32_16x16x32_bf16 v[208:211], a[192:195], a[144:147], 0
  ds_read_b64_tr_b16 v[82:83], v0 offset:32
  v_mfma_f32_16x16x32_bf16 v[208:211], a[196:199], a[148:151], v[208:211]
  v_exp_f32 v169, v169
  v_mfma_f32_16x16x32_bf16 v[208:211], a[200:203], a[152:155], v[208:211]
  ds_read_b128 a[236:239], v13 offset:24576
  v_exp_f32 v170, v170
  v_mfma_f32_16x16x32_bf16 v[208:211], a[204:207], a[156:159], v[208:211]
  ds_write_b64 v27, v[86:87] offset:2592
  v_accvgpr_read_b32 v40, a64
  v_accvgpr_read_b32 v41, a68
  v_accvgpr_read_b32 v42, a72
  v_accvgpr_read_b32 v43, a76
  v_cvt_pk_bf16_f32 v90, v124, v125
  v_pk_mul_f32 v[36:37], v[36:37], v[118:119] op_sel:[0,1] op_sel_hi:[1,1]
  v_pk_mul_f32 v[38:39], v[38:39], v[118:119] op_sel:[0,1] op_sel_hi:[1,1]
  v_cvt_pk_bf16_f32 v91, v126, v127
  v_mfma_f32_16x16x32_bf16 v[192:195], a[204:207], a[140:143], 0
  ds_read_b64_tr_b16 v[84:85], v0 offset:512
  ds_read_b64_tr_b16 v[86:87], v0 offset:544
  v_mfma_f32_16x16x32_bf16 v[192:195], a[200:203], a[136:139], v[192:195]
  s_xor_b32 s43, s48, 0x0
  ds_read_b128 a[240:243], v10 offset:28672
  v_exp_f32 v171, v171
  v_mfma_f32_16x16x32_bf16 v[192:195], a[196:199], a[132:135], v[192:195]
  s_waitcnt vmcnt(12)
  buffer_store_dwordx4 v[64:67], v26, s[24:27], s43 offen sc1
  v_mfma_f32_16x16x32_bf16 v[192:195], a[192:195], a[128:131], v[192:195]
  v_exp_f32 v172, v172
  v_mfma_f32_16x16x32_bf16 v[196:199], a[208:211], a[128:131], 0
  ds_read_b128 a[244:247], v11 offset:28672
  v_cvt_pk_bf16_f32 v168, v168, v169
  v_mfma_f32_16x16x32_bf16 v[196:199], a[212:215], a[132:135], v[196:199]
  ds_write_b64 v27, v[90:91] offset:3104
  v_accvgpr_read_b32 v124, a65
  v_accvgpr_read_b32 v125, a69
  v_accvgpr_read_b32 v126, a73
  v_accvgpr_read_b32 v127, a77
  v_cvt_pk_bf16_f32 v94, v36, v37
  v_pk_mul_f32 v[40:41], v[40:41], v[2:3] op_sel:[0,0] op_sel_hi:[1,0]
  v_pk_mul_f32 v[42:43], v[42:43], v[2:3] op_sel:[0,0] op_sel_hi:[1,0]
  v_cvt_pk_bf16_f32 v95, v38, v39
  v_mfma_f32_16x16x32_bf16 v[196:199], a[216:219], a[136:139], v[196:199]
  ds_read_b64_tr_b16 v[88:89], v0 offset:1024
  ds_read_b64_tr_b16 v[90:91], v0 offset:1056
  v_mfma_f32_16x16x32_bf16 v[196:199], a[220:223], a[140:143], v[196:199]
  ds_read_b128 a[248:251], v12 offset:28672
  v_exp_f32 v173, v173
  v_mfma_f32_16x16x32_bf16 v[212:215], a[220:223], a[156:159], 0
  v_exp_f32 v174, v174
  v_mfma_f32_16x16x32_bf16 v[212:215], a[216:219], a[152:155], v[212:215]
  ds_write_b64 v27, v[94:95] offset:3616
  v_accvgpr_read_b32 v36, a66
  v_accvgpr_read_b32 v37, a70
  v_accvgpr_read_b32 v38, a74
  v_accvgpr_read_b32 v39, a78
  v_cvt_pk_bf16_f32 v96, v40, v41
  v_pk_mul_f32 v[124:125], v[124:125], v[4:5] op_sel:[0,0] op_sel_hi:[1,0]
  v_pk_mul_f32 v[126:127], v[126:127], v[4:5] op_sel:[0,0] op_sel_hi:[1,0]
  v_cvt_pk_bf16_f32 v97, v42, v43
  v_mfma_f32_16x16x32_bf16 v[212:215], a[212:215], a[148:151], v[212:215]
  ds_read_b128 a[252:255], v13 offset:28672
  ds_read_b64_tr_b16 v[92:93], v0 offset:1536
  v_cvt_pk_bf16_f32 v169, v170, v171
  v_mfma_f32_16x16x32_bf16 v[212:215], a[208:211], a[144:147], v[212:215]
  s_add_u32 m0, s30, 1024
  s_xor_b32 s40, s32, 0x12c00
  ds_read_b64_tr_b16 v[94:95], v0 offset:1568
  v_cvt_pk_bf16_f32 v170, v172, v173
  v_mfma_f32_16x16x32_bf16 v[228:231], a[208:211], a[160:163], 0
  s_waitcnt vmcnt(12)
  buffer_load_dwordx4 v23, s[16:19], s40 offen nt lds
  v_mfma_f32_16x16x32_bf16 v[228:231], a[212:215], a[164:167], v[228:231]
  v_exp_f32 v175, v175
  v_mfma_f32_16x16x32_bf16 v[228:231], a[216:219], a[168:171], v[228:231]
  ds_write_b64 v27, v[96:97] offset:2080
  v_accvgpr_read_b32 v40, a67
  v_accvgpr_read_b32 v41, a71
  v_accvgpr_read_b32 v42, a75
  v_accvgpr_read_b32 v43, a79
  v_cvt_pk_bf16_f32 v100, v124, v125
  v_pk_mul_f32 v[36:37], v[36:37], v[6:7] op_sel:[0,0] op_sel_hi:[1,0]
  v_pk_mul_f32 v[38:39], v[38:39], v[6:7] op_sel:[0,0] op_sel_hi:[1,0]
  v_cvt_pk_bf16_f32 v101, v126, v127
  v_mfma_f32_16x16x32_bf16 v[228:231], a[220:223], a[172:175], v[228:231]
  v_exp_f32 v184, v184
  v_mfma_f32_16x16x32_bf16 v[244:247], a[220:223], a[188:191], 0
  v_exp_f32 v185, v185
  v_cvt_pk_bf16_f32 v171, v174, v175
  v_mfma_f32_16x16x32_bf16 v[244:247], a[216:219], a[184:187], v[244:247]
  v_exp_f32 v186, v186
  v_mfma_f32_16x16x32_bf16 v[244:247], a[212:215], a[180:183], v[244:247]
  v_exp_f32 v187, v187
  v_mfma_f32_16x16x32_bf16 v[244:247], a[208:211], a[176:179], v[244:247]
  s_waitcnt vmcnt(19) lgkmcnt(0)
  s_barrier
  v_exp_f32 v188, v188
  v_mfma_f32_16x16x32_bf16 v[248:251], a[224:227], a[176:179], 0
  ds_read_b64_tr_b16 a[192:193], v14
  v_cvt_pk_bf16_f32 v184, v184, v185
  v_mfma_f32_16x16x32_bf16 v[248:251], a[228:231], a[180:183], v[248:251]
  ds_write_b64 v27, v[100:101] offset:2592
  v_accvgpr_read_b32 v132, a96
  v_accvgpr_read_b32 v133, a100
  v_accvgpr_read_b32 v134, a104
  v_accvgpr_read_b32 v135, a108
  v_cvt_pk_bf16_f32 v104, v36, v37
  v_pk_mul_f32 v[40:41], v[40:41], v[8:9] op_sel:[0,0] op_sel_hi:[1,0]
  v_pk_mul_f32 v[42:43], v[42:43], v[8:9] op_sel:[0,0] op_sel_hi:[1,0]
  v_cvt_pk_bf16_f32 v105, v38, v39
  v_mfma_f32_16x16x32_bf16 v[248:251], a[232:235], a[184:187], v[248:251]
  s_add_u32 m0, s30, 2048
  s_xor_b32 s40, s32, 0x2400
  ds_read_b64_tr_b16 a[194:195], v14 offset:4096
  v_exp_f32 v189, v189
  v_mfma_f32_16x16x32_bf16 v[248:251], a[236:239], a[188:191], v[248:251]
  s_waitcnt vmcnt(12)
  buffer_load_dwordx4 v24, s[16:19], s40 offen nt lds
  v_mfma_f32_16x16x32_bf16 v[232:235], a[236:239], a[172:175], 0
  ds_read_b64_tr_b16 a[196:197], v14 offset:8192
  v_mfma_f32_16x16x32_bf16 v[232:235], a[232:235], a[168:171], v[232:235]
  ds_write_b64 v27, v[104:105] offset:3104
  v_accvgpr_read_b32 v36, a97
  v_accvgpr_read_b32 v37, a101
  v_accvgpr_read_b32 v38, a105
  v_accvgpr_read_b32 v39, a109
  v_cvt_pk_bf16_f32 v108, v40, v41
  v_pk_mul_f32 v[132:133], v[132:133], v[2:3] op_sel:[0,1] op_sel_hi:[1,1]
  v_pk_mul_f32 v[134:135], v[134:135], v[2:3] op_sel:[0,1] op_sel_hi:[1,1]
  v_cvt_pk_bf16_f32 v109, v42, v43
  v_mfma_f32_16x16x32_bf16 v[232:235], a[228:231], a[164:167], v[232:235]
  ds_read_b64_tr_b16 a[198:199], v14 offset:12288
  v_exp_f32 v190, v190
  v_mfma_f32_16x16x32_bf16 v[232:235], a[224:227], a[160:163], v[232:235]
  v_exp_f32 v191, v191
  v_mfma_f32_16x16x32_bf16 v[216:219], a[224:227], a[144:147], 0
  ds_read_b64_tr_b16 a[200:201], v15
  v_exp_f32 v192, v192
  v_mfma_f32_16x16x32_bf16 v[216:219], a[228:231], a[148:151], v[216:219]
  ds_write_b64 v27, v[108:109] offset:3616
  v_accvgpr_read_b32 v40, a98
  v_accvgpr_read_b32 v41, a102
  v_accvgpr_read_b32 v42, a106
  v_accvgpr_read_b32 v43, a110
  v_cvt_pk_bf16_f32 v112, v132, v133
  v_pk_mul_f32 v[36:37], v[36:37], v[4:5] op_sel:[0,1] op_sel_hi:[1,1]
  v_pk_mul_f32 v[38:39], v[38:39], v[4:5] op_sel:[0,1] op_sel_hi:[1,1]
  v_cvt_pk_bf16_f32 v113, v134, v135
  v_mfma_f32_16x16x32_bf16 v[216:219], a[232:235], a[152:155], v[216:219]
  s_add_u32 m0, s30, 3072
  s_xor_b32 s40, s32, 0x2800
  ds_read_b64_tr_b16 a[202:203], v15 offset:4096
  v_cvt_pk_bf16_f32 v185, v186, v187
  v_mfma_f32_16x16x32_bf16 v[216:219], a[236:239], a[156:159], v[216:219]
  s_waitcnt vmcnt(12)
  buffer_load_dwordx4 v25, s[16:19], s40 offen nt lds
  v_mfma_f32_16x16x32_bf16 v[200:203], a[236:239], a[140:143], 0
  ds_read_b64_tr_b16 a[204:205], v15 offset:8192
  v_cvt_pk_bf16_f32 v186, v188, v189
  v_mfma_f32_16x16x32_bf16 v[200:203], a[232:235], a[136:139], v[200:203]
  v_exp_f32 v193, v193
  v_mfma_f32_16x16x32_bf16 v[200:203], a[228:231], a[132:135], v[200:203]
  ds_read_b64_tr_b16 a[206:207], v15 offset:12288
  v_exp_f32 v194, v194
  v_mfma_f32_16x16x32_bf16 v[200:203], a[224:227], a[128:131], v[200:203]
  ds_write_b64 v27, v[112:113]
  v_accvgpr_read_b32 v132, a99
  v_accvgpr_read_b32 v133, a103
  v_accvgpr_read_b32 v134, a107
  v_accvgpr_read_b32 v135, a111
  v_cvt_pk_bf16_f32 v116, v36, v37
  v_pk_mul_f32 v[40:41], v[40:41], v[6:7] op_sel:[0,1] op_sel_hi:[1,1]
  v_pk_mul_f32 v[42:43], v[42:43], v[6:7] op_sel:[0,1] op_sel_hi:[1,1]
  v_cvt_pk_bf16_f32 v117, v38, v39
  v_mfma_f32_16x16x32_bf16 v[204:207], a[240:243], a[128:131], 0
  ds_read_b64_tr_b16 a[208:209], v16
  v_cvt_pk_bf16_f32 v187, v190, v191
  v_mfma_f32_16x16x32_bf16 v[204:207], a[244:247], a[132:135], v[204:207]
  v_exp_f32 v195, v195
  v_cvt_pk_bf16_f32 v192, v192, v193
  v_mfma_f32_16x16x32_bf16 v[204:207], a[248:251], a[136:139], v[204:207]
  ds_read_b64_tr_b16 a[210:211], v16 offset:4096
  v_cvt_pk_bf16_f32 v193, v194, v195
  v_mfma_f32_16x16x32_bf16 v[204:207], a[252:255], a[140:143], v[204:207]
  ds_write_b64 v27, v[116:117] offset:512
  v_accvgpr_read_b32 v36, a80
  v_accvgpr_read_b32 v37, a84
L_pg7:
  s_cbranch_execz L_rt0
  v_accvgpr_read_b32 v38, a88
  v_accvgpr_read_b32 v39, a92
  v_cvt_pk_bf16_f32 v120, v40, v41
  v_pk_mul_f32 v[132:133], v[132:133], v[8:9] op_sel:[0,1] op_sel_hi:[1,1]
  v_pk_mul_f32 v[134:135], v[134:135], v[8:9] op_sel:[0,1] op_sel_hi:[1,1]
  v_cvt_pk_bf16_f32 v121, v42, v43
  v_mfma_f32_16x16x32_bf16 v[220:223], a[252:255], a[156:159], 0
  s_xor_b32 s43, s48, 0x6000
  ds_read_b64_tr_b16 a[212:213], v16 offset:8192
  v_mfma_f32_16x16x32_bf16 v[220:223], a[248:251], a[152:155], v[220:223]
  s_waitcnt vmcnt(12)
  buffer_store_dwordx4 v[68:71], v26, s[24:27], s43 offen sc1
  v_mfma_f32_16x16x32_bf16 v[220:223], a[244:247], a[148:151], v[220:223]
  ds_read_b64_tr_b16 a[214:215], v16 offset:12288
  v_mfma_f32_16x16x32_bf16 v[220:223], a[240:243], a[144:147], v[220:223]
  v_exp_f32 v196, v196
  v_mfma_f32_16x16x32_bf16 v[236:239], a[240:243], a[160:163], 0
  ds_read_b64_tr_b16 a[216:217], v17
  v_exp_f32 v197, v197
  v_mfma_f32_16x16x32_bf16 v[236:239], a[244:247], a[164:167], v[236:239]
  ds_write_b64 v27, v[120:121] offset:1024
  v_accvgpr_read_b32 v40, a81
  v_accvgpr_read_b32 v41, a85
  v_accvgpr_read_b32 v42, a89
  v_accvgpr_read_b32 v43, a93
  v_cvt_pk_bf16_f32 v124, v132, v133
  v_pk_mul_f32 v[36:37], v[36:37], v[2:3] op_sel:[0,0] op_sel_hi:[1,0]
  v_pk_mul_f32 v[38:39], v[38:39], v[2:3] op_sel:[0,0] op_sel_hi:[1,0]
  v_cvt_pk_bf16_f32 v125, v134, v135
  v_mfma_f32_16x16x32_bf16 v[236:239], a[248:251], a[168:171], v[236:239]
  ds_read_b64_tr_b16 a[218:219], v17 offset:4096
  v_cvt_pk_bf16_f32 v194, v196, v197
  v_mfma_f32_16x16x32_bf16 v[236:239], a[252:255], a[172:175], v[236:239]
  v_exp_f32 v198, v198
  v_mfma_f32_16x16x32_bf16 v[252:255], a[252:255], a[188:191], 0
  ds_read_b64_tr_b16 a[220:221], v17 offset:8192
  v_exp_f32 v199, v199
  v_mfma_f32_16x16x32_bf16 v[252:255], a[248:251], a[184:187], v[252:255]
  ds_write_b64 v27, v[124:125] offset:1536
  v_accvgpr_read_b32 v132, a82
  v_accvgpr_read_b32 v133, a86
  v_accvgpr_read_b32 v134, a90
  v_accvgpr_read_b32 v135, a94
  v_cvt_pk_bf16_f32 v98, v36, v37
  v_pk_mul_f32 v[40:41], v[40:41], v[4:5] op_sel:[0,0] op_sel_hi:[1,0]
  v_pk_mul_f32 v[42:43], v[42:43], v[4:5] op_sel:[0,0] op_sel_hi:[1,0]
  v_cvt_pk_bf16_f32 v99, v38, v39
  v_mfma_f32_16x16x32_bf16 v[252:255], a[244:247], a[180:183], v[252:255]
  s_add_u32 m0, s30, 114688
  s_xor_b32 s40, s32, 0x3c00
  ds_read_b64_tr_b16 a[222:223], v17 offset:12288
  v_cvt_pk_bf16_f32 v195, v198, v199
  v_mfma_f32_16x16x32_bf16 v[252:255], a[240:243], a[176:179], v[252:255]
  s_waitcnt vmcnt(12)
  buffer_load_dwordx4 v22, s[20:23], s40 offen nt lds
  v_mfma_f32_16x16x32_bf16 v[48:51], v[44:47], v[128:131], 0
  ds_read_b64_tr_b16 a[224:225], v18
  v_mfma_f32_16x16x32_bf16 v[48:51], v[44:47], v[136:139], v[48:51]
  v_exp_f32 v208, v208
  v_mfma_f32_16x16x32_bf16 v[52:55], v[44:47], v[144:147], 0
  ds_read_b64_tr_b16 a[226:227], v18 offset:4096
  v_exp_f32 v209, v209
  v_mfma_f32_16x16x32_bf16 v[52:55], v[44:47], v[152:155], v[52:55]
  ds_write_b64 v27, v[98:99] offset:4160
  v_accvgpr_read_b32 v36, a83
  v_accvgpr_read_b32 v37, a87
  v_accvgpr_read_b32 v38, a91
  v_accvgpr_read_b32 v39, a95
  v_cvt_pk_bf16_f32 v102, v40, v41
  v_pk_mul_f32 v[132:133], v[132:133], v[6:7] op_sel:[0,0] op_sel_hi:[1,0]
  v_pk_mul_f32 v[134:135], v[134:135], v[6:7] op_sel:[0,0] op_sel_hi:[1,0]
  v_cvt_pk_bf16_f32 v103, v42, v43
  v_mfma_f32_16x16x32_bf16 v[56:59], v[44:47], v[160:163], 0
  ds_read_b64_tr_b16 a[228:229], v18 offset:8192
  ds_read_b64_tr_b16 v[96:97], v0 offset:2080
  v_mfma_f32_16x16x32_bf16 v[56:59], v[44:47], v[168:171], v[56:59]
  ds_read_b64_tr_b16 v[98:99], v0 offset:2112
  v_exp_f32 v210, v210
  v_mfma_f32_16x16x32_bf16 v[60:63], v[44:47], v[176:179], 0
  ds_read_b64_tr_b16 a[230:231], v18 offset:12288
  v_cvt_pk_bf16_f32 v208, v208, v209
  v_mfma_f32_16x16x32_bf16 v[60:63], v[44:47], v[184:187], v[60:63]
  s_waitcnt lgkmcnt(7)
  ds_write_b64 v27, v[102:103] offset:4672
  v_accvgpr_read_b32 v40, a112
  v_accvgpr_read_b32 v41, a116
  v_accvgpr_read_b32 v42, a120
  v_accvgpr_read_b32 v43, a124
  v_cvt_pk_bf16_f32 v106, v132, v133
  v_pk_mul_f32 v[36:37], v[36:37], v[8:9] op_sel:[0,0] op_sel_hi:[1,0]
  v_pk_mul_f32 v[38:39], v[38:39], v[8:9] op_sel:[0,0] op_sel_hi:[1,0]
  v_cvt_pk_bf16_f32 v107, v134, v135
  v_mfma_f32_16x16x32_bf16 a[12:15], v[136:139], a[220:223], 0
  ds_read_b64_tr_b16 a[232:233], v19
  ds_read_b64_tr_b16 v[100:101], v0 offset:2592
  v_mfma_f32_16x16x32_bf16 a[12:15], v[128:131], a[216:219], a[12:15]
  ds_read_b64_tr_b16 v[102:103], v0 offset:2624
  v_exp_f32 v211, v211
  v_mfma_f32_16x16x32_bf16 a[8:11], v[128:131], a[208:211], 0
  s_add_u32 m0, s30, 115712
  s_xor_b32 s40, s32, 0x3000
  ds_read_b64_tr_b16 a[234:235], v19 offset:4096
  v_cvt_pk_bf16_f32 v209, v210, v211
  v_mfma_f32_16x16x32_bf16 a[8:11], v[136:139], a[212:215], a[8:11]
  s_waitcnt vmcnt(12)
  buffer_load_dwordx4 v23, s[20:23], s40 offen nt lds
  v_mfma_f32_16x16x32_bf16 a[4:7], v[136:139], a[204:207], 0
  ds_read_b64_tr_b16 a[236:237], v19 offset:8192
  v_mfma_f32_16x16x32_bf16 a[4:7], v[128:131], a[200:203], a[4:7]
  ds_write_b64 v27, v[106:107] offset:5184
  v_accvgpr_read_b32 v132, a113
  v_accvgpr_read_b32 v133, a117
  v_accvgpr_read_b32 v134, a121
  v_accvgpr_read_b32 v135, a125
  v_cvt_pk_bf16_f32 v110, v36, v37
  v_pk_mul_f32 v[40:41], v[40:41], v[2:3] op_sel:[0,1] op_sel_hi:[1,1]
  v_pk_mul_f32 v[42:43], v[42:43], v[2:3] op_sel:[0,1] op_sel_hi:[1,1]
  v_cvt_pk_bf16_f32 v111, v38, v39
  v_mfma_f32_16x16x32_bf16 a[0:3], v[128:131], a[192:195], 0
  ds_read_b64_tr_b16 a[238:239], v19 offset:12288
  ds_read_b64_tr_b16 v[104:105], v0 offset:3104
  v_mfma_f32_16x16x32_bf16 a[0:3], v[136:139], a[196:199], a[0:3]
  ds_read_b64_tr_b16 v[106:107], v0 offset:3136
  v_exp_f32 v212, v212
  v_mfma_f32_16x16x32_bf16 a[32:35], v[152:155], a[196:199], 0
  ds_read_b64_tr_b16 a[240:241], v20
  v_mfma_f32_16x16x32_bf16 a[32:35], v[144:147], a[192:195], a[32:35]
  ds_write_b64 v27, v[110:111] offset:5696
  v_accvgpr_read_b32 v36, a114
  v_accvgpr_read_b32 v37, a118
  v_accvgpr_read_b32 v38, a122
  v_accvgpr_read_b32 v39, a126
  v_cvt_pk_bf16_f32 v114, v40, v41
  v_pk_mul_f32 v[132:133], v[132:133], v[4:5] op_sel:[0,1] op_sel_hi:[1,1]
  v_pk_mul_f32 v[134:135], v[134:135], v[4:5] op_sel:[0,1] op_sel_hi:[1,1]
  v_cvt_pk_bf16_f32 v115, v42, v43
  v_mfma_f32_16x16x32_bf16 a[36:39], v[144:147], a[200:203], 0
  ds_read_b64_tr_b16 a[242:243], v20 offset:4096
  ds_read_b64_tr_b16 v[108:109], v0 offset:3616
  v_mfma_f32_16x16x32_bf16 a[36:39], v[152:155], a[204:207], a[36:39]
  ds_read_b64_tr_b16 v[110:111], v0 offset:3648
  v_exp_f32 v213, v213
  v_mfma_f32_16x16x32_bf16 a[40:43], v[152:155], a[212:215], 0
  s_xor_b32 s43, s48, 0x400
  ds_read_b64_tr_b16 a[244:245], v20 offset:8192
  v_cvt_pk_bf16_f32 v210, v212, v213
  v_mfma_f32_16x16x32_bf16 a[40:43], v[144:147], a[208:211], a[40:43]
  s_waitcnt vmcnt(12)
  buffer_store_dwordx4 v[72:75], v26, s[24:27], s43 offen sc1
  v_mfma_f32_16x16x32_bf16 a[44:47], v[144:147], a[216:219], 0
  ds_read_b64_tr_b16 a[246:247], v20 offset:12288
  v_mfma_f32_16x16x32_bf16 a[44:47], v[152:155], a[220:223], a[44:47]
  ds_write_b64 v27, v[114:115] offset:2080
  v_accvgpr_read_b32 v40, a115
  v_accvgpr_read_b32 v41, a119
  v_accvgpr_read_b32 v42, a123
  v_accvgpr_read_b32 v43, a127
  v_cvt_pk_bf16_f32 v118, v132, v133
  v_pk_mul_f32 v[36:37], v[36:37], v[6:7] op_sel:[0,1] op_sel_hi:[1,1]
  v_pk_mul_f32 v[38:39], v[38:39], v[6:7] op_sel:[0,1] op_sel_hi:[1,1]
  v_cvt_pk_bf16_f32 v119, v134, v135
  v_mfma_f32_16x16x32_bf16 a[76:79], v[168:171], a[220:223], 0
  ds_read_b64_tr_b16 a[248:249], v21
  ds_read_b64_tr_b16 v[112:113], v0
  v_mfma_f32_16x16x32_bf16 a[76:79], v[160:163], a[216:219], a[76:79]
  ds_read_b64_tr_b16 v[114:115], v0 offset:32
  v_exp_f32 v214, v214
  v_mfma_f32_16x16x32_bf16 a[72:75], v[160:163], a[208:211], 0
  ds_read_b64_tr_b16 a[250:251], v21 offset:4096
  v_mfma_f32_16x16x32_bf16 a[72:75], v[168:171], a[212:215], a[72:75]
  ds_write_b64 v27, v[118:119] offset:2592
  v_cvt_pk_bf16_f32 v122, v36, v37
  v_pk_mul_f32 v[40:41], v[40:41], v[8:9] op_sel:[0,1] op_sel_hi:[1,1]
  v_pk_mul_f32 v[42:43], v[42:43], v[8:9] op_sel:[0,1] op_sel_hi:[1,1]
  v_cvt_pk_bf16_f32 v123, v38, v39
  v_mfma_f32_16x16x32_bf16 a[68:71], v[168:171], a[204:207], 0
  ds_read_b64_tr_b16 a[252:253], v21 offset:8192
  ds_read_b64_tr_b16 v[116:117], v0 offset:512
  v_mfma_f32_16x16x32_bf16 a[68:71], v[160:163], a[200:203], a[68:71]
  ds_read_b64_tr_b16 v[118:119], v0 offset:544
  v_exp_f32 v215, v215
  v_mfma_f32_16x16x32_bf16 a[64:67], v[160:163], a[192:195], 0
  s_add_u32 m0, s30, 116736
  s_xor_b32 s40, s32, 0x13800
  ds_read_b64_tr_b16 a[254:255], v21 offset:12288
  v_cvt_pk_bf16_f32 v211, v214, v215
  v_mfma_f32_16x16x32_bf16 a[64:67], v[168:171], a[196:199], a[64:67]
  s_waitcnt vmcnt(12)
  buffer_load_dwordx4 v24, s[20:23], s40 offen nt lds
  v_mfma_f32_16x16x32_bf16 a[96:99], v[184:187], a[196:199], 0
  ds_write_b64 v27, v[122:123] offset:3104
  v_cvt_pk_bf16_f32 v126, v40, v41
  v_cvt_pk_bf16_f32 v127, v42, v43
  v_mfma_f32_16x16x32_bf16 a[96:99], v[176:179], a[192:195], a[96:99]
  s_add_u32 m0, s30, 117760
  s_xor_b32 s40, s32, 0x13400
  ds_read_b64_tr_b16 v[120:121], v0 offset:1024
  ds_read_b64_tr_b16 v[122:123], v0 offset:1056
  v_mfma_f32_16x16x32_bf16 a[100:103], v[176:179], a[200:203], 0
  s_waitcnt vmcnt(12)
  buffer_load_dwordx4 v25, s[20:23], s40 offen nt lds
  v_mfma_f32_16x16x32_bf16 a[100:103], v[184:187], a[204:207], a[100:103]
  s_waitcnt vmcnt(7) lgkmcnt(0)
  s_cmpk_lt_i32 s9, 0x0
  s_cbranch_scc0 L_fb1_1
  s_waitcnt vmcnt(5)
L_fb1_1:
  s_barrier
  v_mfma_f32_16x16x32_bf16 a[104:107], v[184:187], a[212:215], 0
  ds_read_b128 a[192:195], v10 offset:32768
  v_mfma_f32_16x16x32_bf16 a[104:107], v[176:179], a[208:211], a[104:107]
  ds_write_b64 v27, v[126:127] offset:3616
  v_mfma_f32_16x16x32_bf16 a[108:111], v[176:179], a[216:219], 0
  ds_read_b64_tr_b16 v[124:125], v0 offset:1536
  ds_read_b64_tr_b16 v[126:127], v0 offset:1568
  v_mfma_f32_16x16x32_bf16 a[108:111], v[184:187], a[220:223], a[108:111]
  v_exp_f32 v224, v224
  v_mfma_f32_16x16x32_bf16 a[28:31], v[136:139], a[252:255], 0
  ds_read_b128 a[196:199], v11 offset:32768
  v_exp_f32 v225, v225
  v_mfma_f32_16x16x32_bf16 a[28:31], v[128:131], a[248:251], a[28:31]
  v_exp_f32 v226, v226
  v_mfma_f32_16x16x32_bf16 a[24:27], v[128:131], a[240:243], 0
  v_exp_f32 v227, v227
  v_cvt_pk_bf16_f32 v224, v224, v225
  v_mfma_f32_16x16x32_bf16 a[24:27], v[136:139], a[244:247], a[24:27]
  v_exp_f32 v228, v228
  v_mfma_f32_16x16x32_bf16 a[20:23], v[136:139], a[236:239], 0
  s_waitcnt lgkmcnt(1)
  s_xor_b32 s43, s48, 0x6400
  ds_read_b128 a[200:203], v12 offset:32768
  v_exp_f32 v229, v229
  v_mfma_f32_16x16x32_bf16 a[20:23], v[128:131], a[232:235], a[20:23]
  s_waitcnt vmcnt(12)
  buffer_store_dwordx4 v[76:79], v26, s[24:27], s43 offen sc1
  v_mfma_f32_16x16x32_bf16 a[16:19], v[128:131], a[224:227], 0
  v_cvt_pk_bf16_f32 v225, v226, v227
  v_mfma_f32_16x16x32_bf16 a[16:19], v[136:139], a[228:231], a[16:19]
  v_exp_f32 v230, v230
  v_cvt_pk_bf16_f32 v226, v228, v229
  v_mfma_f32_16x16x32_bf16 a[48:51], v[152:155], a[228:231], 0
  ds_read_b128 a[204:207], v13 offset:32768
  v_mfma_f32_16x16x32_bf16 a[48:51], v[144:147], a[224:227], a[48:51]
  v_exp_f32 v231, v231
  v_mfma_f32_16x16x32_bf16 a[52:55], v[144:147], a[232:235], 0
  v_exp_f32 v240, v240
  v_cvt_pk_bf16_f32 v227, v230, v231
  v_mfma_f32_16x16x32_bf16 a[52:55], v[152:155], a[236:239], a[52:55]
  v_exp_f32 v241, v241
  v_mfma_f32_16x16x32_bf16 a[56:59], v[152:155], a[244:247], 0
  ds_read_b128 a[208:211], v10 offset:36864
  v_exp_f32 v242, v242
  v_mfma_f32_16x16x32_bf16 a[56:59], v[144:147], a[240:243], a[56:59]
  v_exp_f32 v243, v243
  v_mfma_f32_16x16x32_bf16 a[60:63], v[144:147], a[248:251], 0
  v_exp_f32 v244, v244
  v_cvt_pk_bf16_f32 v240, v240, v241
  v_mfma_f32_16x16x32_bf16 a[60:63], v[152:155], a[252:255], a[60:63]
  v_exp_f32 v245, v245
  v_mfma_f32_16x16x32_bf16 a[92:95], v[168:171], a[252:255], 0
  s_add_u32 m0, s31, 0
  s_xor_b32 s42, s34, 0x0
  ds_read_b128 a[212:215], v11 offset:36864
  v_cvt_pk_bf16_f32 v241, v242, v243
  v_mfma_f32_16x16x32_bf16 a[92:95], v[160:163], a[248:251], a[92:95]
  s_waitcnt vmcnt(12)
  buffer_load_dwordx4 v22, s[12:15], s42 offen nt lds
  v_mfma_f32_16x16x32_bf16 a[88:91], v[160:163], a[240:243], 0
  v_exp_f32 v246, v246
  v_mfma_f32_16x16x32_bf16 a[88:91], v[168:171], a[244:247], a[88:91]
  v_exp_f32 v247, v247
  v_cvt_pk_bf16_f32 v242, v244, v245
  v_mfma_f32_16x16x32_bf16 a[84:87], v[168:171], a[236:239], 0
  ds_read_b128 a[216:219], v12 offset:36864
  v_cvt_pk_bf16_f32 v243, v246, v247
  v_mfma_f32_16x16x32_bf16 a[84:87], v[160:163], a[232:235], a[84:87]
  v_exp_f32 v200, v200
  v_mfma_f32_16x16x32_bf16 a[80:83], v[160:163], a[224:227], 0
  v_exp_f32 v201, v201
  v_mfma_f32_16x16x32_bf16 a[80:83], v[168:171], a[228:231], a[80:83]
  v_exp_f32 v202, v202
  v_cvt_pk_bf16_f32 v200, v200, v201
  v_mfma_f32_16x16x32_bf16 a[112:115], v[184:187], a[228:231], 0
  ds_read_b128 a[220:223], v13 offset:36864
  v_mfma_f32_16x16x32_bf16 a[112:115], v[176:179], a[224:227], a[112:115]
  v_exp_f32 v203, v203
  v_mfma_f32_16x16x32_bf16 a[116:119], v[176:179], a[232:235], 0
  v_exp_f32 v204, v204
  v_cvt_pk_bf16_f32 v201, v202, v203
  v_mfma_f32_16x16x32_bf16 a[116:119], v[184:187], a[236:239], a[116:119]
  s_add_u32 m0, s31, 1024
  s_xor_b32 s42, s34, 0x6000
  v_exp_f32 v205, v205
  v_mfma_f32_16x16x32_bf16 a[120:123], v[184:187], a[244:247], 0
  s_waitcnt vmcnt(12)
  buffer_load_dwordx4 v23, s[12:15], s42 offen nt lds
  v_mfma_f32_16x16x32_bf16 a[120:123], v[176:179], a[240:243], a[120:123]
  v_exp_f32 v206, v206
  v_mfma_f32_16x16x32_bf16 a[124:127], v[176:179], a[248:251], 0
  v_exp_f32 v207, v207
  v_cvt_pk_bf16_f32 v202, v204, v205
  v_mfma_f32_16x16x32_bf16 a[124:127], v[184:187], a[252:255], a[124:127]
  s_waitcnt lgkmcnt(0)
  v_exp_f32 v216, v216
  v_mfma_f32_16x16x32_bf16 v[176:179], a[192:195], a[176:179], 0
  v_exp_f32 v217, v217
  v_mfma_f32_16x16x32_bf16 v[176:179], a[196:199], a[180:183], v[176:179]
  ds_read_b128 a[224:227], v10 offset:40960
  v_exp_f32 v218, v218
  v_mfma_f32_16x16x32_bf16 v[176:179], a[200:203], a[184:187], v[176:179]
  v_exp_f32 v219, v219
  v_mfma_f32_16x16x32_bf16 v[176:179], a[204:207], a[188:191], v[176:179]
  v_exp_f32 v220, v220
  v_cvt_pk_bf16_f32 v203, v206, v207
  v_mfma_f32_16x16x32_bf16 v[160:163], a[204:207], a[172:175], 0
  ds_read_b128 a[228:231], v11 offset:40960
  v_cvt_pk_bf16_f32 v216, v216, v217
  v_mfma_f32_16x16x32_bf16 v[160:163], a[200:203], a[168:171], v[160:163]
  v_exp_f32 v221, v221
  v_mfma_f32_16x16x32_bf16 v[160:163], a[196:199], a[164:167], v[160:163]
  v_exp_f32 v222, v222
  v_cvt_pk_bf16_f32 v217, v218, v219
  v_mfma_f32_16x16x32_bf16 v[160:163], a[192:195], a[160:163], v[160:163]
  s_add_u32 m0, s31, 2048
  s_xor_b32 s42, s34, 0x400
  ds_read_b128 a[232:235], v12 offset:40960
  v_cvt_pk_bf16_f32 v218, v220, v221
  v_mfma_f32_16x16x32_bf16 v[144:147], a[192:195], a[144:147], 0
  s_waitcnt vmcnt(12)
  buffer_load_dwordx4 v24, s[12:15], s42 offen nt lds
  v_mfma_f32_16x16x32_bf16 v[144:147], a[196:199], a[148:151], v[144:147]
  v_exp_f32 v223, v223
  v_mfma_f32_16x16x32_bf16 v[144:147], a[200:203], a[152:155], v[144:147]
  ds_read_b128 a[236:239], v13 offset:40960
  v_cvt_pk_bf16_f32 v219, v222, v223
  v_mfma_f32_16x16x32_bf16 v[144:147], a[204:207], a[156:159], v[144:147]
  v_exp_f32 v232, v232
  v_mfma_f32_16x16x32_bf16 v[128:131], a[204:207], a[140:143], 0
  v_exp_f32 v233, v233
  v_mfma_f32_16x16x32_bf16 v[128:131], a[200:203], a[136:139], v[128:131]
  ds_read_b128 a[240:243], v10 offset:45056
  v_exp_f32 v234, v234
  v_mfma_f32_16x16x32_bf16 v[128:131], a[196:199], a[132:135], v[128:131]
  v_exp_f32 v235, v235
  v_mfma_f32_16x16x32_bf16 v[128:131], a[192:195], a[128:131], v[128:131]
  v_exp_f32 v236, v236
  v_cvt_pk_bf16_f32 v232, v232, v233
  v_mfma_f32_16x16x32_bf16 v[132:135], a[208:211], a[128:131], 0
  ds_read_b128 a[244:247], v11 offset:45056
  v_cvt_pk_bf16_f32 v233, v234, v235
  v_mfma_f32_16x16x32_bf16 v[132:135], a[212:215], a[132:135], v[132:135]
  v_exp_f32 v237, v237
  v_mfma_f32_16x16x32_bf16 v[132:135], a[216:219], a[136:139], v[132:135]
  v_exp_f32 v238, v238
  v_cvt_pk_bf16_f32 v234, v236, v237
  v_mfma_f32_16x16x32_bf16 v[132:135], a[220:223], a[140:143], v[132:135]
  s_add_u32 m0, s31, 3072
  s_xor_b32 s42, s34, 0x6400
  ds_read_b128 a[248:251], v12 offset:45056
  v_mfma_f32_16x16x32_bf16 v[148:151], a[220:223], a[156:159], 0
  s_waitcnt vmcnt(12)
  buffer_load_dwordx4 v25, s[12:15], s42 offen nt lds
  v_mfma_f32_16x16x32_bf16 v[148:151], a[216:219], a[152:155], v[148:151]
  v_exp_f32 v239, v239
  v_mfma_f32_16x16x32_bf16 v[148:151], a[212:215], a[148:151], v[148:151]
  ds_read_b128 a[252:255], v13 offset:45056
  v_exp_f32 v248, v248
  v_mfma_f32_16x16x32_bf16 v[148:151], a[208:211], a[144:147], v[148:151]
  v_exp_f32 v249, v249
  v_mfma_f32_16x16x32_bf16 v[164:167], a[208:211], a[160:163], 0
  v_exp_f32 v250, v250
  v_cvt_pk_bf16_f32 v235, v238, v239
  v_mfma_f32_16x16x32_bf16 v[164:167], a[212:215], a[164:167], v[164:167]
  v_exp_f32 v251, v251
  v_mfma_f32_16x16x32_bf16 v[164:167], a[216:219], a[168:171], v[164:167]
  v_exp_f32 v252, v252
  v_mfma_f32_16x16x32_bf16 v[164:167], a[220:223], a[172:175], v[164:167]
  v_exp_f32 v253, v253
  v_cvt_pk_bf16_f32 v248, v248, v249
  v_mfma_f32_16x16x32_bf16 v[180:183], a[220:223], a[188:191], 0
  v_exp_f32 v254, v254
  v_mfma_f32_16x16x32_bf16 v[180:183], a[216:219], a[184:187], v[180:183]
  v_exp_f32 v255, v255
  v_cvt_pk_bf16_f32 v249, v250, v251
  v_mfma_f32_16x16x32_bf16 v[180:183], a[212:215], a[180:183], v[180:183]
  v_exp_f32 v128, v128
  v_mfma_f32_16x16x32_bf16 v[180:183], a[208:211], a[176:179], v[180:183]
  s_mov_b64 exec, 0
  s_cmp_eq_u32 s45, 0
  s_cbranch_scc1 L_pg8
  s_cmp_eq_u32 s45, 1
  s_cbranch_scc1 L_pg9
  s_cmp_eq_u32 s45, 2
  s_cbranch_scc1 L_pg10
  s_branch L_pg11
L_rt1:
  s_mov_b64 exec, -1
  s_waitcnt vmcnt(7) lgkmcnt(0)
  s_cmpk_lt_i32 s10, 0x0
  s_cbranch_scc0 L_fb1_2
  s_waitcnt vmcnt(4)
L_fb1_2:
  s_barrier
  v_mfma_f32_16x16x32_bf16 v[184:187], a[224:227], a[176:179], 0
  s_add_u32 m0, s31, 4096
  s_xor_b32 s42, s34, 0x5000
  ds_read_b64_tr_b16 a[192:193], v14 offset:16384
  v_exp_f32 v129, v129
  v_mfma_f32_16x16x32_bf16 v[184:187], a[228:231], a[180:183], v[184:187]
  s_waitcnt vmcnt(12)
  buffer_load_dwordx4 v22, s[12:15], s42 offen nt lds
  v_mfma_f32_16x16x32_bf16 v[184:187], a[232:235], a[184:187], v[184:187]
  ds_read_b64_tr_b16 a[194:195], v14 offset:20480
  v_cvt_pk_bf16_f32 v250, v252, v253
  v_mfma_f32_16x16x32_bf16 v[184:187], a[236:239], a[188:191], v[184:187]
  v_exp_f32 v130, v130
  v_mfma_f32_16x16x32_bf16 v[168:171], a[236:239], a[172:175], 0
  ds_read_b64_tr_b16 a[196:197], v14 offset:24576
  v_cvt_pk_bf16_f32 v251, v254, v255
  v_mfma_f32_16x16x32_bf16 v[168:171], a[232:235], a[168:171], v[168:171]
  v_exp_f32 v131, v131
  v_cvt_pk_bf16_f32 v128, v128, v129
  v_mfma_f32_16x16x32_bf16 v[168:171], a[228:231], a[164:167], v[168:171]
  ds_read_b64_tr_b16 a[198:199], v14 offset:28672
  v_cvt_pk_bf16_f32 v129, v130, v131
  v_mfma_f32_16x16x32_bf16 v[168:171], a[224:227], a[160:163], v[168:171]
  v_exp_f32 v132, v132
  v_mfma_f32_16x16x32_bf16 v[152:155], a[224:227], a[144:147], 0
  ds_read_b64_tr_b16 a[200:201], v15 offset:16384
  v_exp_f32 v133, v133
  v_mfma_f32_16x16x32_bf16 v[152:155], a[228:231], a[148:151], v[152:155]
  v_exp_f32 v134, v134
  v_mfma_f32_16x16x32_bf16 v[152:155], a[232:235], a[152:155], v[152:155]
  ds_read_b64_tr_b16 a[202:203], v15 offset:20480
  v_exp_f32 v135, v135
  v_mfma_f32_16x16x32_bf16 v[152:155], a[236:239], a[156:159], v[152:155]
  v_exp_f32 v144, v144
  v_mfma_f32_16x16x32_bf16 v[136:139], a[236:239], a[140:143], 0
  s_add_u32 m0, s31, 5120
  s_xor_b32 s42, s34, 0x3000
  ds_read_b64_tr_b16 a[204:205], v15 offset:24576
  v_exp_f32 v145, v145
  v_mfma_f32_16x16x32_bf16 v[136:139], a[232:235], a[136:139], v[136:139]
  s_waitcnt vmcnt(12)
  buffer_load_dwordx4 v23, s[12:15], s42 offen nt lds
  v_mfma_f32_16x16x32_bf16 v[136:139], a[228:231], a[132:135], v[136:139]
  ds_read_b64_tr_b16 a[206:207], v15 offset:28672
  v_mfma_f32_16x16x32_bf16 v[136:139], a[224:227], a[128:131], v[136:139]
  v_exp_f32 v146, v146
  v_cvt_pk_bf16_f32 v130, v132, v133
  v_mfma_f32_16x16x32_bf16 v[140:143], a[240:243], a[128:131], 0
  ds_read_b64_tr_b16 a[208:209], v16 offset:16384
  v_cvt_pk_bf16_f32 v131, v134, v135
  v_mfma_f32_16x16x32_bf16 v[140:143], a[244:247], a[132:135], v[140:143]
  v_exp_f32 v147, v147
  v_cvt_pk_bf16_f32 v144, v144, v145
  v_mfma_f32_16x16x32_bf16 v[140:143], a[248:251], a[136:139], v[140:143]
  ds_read_b64_tr_b16 a[210:211], v16 offset:20480
  v_cvt_pk_bf16_f32 v145, v146, v147
  v_mfma_f32_16x16x32_bf16 v[140:143], a[252:255], a[140:143], v[140:143]
  v_exp_f32 v148, v148
  v_mfma_f32_16x16x32_bf16 v[156:159], a[252:255], a[156:159], 0
  ds_read_b64_tr_b16 a[212:213], v16 offset:24576
  v_exp_f32 v149, v149
  v_mfma_f32_16x16x32_bf16 v[156:159], a[248:251], a[152:155], v[156:159]
  v_exp_f32 v150, v150
  v_mfma_f32_16x16x32_bf16 v[156:159], a[244:247], a[148:151], v[156:159]
  s_add_u32 m0, s31, 6144
  s_xor_b32 s42, s34, 0x5400
  ds_read_b64_tr_b16 a[214:215], v16 offset:28672
  v_exp_f32 v151, v151
  v_mfma_f32_16x16x32_bf16 v[156:159], a[240:243], a[144:147], v[156:159]
  s_waitcnt vmcnt(12)
  buffer_load_dwordx4 v24, s[12:15], s42 offen nt lds
  v_mfma_f32_16x16x32_bf16 v[172:175], a[240:243], a[160:163], 0
  ds_read_b64_tr_b16 a[216:217], v17 offset:16384
  v_mfma_f32_16x16x32_bf16 v[172:175], a[244:247], a[164:167], v[172:175]
  v_exp_f32 v160, v160
  v_cvt_pk_bf16_f32 v146, v148, v149
  v_mfma_f32_16x16x32_bf16 v[172:175], a[248:251], a[168:171], v[172:175]
  ds_read_b64_tr_b16 a[218:219], v17 offset:20480
  v_cvt_pk_bf16_f32 v147, v150, v151
  v_mfma_f32_16x16x32_bf16 v[172:175], a[252:255], a[172:175], v[172:175]
  v_exp_f32 v161, v161
  v_mfma_f32_16x16x32_bf16 v[188:191], a[252:255], a[188:191], 0
  ds_read_b64_tr_b16 a[220:221], v17 offset:24576
  v_exp_f32 v162, v162
  v_mfma_f32_16x16x32_bf16 v[188:191], a[248:251], a[184:187], v[188:191]
  v_exp_f32 v163, v163
  v_mfma_f32_16x16x32_bf16 v[188:191], a[244:247], a[180:183], v[188:191]
  ds_read_b64_tr_b16 a[222:223], v17 offset:28672
  v_exp_f32 v164, v164
  v_mfma_f32_16x16x32_bf16 v[188:191], a[240:243], a[176:179], v[188:191]
  v_exp_f32 v165, v165
  v_mfma_f32_16x16x32_bf16 v[48:51], v[44:47], v[192:195], v[48:51]
  ds_read_b64_tr_b16 a[224:225], v18 offset:16384
  v_cvt_pk_bf16_f32 v160, v160, v161
  v_mfma_f32_16x16x32_bf16 v[48:51], v[44:47], v[200:203], v[48:51]
  v_exp_f32 v166, v166
  v_mfma_f32_16x16x32_bf16 v[52:55], v[44:47], v[208:211], v[52:55]
  ds_read_b64_tr_b16 a[226:227], v18 offset:20480
  v_cvt_pk_bf16_f32 v161, v162, v163
  v_mfma_f32_16x16x32_bf16 v[52:55], v[44:47], v[216:219], v[52:55]
  v_mov_b32 v252, 1
  v_cvt_pk_bf16_f32 v162, v164, v165
  v_mfma_f32_16x16x32_bf16 v[56:59], v[44:47], v[224:227], v[56:59]
  ds_read_b64_tr_b16 a[228:229], v18 offset:24576
  v_mfma_f32_16x16x32_bf16 v[56:59], v[44:47], v[232:235], v[56:59]
  s_waitcnt vmcnt(12)
  buffer_atomic_add v252, v26, s[4:7], 0 offen sc0 sc1
  v_mfma_f32_16x16x32_bf16 v[60:63], v[44:47], v[240:243], v[60:63]
  ds_read_b64_tr_b16 a[230:231], v18 offset:28672
  v_mfma_f32_16x16x32_bf16 v[60:63], v[44:47], v[248:251], v[60:63]
  s_waitcnt lgkmcnt(4)
  v_exp_f32 v167, v167
  v_mfma_f32_16x16x32_bf16 a[96:99], v[248:251], a[196:199], a[96:99]
  s_add_u32 m0, s31, 7168
  s_xor_b32 s42, s34, 0x3400
  ds_read_b64_tr_b16 a[232:233], v19 offset:16384
  v_cvt_pk_bf16_f32 v163, v166, v167
  v_mfma_f32_16x16x32_bf16 a[96:99], v[240:243], a[192:195], a[96:99]
  s_waitcnt vmcnt(12)
  buffer_load_dwordx4 v25, s[12:15], s42 offen nt lds
  v_mfma_f32_16x16x32_bf16 a[64:67], v[224:227], a[192:195], a[64:67]
  ds_read_b64_tr_b16 a[234:235], v19 offset:20480
  v_mfma_f32_16x16x32_bf16 a[64:67], v[232:235], a[196:199], a[64:67]
  v_exp_f32 v176, v176
  v_mfma_f32_16x16x32_bf16 a[32:35], v[216:219], a[196:199], a[32:35]
  ds_read_b64_tr_b16 a[236:237], v19 offset:24576
  v_mfma_f32_16x16x32_bf16 a[32:35], v[208:211], a[192:195], a[32:35]
  v_exp_f32 v177, v177
  v_mfma_f32_16x16x32_bf16 a[0:3], v[192:195], a[192:195], a[0:3]
  ds_read_b64_tr_b16 a[238:239], v19 offset:28672
  v_cvt_pk_bf16_f32 v176, v176, v177
  v_mfma_f32_16x16x32_bf16 a[0:3], v[200:203], a[196:199], a[0:3]
  v_exp_f32 v178, v178
  v_mfma_f32_16x16x32_bf16 a[4:7], v[200:203], a[204:207], a[4:7]
  s_add_u32 m0, s30, 16384
  s_xor_b32 s40, s32, 0x12400
  ds_read_b64_tr_b16 a[240:241], v20 offset:16384
  v_mfma_f32_16x16x32_bf16 a[4:7], v[192:195], a[200:203], a[4:7]
  s_waitcnt vmcnt(12)
  buffer_load_dwordx4 v22, s[16:19], s40 offen nt lds
  v_mfma_f32_16x16x32_bf16 a[36:39], v[208:211], a[200:203], a[36:39]
  ds_read_b64_tr_b16 a[242:243], v20 offset:20480
  v_mfma_f32_16x16x32_bf16 a[36:39], v[216:219], a[204:207], a[36:39]
  v_exp_f32 v179, v179
  v_mfma_f32_16x16x32_bf16 a[68:71], v[232:235], a[204:207], a[68:71]
  ds_read_b64_tr_b16 a[244:245], v20 offset:24576
  v_cvt_pk_bf16_f32 v177, v178, v179
  v_mfma_f32_16x16x32_bf16 a[68:71], v[224:227], a[200:203], a[68:71]
  v_exp_f32 v180, v180
  v_mfma_f32_16x16x32_bf16 a[100:103], v[240:243], a[200:203], a[100:103]
  ds_read_b64_tr_b16 a[246:247], v20 offset:28672
  v_mfma_f32_16x16x32_bf16 a[100:103], v[248:251], a[204:207], a[100:103]
  v_exp_f32 v181, v181
  v_mfma_f32_16x16x32_bf16 a[104:107], v[248:251], a[212:215], a[104:107]
  ds_read_b64_tr_b16 a[248:249], v21 offset:16384
  v_cvt_pk_bf16_f32 v178, v180, v181
  v_mfma_f32_16x16x32_bf16 a[104:107], v[240:243], a[208:211], a[104:107]
  v_exp_f32 v182, v182
  v_mfma_f32_16x16x32_bf16 a[72:75], v[224:227], a[208:211], a[72:75]
  ds_read_b64_tr_b16 a[250:251], v21 offset:20480
  v_mfma_f32_16x16x32_bf16 a[72:75], v[232:235], a[212:215], a[72:75]
  v_exp_f32 v183, v183
  v_mfma_f32_16x16x32_bf16 a[40:43], v[216:219], a[212:215], a[40:43]
  s_add_u32 m0, s30, 17408
  s_xor_b32 s40, s32, 0x12800
  ds_read_b64_tr_b16 a[252:253], v21 offset:24576
  v_cvt_pk_bf16_f32 v179, v182, v183
  v_mfma_f32_16x16x32_bf16 a[40:43], v[208:211], a[208:211], a[40:43]
  s_waitcnt vmcnt(12)
  buffer_load_dwordx4 v23, s[16:19], s40 offen nt lds
  v_mfma_f32_16x16x32_bf16 a[8:11], v[192:195], a[208:211], a[8:11]
  ds_read_b64_tr_b16 a[254:255], v21 offset:28672
  v_mfma_f32_16x16x32_bf16 a[8:11], v[200:203], a[212:215], a[8:11]
  v_exp_f32 v136, v136
  v_mfma_f32_16x16x32_bf16 a[12:15], v[200:203], a[220:223], a[12:15]
  v_exp_f32 v137, v137
  v_mfma_f32_16x16x32_bf16 a[12:15], v[192:195], a[216:219], a[12:15]
  v_exp_f32 v138, v138
  v_mfma_f32_16x16x32_bf16 a[44:47], v[208:211], a[216:219], a[44:47]
  v_exp_f32 v139, v139
  v_mfma_f32_16x16x32_bf16 a[44:47], v[216:219], a[220:223], a[44:47]
  s_waitcnt vmcnt(6) lgkmcnt(0)
L_pg8:
  s_cbranch_execz L_rt1
  s_cmpk_lt_i32 s11, 0x0
  s_cbranch_scc0 L_fb1_3
  s_waitcnt vmcnt(5)
L_fb1_3:
  s_barrier
  v_mfma_f32_16x16x32_bf16 a[76:79], v[232:235], a[220:223], a[76:79]
  ds_read_b128 a[192:195], v10 offset:49152
  v_cvt_pk_bf16_f32 v136, v136, v137
  v_mfma_f32_16x16x32_bf16 a[76:79], v[224:227], a[216:219], a[76:79]
  v_exp_f32 v140, v140
  v_mfma_f32_16x16x32_bf16 a[108:111], v[240:243], a[216:219], a[108:111]
  v_exp_f32 v141, v141
  v_mfma_f32_16x16x32_bf16 a[108:111], v[248:251], a[220:223], a[108:111]
  v_exp_f32 v142, v142
  v_mfma_f32_16x16x32_bf16 a[112:115], v[248:251], a[228:231], a[112:115]
  s_add_u32 m0, s30, 18432
  s_xor_b32 s40, s32, 0x2000
  ds_read_b128 a[196:199], v11 offset:49152
  v_cvt_pk_bf16_f32 v137, v138, v139
  v_mfma_f32_16x16x32_bf16 a[112:115], v[240:243], a[224:227], a[112:115]
  s_waitcnt vmcnt(12)
  buffer_load_dwordx4 v24, s[16:19], s40 offen nt lds
  v_mfma_f32_16x16x32_bf16 a[80:83], v[224:227], a[224:227], a[80:83]
  v_exp_f32 v143, v143
  v_mfma_f32_16x16x32_bf16 a[80:83], v[232:235], a[228:231], a[80:83]
  v_exp_f32 v152, v152
  v_mfma_f32_16x16x32_bf16 a[48:51], v[216:219], a[228:231], a[48:51]
  ds_read_b128 a[200:203], v12 offset:49152
  v_cvt_pk_bf16_f32 v138, v140, v141
  v_mfma_f32_16x16x32_bf16 a[48:51], v[208:211], a[224:227], a[48:51]
  v_exp_f32 v153, v153
  v_mfma_f32_16x16x32_bf16 a[16:19], v[192:195], a[224:227], a[16:19]
  v_exp_f32 v154, v154
  v_mfma_f32_16x16x32_bf16 a[16:19], v[200:203], a[228:231], a[16:19]
  v_exp_f32 v155, v155
  v_mfma_f32_16x16x32_bf16 a[20:23], v[200:203], a[236:239], a[20:23]
  ds_read_b128 a[204:207], v13 offset:49152
  v_cvt_pk_bf16_f32 v139, v142, v143
  v_mfma_f32_16x16x32_bf16 a[20:23], v[192:195], a[232:235], a[20:23]
  v_exp_f32 v156, v156
  v_mfma_f32_16x16x32_bf16 a[52:55], v[208:211], a[232:235], a[52:55]
  s_waitcnt vmcnt(8)
  ds_read2_b64 v[2:5], v28 offset0:0 offset1:0
  v_cvt_pk_bf16_f32 v152, v152, v153
  v_mfma_f32_16x16x32_bf16 a[52:55], v[216:219], a[236:239], a[52:55]
  v_exp_f32 v157, v157
  v_mfma_f32_16x16x32_bf16 a[84:87], v[232:235], a[236:239], a[84:87]
  s_xor_b32 s43, s48, 0x5000
  ds_read_b128 a[208:211], v10 offset:53248
  v_cvt_pk_bf16_f32 v153, v154, v155
  v_mfma_f32_16x16x32_bf16 a[84:87], v[224:227], a[232:235], a[84:87]
  s_waitcnt vmcnt(12)
  buffer_store_dwordx4 v[80:83], v26, s[24:27], s43 offen sc1
  v_mfma_f32_16x16x32_bf16 a[116:119], v[240:243], a[232:235], a[116:119]
  v_exp_f32 v158, v158
  v_mfma_f32_16x16x32_bf16 a[116:119], v[248:251], a[236:239], a[116:119]
  v_exp_f32 v159, v159
  v_mfma_f32_16x16x32_bf16 a[120:123], v[248:251], a[244:247], a[120:123]
  ds_read_b128 a[212:215], v11 offset:53248
  v_cvt_pk_bf16_f32 v154, v156, v157
  v_mfma_f32_16x16x32_bf16 a[120:123], v[240:243], a[240:243], a[120:123]
  v_exp_f32 v168, v168
  v_mfma_f32_16x16x32_bf16 a[88:91], v[224:227], a[240:243], a[88:91]
  v_exp_f32 v169, v169
  v_mfma_f32_16x16x32_bf16 a[88:91], v[232:235], a[244:247], a[88:91]
  v_exp_f32 v170, v170
  s_waitcnt lgkmcnt(2)
  v_mfma_f32_16x16x32_bf16 v[2:5], v[32:35], v[2:5], 0
  v_exp_f32 v171, v171
  v_mfma_f32_16x16x32_bf16 a[56:59], v[216:219], a[244:247], a[56:59]
  ds_read_b128 a[216:219], v12 offset:53248
  v_cvt_pk_bf16_f32 v155, v158, v159
  v_mfma_f32_16x16x32_bf16 a[56:59], v[208:211], a[240:243], a[56:59]
  v_exp_f32 v172, v172
  v_mfma_f32_16x16x32_bf16 a[24:27], v[192:195], a[240:243], a[24:27]
  v_exp_f32 v173, v173
  v_mfma_f32_16x16x32_bf16 a[24:27], v[200:203], a[244:247], a[24:27]
  v_cvt_pk_bf16_f32 v64, v2, v3
  v_cvt_pk_bf16_f32 v168, v168, v169
  v_mfma_f32_16x16x32_bf16 a[28:31], v[200:203], a[252:255], a[28:31]
  s_add_u32 m0, s30, 19456
  s_xor_b32 s40, s32, 0x2c00
  ds_read_b128 a[220:223], v13 offset:53248
  v_cvt_pk_bf16_f32 v65, v4, v5
  v_mfma_f32_16x16x32_bf16 a[28:31], v[192:195], a[248:251], a[28:31]
  s_waitcnt vmcnt(12)
  buffer_load_dwordx4 v25, s[16:19], s40 offen nt lds
  v_mfma_f32_16x16x32_bf16 a[60:63], v[208:211], a[248:251], a[60:63]
  v_exp_f32 v174, v174
  v_mfma_f32_16x16x32_bf16 a[60:63], v[216:219], a[252:255], a[60:63]
  v_exp_f32 v175, v175
  v_mfma_f32_16x16x32_bf16 a[92:95], v[232:235], a[252:255], a[92:95]
  v_exp_f32 v184, v184
  v_mfma_f32_16x16x32_bf16 a[92:95], v[224:227], a[248:251], a[92:95]
  ds_read2_b64 v[6:9], v28 offset0:1 offset1:1
  v_cvt_pk_bf16_f32 v169, v170, v171
  v_mfma_f32_16x16x32_bf16 a[124:127], v[240:243], a[248:251], a[124:127]
  v_xor_b32 v28, 0x1000, v28
  v_cvt_pk_bf16_f32 v170, v172, v173
  v_mfma_f32_16x16x32_bf16 a[124:127], v[248:251], a[252:255], a[124:127]
  s_waitcnt lgkmcnt(1)
  v_exp_f32 v185, v185
  v_mfma_f32_16x16x32_bf16 v[240:243], a[192:195], a[176:179], 0
  v_exp_f32 v186, v186
  v_mfma_f32_16x16x32_bf16 v[240:243], a[196:199], a[180:183], v[240:243]
  ds_read_b128 a[224:227], v10 offset:57344
  v_cvt_pk_bf16_f32 v171, v174, v175
  v_mfma_f32_16x16x32_bf16 v[240:243], a[200:203], a[184:187], v[240:243]
  v_exp_f32 v187, v187
  v_mfma_f32_16x16x32_bf16 v[240:243], a[204:207], a[188:191], v[240:243]
  v_exp_f32 v188, v188
  v_mfma_f32_16x16x32_bf16 v[224:227], a[204:207], a[172:175], 0
  s_xor_b32 s43, s48, 0x3000
  ds_read_b128 a[228:231], v11 offset:57344
  v_cvt_pk_bf16_f32 v184, v184, v185
  v_mfma_f32_16x16x32_bf16 v[224:227], a[200:203], a[168:171], v[224:227]
  s_waitcnt vmcnt(12)
  buffer_store_dwordx4 v[84:87], v26, s[24:27], s43 offen sc1
  v_mfma_f32_16x16x32_bf16 v[224:227], a[196:199], a[164:167], v[224:227]
  v_exp_f32 v189, v189
  v_mfma_f32_16x16x32_bf16 v[224:227], a[192:195], a[160:163], v[224:227]
  ds_read_b128 a[232:235], v12 offset:57344
  v_cvt_pk_bf16_f32 v185, v186, v187
  s_waitcnt lgkmcnt(3)
  v_mfma_f32_16x16x32_bf16 v[6:9], v[32:35], v[6:9], 0
  v_exp_f32 v190, v190
  v_mfma_f32_16x16x32_bf16 v[208:211], a[192:195], a[144:147], 0
  v_exp_f32 v191, v191
  v_mfma_f32_16x16x32_bf16 v[208:211], a[196:199], a[148:151], v[208:211]
  v_cvt_pk_bf16_f32 v186, v188, v189
  v_cvt_pk_bf16_f32 v187, v190, v191
  v_mfma_f32_16x16x32_bf16 v[208:211], a[200:203], a[152:155], v[208:211]
  ds_read_b128 a[236:239], v13 offset:57344
  v_mfma_f32_16x16x32_bf16 v[208:211], a[204:207], a[156:159], v[208:211]
  v_cvt_pk_bf16_f32 v66, v6, v7
  v_mfma_f32_16x16x32_bf16 v[192:195], a[204:207], a[140:143], 0
  v_cvt_pk_bf16_f32 v67, v8, v9
  v_mfma_f32_16x16x32_bf16 v[192:195], a[200:203], a[136:139], v[192:195]
  ds_read_b128 a[240:243], v10 offset:61440
  v_mfma_f32_16x16x32_bf16 v[192:195], a[196:199], a[132:135], v[192:195]
  v_mfma_f32_16x16x32_bf16 v[192:195], a[192:195], a[128:131], v[192:195]
  v_mfma_f32_16x16x32_bf16 v[196:199], a[208:211], a[128:131], 0
  ds_read_b128 a[244:247], v11 offset:61440
  v_mfma_f32_16x16x32_bf16 v[196:199], a[212:215], a[132:135], v[196:199]
  s_add_u32 m0, s30, 65536
  s_xor_b32 s40, s32, 0x12000
  ds_read2_b64 v[2:5], v29 offset0:0 offset1:0
  v_mfma_f32_16x16x32_bf16 v[196:199], a[216:219], a[136:139], v[196:199]
  s_waitcnt vmcnt(12)
  buffer_load_dwordx4 v22, s[20:23], s40 offen nt lds
  v_mfma_f32_16x16x32_bf16 v[196:199], a[220:223], a[140:143], v[196:199]
  ds_read_b128 a[248:251], v12 offset:61440
  v_mfma_f32_16x16x32_bf16 v[212:215], a[220:223], a[156:159], 0
  v_mfma_f32_16x16x32_bf16 v[212:215], a[216:219], a[152:155], v[212:215]
  v_mfma_f32_16x16x32_bf16 v[212:215], a[212:215], a[148:151], v[212:215]
  ds_read_b128 a[252:255], v13 offset:61440
  v_mfma_f32_16x16x32_bf16 v[212:215], a[208:211], a[144:147], v[212:215]
  v_mfma_f32_16x16x32_bf16 v[228:231], a[208:211], a[160:163], 0
  v_exp_f32 v192, v192
  v_mfma_f32_16x16x32_bf16 v[228:231], a[212:215], a[164:167], v[228:231]
  v_exp_f32 v193, v193
  v_mfma_f32_16x16x32_bf16 v[228:231], a[216:219], a[168:171], v[228:231]
  s_add_u32 m0, s30, 66560
  s_xor_b32 s40, s32, 0x12c00
  v_exp_f32 v194, v194
  v_mfma_f32_16x16x32_bf16 v[228:231], a[220:223], a[172:175], v[228:231]
  s_waitcnt vmcnt(12)
  buffer_load_dwordx4 v23, s[20:23], s40 offen nt lds
  s_waitcnt lgkmcnt(2)
  v_mfma_f32_16x16x32_bf16 v[2:5], v[32:35], v[2:5], 0
  v_exp_f32 v195, v195
  v_mfma_f32_16x16x32_bf16 v[244:247], a[220:223], a[188:191], 0
  v_exp_f32 v196, v196
  v_mfma_f32_16x16x32_bf16 v[244:247], a[216:219], a[184:187], v[244:247]
  v_exp_f32 v197, v197
  v_mfma_f32_16x16x32_bf16 v[244:247], a[212:215], a[180:183], v[244:247]
  v_exp_f32 v198, v198
  v_mfma_f32_16x16x32_bf16 v[244:247], a[208:211], a[176:179], v[244:247]
  s_waitcnt vmcnt(7) lgkmcnt(0)
  s_cmpk_lt_i32 s8, 0x8
  s_cbranch_scc0 L_fb1_4
  s_waitcnt vmcnt(3)
L_fb1_4:
  s_barrier
  v_mfma_f32_16x16x32_bf16 v[248:251], a[224:227], a[176:179], 0
  ds_read_b64_tr_b16 a[192:193], v14 offset:32768
  v_cvt_pk_bf16_f32 v68, v2, v3
  v_mfma_f32_16x16x32_bf16 v[248:251], a[228:231], a[180:183], v[248:251]
  v_cvt_pk_bf16_f32 v69, v4, v5
  v_cvt_pk_bf16_f32 v192, v192, v193
  v_mfma_f32_16x16x32_bf16 v[248:251], a[232:235], a[184:187], v[248:251]
  ds_read_b64_tr_b16 a[194:195], v14 offset:36864
  v_cvt_pk_bf16_f32 v193, v194, v195
  v_mfma_f32_16x16x32_bf16 v[248:251], a[236:239], a[188:191], v[248:251]
  ds_read2_b64 v[6:9], v29 offset0:1 offset1:1
  v_cvt_pk_bf16_f32 v194, v196, v197
  v_mfma_f32_16x16x32_bf16 v[232:235], a[236:239], a[172:175], 0
  ds_read_b64_tr_b16 a[196:197], v14 offset:40960
  v_xor_b32 v29, 0x1000, v29
  v_mfma_f32_16x16x32_bf16 v[232:235], a[232:235], a[168:171], v[232:235]
  v_exp_f32 v199, v199
  v_mfma_f32_16x16x32_bf16 v[232:235], a[228:231], a[164:167], v[232:235]
  ds_read_b64_tr_b16 a[198:199], v14 offset:45056
  v_cvt_pk_bf16_f32 v195, v198, v199
  v_mfma_f32_16x16x32_bf16 v[232:235], a[224:227], a[160:163], v[232:235]
  v_exp_f32 v208, v208
  v_mfma_f32_16x16x32_bf16 v[216:219], a[224:227], a[144:147], 0
  s_add_u32 m0, s30, 67584
  s_xor_b32 s40, s32, 0x2400
  ds_read_b64_tr_b16 a[200:201], v15 offset:32768
  v_mfma_f32_16x16x32_bf16 v[216:219], a[228:231], a[148:151], v[216:219]
  s_waitcnt vmcnt(12)
  buffer_load_dwordx4 v24, s[20:23], s40 offen nt lds
  v_mfma_f32_16x16x32_bf16 v[216:219], a[232:235], a[152:155], v[216:219]
  ds_read_b64_tr_b16 a[202:203], v15 offset:36864
  v_mfma_f32_16x16x32_bf16 v[216:219], a[236:239], a[156:159], v[216:219]
  v_exp_f32 v209, v209
  s_waitcnt lgkmcnt(4)
  v_mfma_f32_16x16x32_bf16 v[6:9], v[32:35], v[6:9], 0
  v_exp_f32 v210, v210
  v_mfma_f32_16x16x32_bf16 v[200:203], a[236:239], a[140:143], 0
  ds_read_b64_tr_b16 a[204:205], v15 offset:40960
  v_cvt_pk_bf16_f32 v208, v208, v209
  v_mfma_f32_16x16x32_bf16 v[200:203], a[232:235], a[136:139], v[200:203]
  v_exp_f32 v211, v211
  v_mfma_f32_16x16x32_bf16 v[200:203], a[228:231], a[132:135], v[200:203]
  ds_read_b64_tr_b16 a[206:207], v15 offset:45056
  v_cvt_pk_bf16_f32 v209, v210, v211
  v_mfma_f32_16x16x32_bf16 v[200:203], a[224:227], a[128:131], v[200:203]
  v_cvt_pk_bf16_f32 v70, v6, v7
  v_mfma_f32_16x16x32_bf16 v[204:207], a[240:243], a[128:131], 0
  ds_read_b64_tr_b16 a[208:209], v16 offset:32768
  v_cvt_pk_bf16_f32 v71, v8, v9
  v_mfma_f32_16x16x32_bf16 v[204:207], a[244:247], a[132:135], v[204:207]
  v_exp_f32 v212, v212
  v_mfma_f32_16x16x32_bf16 v[204:207], a[248:251], a[136:139], v[204:207]
  ds_read_b64_tr_b16 a[210:211], v16 offset:36864
  v_mfma_f32_16x16x32_bf16 v[204:207], a[252:255], a[140:143], v[204:207]
  s_waitcnt vmcnt(10)
  v_readfirstlane_b32 s44, v252
  v_mfma_f32_16x16x32_bf16 v[220:223], a[252:255], a[156:159], 0
  s_xor_b32 s43, s48, 0x5400
  ds_read_b64_tr_b16 a[212:213], v16 offset:40960
  v_mfma_f32_16x16x32_bf16 v[220:223], a[248:251], a[152:155], v[220:223]
  s_waitcnt vmcnt(12)
  s_sub_u32 s44, s44, s49
  s_add_u32 s49, s49, 64
  s_sub_i32 s8, s44, s98
  s_sub_i32 s9, s44, s99
  s_sub_i32 s10, s44, s100
  s_sub_i32 s11, s44, s101
  buffer_store_dwordx4 v[88:91], v26, s[24:27], s43 offen sc1
  v_mfma_f32_16x16x32_bf16 v[220:223], a[244:247], a[148:151], v[220:223]
  ds_read_b64_tr_b16 a[214:215], v16 offset:45056
  v_mfma_f32_16x16x32_bf16 v[220:223], a[240:243], a[144:147], v[220:223]
  ds_read2_b64 v[2:5], v30 offset0:0 offset1:0
  v_mfma_f32_16x16x32_bf16 v[236:239], a[240:243], a[160:163], 0
  ds_read_b64_tr_b16 a[216:217], v17 offset:32768
  v_mfma_f32_16x16x32_bf16 v[236:239], a[244:247], a[164:167], v[236:239]
  v_exp_f32 v213, v213
  v_mfma_f32_16x16x32_bf16 v[236:239], a[248:251], a[168:171], v[236:239]
  ds_read_b64_tr_b16 a[218:219], v17 offset:36864
  v_cvt_pk_bf16_f32 v210, v212, v213
  v_mfma_f32_16x16x32_bf16 v[236:239], a[252:255], a[172:175], v[236:239]
  v_exp_f32 v214, v214
  v_mfma_f32_16x16x32_bf16 v[252:255], a[252:255], a[188:191], 0
  ds_read_b64_tr_b16 a[220:221], v17 offset:40960
  v_mfma_f32_16x16x32_bf16 v[252:255], a[248:251], a[184:187], v[252:255]
  v_exp_f32 v215, v215
  v_mfma_f32_16x16x32_bf16 v[252:255], a[244:247], a[180:183], v[252:255]
  s_add_u32 m0, s30, 68608
  s_xor_b32 s40, s32, 0x2800
  ds_read_b64_tr_b16 a[222:223], v17 offset:45056
  v_cvt_pk_bf16_f32 v211, v214, v215
  v_mfma_f32_16x16x32_bf16 v[252:255], a[240:243], a[176:179], v[252:255]
  s_waitcnt vmcnt(12)
  buffer_load_dwordx4 v25, s[20:23], s40 offen nt lds
  s_waitcnt lgkmcnt(4)
  v_mfma_f32_16x16x32_bf16 v[2:5], v[32:35], v[2:5], 0
  v_exp_f32 v224, v224
  v_mfma_f32_16x16x32_bf16 v[48:51], v[44:47], v[128:131], v[48:51]
  ds_read_b64_tr_b16 a[224:225], v18 offset:32768
  v_mfma_f32_16x16x32_bf16 v[48:51], v[44:47], v[136:139], v[48:51]
  v_exp_f32 v225, v225
  v_mfma_f32_16x16x32_bf16 v[52:55], v[44:47], v[144:147], v[52:55]
  ds_read_b64_tr_b16 a[226:227], v18 offset:36864
  v_cvt_pk_bf16_f32 v224, v224, v225
  v_mfma_f32_16x16x32_bf16 v[52:55], v[44:47], v[152:155], v[52:55]
  v_cvt_pk_bf16_f32 v72, v2, v3
  v_mfma_f32_16x16x32_bf16 v[56:59], v[44:47], v[160:163], v[56:59]
  ds_read_b64_tr_b16 a[228:229], v18 offset:40960
  v_cvt_pk_bf16_f32 v73, v4, v5
  v_mfma_f32_16x16x32_bf16 v[56:59], v[44:47], v[168:171], v[56:59]
  v_exp_f32 v226, v226
  v_mfma_f32_16x16x32_bf16 v[60:63], v[44:47], v[176:179], v[60:63]
  ds_read_b64_tr_b16 a[230:231], v18 offset:45056
  v_mfma_f32_16x16x32_bf16 v[60:63], v[44:47], v[184:187], v[60:63]
  s_waitcnt lgkmcnt(4)
  v_exp_f32 v227, v227
  v_mfma_f32_16x16x32_bf16 a[96:99], v[184:187], a[196:199], a[96:99]
  ds_read_b64_tr_b16 a[232:233], v19 offset:32768
  v_cvt_pk_bf16_f32 v225, v226, v227
  v_mfma_f32_16x16x32_bf16 a[96:99], v[176:179], a[192:195], a[96:99]
  v_exp_f32 v228, v228
  v_mfma_f32_16x16x32_bf16 a[64:67], v[160:163], a[192:195], a[64:67]
  ds_read_b64_tr_b16 a[234:235], v19 offset:36864
  v_mfma_f32_16x16x32_bf16 a[64:67], v[168:171], a[196:199], a[64:67]
  ds_read2_b64 v[6:9], v30 offset0:1 offset1:1
  v_mfma_f32_16x16x32_bf16 a[32:35], v[152:155], a[196:199], a[32:35]
  s_add_u32 m0, s30, 32768
  s_xor_b32 s40, s32, 0x11800
  ds_read_b64_tr_b16 a[236:237], v19 offset:40960
  v_xor_b32 v30, 0x1000, v30
  v_mfma_f32_16x16x32_bf16 a[32:35], v[144:147], a[192:195], a[32:35]
  s_waitcnt vmcnt(12)
  buffer_load_dwordx4 v22, s[16:19], s40 offen nt lds
  v_mfma_f32_16x16x32_bf16 a[0:3], v[128:131], a[192:195], a[0:3]
  ds_read_b64_tr_b16 a[238:239], v19 offset:45056
  v_mfma_f32_16x16x32_bf16 a[0:3], v[136:139], a[196:199], a[0:3]
  v_exp_f32 v229, v229
  v_mfma_f32_16x16x32_bf16 a[4:7], v[136:139], a[204:207], a[4:7]
  ds_read_b64_tr_b16 a[240:241], v20 offset:32768
  v_cvt_pk_bf16_f32 v226, v228, v229
  v_mfma_f32_16x16x32_bf16 a[4:7], v[128:131], a[200:203], a[4:7]
  v_exp_f32 v230, v230
  v_mfma_f32_16x16x32_bf16 a[36:39], v[144:147], a[200:203], a[36:39]
  ds_read_b64_tr_b16 a[242:243], v20 offset:36864
  v_mfma_f32_16x16x32_bf16 a[36:39], v[152:155], a[204:207], a[36:39]
  v_exp_f32 v231, v231
  s_waitcnt lgkmcnt(4)
  v_mfma_f32_16x16x32_bf16 v[6:9], v[32:35], v[6:9], 0
  v_exp_f32 v240, v240
  v_mfma_f32_16x16x32_bf16 a[68:71], v[168:171], a[204:207], a[68:71]
  ds_read_b64_tr_b16 a[244:245], v20 offset:40960
  v_cvt_pk_bf16_f32 v227, v230, v231
  v_mfma_f32_16x16x32_bf16 a[68:71], v[160:163], a[200:203], a[68:71]
  v_exp_f32 v241, v241
  v_mfma_f32_16x16x32_bf16 a[100:103], v[176:179], a[200:203], a[100:103]
  ds_read_b64_tr_b16 a[246:247], v20 offset:45056
  v_cvt_pk_bf16_f32 v240, v240, v241
  v_mfma_f32_16x16x32_bf16 a[100:103], v[184:187], a[204:207], a[100:103]
  v_cvt_pk_bf16_f32 v74, v6, v7
  v_mfma_f32_16x16x32_bf16 a[104:107], v[184:187], a[212:215], a[104:107]
  s_xor_b32 s43, s48, 0x3400
  ds_read_b64_tr_b16 a[248:249], v21 offset:32768
  v_cvt_pk_bf16_f32 v75, v8, v9
  v_mfma_f32_16x16x32_bf16 a[104:107], v[176:179], a[208:211], a[104:107]
  s_waitcnt vmcnt(12)
  buffer_store_dwordx4 v[92:95], v26, s[24:27], s43 offen sc1
  v_mfma_f32_16x16x32_bf16 a[72:75], v[160:163], a[208:211], a[72:75]
  ds_read_b64_tr_b16 a[250:251], v21 offset:36864
  v_mfma_f32_16x16x32_bf16 a[72:75], v[168:171], a[212:215], a[72:75]
  v_exp_f32 v242, v242
  v_mfma_f32_16x16x32_bf16 a[40:43], v[152:155], a[212:215], a[40:43]
  ds_read_b64_tr_b16 a[252:253], v21 offset:40960
  v_mfma_f32_16x16x32_bf16 a[40:43], v[144:147], a[208:211], a[40:43]
  ds_read2_b64 v[2:5], v31 offset0:0 offset1:0
  v_mfma_f32_16x16x32_bf16 a[8:11], v[128:131], a[208:211], a[8:11]
  ds_read_b64_tr_b16 a[254:255], v21 offset:45056
  v_mfma_f32_16x16x32_bf16 a[8:11], v[136:139], a[212:215], a[8:11]
  v_exp_f32 v243, v243
  v_mfma_f32_16x16x32_bf16 a[12:15], v[136:139], a[220:223], a[12:15]
  v_exp_f32 v244, v244
  v_mfma_f32_16x16x32_bf16 a[12:15], v[128:131], a[216:219], a[12:15]
  v_exp_f32 v245, v245
  v_mfma_f32_16x16x32_bf16 a[44:47], v[144:147], a[216:219], a[44:47]
  v_exp_f32 v246, v246
  v_mfma_f32_16x16x32_bf16 a[44:47], v[152:155], a[220:223], a[44:47]
  s_waitcnt vmcnt(7) lgkmcnt(0)
  s_cmpk_lt_i32 s9, 0x0
  s_cbranch_scc0 L_fb1_5
  s_waitcnt vmcnt(4)
L_fb1_5:
  s_barrier
  v_mfma_f32_16x16x32_bf16 a[76:79], v[168:171], a[220:223], a[76:79]
  s_add_u32 m0, s30, 33792
  s_xor_b32 s40, s32, 0x11400
  ds_read_b128 a[192:195], v10
  v_cvt_pk_bf16_f32 v241, v242, v243
  v_mfma_f32_16x16x32_bf16 a[76:79], v[160:163], a[216:219], a[76:79]
  s_waitcnt vmcnt(12)
  buffer_load_dwordx4 v23, s[16:19], s40 offen nt lds
  v_mfma_f32_16x16x32_bf16 a[108:111], v[176:179], a[216:219], a[108:111]
  v_exp_f32 v247, v247
  v_mfma_f32_16x16x32_bf16 a[108:111], v[184:187], a[220:223], a[108:111]
  v_exp_f32 v200, v200
  v_mfma_f32_16x16x32_bf16 v[2:5], v[32:35], v[2:5], 0
  v_exp_f32 v201, v201
  v_mfma_f32_16x16x32_bf16 a[112:115], v[184:187], a[228:231], a[112:115]
  ds_read_b128 a[196:199], v11
  v_cvt_pk_bf16_f32 v242, v244, v245
  v_mfma_f32_16x16x32_bf16 a[112:115], v[176:179], a[224:227], a[112:115]
  v_exp_f32 v202, v202
  v_mfma_f32_16x16x32_bf16 a[80:83], v[160:163], a[224:227], a[80:83]
  v_exp_f32 v203, v203
  v_mfma_f32_16x16x32_bf16 a[80:83], v[168:171], a[228:231], a[80:83]
  v_cvt_pk_bf16_f32 v76, v2, v3
  v_cvt_pk_bf16_f32 v243, v246, v247
  v_mfma_f32_16x16x32_bf16 a[48:51], v[152:155], a[228:231], a[48:51]
  ds_read_b128 a[200:203], v12
  v_cvt_pk_bf16_f32 v77, v4, v5
  v_mfma_f32_16x16x32_bf16 a[48:51], v[144:147], a[224:227], a[48:51]
  v_exp_f32 v204, v204
  v_mfma_f32_16x16x32_bf16 a[16:19], v[128:131], a[224:227], a[16:19]
  s_add_u32 m0, s30, 34816
  s_xor_b32 s40, s32, 0x1c00
  v_exp_f32 v205, v205
  v_mfma_f32_16x16x32_bf16 a[16:19], v[136:139], a[228:231], a[16:19]
  s_waitcnt vmcnt(12)
  buffer_load_dwordx4 v24, s[16:19], s40 offen nt lds
  v_mfma_f32_16x16x32_bf16 a[20:23], v[136:139], a[236:239], a[20:23]
  ds_read_b128 a[204:207], v13
  v_cvt_pk_bf16_f32 v200, v200, v201
  v_mfma_f32_16x16x32_bf16 a[20:23], v[128:131], a[232:235], a[20:23]
  ds_read2_b64 v[6:9], v31 offset0:1 offset1:1
  v_cvt_pk_bf16_f32 v201, v202, v203
  v_mfma_f32_16x16x32_bf16 a[52:55], v[144:147], a[232:235], a[52:55]
  v_xor_b32 v31, 0x1000, v31
  v_cvt_pk_bf16_f32 v202, v204, v205
  v_mfma_f32_16x16x32_bf16 a[52:55], v[152:155], a[236:239], a[52:55]
  v_exp_f32 v206, v206
  v_mfma_f32_16x16x32_bf16 a[84:87], v[168:171], a[236:239], a[84:87]
  ds_read_b128 a[208:211], v10 offset:4096
  v_mfma_f32_16x16x32_bf16 a[84:87], v[160:163], a[232:235], a[84:87]
  v_exp_f32 v207, v207
  v_mfma_f32_16x16x32_bf16 a[116:119], v[176:179], a[232:235], a[116:119]
  v_exp_f32 v216, v216
  v_mfma_f32_16x16x32_bf16 a[116:119], v[184:187], a[236:239], a[116:119]
  v_exp_f32 v217, v217
  v_mfma_f32_16x16x32_bf16 a[120:123], v[184:187], a[244:247], a[120:123]
  ds_read_b128 a[212:215], v11 offset:4096
  v_cvt_pk_bf16_f32 v203, v206, v207
  v_mfma_f32_16x16x32_bf16 a[120:123], v[176:179], a[240:243], a[120:123]
  v_exp_f32 v218, v218
  v_mfma_f32_16x16x32_bf16 a[88:91], v[160:163], a[240:243], a[88:91]
  s_add_u32 m0, s30, 35840
  s_xor_b32 s40, s32, 0x1000
  v_exp_f32 v219, v219
  v_mfma_f32_16x16x32_bf16 a[88:91], v[168:171], a[244:247], a[88:91]
  s_waitcnt vmcnt(12)
  buffer_load_dwordx4 v25, s[16:19], s40 offen nt lds
  s_waitcnt lgkmcnt(2)
  v_mfma_f32_16x16x32_bf16 v[6:9], v[32:35], v[6:9], 0
  v_exp_f32 v220, v220
  v_mfma_f32_16x16x32_bf16 a[56:59], v[152:155], a[244:247], a[56:59]
  ds_read_b128 a[216:219], v12 offset:4096
  v_cvt_pk_bf16_f32 v216, v216, v217
  v_mfma_f32_16x16x32_bf16 a[56:59], v[144:147], a[240:243], a[56:59]
  v_exp_f32 v221, v221
  v_mfma_f32_16x16x32_bf16 a[24:27], v[128:131], a[240:243], a[24:27]
  v_exp_f32 v222, v222
  v_mfma_f32_16x16x32_bf16 a[24:27], v[136:139], a[244:247], a[24:27]
  v_cvt_pk_bf16_f32 v78, v6, v7
  v_cvt_pk_bf16_f32 v217, v218, v219
  v_mfma_f32_16x16x32_bf16 a[28:31], v[136:139], a[252:255], a[28:31]
  ds_read_b128 a[220:223], v13 offset:4096
  v_cvt_pk_bf16_f32 v79, v8, v9
  v_mfma_f32_16x16x32_bf16 a[28:31], v[128:131], a[248:251], a[28:31]
  v_exp_f32 v223, v223
  v_mfma_f32_16x16x32_bf16 a[60:63], v[144:147], a[248:251], a[60:63]
  v_exp_f32 v232, v232
  v_mfma_f32_16x16x32_bf16 a[60:63], v[152:155], a[252:255], a[60:63]
  v_exp_f32 v233, v233
  v_mfma_f32_16x16x32_bf16 a[92:95], v[168:171], a[252:255], a[92:95]
  s_waitcnt vmcnt(16)
  ds_read2_b64 v[2:5], v28 offset0:0 offset1:0
  v_cvt_pk_bf16_f32 v218, v220, v221
  v_mfma_f32_16x16x32_bf16 a[92:95], v[160:163], a[248:251], a[92:95]
  v_exp_f32 v234, v234
  v_mfma_f32_16x16x32_bf16 a[124:127], v[176:179], a[248:251], a[124:127]
  s_add_u32 m0, s31, 0
  s_xor_b32 s42, s34, 0xe800
  v_exp_f32 v235, v235
  v_mfma_f32_16x16x32_bf16 a[124:127], v[184:187], a[252:255], a[124:127]
  s_waitcnt lgkmcnt(1)
  s_waitcnt vmcnt(12)
  buffer_load_dwordx4 v22, s[12:15], s42 offen nt lds
  v_mfma_f32_16x16x32_bf16 v[176:179], a[192:195], a[176:179], 0
  v_exp_f32 v236, v236
  v_mfma_f32_16x16x32_bf16 v[176:179], a[196:199], a[180:183], v[176:179]
  ds_read_b128 a[224:227], v10 offset:8192
  v_cvt_pk_bf16_f32 v219, v222, v223
  v_mfma_f32_16x16x32_bf16 v[176:179], a[200:203], a[184:187], v[176:179]
  v_exp_f32 v237, v237
  v_mfma_f32_16x16x32_bf16 v[176:179], a[204:207], a[188:191], v[176:179]
  v_exp_f32 v238, v238
  v_mfma_f32_16x16x32_bf16 v[160:163], a[204:207], a[172:175], 0
  ds_read_b128 a[228:231], v11 offset:8192
  v_cvt_pk_bf16_f32 v232, v232, v233
  v_mfma_f32_16x16x32_bf16 v[160:163], a[200:203], a[168:171], v[160:163]
  v_exp_f32 v239, v239
  v_mfma_f32_16x16x32_bf16 v[160:163], a[196:199], a[164:167], v[160:163]
  v_exp_f32 v248, v248
  v_mfma_f32_16x16x32_bf16 v[160:163], a[192:195], a[160:163], v[160:163]
  ds_read_b128 a[232:235], v12 offset:8192
  v_cvt_pk_bf16_f32 v233, v234, v235
  s_waitcnt lgkmcnt(3)
  v_mfma_f32_16x16x32_bf16 v[2:5], v[32:35], v[2:5], 0
  v_exp_f32 v249, v249
  v_mfma_f32_16x16x32_bf16 v[144:147], a[192:195], a[144:147], 0
  v_exp_f32 v250, v250
  v_mfma_f32_16x16x32_bf16 v[144:147], a[196:199], a[148:151], v[144:147]
  v_exp_f32 v251, v251
  v_mfma_f32_16x16x32_bf16 v[144:147], a[200:203], a[152:155], v[144:147]
  ds_read_b128 a[236:239], v13 offset:8192
  v_cvt_pk_bf16_f32 v234, v236, v237
  v_mfma_f32_16x16x32_bf16 v[144:147], a[204:207], a[156:159], v[144:147]
  v_cvt_pk_bf16_f32 v80, v2, v3
  v_cvt_pk_bf16_f32 v235, v238, v239
  v_mfma_f32_16x16x32_bf16 v[128:131], a[204:207], a[140:143], 0
  v_cvt_pk_bf16_f32 v81, v4, v5
  v_cvt_pk_bf16_f32 v248, v248, v249
  v_mfma_f32_16x16x32_bf16 v[128:131], a[200:203], a[136:139], v[128:131]
  s_add_u32 m0, s31, 1024
  s_xor_b32 s42, s34, 0x8800
  ds_read_b128 a[240:243], v10 offset:12288
  v_cvt_pk_bf16_f32 v249, v250, v251
  v_mfma_f32_16x16x32_bf16 v[128:131], a[196:199], a[132:135], v[128:131]
  s_waitcnt vmcnt(12)
  buffer_load_dwordx4 v23, s[12:15], s42 offen nt lds
  v_mfma_f32_16x16x32_bf16 v[128:131], a[192:195], a[128:131], v[128:131]
  ds_read2_b64 v[6:9], v28 offset0:1 offset1:1
  v_mfma_f32_16x16x32_bf16 v[132:135], a[208:211], a[128:131], 0
  ds_read_b128 a[244:247], v11 offset:12288
  v_xor_b32 v28, 0x1000, v28
  v_mfma_f32_16x16x32_bf16 v[132:135], a[212:215], a[132:135], v[132:135]
  v_exp_f32 v252, v252
  v_mfma_f32_16x16x32_bf16 v[132:135], a[216:219], a[136:139], v[132:135]
  v_exp_f32 v253, v253
  v_mfma_f32_16x16x32_bf16 v[132:135], a[220:223], a[140:143], v[132:135]
  ds_read_b128 a[248:251], v12 offset:12288
  v_cvt_pk_bf16_f32 v250, v252, v253
  v_mfma_f32_16x16x32_bf16 v[148:151], a[220:223], a[156:159], 0
  v_exp_f32 v254, v254
  v_mfma_f32_16x16x32_bf16 v[148:151], a[216:219], a[152:155], v[148:151]
  v_exp_f32 v255, v255
  v_mfma_f32_16x16x32_bf16 v[148:151], a[212:215], a[148:151], v[148:151]
  s_add_u32 m0, s31, 2048
  s_xor_b32 s42, s34, 0xec00
  ds_read_b128 a[252:255], v13 offset:12288
  v_cvt_pk_bf16_f32 v251, v254, v255
  v_mfma_f32_16x16x32_bf16 v[148:151], a[208:211], a[144:147], v[148:151]
  s_waitcnt vmcnt(12)
  buffer_load_dwordx4 v24, s[12:15], s42 offen nt lds
  s_waitcnt lgkmcnt(3)
  v_mfma_f32_16x16x32_bf16 v[6:9], v[32:35], v[6:9], 0
  v_mfma_f32_16x16x32_bf16 v[164:167], a[208:211], a[160:163], 0
  v_exp_f32 v128, v128
  v_mfma_f32_16x16x32_bf16 v[164:167], a[212:215], a[164:167], v[164:167]
  v_exp_f32 v129, v129
  v_mfma_f32_16x16x32_bf16 v[164:167], a[216:219], a[168:171], v[164:167]
  v_exp_f32 v130, v130
  v_mfma_f32_16x16x32_bf16 v[164:167], a[220:223], a[172:175], v[164:167]
  s_nop 0
  v_cvt_pk_bf16_f32 v82, v6, v7
  v_cvt_pk_bf16_f32 v128, v128, v129
  v_mfma_f32_16x16x32_bf16 v[180:183], a[220:223], a[188:191], 0
  v_cvt_pk_bf16_f32 v83, v8, v9
  v_mfma_f32_16x16x32_bf16 v[180:183], a[216:219], a[184:187], v[180:183]
  v_exp_f32 v131, v131
  v_mfma_f32_16x16x32_bf16 v[180:183], a[212:215], a[180:183], v[180:183]
  v_exp_f32 v132, v132
  v_mfma_f32_16x16x32_bf16 v[180:183], a[208:211], a[176:179], v[180:183]
  s_waitcnt vmcnt(7) lgkmcnt(0)
  s_cmpk_lt_i32 s10, 0x0
  s_cbranch_scc0 L_fb1_6
  s_waitcnt vmcnt(2)
L_fb1_6:
  s_barrier
  v_mfma_f32_16x16x32_bf16 v[184:187], a[224:227], a[176:179], 0
  ds_read_b64_tr_b16 a[192:193], v14 offset:49152
  v_cvt_pk_bf16_f32 v129, v130, v131
  v_mfma_f32_16x16x32_bf16 v[184:187], a[228:231], a[180:183], v[184:187]
  v_exp_f32 v133, v133
  v_mfma_f32_16x16x32_bf16 v[184:187], a[232:235], a[184:187], v[184:187]
  ds_read_b64_tr_b16 a[194:195], v14 offset:53248
  v_cvt_pk_bf16_f32 v130, v132, v133
  v_mfma_f32_16x16x32_bf16 v[184:187], a[236:239], a[188:191], v[184:187]
  ds_read2_b64 v[2:5], v29 offset0:0 offset1:0
  v_mfma_f32_16x16x32_bf16 v[168:171], a[236:239], a[172:175], 0
  s_add_u32 m0, s31, 3072
  s_xor_b32 s42, s34, 0x8c00
  ds_read_b64_tr_b16 a[196:197], v14 offset:57344
  v_mfma_f32_16x16x32_bf16 v[168:171], a[232:235], a[168:171], v[168:171]
  s_waitcnt vmcnt(12)
  buffer_load_dwordx4 v25, s[12:15], s42 offen nt lds
  v_mfma_f32_16x16x32_bf16 v[168:171], a[228:231], a[164:167], v[168:171]
  ds_read_b64_tr_b16 a[198:199], v14 offset:61440
  v_mfma_f32_16x16x32_bf16 v[168:171], a[224:227], a[160:163], v[168:171]
  v_exp_f32 v134, v134
  v_mfma_f32_16x16x32_bf16 v[152:155], a[224:227], a[144:147], 0
  ds_read_b64_tr_b16 a[200:201], v15 offset:49152
  v_mfma_f32_16x16x32_bf16 v[152:155], a[228:231], a[148:151], v[152:155]
  v_exp_f32 v135, v135
  v_mfma_f32_16x16x32_bf16 v[152:155], a[232:235], a[152:155], v[152:155]
  ds_read_b64_tr_b16 a[202:203], v15 offset:53248
L_pg9:
  s_cbranch_execz L_rt1
  v_cvt_pk_bf16_f32 v131, v134, v135
  v_mfma_f32_16x16x32_bf16 v[152:155], a[236:239], a[156:159], v[152:155]
  v_exp_f32 v144, v144
  s_waitcnt lgkmcnt(4)
  v_mfma_f32_16x16x32_bf16 v[2:5], v[32:35], v[2:5], 0
  v_exp_f32 v145, v145
  v_mfma_f32_16x16x32_bf16 v[136:139], a[236:239], a[140:143], 0
  ds_read_b64_tr_b16 a[204:205], v15 offset:57344
  v_cvt_pk_bf16_f32 v144, v144, v145
  v_mfma_f32_16x16x32_bf16 v[136:139], a[232:235], a[136:139], v[136:139]
  v_exp_f32 v146, v146
  v_mfma_f32_16x16x32_bf16 v[136:139], a[228:231], a[132:135], v[136:139]
  ds_read_b64_tr_b16 a[206:207], v15 offset:61440
  v_mfma_f32_16x16x32_bf16 v[136:139], a[224:227], a[128:131], v[136:139]
  v_cvt_pk_bf16_f32 v84, v2, v3
  v_mfma_f32_16x16x32_bf16 v[140:143], a[240:243], a[128:131], 0
  s_xor_b32 s43, s48, 0xe800
  ds_read_b64_tr_b16 a[208:209], v16 offset:49152
  v_cvt_pk_bf16_f32 v85, v4, v5
  v_mfma_f32_16x16x32_bf16 v[140:143], a[244:247], a[132:135], v[140:143]
  s_waitcnt vmcnt(12)
  buffer_store_dwordx4 v[96:99], v26, s[24:27], s43 offen sc1
  v_mfma_f32_16x16x32_bf16 v[140:143], a[248:251], a[136:139], v[140:143]
  ds_read_b64_tr_b16 a[210:211], v16 offset:53248
  v_mfma_f32_16x16x32_bf16 v[140:143], a[252:255], a[140:143], v[140:143]
  v_exp_f32 v147, v147
  v_mfma_f32_16x16x32_bf16 v[156:159], a[252:255], a[156:159], 0
  ds_read_b64_tr_b16 a[212:213], v16 offset:57344
  v_cvt_pk_bf16_f32 v145, v146, v147
  v_mfma_f32_16x16x32_bf16 v[156:159], a[248:251], a[152:155], v[156:159]
  ds_read2_b64 v[6:9], v29 offset0:1 offset1:1
  v_mfma_f32_16x16x32_bf16 v[156:159], a[244:247], a[148:151], v[156:159]
  ds_read_b64_tr_b16 a[214:215], v16 offset:61440
  v_xor_b32 v29, 0x1000, v29
  v_mfma_f32_16x16x32_bf16 v[156:159], a[240:243], a[144:147], v[156:159]
  v_exp_f32 v148, v148
  v_mfma_f32_16x16x32_bf16 v[172:175], a[240:243], a[160:163], 0
  ds_read_b64_tr_b16 a[216:217], v17 offset:49152
  v_mfma_f32_16x16x32_bf16 v[172:175], a[244:247], a[164:167], v[172:175]
  v_exp_f32 v149, v149
  v_mfma_f32_16x16x32_bf16 v[172:175], a[248:251], a[168:171], v[172:175]
  s_add_u32 m0, s30, 81920
  s_xor_b32 s40, s32, 0x12400
  ds_read_b64_tr_b16 a[218:219], v17 offset:53248
  v_cvt_pk_bf16_f32 v146, v148, v149
  v_mfma_f32_16x16x32_bf16 v[172:175], a[252:255], a[172:175], v[172:175]
  s_waitcnt vmcnt(12)
  buffer_load_dwordx4 v22, s[20:23], s40 offen nt lds
  v_mfma_f32_16x16x32_bf16 v[188:191], a[252:255], a[188:191], 0
  ds_read_b64_tr_b16 a[220:221], v17 offset:57344
  v_mfma_f32_16x16x32_bf16 v[188:191], a[248:251], a[184:187], v[188:191]
  v_exp_f32 v150, v150
  v_mfma_f32_16x16x32_bf16 v[188:191], a[244:247], a[180:183], v[188:191]
  ds_read_b64_tr_b16 a[222:223], v17 offset:61440
  v_mfma_f32_16x16x32_bf16 v[188:191], a[240:243], a[176:179], v[188:191]
  v_exp_f32 v151, v151
  s_waitcnt lgkmcnt(5)
  v_mfma_f32_16x16x32_bf16 v[6:9], v[32:35], v[6:9], 0
  v_exp_f32 v160, v160
  v_mfma_f32_16x16x32_bf16 v[48:51], v[44:47], v[192:195], v[48:51]
  ds_read_b64_tr_b16 a[224:225], v18 offset:49152
  v_cvt_pk_bf16_f32 v147, v150, v151
  v_mfma_f32_16x16x32_bf16 v[48:51], v[44:47], v[200:203], v[48:51]
  v_exp_f32 v161, v161
  v_mfma_f32_16x16x32_bf16 v[52:55], v[44:47], v[208:211], v[52:55]
  ds_read_b64_tr_b16 a[226:227], v18 offset:53248
  v_cvt_pk_bf16_f32 v160, v160, v161
  v_mfma_f32_16x16x32_bf16 v[52:55], v[44:47], v[216:219], v[52:55]
  v_cvt_pk_bf16_f32 v86, v6, v7
  v_mfma_f32_16x16x32_bf16 v[56:59], v[44:47], v[224:227], v[56:59]
  ds_read_b64_tr_b16 a[228:229], v18 offset:57344
  v_cvt_pk_bf16_f32 v87, v8, v9
  v_mfma_f32_16x16x32_bf16 v[56:59], v[44:47], v[232:235], v[56:59]
  v_mov_b32 v252, 1
  v_mfma_f32_16x16x32_bf16 v[60:63], v[44:47], v[240:243], v[60:63]
  ds_read_b64_tr_b16 a[230:231], v18 offset:61440
  v_mfma_f32_16x16x32_bf16 v[60:63], v[44:47], v[248:251], v[60:63]
  s_waitcnt lgkmcnt(4)
  s_waitcnt vmcnt(12)
  buffer_atomic_add v252, v26, s[4:7], 0 offen sc0 sc1
  v_mfma_f32_16x16x32_bf16 a[96:99], v[248:251], a[196:199], a[96:99]
  ds_read_b64_tr_b16 a[232:233], v19 offset:49152
  v_mfma_f32_16x16x32_bf16 a[96:99], v[240:243], a[192:195], a[96:99]
  ds_read2_b64 v[2:5], v30 offset0:0 offset1:0
  v_mfma_f32_16x16x32_bf16 a[64:67], v[224:227], a[192:195], a[64:67]
  s_add_u32 m0, s30, 82944
  s_xor_b32 s40, s32, 0x12800
  ds_read_b64_tr_b16 a[234:235], v19 offset:53248
  v_mfma_f32_16x16x32_bf16 a[64:67], v[232:235], a[196:199], a[64:67]
  s_waitcnt vmcnt(12)
  buffer_load_dwordx4 v23, s[20:23], s40 offen nt lds
  v_mfma_f32_16x16x32_bf16 a[32:35], v[216:219], a[196:199], a[32:35]
  ds_read_b64_tr_b16 a[236:237], v19 offset:57344
  v_mfma_f32_16x16x32_bf16 a[32:35], v[208:211], a[192:195], a[32:35]
  v_exp_f32 v162, v162
  v_mfma_f32_16x16x32_bf16 a[0:3], v[192:195], a[192:195], a[0:3]
  ds_read_b64_tr_b16 a[238:239], v19 offset:61440
  v_mfma_f32_16x16x32_bf16 a[0:3], v[200:203], a[196:199], a[0:3]
  v_exp_f32 v163, v163
  v_mfma_f32_16x16x32_bf16 a[4:7], v[200:203], a[204:207], a[4:7]
  ds_read_b64_tr_b16 a[240:241], v20 offset:49152
  v_cvt_pk_bf16_f32 v161, v162, v163
  v_mfma_f32_16x16x32_bf16 a[4:7], v[192:195], a[200:203], a[4:7]
  v_exp_f32 v164, v164
  v_mfma_f32_16x16x32_bf16 a[36:39], v[208:211], a[200:203], a[36:39]
  s_xor_b32 s43, s48, 0x8800
  ds_read_b64_tr_b16 a[242:243], v20 offset:53248
  v_mfma_f32_16x16x32_bf16 a[36:39], v[216:219], a[204:207], a[36:39]
  s_waitcnt vmcnt(12)
  buffer_store_dwordx4 v[100:103], v26, s[24:27], s43 offen sc1
  s_waitcnt lgkmcnt(5)
  v_mfma_f32_16x16x32_bf16 v[2:5], v[32:35], v[2:5], 0
  v_exp_f32 v165, v165
  v_mfma_f32_16x16x32_bf16 a[68:71], v[232:235], a[204:207], a[68:71]
  ds_read_b64_tr_b16 a[244:245], v20 offset:57344
  v_cvt_pk_bf16_f32 v162, v164, v165
  v_mfma_f32_16x16x32_bf16 a[68:71], v[224:227], a[200:203], a[68:71]
  v_exp_f32 v166, v166
  v_mfma_f32_16x16x32_bf16 a[100:103], v[240:243], a[200:203], a[100:103]
  ds_read_b64_tr_b16 a[246:247], v20 offset:61440
  v_mfma_f32_16x16x32_bf16 a[100:103], v[248:251], a[204:207], a[100:103]
  v_cvt_pk_bf16_f32 v88, v2, v3
  v_mfma_f32_16x16x32_bf16 a[104:107], v[248:251], a[212:215], a[104:107]
  ds_read_b64_tr_b16 a[248:249], v21 offset:49152
  v_cvt_pk_bf16_f32 v89, v4, v5
  v_mfma_f32_16x16x32_bf16 a[104:107], v[240:243], a[208:211], a[104:107]
  v_exp_f32 v167, v167
  v_mfma_f32_16x16x32_bf16 a[72:75], v[224:227], a[208:211], a[72:75]
  ds_read_b64_tr_b16 a[250:251], v21 offset:53248
  v_cvt_pk_bf16_f32 v163, v166, v167
  v_mfma_f32_16x16x32_bf16 a[72:75], v[232:235], a[212:215], a[72:75]
  v_exp_f32 v176, v176
  v_mfma_f32_16x16x32_bf16 a[40:43], v[216:219], a[212:215], a[40:43]
  ds_read_b64_tr_b16 a[252:253], v21 offset:57344
  v_mfma_f32_16x16x32_bf16 a[40:43], v[208:211], a[208:211], a[40:43]
  ds_read2_b64 v[6:9], v30 offset0:1 offset1:1
  v_mfma_f32_16x16x32_bf16 a[8:11], v[192:195], a[208:211], a[8:11]
  s_add_u32 m0, s30, 83968
  s_xor_b32 s40, s32, 0x2000
  ds_read_b64_tr_b16 a[254:255], v21 offset:61440
  v_xor_b32 v30, 0x1000, v30
  v_mfma_f32_16x16x32_bf16 a[8:11], v[200:203], a[212:215], a[8:11]
  s_waitcnt vmcnt(12)
  buffer_load_dwordx4 v24, s[20:23], s40 offen nt lds
  v_mfma_f32_16x16x32_bf16 a[12:15], v[200:203], a[220:223], a[12:15]
  v_exp_f32 v177, v177
  v_mfma_f32_16x16x32_bf16 a[12:15], v[192:195], a[216:219], a[12:15]
  v_exp_f32 v178, v178
  v_mfma_f32_16x16x32_bf16 a[44:47], v[208:211], a[216:219], a[44:47]
  v_exp_f32 v179, v179
  v_mfma_f32_16x16x32_bf16 a[44:47], v[216:219], a[220:223], a[44:47]
  s_waitcnt vmcnt(7) lgkmcnt(0)
  s_cmpk_lt_i32 s11, 0x0
  s_cbranch_scc0 L_fb1_7
  s_waitcnt vmcnt(2)
L_fb1_7:
  s_barrier
  v_mfma_f32_16x16x32_bf16 a[76:79], v[232:235], a[220:223], a[76:79]
  ds_read_b128 a[192:195], v10 offset:16384
  v_cvt_pk_bf16_f32 v176, v176, v177
  v_mfma_f32_16x16x32_bf16 a[76:79], v[224:227], a[216:219], a[76:79]
  v_exp_f32 v180, v180
  v_mfma_f32_16x16x32_bf16 a[108:111], v[240:243], a[216:219], a[108:111]
  v_exp_f32 v181, v181
  v_mfma_f32_16x16x32_bf16 a[108:111], v[248:251], a[220:223], a[108:111]
  v_exp_f32 v182, v182
  v_mfma_f32_16x16x32_bf16 v[6:9], v[32:35], v[6:9], 0
  v_exp_f32 v183, v183
  v_mfma_f32_16x16x32_bf16 a[112:115], v[248:251], a[228:231], a[112:115]
  s_add_u32 m0, s30, 84992
  s_xor_b32 s40, s32, 0x2c00
  ds_read_b128 a[196:199], v11 offset:16384
  v_cvt_pk_bf16_f32 v177, v178, v179
  v_mfma_f32_16x16x32_bf16 a[112:115], v[240:243], a[224:227], a[112:115]
  s_waitcnt vmcnt(12)
  buffer_load_dwordx4 v25, s[20:23], s40 offen nt lds
  v_mfma_f32_16x16x32_bf16 a[80:83], v[224:227], a[224:227], a[80:83]
  v_exp_f32 v136, v136
  v_mfma_f32_16x16x32_bf16 a[80:83], v[232:235], a[228:231], a[80:83]
  v_cvt_pk_bf16_f32 v90, v6, v7
  v_cvt_pk_bf16_f32 v178, v180, v181
  v_mfma_f32_16x16x32_bf16 a[48:51], v[216:219], a[228:231], a[48:51]
  ds_read_b128 a[200:203], v12 offset:16384
  v_cvt_pk_bf16_f32 v91, v8, v9
  v_mfma_f32_16x16x32_bf16 a[48:51], v[208:211], a[224:227], a[48:51]
  v_exp_f32 v137, v137
  v_mfma_f32_16x16x32_bf16 a[16:19], v[192:195], a[224:227], a[16:19]
  v_exp_f32 v138, v138
  v_mfma_f32_16x16x32_bf16 a[16:19], v[200:203], a[228:231], a[16:19]
  ds_read2_b64 v[2:5], v31 offset0:0 offset1:0
  v_cvt_pk_bf16_f32 v179, v182, v183
  v_mfma_f32_16x16x32_bf16 a[20:23], v[200:203], a[236:239], a[20:23]
  ds_read_b128 a[204:207], v13 offset:16384
  v_cvt_pk_bf16_f32 v136, v136, v137
  v_mfma_f32_16x16x32_bf16 a[20:23], v[192:195], a[232:235], a[20:23]
  v_exp_f32 v139, v139
  v_mfma_f32_16x16x32_bf16 a[52:55], v[208:211], a[232:235], a[52:55]
  v_exp_f32 v140, v140
  v_mfma_f32_16x16x32_bf16 a[52:55], v[216:219], a[236:239], a[52:55]
  v_exp_f32 v141, v141
  v_mfma_f32_16x16x32_bf16 a[84:87], v[232:235], a[236:239], a[84:87]
  ds_read_b128 a[208:211], v10 offset:20480
  v_cvt_pk_bf16_f32 v137, v138, v139
  v_mfma_f32_16x16x32_bf16 a[84:87], v[224:227], a[232:235], a[84:87]
  s_xor_b32 s43, s48, 0xec00
  v_exp_f32 v142, v142
  v_mfma_f32_16x16x32_bf16 a[116:119], v[240:243], a[232:235], a[116:119]
  s_waitcnt vmcnt(12)
  buffer_store_dwordx4 v[104:107], v26, s[24:27], s43 offen sc1
  v_mfma_f32_16x16x32_bf16 a[116:119], v[248:251], a[236:239], a[116:119]
  v_exp_f32 v143, v143
  s_waitcnt lgkmcnt(2)
  v_mfma_f32_16x16x32_bf16 v[2:5], v[32:35], v[2:5], 0
  v_exp_f32 v152, v152
  v_mfma_f32_16x16x32_bf16 a[120:123], v[248:251], a[244:247], a[120:123]
  ds_read_b128 a[212:215], v11 offset:20480
  v_cvt_pk_bf16_f32 v138, v140, v141
  v_mfma_f32_16x16x32_bf16 a[120:123], v[240:243], a[240:243], a[120:123]
  v_exp_f32 v153, v153
  v_mfma_f32_16x16x32_bf16 a[88:91], v[224:227], a[240:243], a[88:91]
  v_exp_f32 v154, v154
  v_mfma_f32_16x16x32_bf16 a[88:91], v[232:235], a[244:247], a[88:91]
  v_cvt_pk_bf16_f32 v92, v2, v3
  v_cvt_pk_bf16_f32 v139, v142, v143
  v_mfma_f32_16x16x32_bf16 a[56:59], v[216:219], a[244:247], a[56:59]
  ds_read_b128 a[216:219], v12 offset:20480
  v_cvt_pk_bf16_f32 v93, v4, v5
  v_mfma_f32_16x16x32_bf16 a[56:59], v[208:211], a[240:243], a[56:59]
  v_exp_f32 v155, v155
  v_mfma_f32_16x16x32_bf16 a[24:27], v[192:195], a[240:243], a[24:27]
  v_exp_f32 v156, v156
  v_mfma_f32_16x16x32_bf16 a[24:27], v[200:203], a[244:247], a[24:27]
  v_exp_f32 v157, v157
  v_mfma_f32_16x16x32_bf16 a[28:31], v[200:203], a[252:255], a[28:31]
  s_add_u32 m0, s30, 49152
  s_xor_b32 s40, s32, 0x11c00
  ds_read_b128 a[220:223], v13 offset:20480
  v_cvt_pk_bf16_f32 v152, v152, v153
  v_mfma_f32_16x16x32_bf16 a[28:31], v[192:195], a[248:251], a[28:31]
  s_waitcnt vmcnt(12)
  buffer_load_dwordx4 v22, s[16:19], s40 offen nt lds
  v_mfma_f32_16x16x32_bf16 a[60:63], v[208:211], a[248:251], a[60:63]
  ds_read2_b64 v[6:9], v31 offset0:1 offset1:1
  v_cvt_pk_bf16_f32 v153, v154, v155
  v_mfma_f32_16x16x32_bf16 a[60:63], v[216:219], a[252:255], a[60:63]
  v_xor_b32 v31, 0x1000, v31
  v_cvt_pk_bf16_f32 v154, v156, v157
  v_mfma_f32_16x16x32_bf16 a[92:95], v[232:235], a[252:255], a[92:95]
  v_exp_f32 v158, v158
  v_mfma_f32_16x16x32_bf16 a[92:95], v[224:227], a[248:251], a[92:95]
  v_exp_f32 v159, v159
  v_mfma_f32_16x16x32_bf16 a[124:127], v[240:243], a[248:251], a[124:127]
  v_exp_f32 v168, v168
  v_mfma_f32_16x16x32_bf16 a[124:127], v[248:251], a[252:255], a[124:127]
  s_waitcnt lgkmcnt(1)
  v_exp_f32 v169, v169
  v_mfma_f32_16x16x32_bf16 v[240:243], a[192:195], a[176:179], 0
  v_exp_f32 v170, v170
  v_mfma_f32_16x16x32_bf16 v[240:243], a[196:199], a[180:183], v[240:243]
  ds_read_b128 a[224:227], v10 offset:24576
  v_cvt_pk_bf16_f32 v155, v158, v159
  v_mfma_f32_16x16x32_bf16 v[240:243], a[200:203], a[184:187], v[240:243]
  v_exp_f32 v171, v171
  v_mfma_f32_16x16x32_bf16 v[240:243], a[204:207], a[188:191], v[240:243]
  v_exp_f32 v172, v172
  s_waitcnt lgkmcnt(1)
  v_mfma_f32_16x16x32_bf16 v[6:9], v[32:35], v[6:9], 0
  v_exp_f32 v173, v173
  v_mfma_f32_16x16x32_bf16 v[224:227], a[204:207], a[172:175], 0
  s_add_u32 m0, s31, 4096
  s_xor_b32 s42, s34, 0xb800
  ds_read_b128 a[228:231], v11 offset:24576
  v_cvt_pk_bf16_f32 v168, v168, v169
  v_mfma_f32_16x16x32_bf16 v[224:227], a[200:203], a[168:171], v[224:227]
  s_waitcnt vmcnt(12)
  buffer_load_dwordx4 v22, s[12:15], s42 offen nt lds
  v_mfma_f32_16x16x32_bf16 v[224:227], a[196:199], a[164:167], v[224:227]
  v_exp_f32 v174, v174
  v_mfma_f32_16x16x32_bf16 v[224:227], a[192:195], a[160:163], v[224:227]
  ds_read_b128 a[232:235], v12 offset:24576
  v_cvt_pk_bf16_f32 v94, v6, v7
  v_mfma_f32_16x16x32_bf16 v[208:211], a[192:195], a[144:147], 0
  v_cvt_pk_bf16_f32 v95, v8, v9
  v_cvt_pk_bf16_f32 v169, v170, v171
  v_mfma_f32_16x16x32_bf16 v[208:211], a[196:199], a[148:151], v[208:211]
  v_exp_f32 v175, v175
  v_mfma_f32_16x16x32_bf16 v[208:211], a[200:203], a[152:155], v[208:211]
  ds_read_b128 a[236:239], v13 offset:24576
  v_cvt_pk_bf16_f32 v170, v172, v173
  v_mfma_f32_16x16x32_bf16 v[208:211], a[204:207], a[156:159], v[208:211]
  v_exp_f32 v184, v184
  v_mfma_f32_16x16x32_bf16 v[192:195], a[204:207], a[140:143], 0
  v_exp_f32 v185, v185
  v_mfma_f32_16x16x32_bf16 v[192:195], a[200:203], a[136:139], v[192:195]
  ds_read_b128 a[240:243], v10 offset:28672
  v_cvt_pk_bf16_f32 v171, v174, v175
  v_mfma_f32_16x16x32_bf16 v[192:195], a[196:199], a[132:135], v[192:195]
  s_waitcnt vmcnt(10)
  ds_read2_b64 v[2:5], v28 offset0:0 offset1:0
  v_cvt_pk_bf16_f32 v184, v184, v185
  v_mfma_f32_16x16x32_bf16 v[192:195], a[192:195], a[128:131], v[192:195]
  v_exp_f32 v186, v186
  v_mfma_f32_16x16x32_bf16 v[196:199], a[208:211], a[128:131], 0
  s_add_u32 m0, s31, 5120
  s_xor_b32 s42, s34, 0xd800
  ds_read_b128 a[244:247], v11 offset:28672
  v_mfma_f32_16x16x32_bf16 v[196:199], a[212:215], a[132:135], v[196:199]
  s_waitcnt vmcnt(12)
  buffer_load_dwordx4 v23, s[12:15], s42 offen nt lds
  v_mfma_f32_16x16x32_bf16 v[196:199], a[216:219], a[136:139], v[196:199]
  v_exp_f32 v187, v187
  v_mfma_f32_16x16x32_bf16 v[196:199], a[220:223], a[140:143], v[196:199]
  ds_read_b128 a[248:251], v12 offset:28672
  v_cvt_pk_bf16_f32 v185, v186, v187
  v_mfma_f32_16x16x32_bf16 v[212:215], a[220:223], a[156:159], 0
  v_exp_f32 v188, v188
  v_mfma_f32_16x16x32_bf16 v[212:215], a[216:219], a[152:155], v[212:215]
  v_exp_f32 v189, v189
  v_mfma_f32_16x16x32_bf16 v[212:215], a[212:215], a[148:151], v[212:215]
  ds_read_b128 a[252:255], v13 offset:28672
  v_cvt_pk_bf16_f32 v186, v188, v189
  v_mfma_f32_16x16x32_bf16 v[212:215], a[208:211], a[144:147], v[212:215]
  v_exp_f32 v190, v190
  s_waitcnt lgkmcnt(3)
  v_mfma_f32_16x16x32_bf16 v[2:5], v[32:35], v[2:5], 0
  v_exp_f32 v191, v191
  v_mfma_f32_16x16x32_bf16 v[228:231], a[208:211], a[160:163], 0
  v_exp_f32 v192, v192
  v_mfma_f32_16x16x32_bf16 v[228:231], a[212:215], a[164:167], v[228:231]
  v_exp_f32 v193, v193
  v_mfma_f32_16x16x32_bf16 v[228:231], a[216:219], a[168:171], v[228:231]
  v_exp_f32 v194, v194
  v_mfma_f32_16x16x32_bf16 v[228:231], a[220:223], a[172:175], v[228:231]
  v_cvt_pk_bf16_f32 v96, v2, v3
  v_cvt_pk_bf16_f32 v187, v190, v191
  v_mfma_f32_16x16x32_bf16 v[244:247], a[220:223], a[188:191], 0
  s_add_u32 m0, s31, 6144
  s_xor_b32 s42, s34, 0xbc00
  v_cvt_pk_bf16_f32 v97, v4, v5
  v_cvt_pk_bf16_f32 v192, v192, v193
  v_mfma_f32_16x16x32_bf16 v[244:247], a[216:219], a[184:187], v[244:247]
  s_waitcnt vmcnt(12)
  buffer_load_dwordx4 v24, s[12:15], s42 offen nt lds
  v_mfma_f32_16x16x32_bf16 v[244:247], a[212:215], a[180:183], v[244:247]
  v_exp_f32 v195, v195
  v_mfma_f32_16x16x32_bf16 v[244:247], a[208:211], a[176:179], v[244:247]
  s_waitcnt vmcnt(7) lgkmcnt(0)
  s_cmpk_lt_i32 s8, 0xfffc
  s_cbranch_scc0 L_fb1_8
  s_waitcnt vmcnt(2)
L_fb1_8:
  s_barrier
  v_mfma_f32_16x16x32_bf16 v[248:251], a[224:227], a[176:179], 0
  ds_read_b64_tr_b16 a[192:193], v14
  v_cvt_pk_bf16_f32 v193, v194, v195
  v_mfma_f32_16x16x32_bf16 v[248:251], a[228:231], a[180:183], v[248:251]
  ds_read2_b64 v[6:9], v28 offset0:1 offset1:1
  v_mfma_f32_16x16x32_bf16 v[248:251], a[232:235], a[184:187], v[248:251]
  ds_read_b64_tr_b16 a[194:195], v14 offset:4096
  v_xor_b32 v28, 0x1000, v28
  v_mfma_f32_16x16x32_bf16 v[248:251], a[236:239], a[188:191], v[248:251]
  v_exp_f32 v196, v196
  v_mfma_f32_16x16x32_bf16 v[232:235], a[236:239], a[172:175], 0
  ds_read_b64_tr_b16 a[196:197], v14 offset:8192
  v_mfma_f32_16x16x32_bf16 v[232:235], a[232:235], a[168:171], v[232:235]
  v_exp_f32 v197, v197
  v_mfma_f32_16x16x32_bf16 v[232:235], a[228:231], a[164:167], v[232:235]
  ds_read_b64_tr_b16 a[198:199], v14 offset:12288
  v_cvt_pk_bf16_f32 v194, v196, v197
  v_mfma_f32_16x16x32_bf16 v[232:235], a[224:227], a[160:163], v[232:235]
  v_exp_f32 v198, v198
  v_mfma_f32_16x16x32_bf16 v[216:219], a[224:227], a[144:147], 0
  s_add_u32 m0, s31, 7168
  s_xor_b32 s42, s34, 0xdc00
  ds_read_b64_tr_b16 a[200:201], v15
  v_mfma_f32_16x16x32_bf16 v[216:219], a[228:231], a[148:151], v[216:219]
  s_waitcnt vmcnt(12)
  buffer_load_dwordx4 v25, s[12:15], s42 offen nt lds
  v_mfma_f32_16x16x32_bf16 v[216:219], a[232:235], a[152:155], v[216:219]
  ds_read_b64_tr_b16 a[202:203], v15 offset:4096
  v_mfma_f32_16x16x32_bf16 v[216:219], a[236:239], a[156:159], v[216:219]
  v_exp_f32 v199, v199
  s_waitcnt lgkmcnt(5)
  v_mfma_f32_16x16x32_bf16 v[6:9], v[32:35], v[6:9], 0
  v_exp_f32 v208, v208
  v_mfma_f32_16x16x32_bf16 v[200:203], a[236:239], a[140:143], 0
  ds_read_b64_tr_b16 a[204:205], v15 offset:8192
  v_cvt_pk_bf16_f32 v195, v198, v199
  v_mfma_f32_16x16x32_bf16 v[200:203], a[232:235], a[136:139], v[200:203]
  v_exp_f32 v209, v209
  v_mfma_f32_16x16x32_bf16 v[200:203], a[228:231], a[132:135], v[200:203]
  ds_read_b64_tr_b16 a[206:207], v15 offset:12288
  v_cvt_pk_bf16_f32 v208, v208, v209
  v_mfma_f32_16x16x32_bf16 v[200:203], a[224:227], a[128:131], v[200:203]
  v_cvt_pk_bf16_f32 v98, v6, v7
  v_mfma_f32_16x16x32_bf16 v[204:207], a[240:243], a[128:131], 0
  ds_read_b64_tr_b16 a[208:209], v16
  v_cvt_pk_bf16_f32 v99, v8, v9
  v_mfma_f32_16x16x32_bf16 v[204:207], a[244:247], a[132:135], v[204:207]
  v_exp_f32 v210, v210
  v_mfma_f32_16x16x32_bf16 v[204:207], a[248:251], a[136:139], v[204:207]
  ds_read_b64_tr_b16 a[210:211], v16 offset:4096
  v_mfma_f32_16x16x32_bf16 v[204:207], a[252:255], a[140:143], v[204:207]
  s_waitcnt vmcnt(10)
  v_readfirstlane_b32 s44, v252
  v_mfma_f32_16x16x32_bf16 v[220:223], a[252:255], a[156:159], 0
  ds_read_b64_tr_b16 a[212:213], v16 offset:8192
  v_mfma_f32_16x16x32_bf16 v[220:223], a[248:251], a[152:155], v[220:223]
  s_sub_u32 s44, s44, s49
  s_add_u32 s49, s49, 64
  s_sub_i32 s8, s44, s98
  s_sub_i32 s9, s44, s99
  s_sub_i32 s10, s44, s100
  s_sub_i32 s11, s44, s101
  ds_read2_b64 v[2:5], v29 offset0:0 offset1:0
  v_mfma_f32_16x16x32_bf16 v[220:223], a[244:247], a[148:151], v[220:223]
  s_add_u32 m0, s30, 50176
  s_xor_b32 s40, s32, 0x11000
  ds_read_b64_tr_b16 a[214:215], v16 offset:12288
  v_mfma_f32_16x16x32_bf16 v[220:223], a[240:243], a[144:147], v[220:223]
  s_waitcnt vmcnt(12)
  buffer_load_dwordx4 v23, s[16:19], s40 offen nt lds
  v_mfma_f32_16x16x32_bf16 v[236:239], a[240:243], a[160:163], 0
  ds_read_b64_tr_b16 a[216:217], v17
  v_mfma_f32_16x16x32_bf16 v[236:239], a[244:247], a[164:167], v[236:239]
  v_exp_f32 v211, v211
  v_mfma_f32_16x16x32_bf16 v[236:239], a[248:251], a[168:171], v[236:239]
  ds_read_b64_tr_b16 a[218:219], v17 offset:4096
  v_cvt_pk_bf16_f32 v209, v210, v211
  v_mfma_f32_16x16x32_bf16 v[236:239], a[252:255], a[172:175], v[236:239]
  v_exp_f32 v212, v212
  v_mfma_f32_16x16x32_bf16 v[252:255], a[252:255], a[188:191], 0
  ds_read_b64_tr_b16 a[220:221], v17 offset:8192
  v_mfma_f32_16x16x32_bf16 v[252:255], a[248:251], a[184:187], v[252:255]
  v_exp_f32 v213, v213
  v_mfma_f32_16x16x32_bf16 v[252:255], a[244:247], a[180:183], v[252:255]
  ds_read_b64_tr_b16 a[222:223], v17 offset:12288
  v_cvt_pk_bf16_f32 v210, v212, v213
  v_mfma_f32_16x16x32_bf16 v[252:255], a[240:243], a[176:179], v[252:255]
  v_exp_f32 v214, v214
  s_waitcnt lgkmcnt(5)
  v_mfma_f32_16x16x32_bf16 v[2:5], v[32:35], v[2:5], 0
  v_exp_f32 v215, v215
  v_mfma_f32_16x16x32_bf16 v[48:51], v[44:47], v[128:131], v[48:51]
  s_xor_b32 s43, s48, 0x8c00
  ds_read_b64_tr_b16 a[224:225], v18
  v_cvt_pk_bf16_f32 v211, v214, v215
  v_mfma_f32_16x16x32_bf16 v[48:51], v[44:47], v[136:139], v[48:51]
  s_waitcnt vmcnt(12)
  buffer_store_dwordx4 v[108:111], v26, s[24:27], s43 offen sc1
  v_mfma_f32_16x16x32_bf16 v[52:55], v[44:47], v[144:147], v[52:55]
  ds_read_b64_tr_b16 a[226:227], v18 offset:4096
  v_mfma_f32_16x16x32_bf16 v[52:55], v[44:47], v[152:155], v[52:55]
  v_cvt_pk_bf16_f32 v100, v2, v3
  v_mfma_f32_16x16x32_bf16 v[56:59], v[44:47], v[160:163], v[56:59]
  ds_read_b64_tr_b16 a[228:229], v18 offset:8192
  v_cvt_pk_bf16_f32 v101, v4, v5
  v_mfma_f32_16x16x32_bf16 v[56:59], v[44:47], v[168:171], v[56:59]
  v_exp_f32 v224, v224
  v_mfma_f32_16x16x32_bf16 v[60:63], v[44:47], v[176:179], v[60:63]
  ds_read_b64_tr_b16 a[230:231], v18 offset:12288
  v_mfma_f32_16x16x32_bf16 v[60:63], v[44:47], v[184:187], v[60:63]
  s_waitcnt lgkmcnt(4)
  ds_read2_b64 v[6:9], v29 offset0:1 offset1:1
  v_mfma_f32_16x16x32_bf16 a[96:99], v[184:187], a[196:199], a[96:99]
  ds_read_b64_tr_b16 a[232:233], v19
  v_xor_b32 v29, 0x1000, v29
  v_mfma_f32_16x16x32_bf16 a[96:99], v[176:179], a[192:195], a[96:99]
  v_exp_f32 v225, v225
  v_mfma_f32_16x16x32_bf16 a[64:67], v[160:163], a[192:195], a[64:67]
  ds_read_b64_tr_b16 a[234:235], v19 offset:4096
  v_cvt_pk_bf16_f32 v224, v224, v225
  v_mfma_f32_16x16x32_bf16 a[64:67], v[168:171], a[196:199], a[64:67]
  v_exp_f32 v226, v226
  v_mfma_f32_16x16x32_bf16 a[32:35], v[152:155], a[196:199], a[32:35]
  s_add_u32 m0, s30, 51200
  s_xor_b32 s40, s32, 0x1800
  ds_read_b64_tr_b16 a[236:237], v19 offset:8192
  v_mfma_f32_16x16x32_bf16 a[32:35], v[144:147], a[192:195], a[32:35]
  s_waitcnt vmcnt(12)
  buffer_load_dwordx4 v24, s[16:19], s40 offen nt lds
  v_mfma_f32_16x16x32_bf16 a[0:3], v[128:131], a[192:195], a[0:3]
  ds_read_b64_tr_b16 a[238:239], v19 offset:12288
  v_mfma_f32_16x16x32_bf16 a[0:3], v[136:139], a[196:199], a[0:3]
  v_exp_f32 v227, v227
  s_waitcnt lgkmcnt(4)
  v_mfma_f32_16x16x32_bf16 v[6:9], v[32:35], v[6:9], 0
  v_exp_f32 v228, v228
  v_mfma_f32_16x16x32_bf16 a[4:7], v[136:139], a[204:207], a[4:7]
  ds_read_b64_tr_b16 a[240:241], v20
  v_cvt_pk_bf16_f32 v225, v226, v227
  v_mfma_f32_16x16x32_bf16 a[4:7], v[128:131], a[200:203], a[4:7]
  v_exp_f32 v229, v229
  v_mfma_f32_16x16x32_bf16 a[36:39], v[144:147], a[200:203], a[36:39]
  ds_read_b64_tr_b16 a[242:243], v20 offset:4096
  v_cvt_pk_bf16_f32 v226, v228, v229
  v_mfma_f32_16x16x32_bf16 a[36:39], v[152:155], a[204:207], a[36:39]
  v_cvt_pk_bf16_f32 v102, v6, v7
  v_mfma_f32_16x16x32_bf16 a[68:71], v[168:171], a[204:207], a[68:71]
  ds_read_b64_tr_b16 a[244:245], v20 offset:8192
  v_cvt_pk_bf16_f32 v103, v8, v9
  v_mfma_f32_16x16x32_bf16 a[68:71], v[160:163], a[200:203], a[68:71]
  v_exp_f32 v230, v230
  v_mfma_f32_16x16x32_bf16 a[100:103], v[176:179], a[200:203], a[100:103]
  ds_read_b64_tr_b16 a[246:247], v20 offset:12288
  v_mfma_f32_16x16x32_bf16 a[100:103], v[184:187], a[204:207], a[100:103]
  v_exp_f32 v231, v231
  v_mfma_f32_16x16x32_bf16 a[104:107], v[184:187], a[212:215], a[104:107]
  s_add_u32 m0, s30, 52224
  s_xor_b32 s40, s32, 0x1400
  ds_read_b64_tr_b16 a[248:249], v21
  v_cvt_pk_bf16_f32 v227, v230, v231
  v_mfma_f32_16x16x32_bf16 a[104:107], v[176:179], a[208:211], a[104:107]
  s_waitcnt vmcnt(12)
  buffer_load_dwordx4 v25, s[16:19], s40 offen nt lds
  v_mfma_f32_16x16x32_bf16 a[72:75], v[160:163], a[208:211], a[72:75]
  ds_read_b64_tr_b16 a[250:251], v21 offset:4096
  v_mfma_f32_16x16x32_bf16 a[72:75], v[168:171], a[212:215], a[72:75]
  ds_read2_b64 v[2:5], v30 offset0:0 offset1:0
  v_mfma_f32_16x16x32_bf16 a[40:43], v[152:155], a[212:215], a[40:43]
  ds_read_b64_tr_b16 a[252:253], v21 offset:8192
  v_mfma_f32_16x16x32_bf16 a[40:43], v[144:147], a[208:211], a[40:43]
  v_exp_f32 v240, v240
  v_mfma_f32_16x16x32_bf16 a[8:11], v[128:131], a[208:211], a[8:11]
  ds_read_b64_tr_b16 a[254:255], v21 offset:12288
  v_mfma_f32_16x16x32_bf16 a[8:11], v[136:139], a[212:215], a[8:11]
  v_exp_f32 v241, v241
  v_mfma_f32_16x16x32_bf16 a[12:15], v[136:139], a[220:223], a[12:15]
  v_exp_f32 v242, v242
  v_mfma_f32_16x16x32_bf16 a[12:15], v[128:131], a[216:219], a[12:15]
  v_exp_f32 v243, v243
  v_mfma_f32_16x16x32_bf16 a[44:47], v[144:147], a[216:219], a[44:47]
  v_exp_f32 v244, v244
  v_mfma_f32_16x16x32_bf16 a[44:47], v[152:155], a[220:223], a[44:47]
  s_waitcnt vmcnt(7) lgkmcnt(0)
  s_cmpk_lt_i32 s9, 0x0
  s_cbranch_scc0 L_fb1_9
  s_waitcnt vmcnt(2)
L_fb1_9:
  s_barrier
  v_mfma_f32_16x16x32_bf16 a[76:79], v[168:171], a[220:223], a[76:79]
  s_xor_b32 s43, s48, 0xb800
  ds_read_b128 a[192:195], v10 offset:32768
  v_cvt_pk_bf16_f32 v240, v240, v241
  v_mfma_f32_16x16x32_bf16 a[76:79], v[160:163], a[216:219], a[76:79]
  s_waitcnt vmcnt(12)
  buffer_store_dwordx4 v[112:115], v26, s[24:27], s43 offen sc1
  v_mfma_f32_16x16x32_bf16 a[108:111], v[176:179], a[216:219], a[108:111]
  v_exp_f32 v245, v245
  v_mfma_f32_16x16x32_bf16 a[108:111], v[184:187], a[220:223], a[108:111]
  v_exp_f32 v246, v246
  v_mfma_f32_16x16x32_bf16 v[2:5], v[32:35], v[2:5], 0
  v_exp_f32 v247, v247
  v_mfma_f32_16x16x32_bf16 a[112:115], v[184:187], a[228:231], a[112:115]
  ds_read_b128 a[196:199], v11 offset:32768
  v_cvt_pk_bf16_f32 v241, v242, v243
  v_mfma_f32_16x16x32_bf16 a[112:115], v[176:179], a[224:227], a[112:115]
  v_exp_f32 v200, v200
  v_mfma_f32_16x16x32_bf16 a[80:83], v[160:163], a[224:227], a[80:83]
  v_exp_f32 v201, v201
  v_mfma_f32_16x16x32_bf16 a[80:83], v[168:171], a[228:231], a[80:83]
  v_cvt_pk_bf16_f32 v104, v2, v3
  v_cvt_pk_bf16_f32 v242, v244, v245
  v_mfma_f32_16x16x32_bf16 a[48:51], v[152:155], a[228:231], a[48:51]
  ds_read_b128 a[200:203], v12 offset:32768
  v_cvt_pk_bf16_f32 v105, v4, v5
  v_mfma_f32_16x16x32_bf16 a[48:51], v[144:147], a[224:227], a[48:51]
  v_exp_f32 v202, v202
  v_mfma_f32_16x16x32_bf16 a[16:19], v[128:131], a[224:227], a[16:19]
  ds_read2_b64 v[6:9], v30 offset0:1 offset1:1
  v_cvt_pk_bf16_f32 v243, v246, v247
  v_mfma_f32_16x16x32_bf16 a[16:19], v[136:139], a[228:231], a[16:19]
  v_xor_b32 v30, 0x1000, v30
  v_cvt_pk_bf16_f32 v200, v200, v201
  v_mfma_f32_16x16x32_bf16 a[20:23], v[136:139], a[236:239], a[20:23]
  s_add_u32 m0, s30, 98304
  s_xor_b32 s40, s32, 0x11800
  ds_read_b128 a[204:207], v13 offset:32768
  v_mfma_f32_16x16x32_bf16 a[20:23], v[128:131], a[232:235], a[20:23]
  s_waitcnt vmcnt(12)
  buffer_load_dwordx4 v22, s[20:23], s40 offen nt lds
  v_mfma_f32_16x16x32_bf16 a[52:55], v[144:147], a[232:235], a[52:55]
  v_exp_f32 v203, v203
  v_mfma_f32_16x16x32_bf16 a[52:55], v[152:155], a[236:239], a[52:55]
  v_exp_f32 v204, v204
  v_mfma_f32_16x16x32_bf16 a[84:87], v[168:171], a[236:239], a[84:87]
  ds_read_b128 a[208:211], v10 offset:36864
  v_cvt_pk_bf16_f32 v201, v202, v203
  v_mfma_f32_16x16x32_bf16 a[84:87], v[160:163], a[232:235], a[84:87]
L_pg10:
  s_cbranch_execz L_rt1
  v_exp_f32 v205, v205
  v_mfma_f32_16x16x32_bf16 a[116:119], v[176:179], a[232:235], a[116:119]
  v_exp_f32 v206, v206
  v_mfma_f32_16x16x32_bf16 a[116:119], v[184:187], a[236:239], a[116:119]
  v_exp_f32 v207, v207
  s_waitcnt lgkmcnt(2)
  v_mfma_f32_16x16x32_bf16 v[6:9], v[32:35], v[6:9], 0
  v_exp_f32 v216, v216
  v_mfma_f32_16x16x32_bf16 a[120:123], v[184:187], a[244:247], a[120:123]
  ds_read_b128 a[212:215], v11 offset:36864
  v_cvt_pk_bf16_f32 v202, v204, v205
  v_mfma_f32_16x16x32_bf16 a[120:123], v[176:179], a[240:243], a[120:123]
  v_exp_f32 v217, v217
  v_mfma_f32_16x16x32_bf16 a[88:91], v[160:163], a[240:243], a[88:91]
  v_exp_f32 v218, v218
  v_mfma_f32_16x16x32_bf16 a[88:91], v[168:171], a[244:247], a[88:91]
  v_cvt_pk_bf16_f32 v106, v6, v7
  v_cvt_pk_bf16_f32 v203, v206, v207
  v_mfma_f32_16x16x32_bf16 a[56:59], v[152:155], a[244:247], a[56:59]
  s_add_u32 m0, s30, 99328
  s_xor_b32 s40, s32, 0x11400
  ds_read_b128 a[216:219], v12 offset:36864
  v_cvt_pk_bf16_f32 v107, v8, v9
  v_mfma_f32_16x16x32_bf16 a[56:59], v[144:147], a[240:243], a[56:59]
  s_waitcnt vmcnt(12)
  buffer_load_dwordx4 v23, s[20:23], s40 offen nt lds
  v_mfma_f32_16x16x32_bf16 a[24:27], v[128:131], a[240:243], a[24:27]
  v_exp_f32 v219, v219
  v_mfma_f32_16x16x32_bf16 a[24:27], v[136:139], a[244:247], a[24:27]
  v_exp_f32 v220, v220
  v_mfma_f32_16x16x32_bf16 a[28:31], v[136:139], a[252:255], a[28:31]
  ds_read_b128 a[220:223], v13 offset:36864
  v_cvt_pk_bf16_f32 v216, v216, v217
  v_mfma_f32_16x16x32_bf16 a[28:31], v[128:131], a[248:251], a[28:31]
  ds_read2_b64 v[2:5], v31 offset0:0 offset1:0
  v_cvt_pk_bf16_f32 v217, v218, v219
  v_mfma_f32_16x16x32_bf16 a[60:63], v[144:147], a[248:251], a[60:63]
  v_exp_f32 v221, v221
  v_mfma_f32_16x16x32_bf16 a[60:63], v[152:155], a[252:255], a[60:63]
  v_exp_f32 v222, v222
  v_mfma_f32_16x16x32_bf16 a[92:95], v[168:171], a[252:255], a[92:95]
  v_exp_f32 v223, v223
  v_mfma_f32_16x16x32_bf16 a[92:95], v[160:163], a[248:251], a[92:95]
  v_exp_f32 v232, v232
  v_mfma_f32_16x16x32_bf16 a[124:127], v[176:179], a[248:251], a[124:127]
  v_exp_f32 v233, v233
  v_mfma_f32_16x16x32_bf16 a[124:127], v[184:187], a[252:255], a[124:127]
  s_waitcnt lgkmcnt(1)
  s_add_u32 m0, s30, 100352
  s_xor_b32 s40, s32, 0x1c00
  v_exp_f32 v234, v234
  v_mfma_f32_16x16x32_bf16 v[176:179], a[192:195], a[176:179], 0
  s_waitcnt vmcnt(12)
  buffer_load_dwordx4 v24, s[20:23], s40 offen nt lds
  v_mfma_f32_16x16x32_bf16 v[176:179], a[196:199], a[180:183], v[176:179]
  ds_read_b128 a[224:227], v10 offset:40960
  v_cvt_pk_bf16_f32 v218, v220, v221
  v_mfma_f32_16x16x32_bf16 v[176:179], a[200:203], a[184:187], v[176:179]
  v_exp_f32 v235, v235
  v_mfma_f32_16x16x32_bf16 v[176:179], a[204:207], a[188:191], v[176:179]
  v_exp_f32 v236, v236
  s_waitcnt lgkmcnt(1)
  v_mfma_f32_16x16x32_bf16 v[2:5], v[32:35], v[2:5], 0
  v_exp_f32 v237, v237
  v_mfma_f32_16x16x32_bf16 v[160:163], a[204:207], a[172:175], 0
  ds_read_b128 a[228:231], v11 offset:40960
  v_cvt_pk_bf16_f32 v219, v222, v223
  v_mfma_f32_16x16x32_bf16 v[160:163], a[200:203], a[168:171], v[160:163]
  v_exp_f32 v238, v238
  v_mfma_f32_16x16x32_bf16 v[160:163], a[196:199], a[164:167], v[160:163]
  v_exp_f32 v239, v239
  v_mfma_f32_16x16x32_bf16 v[160:163], a[192:195], a[160:163], v[160:163]
  ds_read_b128 a[232:235], v12 offset:40960
  v_cvt_pk_bf16_f32 v108, v2, v3
  v_mfma_f32_16x16x32_bf16 v[144:147], a[192:195], a[144:147], 0
  v_cvt_pk_bf16_f32 v109, v4, v5
  v_cvt_pk_bf16_f32 v232, v232, v233
  v_mfma_f32_16x16x32_bf16 v[144:147], a[196:199], a[148:151], v[144:147]
  v_exp_f32 v248, v248
  v_mfma_f32_16x16x32_bf16 v[144:147], a[200:203], a[152:155], v[144:147]
  ds_read_b128 a[236:239], v13 offset:40960
  v_cvt_pk_bf16_f32 v233, v234, v235
  v_mfma_f32_16x16x32_bf16 v[144:147], a[204:207], a[156:159], v[144:147]
  v_exp_f32 v249, v249
  v_mfma_f32_16x16x32_bf16 v[128:131], a[204:207], a[140:143], 0
  ds_read2_b64 v[6:9], v31 offset0:1 offset1:1
  v_cvt_pk_bf16_f32 v234, v236, v237
  v_mfma_f32_16x16x32_bf16 v[128:131], a[200:203], a[136:139], v[128:131]
  s_xor_b32 s43, s48, 0xd800
  ds_read_b128 a[240:243], v10 offset:45056
  v_xor_b32 v31, 0x1000, v31
  v_mfma_f32_16x16x32_bf16 v[128:131], a[196:199], a[132:135], v[128:131]
  s_waitcnt vmcnt(12)
  buffer_store_dwordx4 v[116:119], v26, s[24:27], s43 offen sc1
  v_mfma_f32_16x16x32_bf16 v[128:131], a[192:195], a[128:131], v[128:131]
  v_exp_f32 v250, v250
  v_mfma_f32_16x16x32_bf16 v[132:135], a[208:211], a[128:131], 0
  ds_read_b128 a[244:247], v11 offset:45056
  v_cvt_pk_bf16_f32 v235, v238, v239
  v_mfma_f32_16x16x32_bf16 v[132:135], a[212:215], a[132:135], v[132:135]
  v_exp_f32 v251, v251
  v_mfma_f32_16x16x32_bf16 v[132:135], a[216:219], a[136:139], v[132:135]
  v_exp_f32 v252, v252
  v_mfma_f32_16x16x32_bf16 v[132:135], a[220:223], a[140:143], v[132:135]
  ds_read_b128 a[248:251], v12 offset:45056
  v_cvt_pk_bf16_f32 v248, v248, v249
  v_mfma_f32_16x16x32_bf16 v[148:151], a[220:223], a[156:159], 0
  v_exp_f32 v253, v253
  v_mfma_f32_16x16x32_bf16 v[148:151], a[216:219], a[152:155], v[148:151]
  v_exp_f32 v254, v254
  v_mfma_f32_16x16x32_bf16 v[148:151], a[212:215], a[148:151], v[148:151]
  s_add_u32 m0, s30, 101376
  s_xor_b32 s40, s32, 0x1000
  ds_read_b128 a[252:255], v13 offset:45056
  v_cvt_pk_bf16_f32 v249, v250, v251
  v_mfma_f32_16x16x32_bf16 v[148:151], a[208:211], a[144:147], v[148:151]
  s_waitcnt vmcnt(12)
  buffer_load_dwordx4 v25, s[20:23], s40 offen nt lds
  s_waitcnt lgkmcnt(4)
  v_mfma_f32_16x16x32_bf16 v[6:9], v[32:35], v[6:9], 0
  v_exp_f32 v255, v255
  v_mfma_f32_16x16x32_bf16 v[164:167], a[208:211], a[160:163], 0
  v_exp_f32 v128, v128
  v_mfma_f32_16x16x32_bf16 v[164:167], a[212:215], a[164:167], v[164:167]
  v_exp_f32 v129, v129
  v_mfma_f32_16x16x32_bf16 v[164:167], a[216:219], a[168:171], v[164:167]
  v_exp_f32 v130, v130
  v_mfma_f32_16x16x32_bf16 v[164:167], a[220:223], a[172:175], v[164:167]
  v_cvt_pk_bf16_f32 v110, v6, v7
  v_cvt_pk_bf16_f32 v250, v252, v253
  v_mfma_f32_16x16x32_bf16 v[180:183], a[220:223], a[188:191], 0
  v_cvt_pk_bf16_f32 v111, v8, v9
  v_cvt_pk_bf16_f32 v251, v254, v255
  v_mfma_f32_16x16x32_bf16 v[180:183], a[216:219], a[184:187], v[180:183]
  v_exp_f32 v131, v131
  v_mfma_f32_16x16x32_bf16 v[180:183], a[212:215], a[180:183], v[180:183]
  v_exp_f32 v132, v132
  v_mfma_f32_16x16x32_bf16 v[180:183], a[208:211], a[176:179], v[180:183]
  s_mov_b64 exec, 0
  s_cmp_eq_u32 s45, 0
  s_cbranch_scc1 L_pg12
  s_cmp_eq_u32 s45, 1
  s_cbranch_scc1 L_pg13
  s_cmp_eq_u32 s45, 2
  s_cbranch_scc1 L_pg14
  s_branch L_pg15
L_rt2:
  s_mov_b64 exec, -1
  s_waitcnt vmcnt(7) lgkmcnt(0)
  s_cmpk_lt_i32 s10, 0xfffa
  s_cbranch_scc0 L_fb1_10
  s_waitcnt vmcnt(2)
L_fb1_10:
  s_barrier
  v_mfma_f32_16x16x32_bf16 v[184:187], a[224:227], a[176:179], 0
  ds_read_b64_tr_b16 a[192:193], v14 offset:16384
  v_cvt_pk_bf16_f32 v128, v128, v129
  v_mfma_f32_16x16x32_bf16 v[184:187], a[228:231], a[180:183], v[184:187]
  s_waitcnt vmcnt(10)
  ds_read2_b64 v[2:5], v28 offset0:0 offset1:0
  v_cvt_pk_bf16_f32 v129, v130, v131
  v_mfma_f32_16x16x32_bf16 v[184:187], a[232:235], a[184:187], v[184:187]
  ds_read_b64_tr_b16 a[194:195], v14 offset:20480
  v_mfma_f32_16x16x32_bf16 v[184:187], a[236:239], a[188:191], v[184:187]
  v_exp_f32 v133, v133
  v_mfma_f32_16x16x32_bf16 v[168:171], a[236:239], a[172:175], 0
  s_add_u32 m0, s30, 0
  s_xor_b32 s40, s33, 0x0
  ds_read_b64_tr_b16 a[196:197], v14 offset:24576
  v_cvt_pk_bf16_f32 v130, v132, v133
  v_mfma_f32_16x16x32_bf16 v[168:171], a[232:235], a[168:171], v[168:171]
  s_waitcnt vmcnt(12)
  buffer_load_dwordx4 v22, s[16:19], s40 offen nt lds
  v_mfma_f32_16x16x32_bf16 v[168:171], a[228:231], a[164:167], v[168:171]
  ds_read_b64_tr_b16 a[198:199], v14 offset:28672
  v_mfma_f32_16x16x32_bf16 v[168:171], a[224:227], a[160:163], v[168:171]
  v_exp_f32 v134, v134
  v_mfma_f32_16x16x32_bf16 v[152:155], a[224:227], a[144:147], 0
  ds_read_b64_tr_b16 a[200:201], v15 offset:16384
  v_mfma_f32_16x16x32_bf16 v[152:155], a[228:231], a[148:151], v[152:155]
  v_exp_f32 v135, v135
  v_mfma_f32_16x16x32_bf16 v[152:155], a[232:235], a[152:155], v[152:155]
  ds_read_b64_tr_b16 a[202:203], v15 offset:20480
  v_cvt_pk_bf16_f32 v131, v134, v135
  v_mfma_f32_16x16x32_bf16 v[152:155], a[236:239], a[156:159], v[152:155]
  v_exp_f32 v144, v144
  s_waitcnt lgkmcnt(5)
  v_mfma_f32_16x16x32_bf16 v[2:5], v[32:35], v[2:5], 0
  v_exp_f32 v145, v145
  v_mfma_f32_16x16x32_bf16 v[136:139], a[236:239], a[140:143], 0
  ds_read_b64_tr_b16 a[204:205], v15 offset:24576
  v_cvt_pk_bf16_f32 v144, v144, v145
  v_mfma_f32_16x16x32_bf16 v[136:139], a[232:235], a[136:139], v[136:139]
  v_exp_f32 v146, v146
  v_mfma_f32_16x16x32_bf16 v[136:139], a[228:231], a[132:135], v[136:139]
  ds_read_b64_tr_b16 a[206:207], v15 offset:28672
  v_mfma_f32_16x16x32_bf16 v[136:139], a[224:227], a[128:131], v[136:139]
  v_cvt_pk_bf16_f32 v112, v2, v3
  v_mfma_f32_16x16x32_bf16 v[140:143], a[240:243], a[128:131], 0
  s_xor_b32 s43, s48, 0xbc00
  ds_read_b64_tr_b16 a[208:209], v16 offset:16384
  v_cvt_pk_bf16_f32 v113, v4, v5
  v_mfma_f32_16x16x32_bf16 v[140:143], a[244:247], a[132:135], v[140:143]
  s_waitcnt vmcnt(12)
  buffer_store_dwordx4 v[120:123], v26, s[24:27], s43 offen sc1
  v_mfma_f32_16x16x32_bf16 v[140:143], a[248:251], a[136:139], v[140:143]
  ds_read_b64_tr_b16 a[210:211], v16 offset:20480
  v_mfma_f32_16x16x32_bf16 v[140:143], a[252:255], a[140:143], v[140:143]
  ds_read2_b64 v[6:9], v28 offset0:1 offset1:1
  v_mfma_f32_16x16x32_bf16 v[156:159], a[252:255], a[156:159], 0
  ds_read_b64_tr_b16 a[212:213], v16 offset:24576
  v_xor_b32 v28, 0x1000, v28
  v_mfma_f32_16x16x32_bf16 v[156:159], a[248:251], a[152:155], v[156:159]
  v_exp_f32 v147, v147
  v_mfma_f32_16x16x32_bf16 v[156:159], a[244:247], a[148:151], v[156:159]
  ds_read_b64_tr_b16 a[214:215], v16 offset:28672
  v_cvt_pk_bf16_f32 v145, v146, v147
  v_mfma_f32_16x16x32_bf16 v[156:159], a[240:243], a[144:147], v[156:159]
  v_exp_f32 v148, v148
  v_mfma_f32_16x16x32_bf16 v[172:175], a[240:243], a[160:163], 0
  ds_read_b64_tr_b16 a[216:217], v17 offset:16384
  v_mfma_f32_16x16x32_bf16 v[172:175], a[244:247], a[164:167], v[172:175]
  v_exp_f32 v149, v149
  v_mfma_f32_16x16x32_bf16 v[172:175], a[248:251], a[168:171], v[172:175]
  s_add_u32 m0, s30, 1024
  s_xor_b32 s40, s33, 0xc00
  ds_read_b64_tr_b16 a[218:219], v17 offset:20480
  v_cvt_pk_bf16_f32 v146, v148, v149
  v_mfma_f32_16x16x32_bf16 v[172:175], a[252:255], a[172:175], v[172:175]
  s_waitcnt vmcnt(12)
  buffer_load_dwordx4 v23, s[16:19], s40 offen nt lds
  s_waitcnt lgkmcnt(4)
  v_mfma_f32_16x16x32_bf16 v[6:9], v[32:35], v[6:9], 0
  v_exp_f32 v150, v150
  v_mfma_f32_16x16x32_bf16 v[188:191], a[252:255], a[188:191], 0
  ds_read_b64_tr_b16 a[220:221], v17 offset:24576
  v_mfma_f32_16x16x32_bf16 v[188:191], a[248:251], a[184:187], v[188:191]
  v_exp_f32 v151, v151
  v_mfma_f32_16x16x32_bf16 v[188:191], a[244:247], a[180:183], v[188:191]
  ds_read_b64_tr_b16 a[222:223], v17 offset:28672
  v_cvt_pk_bf16_f32 v147, v150, v151
  v_mfma_f32_16x16x32_bf16 v[188:191], a[240:243], a[176:179], v[188:191]
  v_cvt_pk_bf16_f32 v114, v6, v7
  v_mfma_f32_16x16x32_bf16 v[48:51], v[44:47], v[192:195], v[48:51]
  ds_read_b64_tr_b16 a[224:225], v18 offset:16384
  v_cvt_pk_bf16_f32 v115, v8, v9
  v_mfma_f32_16x16x32_bf16 v[48:51], v[44:47], v[200:203], v[48:51]
  v_exp_f32 v160, v160
  v_mfma_f32_16x16x32_bf16 v[52:55], v[44:47], v[208:211], v[52:55]
  ds_read_b64_tr_b16 a[226:227], v18 offset:20480
  v_mfma_f32_16x16x32_bf16 v[52:55], v[44:47], v[216:219], v[52:55]
  v_mov_b32 v252, 1
  v_mfma_f32_16x16x32_bf16 v[56:59], v[44:47], v[224:227], v[56:59]
  ds_read_b64_tr_b16 a[228:229], v18 offset:24576
  v_mfma_f32_16x16x32_bf16 v[56:59], v[44:47], v[232:235], v[56:59]
  s_waitcnt vmcnt(12)
  buffer_atomic_add v252, v26, s[4:7], 0 offen sc0 sc1
  v_mfma_f32_16x16x32_bf16 v[60:63], v[44:47], v[240:243], v[60:63]
  ds_read_b64_tr_b16 a[230:231], v18 offset:28672
  v_mfma_f32_16x16x32_bf16 v[60:63], v[44:47], v[248:251], v[60:63]
  s_waitcnt lgkmcnt(4)
  ds_read2_b64 v[2:5], v29 offset0:0 offset1:0
  v_mfma_f32_16x16x32_bf16 a[96:99], v[248:251], a[196:199], a[96:99]
  s_add_u32 m0, s30, 2048
  s_xor_b32 s40, s33, 0x10400
  ds_read_b64_tr_b16 a[232:233], v19 offset:16384
  v_mfma_f32_16x16x32_bf16 a[96:99], v[240:243], a[192:195], a[96:99]
  s_waitcnt vmcnt(12)
  buffer_load_dwordx4 v24, s[16:19], s40 offen nt lds
  v_mfma_f32_16x16x32_bf16 a[64:67], v[224:227], a[192:195], a[64:67]
  ds_read_b64_tr_b16 a[234:235], v19 offset:20480
  v_mfma_f32_16x16x32_bf16 a[64:67], v[232:235], a[196:199], a[64:67]
  v_exp_f32 v161, v161
  v_mfma_f32_16x16x32_bf16 a[32:35], v[216:219], a[196:199], a[32:35]
  ds_read_b64_tr_b16 a[236:237], v19 offset:24576
  v_cvt_pk_bf16_f32 v160, v160, v161
  v_mfma_f32_16x16x32_bf16 a[32:35], v[208:211], a[192:195], a[32:35]
  v_exp_f32 v162, v162
  v_mfma_f32_16x16x32_bf16 a[0:3], v[192:195], a[192:195], a[0:3]
  ds_read_b64_tr_b16 a[238:239], v19 offset:28672
  v_mfma_f32_16x16x32_bf16 a[0:3], v[200:203], a[196:199], a[0:3]
  v_exp_f32 v163, v163
  s_waitcnt lgkmcnt(4)
  v_mfma_f32_16x16x32_bf16 v[2:5], v[32:35], v[2:5], 0
  v_exp_f32 v164, v164
  v_mfma_f32_16x16x32_bf16 a[4:7], v[200:203], a[204:207], a[4:7]
  ds_read_b64_tr_b16 a[240:241], v20 offset:16384
  v_cvt_pk_bf16_f32 v161, v162, v163
  v_mfma_f32_16x16x32_bf16 a[4:7], v[192:195], a[200:203], a[4:7]
  v_exp_f32 v165, v165
  v_mfma_f32_16x16x32_bf16 a[36:39], v[208:211], a[200:203], a[36:39]
  ds_read_b64_tr_b16 a[242:243], v20 offset:20480
  v_cvt_pk_bf16_f32 v162, v164, v165
  v_mfma_f32_16x16x32_bf16 a[36:39], v[216:219], a[204:207], a[36:39]
  v_cvt_pk_bf16_f32 v116, v2, v3
  v_mfma_f32_16x16x32_bf16 a[68:71], v[232:235], a[204:207], a[68:71]
  ds_read_b64_tr_b16 a[244:245], v20 offset:24576
  v_cvt_pk_bf16_f32 v117, v4, v5
  v_mfma_f32_16x16x32_bf16 a[68:71], v[224:227], a[200:203], a[68:71]
  v_exp_f32 v166, v166
  v_mfma_f32_16x16x32_bf16 a[100:103], v[240:243], a[200:203], a[100:103]
  s_xor_b32 s43, s48, 0xdc00
  ds_read_b64_tr_b16 a[246:247], v20 offset:28672
  v_mfma_f32_16x16x32_bf16 a[100:103], v[248:251], a[204:207], a[100:103]
  s_waitcnt vmcnt(12)
  buffer_store_dwordx4 v[124:127], v26, s[24:27], s43 offen sc1
  v_mfma_f32_16x16x32_bf16 a[104:107], v[248:251], a[212:215], a[104:107]
  ds_read_b64_tr_b16 a[248:249], v21 offset:16384
  v_mfma_f32_16x16x32_bf16 a[104:107], v[240:243], a[208:211], a[104:107]
  ds_read2_b64 v[6:9], v29 offset0:1 offset1:1
  v_mfma_f32_16x16x32_bf16 a[72:75], v[224:227], a[208:211], a[72:75]
  ds_read_b64_tr_b16 a[250:251], v21 offset:20480
  v_xor_b32 v29, 0x1000, v29
  v_mfma_f32_16x16x32_bf16 a[72:75], v[232:235], a[212:215], a[72:75]
  v_exp_f32 v167, v167
  v_mfma_f32_16x16x32_bf16 a[40:43], v[216:219], a[212:215], a[40:43]
  ds_read_b64_tr_b16 a[252:253], v21 offset:24576
  v_cvt_pk_bf16_f32 v163, v166, v167
  v_mfma_f32_16x16x32_bf16 a[40:43], v[208:211], a[208:211], a[40:43]
  v_exp_f32 v176, v176
  v_mfma_f32_16x16x32_bf16 a[8:11], v[192:195], a[208:211], a[8:11]
  ds_read_b64_tr_b16 a[254:255], v21 offset:28672
  v_mfma_f32_16x16x32_bf16 a[8:11], v[200:203], a[212:215], a[8:11]
  v_exp_f32 v177, v177
  v_mfma_f32_16x16x32_bf16 a[12:15], v[200:203], a[220:223], a[12:15]
  v_exp_f32 v178, v178
  v_mfma_f32_16x16x32_bf16 a[12:15], v[192:195], a[216:219], a[12:15]
  v_exp_f32 v179, v179
  v_mfma_f32_16x16x32_bf16 a[44:47], v[208:211], a[216:219], a[44:47]
  v_exp_f32 v180, v180
  v_mfma_f32_16x16x32_bf16 a[44:47], v[216:219], a[220:223], a[44:47]
  s_waitcnt vmcnt(7) lgkmcnt(0)
  s_cmpk_lt_i32 s11, 0xfffc
  s_cbranch_scc0 L_fb1_11
  s_waitcnt vmcnt(1)
L_fb1_11:
  s_barrier
  v_mfma_f32_16x16x32_bf16 a[76:79], v[232:235], a[220:223], a[76:79]
  s_add_u32 m0, s30, 3072
  s_xor_b32 s40, s33, 0x10800
  ds_read_b128 a[192:195], v10 offset:49152
  v_cvt_pk_bf16_f32 v176, v176, v177
  v_mfma_f32_16x16x32_bf16 a[76:79], v[224:227], a[216:219], a[76:79]
  s_waitcnt vmcnt(12)
  buffer_load_dwordx4 v25, s[16:19], s40 offen nt lds
  v_mfma_f32_16x16x32_bf16 a[108:111], v[240:243], a[216:219], a[108:111]
  v_exp_f32 v181, v181
  v_mfma_f32_16x16x32_bf16 a[108:111], v[248:251], a[220:223], a[108:111]
  v_exp_f32 v182, v182
  v_mfma_f32_16x16x32_bf16 v[6:9], v[32:35], v[6:9], 0
  v_exp_f32 v183, v183
  v_mfma_f32_16x16x32_bf16 a[112:115], v[248:251], a[228:231], a[112:115]
  ds_read_b128 a[196:199], v11 offset:49152
  v_cvt_pk_bf16_f32 v177, v178, v179
  v_mfma_f32_16x16x32_bf16 a[112:115], v[240:243], a[224:227], a[112:115]
  v_exp_f32 v136, v136
  v_mfma_f32_16x16x32_bf16 a[80:83], v[224:227], a[224:227], a[80:83]
  v_exp_f32 v137, v137
  v_mfma_f32_16x16x32_bf16 a[80:83], v[232:235], a[228:231], a[80:83]
  v_cvt_pk_bf16_f32 v118, v6, v7
  v_cvt_pk_bf16_f32 v178, v180, v181
  v_mfma_f32_16x16x32_bf16 a[48:51], v[216:219], a[228:231], a[48:51]
  ds_read_b128 a[200:203], v12 offset:49152
  v_cvt_pk_bf16_f32 v119, v8, v9
  v_mfma_f32_16x16x32_bf16 a[48:51], v[208:211], a[224:227], a[48:51]
  ds_read2_b64 v[2:5], v30 offset0:0 offset1:0
  v_cvt_pk_bf16_f32 v179, v182, v183
  v_mfma_f32_16x16x32_bf16 a[16:19], v[192:195], a[224:227], a[16:19]
  v_exp_f32 v138, v138
  v_mfma_f32_16x16x32_bf16 a[16:19], v[200:203], a[228:231], a[16:19]
  v_exp_f32 v139, v139
  v_mfma_f32_16x16x32_bf16 a[20:23], v[200:203], a[236:239], a[20:23]
  ds_read_b128 a[204:207], v13 offset:49152
  v_cvt_pk_bf16_f32 v136, v136, v137
  v_mfma_f32_16x16x32_bf16 a[20:23], v[192:195], a[232:235], a[20:23]
  s_add_u32 m0, s30, 114688
  s_xor_b32 s40, s32, 0x11c00
  v_exp_f32 v140, v140
  v_mfma_f32_16x16x32_bf16 a[52:55], v[208:211], a[232:235], a[52:55]
  s_waitcnt vmcnt(12)
  buffer_load_dwordx4 v22, s[20:23], s40 offen nt lds
  v_mfma_f32_16x16x32_bf16 a[52:55], v[216:219], a[236:239], a[52:55]
  v_exp_f32 v141, v141
  v_mfma_f32_16x16x32_bf16 a[84:87], v[232:235], a[236:239], a[84:87]
  ds_read_b128 a[208:211], v10 offset:53248
  v_cvt_pk_bf16_f32 v137, v138, v139
  v_mfma_f32_16x16x32_bf16 a[84:87], v[224:227], a[232:235], a[84:87]
  v_exp_f32 v142, v142
  v_mfma_f32_16x16x32_bf16 a[116:119], v[240:243], a[232:235], a[116:119]
  v_exp_f32 v143, v143
  v_mfma_f32_16x16x32_bf16 a[116:119], v[248:251], a[236:239], a[116:119]
  v_exp_f32 v152, v152
  s_waitcnt lgkmcnt(2)
  v_mfma_f32_16x16x32_bf16 v[2:5], v[32:35], v[2:5], 0
  v_exp_f32 v153, v153
  v_mfma_f32_16x16x32_bf16 a[120:123], v[248:251], a[244:247], a[120:123]
  ds_read_b128 a[212:215], v11 offset:53248
  v_cvt_pk_bf16_f32 v138, v140, v141
  v_mfma_f32_16x16x32_bf16 a[120:123], v[240:243], a[240:243], a[120:123]
  v_exp_f32 v154, v154
  v_mfma_f32_16x16x32_bf16 a[88:91], v[224:227], a[240:243], a[88:91]
  v_exp_f32 v155, v155
  v_mfma_f32_16x16x32_bf16 a[88:91], v[232:235], a[244:247], a[88:91]
  v_cvt_pk_bf16_f32 v120, v2, v3
  v_cvt_pk_bf16_f32 v139, v142, v143
  v_mfma_f32_16x16x32_bf16 a[56:59], v[216:219], a[244:247], a[56:59]
  ds_read_b128 a[216:219], v12 offset:53248
  v_cvt_pk_bf16_f32 v121, v4, v5
  v_mfma_f32_16x16x32_bf16 a[56:59], v[208:211], a[240:243], a[56:59]
  v_exp_f32 v156, v156
  v_mfma_f32_16x16x32_bf16 a[24:27], v[192:195], a[240:243], a[24:27]
  s_add_u32 m0, s30, 115712
  s_xor_b32 s40, s32, 0x11000
  v_exp_f32 v157, v157
  v_mfma_f32_16x16x32_bf16 a[24:27], v[200:203], a[244:247], a[24:27]
  s_waitcnt vmcnt(12)
  buffer_load_dwordx4 v23, s[20:23], s40 offen nt lds
  v_mfma_f32_16x16x32_bf16 a[28:31], v[200:203], a[252:255], a[28:31]
  ds_read_b128 a[220:223], v13 offset:53248
  v_cvt_pk_bf16_f32 v152, v152, v153
  v_mfma_f32_16x16x32_bf16 a[28:31], v[192:195], a[248:251], a[28:31]
  ds_read2_b64 v[6:9], v30 offset0:1 offset1:1
  v_cvt_pk_bf16_f32 v153, v154, v155
  v_mfma_f32_16x16x32_bf16 a[60:63], v[208:211], a[248:251], a[60:63]
  v_xor_b32 v30, 0x1000, v30
  v_cvt_pk_bf16_f32 v154, v156, v157
  v_mfma_f32_16x16x32_bf16 a[60:63], v[216:219], a[252:255], a[60:63]
  v_exp_f32 v158, v158
  v_mfma_f32_16x16x32_bf16 a[92:95], v[232:235], a[252:255], a[92:95]
  v_exp_f32 v159, v159
  v_mfma_f32_16x16x32_bf16 a[92:95], v[224:227], a[248:251], a[92:95]
  v_exp_f32 v168, v168
  v_mfma_f32_16x16x32_bf16 a[124:127], v[240:243], a[248:251], a[124:127]
  v_exp_f32 v169, v169
  v_mfma_f32_16x16x32_bf16 a[124:127], v[248:251], a[252:255], a[124:127]
  s_waitcnt lgkmcnt(1)
  v_exp_f32 v170, v170
  v_mfma_f32_16x16x32_bf16 v[240:243], a[192:195], a[176:179], 0
  v_exp_f32 v171, v171
  v_mfma_f32_16x16x32_bf16 v[240:243], a[196:199], a[180:183], v[240:243]
  ds_read_b128 a[224:227], v10 offset:57344
  v_cvt_pk_bf16_f32 v155, v158, v159
  v_mfma_f32_16x16x32_bf16 v[240:243], a[200:203], a[184:187], v[240:243]
  v_exp_f32 v172, v172
  v_mfma_f32_16x16x32_bf16 v[240:243], a[204:207], a[188:191], v[240:243]
  v_exp_f32 v173, v173
  s_waitcnt lgkmcnt(1)
  v_mfma_f32_16x16x32_bf16 v[6:9], v[32:35], v[6:9], 0
  v_exp_f32 v174, v174
  v_mfma_f32_16x16x32_bf16 v[224:227], a[204:207], a[172:175], 0
  s_add_u32 m0, s30, 116736
  s_xor_b32 s40, s32, 0x1800
  ds_read_b128 a[228:231], v11 offset:57344
  v_cvt_pk_bf16_f32 v168, v168, v169
  v_mfma_f32_16x16x32_bf16 v[224:227], a[200:203], a[168:171], v[224:227]
  s_waitcnt vmcnt(12)
  buffer_load_dwordx4 v24, s[20:23], s40 offen nt lds
  v_mfma_f32_16x16x32_bf16 v[224:227], a[196:199], a[164:167], v[224:227]
  v_exp_f32 v175, v175
  v_mfma_f32_16x16x32_bf16 v[224:227], a[192:195], a[160:163], v[224:227]
  ds_read_b128 a[232:235], v12 offset:57344
  v_cvt_pk_bf16_f32 v122, v6, v7
  v_mfma_f32_16x16x32_bf16 v[208:211], a[192:195], a[144:147], 0
  v_cvt_pk_bf16_f32 v123, v8, v9
  v_cvt_pk_bf16_f32 v169, v170, v171
  v_mfma_f32_16x16x32_bf16 v[208:211], a[196:199], a[148:151], v[208:211]
  v_exp_f32 v184, v184
  v_mfma_f32_16x16x32_bf16 v[208:211], a[200:203], a[152:155], v[208:211]
  ds_read_b128 a[236:239], v13 offset:57344
  v_cvt_pk_bf16_f32 v170, v172, v173
  v_mfma_f32_16x16x32_bf16 v[208:211], a[204:207], a[156:159], v[208:211]
  ds_read2_b64 v[2:5], v31 offset0:0 offset1:0
  v_cvt_pk_bf16_f32 v171, v174, v175
  v_mfma_f32_16x16x32_bf16 v[192:195], a[204:207], a[140:143], 0
  v_exp_f32 v185, v185
  v_mfma_f32_16x16x32_bf16 v[192:195], a[200:203], a[136:139], v[192:195]
  ds_read_b128 a[240:243], v10 offset:61440
  v_cvt_pk_bf16_f32 v184, v184, v185
  v_mfma_f32_16x16x32_bf16 v[192:195], a[196:199], a[132:135], v[192:195]
  v_exp_f32 v186, v186
  v_mfma_f32_16x16x32_bf16 v[192:195], a[192:195], a[128:131], v[192:195]
  v_exp_f32 v187, v187
  v_mfma_f32_16x16x32_bf16 v[196:199], a[208:211], a[128:131], 0
  ds_read_b128 a[244:247], v11 offset:61440
  v_cvt_pk_bf16_f32 v185, v186, v187
  v_mfma_f32_16x16x32_bf16 v[196:199], a[212:215], a[132:135], v[196:199]
  v_exp_f32 v188, v188
  v_mfma_f32_16x16x32_bf16 v[196:199], a[216:219], a[136:139], v[196:199]
  v_exp_f32 v189, v189
  v_mfma_f32_16x16x32_bf16 v[196:199], a[220:223], a[140:143], v[196:199]
  s_add_u32 m0, s30, 117760
  s_xor_b32 s40, s32, 0x1400
  ds_read_b128 a[248:251], v12 offset:61440
  v_cvt_pk_bf16_f32 v186, v188, v189
  s_waitcnt lgkmcnt(3)
  v_mfma_f32_16x16x32_bf16 v[2:5], v[32:35], v[2:5], 0
  v_exp_f32 v190, v190
  v_mfma_f32_16x16x32_bf16 v[212:215], a[220:223], a[156:159], 0
  s_waitcnt vmcnt(12)
  buffer_load_dwordx4 v25, s[20:23], s40 offen nt lds
  v_mfma_f32_16x16x32_bf16 v[212:215], a[216:219], a[152:155], v[212:215]
  v_exp_f32 v191, v191
  v_mfma_f32_16x16x32_bf16 v[212:215], a[212:215], a[148:151], v[212:215]
  ds_read_b128 a[252:255], v13 offset:61440
  v_cvt_pk_bf16_f32 v187, v190, v191
  v_mfma_f32_16x16x32_bf16 v[212:215], a[208:211], a[144:147], v[212:215]
  v_cvt_pk_bf16_f32 v124, v2, v3
  v_mfma_f32_16x16x32_bf16 v[228:231], a[208:211], a[160:163], 0
  v_cvt_pk_bf16_f32 v125, v4, v5
  v_mfma_f32_16x16x32_bf16 v[228:231], a[212:215], a[164:167], v[228:231]
  v_exp_f32 v192, v192
  v_mfma_f32_16x16x32_bf16 v[228:231], a[216:219], a[168:171], v[228:231]
  v_exp_f32 v193, v193
  v_mfma_f32_16x16x32_bf16 v[228:231], a[220:223], a[172:175], v[228:231]
  v_exp_f32 v194, v194
  v_mfma_f32_16x16x32_bf16 v[244:247], a[220:223], a[188:191], 0
  v_exp_f32 v195, v195
  v_mfma_f32_16x16x32_bf16 v[244:247], a[216:219], a[184:187], v[244:247]
  v_exp_f32 v196, v196
  v_mfma_f32_16x16x32_bf16 v[244:247], a[212:215], a[180:183], v[244:247]
  ds_read2_b64 v[6:9], v31 offset0:1 offset1:1
  v_cvt_pk_bf16_f32 v192, v192, v193
  v_mfma_f32_16x16x32_bf16 v[244:247], a[208:211], a[176:179], v[244:247]
  s_waitcnt vmcnt(7) lgkmcnt(0)
  s_cmpk_lt_i32 s8, 0x0
  s_cbranch_scc0 L_fb1_12
  s_waitcnt vmcnt(2)
L_fb1_12:
  s_barrier
  v_mfma_f32_16x16x32_bf16 v[248:251], a[224:227], a[176:179], 0
  s_add_u32 m0, s30, 16384
  s_xor_b32 s40, s33, 0x400
  ds_read_b64_tr_b16 a[192:193], v14 offset:32768
  v_xor_b32 v31, 0x1000, v31
  v_mfma_f32_16x16x32_bf16 v[248:251], a[228:231], a[180:183], v[248:251]
  s_waitcnt vmcnt(12)
  buffer_load_dwordx4 v22, s[16:19], s40 offen nt lds
  v_mfma_f32_16x16x32_bf16 v[248:251], a[232:235], a[184:187], v[248:251]
  ds_read_b64_tr_b16 a[194:195], v14 offset:36864
  v_cvt_pk_bf16_f32 v193, v194, v195
  v_mfma_f32_16x16x32_bf16 v[248:251], a[236:239], a[188:191], v[248:251]
  v_exp_f32 v197, v197
  v_mfma_f32_16x16x32_bf16 v[232:235], a[236:239], a[172:175], 0
  ds_read_b64_tr_b16 a[196:197], v14 offset:40960
  v_cvt_pk_bf16_f32 v194, v196, v197
  v_mfma_f32_16x16x32_bf16 v[232:235], a[232:235], a[168:171], v[232:235]
  v_exp_f32 v198, v198
  v_mfma_f32_16x16x32_bf16 v[232:235], a[228:231], a[164:167], v[232:235]
  ds_read_b64_tr_b16 a[198:199], v14 offset:45056
  v_mfma_f32_16x16x32_bf16 v[232:235], a[224:227], a[160:163], v[232:235]
  v_exp_f32 v199, v199
  v_mfma_f32_16x16x32_bf16 v[6:9], v[32:35], v[6:9], 0
  v_exp_f32 v208, v208
  v_mfma_f32_16x16x32_bf16 v[216:219], a[224:227], a[144:147], 0
  ds_read_b64_tr_b16 a[200:201], v15 offset:32768
  v_cvt_pk_bf16_f32 v195, v198, v199
  v_mfma_f32_16x16x32_bf16 v[216:219], a[228:231], a[148:151], v[216:219]
  v_exp_f32 v209, v209
  v_mfma_f32_16x16x32_bf16 v[216:219], a[232:235], a[152:155], v[216:219]
  ds_read_b64_tr_b16 a[202:203], v15 offset:36864
  v_cvt_pk_bf16_f32 v208, v208, v209
  v_mfma_f32_16x16x32_bf16 v[216:219], a[236:239], a[156:159], v[216:219]
  v_cvt_pk_bf16_f32 v126, v6, v7
  v_mfma_f32_16x16x32_bf16 v[200:203], a[236:239], a[140:143], 0
  ds_read_b64_tr_b16 a[204:205], v15 offset:40960
  v_cvt_pk_bf16_f32 v127, v8, v9
  v_mfma_f32_16x16x32_bf16 v[200:203], a[232:235], a[136:139], v[200:203]
  v_exp_f32 v210, v210
  v_mfma_f32_16x16x32_bf16 v[200:203], a[228:231], a[132:135], v[200:203]
  s_add_u32 m0, s30, 17408
  s_xor_b32 s40, s33, 0x800
  ds_read_b64_tr_b16 a[206:207], v15 offset:45056
  v_mfma_f32_16x16x32_bf16 v[200:203], a[224:227], a[128:131], v[200:203]
  s_waitcnt vmcnt(12)
  buffer_load_dwordx4 v23, s[16:19], s40 offen nt lds
  v_mfma_f32_16x16x32_bf16 v[204:207], a[240:243], a[128:131], 0
  ds_read_b64_tr_b16 a[208:209], v16 offset:32768
  v_mfma_f32_16x16x32_bf16 v[204:207], a[244:247], a[132:135], v[204:207]
  v_exp_f32 v211, v211
  v_mfma_f32_16x16x32_bf16 v[204:207], a[248:251], a[136:139], v[204:207]
  ds_read_b64_tr_b16 a[210:211], v16 offset:36864
  v_cvt_pk_bf16_f32 v209, v210, v211
  v_mfma_f32_16x16x32_bf16 v[204:207], a[252:255], a[140:143], v[204:207]
  s_waitcnt vmcnt(9)
  v_readfirstlane_b32 s44, v252
  v_mfma_f32_16x16x32_bf16 v[220:223], a[252:255], a[156:159], 0
  ds_read_b64_tr_b16 a[212:213], v16 offset:40960
  v_mfma_f32_16x16x32_bf16 v[220:223], a[248:251], a[152:155], v[220:223]
  s_sub_u32 s44, s44, s49
  s_add_u32 s49, s49, 64
  s_sub_i32 s8, s44, s98
  s_sub_i32 s9, s44, s99
  s_sub_i32 s10, s44, s100
  s_sub_i32 s11, s44, s101
  v_exp_f32 v212, v212
  v_mfma_f32_16x16x32_bf16 v[220:223], a[244:247], a[148:151], v[220:223]
  ds_read_b64_tr_b16 a[214:215], v16 offset:45056
  v_mfma_f32_16x16x32_bf16 v[220:223], a[240:243], a[144:147], v[220:223]
  v_exp_f32 v213, v213
  v_mfma_f32_16x16x32_bf16 v[236:239], a[240:243], a[160:163], 0
  ds_read_b64_tr_b16 a[216:217], v17 offset:32768
L_pg11:
  s_cbranch_execz L_rt1
  v_cvt_pk_bf16_f32 v210, v212, v213
  v_mfma_f32_16x16x32_bf16 v[236:239], a[244:247], a[164:167], v[236:239]
  v_exp_f32 v214, v214
  v_mfma_f32_16x16x32_bf16 v[236:239], a[248:251], a[168:171], v[236:239]
  ds_read_b64_tr_b16 a[218:219], v17 offset:36864
  v_mfma_f32_16x16x32_bf16 v[236:239], a[252:255], a[172:175], v[236:239]
  v_exp_f32 v215, v215
  v_mfma_f32_16x16x32_bf16 v[252:255], a[252:255], a[188:191], 0
  s_add_u32 m0, s30, 18432
  s_xor_b32 s40, s33, 0x10000
  ds_read_b64_tr_b16 a[220:221], v17 offset:40960
  v_cvt_pk_bf16_f32 v211, v214, v215
  v_mfma_f32_16x16x32_bf16 v[252:255], a[248:251], a[184:187], v[252:255]
  s_waitcnt vmcnt(12)
  buffer_load_dwordx4 v24, s[16:19], s40 offen nt lds
  v_mfma_f32_16x16x32_bf16 v[252:255], a[244:247], a[180:183], v[252:255]
  ds_read_b64_tr_b16 a[222:223], v17 offset:45056
  v_mfma_f32_16x16x32_bf16 v[252:255], a[240:243], a[176:179], v[252:255]
  v_exp_f32 v224, v224
  v_mfma_f32_16x16x32_bf16 v[48:51], v[44:47], v[128:131], v[48:51]
  ds_read_b64_tr_b16 a[224:225], v18 offset:32768
  v_accvgpr_write_b32 a128, v64
  v_mfma_f32_16x16x32_bf16 v[48:51], v[44:47], v[136:139], v[48:51]
  v_accvgpr_write_b32 a129, v65
  v_mfma_f32_16x16x32_bf16 v[52:55], v[44:47], v[144:147], v[52:55]
  ds_read_b64_tr_b16 a[226:227], v18 offset:36864
  v_accvgpr_write_b32 a130, v66
  v_mfma_f32_16x16x32_bf16 v[52:55], v[44:47], v[152:155], v[52:55]
  v_accvgpr_write_b32 a131, v67
  v_exp_f32 v225, v225
  v_mfma_f32_16x16x32_bf16 v[56:59], v[44:47], v[160:163], v[56:59]
  ds_read_b64_tr_b16 a[228:229], v18 offset:40960
  v_accvgpr_write_b32 a132, v68
  v_mfma_f32_16x16x32_bf16 v[56:59], v[44:47], v[168:171], v[56:59]
  v_accvgpr_write_b32 a133, v69
  v_exp_f32 v226, v226
  v_mfma_f32_16x16x32_bf16 v[60:63], v[44:47], v[176:179], v[60:63]
  ds_read_b64_tr_b16 a[230:231], v18 offset:45056
  v_accvgpr_write_b32 a134, v70
  v_mfma_f32_16x16x32_bf16 v[60:63], v[44:47], v[184:187], v[60:63]
  s_waitcnt lgkmcnt(4)
  v_accvgpr_write_b32 a135, v71
  v_exp_f32 v227, v227
  v_mfma_f32_16x16x32_bf16 a[96:99], v[184:187], a[196:199], a[96:99]
  s_add_u32 m0, s30, 19456
  s_xor_b32 s40, s33, 0x10c00
  ds_read_b64_tr_b16 a[232:233], v19 offset:32768
  v_accvgpr_write_b32 a136, v72
  v_mfma_f32_16x16x32_bf16 a[96:99], v[176:179], a[192:195], a[96:99]
  s_waitcnt vmcnt(12)
  buffer_load_dwordx4 v25, s[16:19], s40 offen nt lds
  v_mfma_f32_16x16x32_bf16 a[64:67], v[160:163], a[192:195], a[64:67]
  ds_read_b64_tr_b16 a[234:235], v19 offset:36864
  v_accvgpr_write_b32 a137, v73
  v_mfma_f32_16x16x32_bf16 a[64:67], v[168:171], a[196:199], a[64:67]
  v_accvgpr_write_b32 a138, v74
  v_cvt_pk_bf16_f32 v224, v224, v225
  v_mfma_f32_16x16x32_bf16 a[32:35], v[152:155], a[196:199], a[32:35]
  ds_read_b64_tr_b16 a[236:237], v19 offset:40960
  v_accvgpr_write_b32 a139, v75
  v_cvt_pk_bf16_f32 v225, v226, v227
  v_mfma_f32_16x16x32_bf16 a[32:35], v[144:147], a[192:195], a[32:35]
  v_accvgpr_write_b32 a140, v76
  v_mfma_f32_16x16x32_bf16 a[0:3], v[128:131], a[192:195], a[0:3]
  ds_read_b64_tr_b16 a[238:239], v19 offset:45056
  v_accvgpr_write_b32 a141, v77
  v_mfma_f32_16x16x32_bf16 a[0:3], v[136:139], a[196:199], a[0:3]
  v_accvgpr_write_b32 a142, v78
  v_exp_f32 v228, v228
  v_mfma_f32_16x16x32_bf16 a[4:7], v[136:139], a[204:207], a[4:7]
  ds_read_b64_tr_b16 a[240:241], v20 offset:32768
  v_accvgpr_write_b32 a143, v79
  v_mfma_f32_16x16x32_bf16 a[4:7], v[128:131], a[200:203], a[4:7]
  v_accvgpr_write_b32 a144, v80
  v_exp_f32 v229, v229
  v_mfma_f32_16x16x32_bf16 a[36:39], v[144:147], a[200:203], a[36:39]
  ds_read_b64_tr_b16 a[242:243], v20 offset:36864
  v_accvgpr_write_b32 a145, v81
  v_mfma_f32_16x16x32_bf16 a[36:39], v[152:155], a[204:207], a[36:39]
  v_accvgpr_write_b32 a146, v82
  v_exp_f32 v230, v230
  v_mfma_f32_16x16x32_bf16 a[68:71], v[168:171], a[204:207], a[68:71]
  s_add_u32 m0, s30, 65536
  s_xor_b32 s40, s33, 0x0
  ds_read_b64_tr_b16 a[244:245], v20 offset:40960
  v_accvgpr_write_b32 a147, v83
  v_mfma_f32_16x16x32_bf16 a[68:71], v[160:163], a[200:203], a[68:71]
  s_waitcnt vmcnt(12)
  buffer_load_dwordx4 v22, s[20:23], s40 offen nt lds
  v_mfma_f32_16x16x32_bf16 a[100:103], v[176:179], a[200:203], a[100:103]
  ds_read_b64_tr_b16 a[246:247], v20 offset:45056
  v_accvgpr_write_b32 a148, v84
  v_mfma_f32_16x16x32_bf16 a[100:103], v[184:187], a[204:207], a[100:103]
  v_accvgpr_write_b32 a149, v85
  v_cvt_pk_bf16_f32 v226, v228, v229
  v_mfma_f32_16x16x32_bf16 a[104:107], v[184:187], a[212:215], a[104:107]
  ds_read_b64_tr_b16 a[248:249], v21 offset:32768
  v_accvgpr_write_b32 a150, v86
  v_mfma_f32_16x16x32_bf16 a[104:107], v[176:179], a[208:211], a[104:107]
  v_accvgpr_write_b32 a151, v87
  v_exp_f32 v231, v231
  v_mfma_f32_16x16x32_bf16 a[72:75], v[160:163], a[208:211], a[72:75]
  ds_read_b64_tr_b16 a[250:251], v21 offset:36864
  v_accvgpr_write_b32 a152, v88
  v_mfma_f32_16x16x32_bf16 a[72:75], v[168:171], a[212:215], a[72:75]
  v_accvgpr_write_b32 a153, v89
  v_exp_f32 v240, v240
  v_mfma_f32_16x16x32_bf16 a[40:43], v[152:155], a[212:215], a[40:43]
  ds_read_b64_tr_b16 a[252:253], v21 offset:40960
  v_accvgpr_write_b32 a154, v90
  v_mfma_f32_16x16x32_bf16 a[40:43], v[144:147], a[208:211], a[40:43]
  v_accvgpr_write_b32 a155, v91
  v_exp_f32 v241, v241
  v_mfma_f32_16x16x32_bf16 a[8:11], v[128:131], a[208:211], a[8:11]
  ds_read_b64_tr_b16 a[254:255], v21 offset:45056
  v_accvgpr_write_b32 a156, v92
  v_mfma_f32_16x16x32_bf16 a[8:11], v[136:139], a[212:215], a[8:11]
  v_accvgpr_write_b32 a157, v93
  v_cvt_pk_bf16_f32 v227, v230, v231
  v_mfma_f32_16x16x32_bf16 a[12:15], v[136:139], a[220:223], a[12:15]
  v_accvgpr_write_b32 a158, v94
  v_exp_f32 v242, v242
  v_mfma_f32_16x16x32_bf16 a[12:15], v[128:131], a[216:219], a[12:15]
  s_add_u32 m0, s30, 66560
  s_xor_b32 s40, s33, 0xc00
  v_accvgpr_write_b32 a159, v95
  v_cvt_pk_bf16_f32 v240, v240, v241
  v_mfma_f32_16x16x32_bf16 a[44:47], v[144:147], a[216:219], a[44:47]
  s_waitcnt vmcnt(12)
  buffer_load_dwordx4 v23, s[20:23], s40 offen nt lds
  v_mfma_f32_16x16x32_bf16 a[44:47], v[152:155], a[220:223], a[44:47]
  s_waitcnt vmcnt(7) lgkmcnt(0)
  s_cmpk_lt_i32 s9, 0x0
  s_cbranch_scc0 L_fb1_13
  s_waitcnt vmcnt(3)
L_fb1_13:
  s_barrier
  v_mfma_f32_16x16x32_bf16 a[76:79], v[168:171], a[220:223], a[76:79]
  ds_read_b128 a[192:195], v10
  v_accvgpr_write_b32 a160, v96
  v_mfma_f32_16x16x32_bf16 a[76:79], v[160:163], a[216:219], a[76:79]
  v_accvgpr_write_b32 a161, v97
  v_exp_f32 v243, v243
  v_mfma_f32_16x16x32_bf16 a[108:111], v[176:179], a[216:219], a[108:111]
  v_accvgpr_write_b32 a162, v98
  v_cvt_pk_bf16_f32 v241, v242, v243
  v_mfma_f32_16x16x32_bf16 a[108:111], v[184:187], a[220:223], a[108:111]
  v_accvgpr_write_b32 a163, v99
  v_exp_f32 v244, v244
  v_mfma_f32_16x16x32_bf16 a[112:115], v[184:187], a[228:231], a[112:115]
  ds_read_b128 a[196:199], v11
  v_accvgpr_write_b32 a164, v100
  v_mfma_f32_16x16x32_bf16 a[112:115], v[176:179], a[224:227], a[112:115]
  v_accvgpr_write_b32 a165, v101
  v_mfma_f32_16x16x32_bf16 a[80:83], v[160:163], a[224:227], a[80:83]
  v_accvgpr_write_b32 a166, v102
  v_exp_f32 v245, v245
  v_mfma_f32_16x16x32_bf16 a[80:83], v[168:171], a[228:231], a[80:83]
  v_accvgpr_write_b32 a167, v103
  v_cvt_pk_bf16_f32 v242, v244, v245
  v_mfma_f32_16x16x32_bf16 a[48:51], v[152:155], a[228:231], a[48:51]
  ds_read_b128 a[200:203], v12
  v_accvgpr_write_b32 a168, v104
  v_mfma_f32_16x16x32_bf16 a[48:51], v[144:147], a[224:227], a[48:51]
  s_add_u32 m0, s30, 67584
  s_xor_b32 s40, s33, 0x10400
  v_accvgpr_write_b32 a169, v105
  v_exp_f32 v246, v246
  v_mfma_f32_16x16x32_bf16 a[16:19], v[128:131], a[224:227], a[16:19]
  s_waitcnt vmcnt(12)
  buffer_load_dwordx4 v24, s[20:23], s40 offen nt lds
  v_mfma_f32_16x16x32_bf16 a[16:19], v[136:139], a[228:231], a[16:19]
  v_accvgpr_write_b32 a170, v106
  v_mfma_f32_16x16x32_bf16 a[20:23], v[136:139], a[236:239], a[20:23]
  ds_read_b128 a[204:207], v13
  v_accvgpr_write_b32 a171, v107
  v_mfma_f32_16x16x32_bf16 a[20:23], v[128:131], a[232:235], a[20:23]
  v_accvgpr_write_b32 a172, v108
  v_exp_f32 v247, v247
  v_mfma_f32_16x16x32_bf16 a[52:55], v[144:147], a[232:235], a[52:55]
  v_accvgpr_write_b32 a173, v109
  v_cvt_pk_bf16_f32 v243, v246, v247
  v_mfma_f32_16x16x32_bf16 a[52:55], v[152:155], a[236:239], a[52:55]
  v_accvgpr_write_b32 a174, v110
  v_exp_f32 v200, v200
  v_mfma_f32_16x16x32_bf16 a[84:87], v[168:171], a[236:239], a[84:87]
  ds_read_b128 a[208:211], v10 offset:4096
  v_accvgpr_write_b32 a175, v111
  v_mfma_f32_16x16x32_bf16 a[84:87], v[160:163], a[232:235], a[84:87]
  v_accvgpr_write_b32 a176, v112
  v_exp_f32 v201, v201
  v_mfma_f32_16x16x32_bf16 a[116:119], v[176:179], a[232:235], a[116:119]
  v_accvgpr_write_b32 a177, v113
  v_cvt_pk_bf16_f32 v200, v200, v201
  v_mfma_f32_16x16x32_bf16 a[116:119], v[184:187], a[236:239], a[116:119]
  v_accvgpr_write_b32 a178, v114
  v_mfma_f32_16x16x32_bf16 a[120:123], v[184:187], a[244:247], a[120:123]
  ds_read_b128 a[212:215], v11 offset:4096
  v_accvgpr_write_b32 a179, v115
  v_mfma_f32_16x16x32_bf16 a[120:123], v[176:179], a[240:243], a[120:123]
  s_add_u32 m0, s30, 68608
  s_xor_b32 s40, s33, 0x10800
  v_accvgpr_write_b32 a180, v116
  v_exp_f32 v202, v202
  v_mfma_f32_16x16x32_bf16 a[88:91], v[160:163], a[240:243], a[88:91]
  s_waitcnt vmcnt(12)
  buffer_load_dwordx4 v25, s[20:23], s40 offen nt lds
  v_mfma_f32_16x16x32_bf16 a[88:91], v[168:171], a[244:247], a[88:91]
  v_accvgpr_write_b32 a181, v117
  v_mfma_f32_16x16x32_bf16 a[56:59], v[152:155], a[244:247], a[56:59]
  ds_read_b128 a[216:219], v12 offset:4096
  v_accvgpr_write_b32 a182, v118
  v_mfma_f32_16x16x32_bf16 a[56:59], v[144:147], a[240:243], a[56:59]
  v_accvgpr_write_b32 a183, v119
  v_exp_f32 v203, v203
  v_mfma_f32_16x16x32_bf16 a[24:27], v[128:131], a[240:243], a[24:27]
  v_accvgpr_write_b32 a184, v120
  v_cvt_pk_bf16_f32 v201, v202, v203
  v_mfma_f32_16x16x32_bf16 a[24:27], v[136:139], a[244:247], a[24:27]
  v_accvgpr_write_b32 a185, v121
  v_exp_f32 v204, v204
  v_mfma_f32_16x16x32_bf16 a[28:31], v[136:139], a[252:255], a[28:31]
  ds_read_b128 a[220:223], v13 offset:4096
  v_accvgpr_write_b32 a186, v122
  v_mfma_f32_16x16x32_bf16 a[28:31], v[128:131], a[248:251], a[28:31]
  v_accvgpr_write_b32 a187, v123
  v_exp_f32 v205, v205
  v_mfma_f32_16x16x32_bf16 a[60:63], v[144:147], a[248:251], a[60:63]
  v_accvgpr_write_b32 a188, v124
  v_cvt_pk_bf16_f32 v202, v204, v205
  v_mfma_f32_16x16x32_bf16 a[60:63], v[152:155], a[252:255], a[60:63]
  v_accvgpr_write_b32 a189, v125
  v_mfma_f32_16x16x32_bf16 a[92:95], v[168:171], a[252:255], a[92:95]
  v_accvgpr_write_b32 a190, v126
  v_exp_f32 v206, v206
  v_mfma_f32_16x16x32_bf16 a[92:95], v[160:163], a[248:251], a[92:95]
  s_add_u32 m0, s30, 32768
  s_xor_b32 s40, s33, 0x3800
  v_accvgpr_write_b32 a191, v127
  v_mfma_f32_16x16x32_bf16 a[124:127], v[176:179], a[248:251], a[124:127]
  s_waitcnt vmcnt(12)
  buffer_load_dwordx4 v22, s[16:19], s40 offen nt lds
  v_mfma_f32_16x16x32_bf16 a[124:127], v[184:187], a[252:255], a[124:127]
  s_waitcnt lgkmcnt(0)
  v_exp_f32 v207, v207
  v_mfma_f32_16x16x32_bf16 v[176:179], a[192:195], a[176:179], 0
  v_exp_f32 v216, v216
  v_cvt_pk_bf16_f32 v203, v206, v207
  v_mfma_f32_16x16x32_bf16 v[176:179], a[196:199], a[180:183], v[176:179]
  ds_read_b128 a[224:227], v10 offset:8192
  v_mfma_f32_16x16x32_bf16 v[176:179], a[200:203], a[184:187], v[176:179]
  v_exp_f32 v217, v217
  v_mfma_f32_16x16x32_bf16 v[176:179], a[204:207], a[188:191], v[176:179]
  v_exp_f32 v218, v218
  v_cvt_pk_bf16_f32 v216, v216, v217
  v_mfma_f32_16x16x32_bf16 v[160:163], a[204:207], a[172:175], 0
  ds_read_b128 a[228:231], v11 offset:8192
  v_mfma_f32_16x16x32_bf16 v[160:163], a[200:203], a[168:171], v[160:163]
  v_exp_f32 v219, v219
  v_mfma_f32_16x16x32_bf16 v[160:163], a[196:199], a[164:167], v[160:163]
  v_exp_f32 v220, v220
  v_cvt_pk_bf16_f32 v217, v218, v219
  v_mfma_f32_16x16x32_bf16 v[160:163], a[192:195], a[160:163], v[160:163]
  ds_read_b128 a[232:235], v12 offset:8192
  v_mfma_f32_16x16x32_bf16 v[144:147], a[192:195], a[144:147], 0
  v_exp_f32 v221, v221
  v_mfma_f32_16x16x32_bf16 v[144:147], a[196:199], a[148:151], v[144:147]
  v_exp_f32 v222, v222
  v_cvt_pk_bf16_f32 v218, v220, v221
  v_mfma_f32_16x16x32_bf16 v[144:147], a[200:203], a[152:155], v[144:147]
  ds_read_b128 a[236:239], v13 offset:8192
  v_mfma_f32_16x16x32_bf16 v[144:147], a[204:207], a[156:159], v[144:147]
  v_exp_f32 v223, v223
  v_mfma_f32_16x16x32_bf16 v[128:131], a[204:207], a[140:143], 0
  v_exp_f32 v232, v232
  v_cvt_pk_bf16_f32 v219, v222, v223
  v_mfma_f32_16x16x32_bf16 v[128:131], a[200:203], a[136:139], v[128:131]
  s_add_u32 m0, s30, 33792
  s_xor_b32 s40, s33, 0x3400
  ds_read_b128 a[240:243], v10 offset:12288
  v_mfma_f32_16x16x32_bf16 v[128:131], a[196:199], a[132:135], v[128:131]
  s_waitcnt vmcnt(12)
  buffer_load_dwordx4 v23, s[16:19], s40 offen nt lds
  v_mfma_f32_16x16x32_bf16 v[128:131], a[192:195], a[128:131], v[128:131]
  v_exp_f32 v233, v233
  v_mfma_f32_16x16x32_bf16 v[132:135], a[208:211], a[128:131], 0
  ds_read_b128 a[244:247], v11 offset:12288
  v_exp_f32 v234, v234
  v_mfma_f32_16x16x32_bf16 v[132:135], a[212:215], a[132:135], v[132:135]
  v_exp_f32 v235, v235
  v_mfma_f32_16x16x32_bf16 v[132:135], a[216:219], a[136:139], v[132:135]
  v_exp_f32 v236, v236
  v_cvt_pk_bf16_f32 v232, v232, v233
  v_mfma_f32_16x16x32_bf16 v[132:135], a[220:223], a[140:143], v[132:135]
  ds_read_b128 a[248:251], v12 offset:12288
  v_cvt_pk_bf16_f32 v233, v234, v235
  v_mfma_f32_16x16x32_bf16 v[148:151], a[220:223], a[156:159], 0
  v_exp_f32 v237, v237
  v_mfma_f32_16x16x32_bf16 v[148:151], a[216:219], a[152:155], v[148:151]
  v_exp_f32 v238, v238
  v_cvt_pk_bf16_f32 v234, v236, v237
  v_mfma_f32_16x16x32_bf16 v[148:151], a[212:215], a[148:151], v[148:151]
  ds_read_b128 a[252:255], v13 offset:12288
  v_mfma_f32_16x16x32_bf16 v[148:151], a[208:211], a[144:147], v[148:151]
  v_exp_f32 v239, v239
  v_mfma_f32_16x16x32_bf16 v[164:167], a[208:211], a[160:163], 0
  v_exp_f32 v248, v248
  v_cvt_pk_bf16_f32 v235, v238, v239
  v_mfma_f32_16x16x32_bf16 v[164:167], a[212:215], a[164:167], v[164:167]
  v_exp_f32 v249, v249
  v_mfma_f32_16x16x32_bf16 v[164:167], a[216:219], a[168:171], v[164:167]
  s_add_u32 m0, s30, 34816
  s_xor_b32 s40, s33, 0x13c00
  v_exp_f32 v250, v250
  v_cvt_pk_bf16_f32 v248, v248, v249
  v_mfma_f32_16x16x32_bf16 v[164:167], a[220:223], a[172:175], v[164:167]
  s_waitcnt vmcnt(12)
  buffer_load_dwordx4 v24, s[16:19], s40 offen nt lds
  v_mfma_f32_16x16x32_bf16 v[180:183], a[220:223], a[188:191], 0
  v_exp_f32 v251, v251
  v_mfma_f32_16x16x32_bf16 v[180:183], a[216:219], a[184:187], v[180:183]
  v_exp_f32 v252, v252
  v_mfma_f32_16x16x32_bf16 v[180:183], a[212:215], a[180:183], v[180:183]
  v_exp_f32 v253, v253
  v_mfma_f32_16x16x32_bf16 v[180:183], a[208:211], a[176:179], v[180:183]
  s_waitcnt vmcnt(7) lgkmcnt(0)
  s_cmpk_lt_i32 s10, 0x0
  s_cbranch_scc0 L_fb1_14
  s_waitcnt vmcnt(3)
L_fb1_14:
  s_barrier
  v_cvt_pk_bf16_f32 v249, v250, v251
  v_mfma_f32_16x16x32_bf16 v[184:187], a[224:227], a[176:179], 0
  ds_read_b64_tr_b16 a[192:193], v14 offset:49152
  v_cvt_pk_bf16_f32 v250, v252, v253
  v_mfma_f32_16x16x32_bf16 v[184:187], a[228:231], a[180:183], v[184:187]
  v_exp_f32 v254, v254
  v_mfma_f32_16x16x32_bf16 v[184:187], a[232:235], a[184:187], v[184:187]
  ds_read_b64_tr_b16 a[194:195], v14 offset:53248
  v_exp_f32 v255, v255
  v_mfma_f32_16x16x32_bf16 v[184:187], a[236:239], a[188:191], v[184:187]
  v_exp_f32 v128, v128
  v_mfma_f32_16x16x32_bf16 v[168:171], a[236:239], a[172:175], 0
  ds_read_b64_tr_b16 a[196:197], v14 offset:57344
  v_exp_f32 v129, v129
  v_mfma_f32_16x16x32_bf16 v[168:171], a[232:235], a[168:171], v[168:171]
  v_exp_f32 v130, v130
  v_mfma_f32_16x16x32_bf16 v[168:171], a[228:231], a[164:167], v[168:171]
  ds_read_b64_tr_b16 a[198:199], v14 offset:61440
  v_exp_f32 v131, v131
  v_mfma_f32_16x16x32_bf16 v[168:171], a[224:227], a[160:163], v[168:171]
  v_exp_f32 v132, v132
  v_mfma_f32_16x16x32_bf16 v[152:155], a[224:227], a[144:147], 0
  ds_read_b64_tr_b16 a[200:201], v15 offset:49152
  v_cvt_pk_bf16_f32 v251, v254, v255
  v_mfma_f32_16x16x32_bf16 v[152:155], a[228:231], a[148:151], v[152:155]
  v_exp_f32 v133, v133
  v_cvt_pk_bf16_f32 v128, v128, v129
  v_mfma_f32_16x16x32_bf16 v[152:155], a[232:235], a[152:155], v[152:155]
  s_add_u32 m0, s30, 35840
  s_xor_b32 s40, s33, 0x13000
  ds_read_b64_tr_b16 a[202:203], v15 offset:53248
  v_cvt_pk_bf16_f32 v129, v130, v131
  v_mfma_f32_16x16x32_bf16 v[152:155], a[236:239], a[156:159], v[152:155]
  s_waitcnt vmcnt(12)
  buffer_load_dwordx4 v25, s[16:19], s40 offen nt lds
  v_mfma_f32_16x16x32_bf16 v[136:139], a[236:239], a[140:143], 0
  ds_read_b64_tr_b16 a[204:205], v15 offset:57344
  v_cvt_pk_bf16_f32 v130, v132, v133
  v_mfma_f32_16x16x32_bf16 v[136:139], a[232:235], a[136:139], v[136:139]
  v_exp_f32 v134, v134
  v_mfma_f32_16x16x32_bf16 v[136:139], a[228:231], a[132:135], v[136:139]
  ds_read_b64_tr_b16 a[206:207], v15 offset:61440
  v_exp_f32 v135, v135
  v_mfma_f32_16x16x32_bf16 v[136:139], a[224:227], a[128:131], v[136:139]
  v_exp_f32 v144, v144
  v_mfma_f32_16x16x32_bf16 v[140:143], a[240:243], a[128:131], 0
  ds_read_b64_tr_b16 a[208:209], v16 offset:49152
  v_exp_f32 v145, v145
  v_mfma_f32_16x16x32_bf16 v[140:143], a[244:247], a[132:135], v[140:143]
  v_exp_f32 v146, v146
  v_mfma_f32_16x16x32_bf16 v[140:143], a[248:251], a[136:139], v[140:143]
  ds_read_b64_tr_b16 a[210:211], v16 offset:53248
  v_cvt_pk_bf16_f32 v131, v134, v135
  v_mfma_f32_16x16x32_bf16 v[140:143], a[252:255], a[140:143], v[140:143]
  v_exp_f32 v147, v147
  v_cvt_pk_bf16_f32 v144, v144, v145
  v_mfma_f32_16x16x32_bf16 v[156:159], a[252:255], a[156:159], 0
  ds_read_b64_tr_b16 a[212:213], v16 offset:57344
  v_cvt_pk_bf16_f32 v145, v146, v147
  v_mfma_f32_16x16x32_bf16 v[156:159], a[248:251], a[152:155], v[156:159]
  v_exp_f32 v148, v148
  v_mfma_f32_16x16x32_bf16 v[156:159], a[244:247], a[148:151], v[156:159]
  ds_read_b64_tr_b16 a[214:215], v16 offset:61440
  v_exp_f32 v149, v149
  v_mfma_f32_16x16x32_bf16 v[156:159], a[240:243], a[144:147], v[156:159]
  v_exp_f32 v150, v150
  v_mfma_f32_16x16x32_bf16 v[172:175], a[240:243], a[160:163], 0
  s_add_u32 m0, s30, 81920
  s_xor_b32 s40, s33, 0x400
  ds_read_b64_tr_b16 a[216:217], v17 offset:49152
  v_exp_f32 v151, v151
  v_mfma_f32_16x16x32_bf16 v[172:175], a[244:247], a[164:167], v[172:175]
  s_waitcnt vmcnt(12)
  buffer_load_dwordx4 v22, s[20:23], s40 offen nt lds
  v_mfma_f32_16x16x32_bf16 v[172:175], a[248:251], a[168:171], v[172:175]
  ds_read_b64_tr_b16 a[218:219], v17 offset:53248
  v_cvt_pk_bf16_f32 v146, v148, v149
  v_mfma_f32_16x16x32_bf16 v[172:175], a[252:255], a[172:175], v[172:175]
  v_exp_f32 v160, v160
  v_mfma_f32_16x16x32_bf16 v[188:191], a[252:255], a[188:191], 0
  ds_read_b64_tr_b16 a[220:221], v17 offset:57344
  v_cvt_pk_bf16_f32 v147, v150, v151
  v_mfma_f32_16x16x32_bf16 v[188:191], a[248:251], a[184:187], v[188:191]
  v_exp_f32 v161, v161
  v_mfma_f32_16x16x32_bf16 v[188:191], a[244:247], a[180:183], v[188:191]
  ds_read_b64_tr_b16 a[222:223], v17 offset:61440
  v_exp_f32 v162, v162
  v_mfma_f32_16x16x32_bf16 v[188:191], a[240:243], a[176:179], v[188:191]
  v_exp_f32 v163, v163
  v_mfma_f32_16x16x32_bf16 v[48:51], v[44:47], v[192:195], v[48:51]
  ds_read_b64_tr_b16 a[224:225], v18 offset:49152
  v_exp_f32 v164, v164
  v_mfma_f32_16x16x32_bf16 v[48:51], v[44:47], v[200:203], v[48:51]
  v_lshrrev_b32 v120, 8, v26
  v_cvt_pk_bf16_f32 v160, v160, v161
  v_mfma_f32_16x16x32_bf16 v[52:55], v[44:47], v[208:211], v[52:55]
  ds_read_b64_tr_b16 a[226:227], v18 offset:53248
  v_lshl_add_u32 v120, v120, 5, s31
  v_cvt_pk_bf16_f32 v161, v162, v163
  v_mfma_f32_16x16x32_bf16 v[52:55], v[44:47], v[216:219], v[52:55]
  v_exp_f32 v165, v165
  v_mfma_f32_16x16x32_bf16 v[56:59], v[44:47], v[224:227], v[56:59]
  ds_read_b64_tr_b16 a[228:229], v18 offset:57344
  v_cvt_pk_bf16_f32 v162, v164, v165
  v_mfma_f32_16x16x32_bf16 v[56:59], v[44:47], v[232:235], v[56:59]
  v_exp_f32 v166, v166
  v_mfma_f32_16x16x32_bf16 v[60:63], v[44:47], v[240:243], v[60:63]
  s_add_u32 m0, s30, 82944
  s_xor_b32 s40, s33, 0x800
  ds_read_b64_tr_b16 a[230:231], v18 offset:61440
  v_exp_f32 v167, v167
  v_mfma_f32_16x16x32_bf16 v[60:63], v[44:47], v[248:251], v[60:63]
  s_waitcnt lgkmcnt(4)
  s_waitcnt vmcnt(12)
  buffer_load_dwordx4 v23, s[20:23], s40 offen nt lds
  v_mfma_f32_16x16x32_bf16 a[12:15], v[200:203], a[220:223], a[12:15]
  ds_read_b64_tr_b16 a[232:233], v19 offset:49152
  v_rcp_f32 v112, v48
  v_mfma_f32_16x16x32_bf16 a[12:15], v[192:195], a[216:219], a[12:15]
  v_cvt_pk_bf16_f32 v163, v166, v167
  v_mfma_f32_16x16x32_bf16 a[8:11], v[192:195], a[208:211], a[8:11]
  ds_read_b64_tr_b16 a[234:235], v19 offset:53248
  v_rcp_f32 v113, v52
  v_mfma_f32_16x16x32_bf16 a[8:11], v[200:203], a[212:215], a[8:11]
  s_nop 0
  ds_write_b64 v27, v[112:113] offset:6208
  v_mfma_f32_16x16x32_bf16 a[4:7], v[200:203], a[204:207], a[4:7]
  ds_read_b64_tr_b16 a[236:237], v19 offset:57344
  ds_read_b128 v[112:115], v120 offset:6208
  v_mfma_f32_16x16x32_bf16 a[4:7], v[192:195], a[200:203], a[4:7]
  v_exp_f32 v176, v176
  v_mfma_f32_16x16x32_bf16 a[0:3], v[192:195], a[192:195], a[0:3]
  ds_read_b64_tr_b16 a[238:239], v19 offset:61440
  ds_read_b128 v[116:119], v120 offset:6224
  v_mfma_f32_16x16x32_bf16 a[0:3], v[200:203], a[196:199], a[0:3]
  v_exp_f32 v177, v177
  v_mfma_f32_16x16x32_bf16 a[32:35], v[216:219], a[196:199], a[32:35]
  ds_read_b64_tr_b16 a[240:241], v20 offset:49152
  v_exp_f32 v178, v178
  v_mfma_f32_16x16x32_bf16 a[32:35], v[208:211], a[192:195], a[32:35]
  v_exp_f32 v179, v179
  v_mfma_f32_16x16x32_bf16 a[36:39], v[208:211], a[200:203], a[36:39]
  ds_read_b64_tr_b16 a[242:243], v20 offset:53248
  v_exp_f32 v180, v180
  v_mfma_f32_16x16x32_bf16 a[36:39], v[216:219], a[204:207], a[36:39]
  v_accvgpr_read_b32 v36, a0
  v_accvgpr_read_b32 v37, a4
  v_accvgpr_read_b32 v38, a8
  v_accvgpr_read_b32 v39, a12
  v_mfma_f32_16x16x32_bf16 a[40:43], v[216:219], a[212:215], a[40:43]
  s_add_u32 m0, s30, 83968
  s_xor_b32 s40, s33, 0x10000
  ds_read_b64_tr_b16 a[244:245], v20 offset:57344
  v_cvt_pk_bf16_f32 v176, v176, v177
  v_mfma_f32_16x16x32_bf16 a[40:43], v[208:211], a[208:211], a[40:43]
  s_waitcnt vmcnt(12)
  buffer_load_dwordx4 v24, s[20:23], s40 offen nt lds
  v_mfma_f32_16x16x32_bf16 a[44:47], v[208:211], a[216:219], a[44:47]
  ds_read_b64_tr_b16 a[246:247], v20 offset:61440
  v_cvt_pk_bf16_f32 v177, v178, v179
  v_mfma_f32_16x16x32_bf16 a[44:47], v[216:219], a[220:223], a[44:47]
  v_accvgpr_read_b32 v40, a1
  v_accvgpr_read_b32 v41, a5
  v_accvgpr_read_b32 v42, a9
  s_waitcnt lgkmcnt(6)
  v_pk_mul_f32 v[36:37], v[36:37], v[112:113] op_sel:[0,0] op_sel_hi:[1,0]
  v_pk_mul_f32 v[38:39], v[38:39], v[112:113] op_sel:[0,0] op_sel_hi:[1,0]
  v_accvgpr_read_b32 v43, a13
  v_mfma_f32_16x16x32_bf16 a[76:79], v[232:235], a[220:223], a[76:79]
  ds_read_b64_tr_b16 a[248:249], v21 offset:49152
  v_subrev_u32 v50, 0x37800000, v48
  v_mfma_f32_16x16x32_bf16 a[76:79], v[224:227], a[216:219], a[76:79]
  v_exp_f32 v181, v181
  v_subrev_u32 v54, 0x37800000, v52
  v_mfma_f32_16x16x32_bf16 a[72:75], v[224:227], a[208:211], a[72:75]
  ds_read_b64_tr_b16 a[250:251], v21 offset:53248
  v_cvt_pk_bf16_f32 v178, v180, v181
  v_mfma_f32_16x16x32_bf16 a[72:75], v[232:235], a[212:215], a[72:75]
  v_accvgpr_read_b32 v124, a2
  v_accvgpr_read_b32 v125, a6
  v_accvgpr_read_b32 v126, a10
  v_accvgpr_read_b32 v127, a14
  v_cvt_pk_bf16_f32 v64, v36, v37
  v_pk_mul_f32 v[40:41], v[40:41], v[114:115] op_sel:[0,0] op_sel_hi:[1,0]
  v_pk_mul_f32 v[42:43], v[42:43], v[114:115] op_sel:[0,0] op_sel_hi:[1,0]
  v_cvt_pk_bf16_f32 v65, v38, v39
  v_mfma_f32_16x16x32_bf16 a[68:71], v[232:235], a[204:207], a[68:71]
  s_add_u32 m0, s30, 84992
  s_xor_b32 s40, s33, 0x10c00
  ds_read_b64_tr_b16 a[252:253], v21 offset:57344
  v_exp_f32 v182, v182
  v_mfma_f32_16x16x32_bf16 a[68:71], v[224:227], a[200:203], a[68:71]
  s_waitcnt vmcnt(12)
  buffer_load_dwordx4 v25, s[20:23], s40 offen nt lds
  v_mfma_f32_16x16x32_bf16 a[64:67], v[224:227], a[192:195], a[64:67]
  ds_read_b64_tr_b16 a[254:255], v21 offset:61440
  v_mfma_f32_16x16x32_bf16 a[64:67], v[232:235], a[196:199], a[64:67]
  ds_write_b64 v27, v[64:65] offset:2080
  v_accvgpr_read_b32 v36, a3
  v_accvgpr_read_b32 v37, a7
  v_accvgpr_read_b32 v38, a11
  v_accvgpr_read_b32 v39, a15
  v_cvt_pk_bf16_f32 v68, v40, v41
  s_waitcnt lgkmcnt(9)
  v_pk_mul_f32 v[124:125], v[124:125], v[116:117] op_sel:[0,0] op_sel_hi:[1,0]
  v_pk_mul_f32 v[126:127], v[126:127], v[116:117] op_sel:[0,0] op_sel_hi:[1,0]
  v_cvt_pk_bf16_f32 v69, v42, v43
  v_mfma_f32_16x16x32_bf16 a[96:99], v[248:251], a[196:199], a[96:99]
  v_exp_f32 v183, v183
  v_subrev_u32 v58, 0x37800000, v56
  v_mfma_f32_16x16x32_bf16 a[96:99], v[240:243], a[192:195], a[96:99]
  v_exp_f32 v136, v136
  v_mfma_f32_16x16x32_bf16 a[100:103], v[240:243], a[200:203], a[100:103]
  ds_write_b64 v27, v[68:69] offset:2592
  v_accvgpr_read_b32 v40, a32
  v_accvgpr_read_b32 v41, a36
  v_accvgpr_read_b32 v42, a40
  v_accvgpr_read_b32 v43, a44
  v_cvt_pk_bf16_f32 v72, v124, v125
  v_pk_mul_f32 v[36:37], v[36:37], v[118:119] op_sel:[0,0] op_sel_hi:[1,0]
  v_pk_mul_f32 v[38:39], v[38:39], v[118:119] op_sel:[0,0] op_sel_hi:[1,0]
  v_cvt_pk_bf16_f32 v73, v126, v127
  v_mfma_f32_16x16x32_bf16 a[100:103], v[248:251], a[204:207], a[100:103]
  s_waitcnt vmcnt(7) lgkmcnt(0)
  s_cmpk_lt_i32 s11, 0x0
  s_cbranch_scc0 L_fb1_15
  s_waitcnt vmcnt(3)
L_fb1_15:
  s_barrier
  v_cvt_pk_bf16_f32 v179, v182, v183
  v_mfma_f32_16x16x32_bf16 a[104:107], v[248:251], a[212:215], a[104:107]
  s_add_u32 m0, s30, 49152
  s_xor_b32 s40, s33, 0x3c00
  ds_read_b128 a[192:195], v10 offset:16384
  v_subrev_u32 v62, 0x37800000, v60
  v_mfma_f32_16x16x32_bf16 a[104:107], v[240:243], a[208:211], a[104:107]
  s_waitcnt vmcnt(12)
  buffer_load_dwordx4 v22, s[16:19], s40 offen nt lds
  v_mfma_f32_16x16x32_bf16 a[108:111], v[240:243], a[216:219], a[108:111]
  ds_write_b64 v27, v[72:73] offset:3104
  v_accvgpr_read_b32 v124, a33
  v_accvgpr_read_b32 v125, a37
  v_accvgpr_read_b32 v126, a41
  v_accvgpr_read_b32 v127, a45
  v_cvt_pk_bf16_f32 v76, v36, v37
L_pg12:
  s_cbranch_execz L_rt2
  v_pk_mul_f32 v[40:41], v[40:41], v[112:113] op_sel:[0,1] op_sel_hi:[1,1]
  v_pk_mul_f32 v[42:43], v[42:43], v[112:113] op_sel:[0,1] op_sel_hi:[1,1]
  v_cvt_pk_bf16_f32 v77, v38, v39
  v_mfma_f32_16x16x32_bf16 a[108:111], v[248:251], a[220:223], a[108:111]
  v_exp_f32 v137, v137
  v_mfma_f32_16x16x32_bf16 a[28:31], v[200:203], a[252:255], a[28:31]
  ds_read_b128 a[196:199], v11 offset:16384
  v_rcp_f32 v2, v56
  v_mfma_f32_16x16x32_bf16 a[28:31], v[192:195], a[248:251], a[28:31]
  v_exp_f32 v138, v138
  v_mfma_f32_16x16x32_bf16 a[24:27], v[192:195], a[240:243], a[24:27]
  ds_write_b64 v27, v[76:77] offset:3616
  v_accvgpr_read_b32 v36, a34
  v_accvgpr_read_b32 v37, a38
  v_accvgpr_read_b32 v38, a42
  v_accvgpr_read_b32 v39, a46
  v_cvt_pk_bf16_f32 v80, v40, v41
  v_pk_mul_f32 v[124:125], v[124:125], v[114:115] op_sel:[0,1] op_sel_hi:[1,1]
  v_pk_mul_f32 v[126:127], v[126:127], v[114:115] op_sel:[0,1] op_sel_hi:[1,1]
  v_cvt_pk_bf16_f32 v81, v42, v43
  v_mfma_f32_16x16x32_bf16 a[24:27], v[200:203], a[244:247], a[24:27]
  v_exp_f32 v139, v139
  v_mfma_f32_16x16x32_bf16 a[20:23], v[200:203], a[236:239], a[20:23]
  ds_read_b128 a[200:203], v12 offset:16384
  v_rcp_f32 v3, v60
  v_mfma_f32_16x16x32_bf16 a[20:23], v[192:195], a[232:235], a[20:23]
  s_nop 0
  ds_write_b64 v27, v[2:3] offset:6720
  v_mfma_f32_16x16x32_bf16 a[16:19], v[192:195], a[224:227], a[16:19]
  s_add_u32 m0, s30, 50176
  s_xor_b32 s40, s33, 0x3000
  ds_write_b64 v27, v[80:81]
  v_accvgpr_read_b32 v40, a35
  v_accvgpr_read_b32 v41, a39
  v_accvgpr_read_b32 v42, a43
  v_accvgpr_read_b32 v43, a47
  v_cvt_pk_bf16_f32 v84, v124, v125
  v_pk_mul_f32 v[36:37], v[36:37], v[116:117] op_sel:[0,1] op_sel_hi:[1,1]
  v_pk_mul_f32 v[38:39], v[38:39], v[116:117] op_sel:[0,1] op_sel_hi:[1,1]
  v_cvt_pk_bf16_f32 v85, v126, v127
  v_mfma_f32_16x16x32_bf16 a[16:19], v[200:203], a[228:231], a[16:19]
  s_waitcnt vmcnt(12)
  buffer_load_dwordx4 v23, s[16:19], s40 offen nt lds
  v_mfma_f32_16x16x32_bf16 a[48:51], v[216:219], a[228:231], a[48:51]
  ds_read_b128 a[204:207], v13 offset:16384
  ds_read_b128 v[2:5], v120 offset:6720
  v_mfma_f32_16x16x32_bf16 a[48:51], v[208:211], a[224:227], a[48:51]
  v_max3_u32 v51, v50, v54, v58
  v_mfma_f32_16x16x32_bf16 a[52:55], v[208:211], a[232:235], a[52:55]
  ds_write_b64 v27, v[84:85] offset:512
  v_accvgpr_read_b32 v124, a16
  v_accvgpr_read_b32 v125, a20
  v_accvgpr_read_b32 v126, a24
  v_accvgpr_read_b32 v127, a28
  v_cvt_pk_bf16_f32 v88, v36, v37
  v_pk_mul_f32 v[40:41], v[40:41], v[118:119] op_sel:[0,1] op_sel_hi:[1,1]
  v_pk_mul_f32 v[42:43], v[42:43], v[118:119] op_sel:[0,1] op_sel_hi:[1,1]
  v_cvt_pk_bf16_f32 v89, v38, v39
  v_mfma_f32_16x16x32_bf16 a[52:55], v[216:219], a[236:239], a[52:55]
  v_exp_f32 v140, v140
  v_max_u32 v51, v51, v62
  v_mfma_f32_16x16x32_bf16 a[56:59], v[216:219], a[244:247], a[56:59]
  ds_read_b128 a[208:211], v10 offset:20480
  ds_read_b128 v[6:9], v120 offset:6736
  v_mfma_f32_16x16x32_bf16 a[56:59], v[208:211], a[240:243], a[56:59]
  v_exp_f32 v141, v141
  v_cmp_gt_u32 vcc, 0x18000000, v51
  v_mfma_f32_16x16x32_bf16 a[60:63], v[208:211], a[248:251], a[60:63]
  ds_write_b64 v27, v[88:89] offset:1024
  v_accvgpr_read_b32 v36, a17
  v_accvgpr_read_b32 v37, a21
  v_accvgpr_read_b32 v38, a25
  v_accvgpr_read_b32 v39, a29
  v_cvt_pk_bf16_f32 v92, v40, v41
  v_pk_mul_f32 v[124:125], v[124:125], v[112:113] op_sel:[0,0] op_sel_hi:[1,0]
  v_pk_mul_f32 v[126:127], v[126:127], v[112:113] op_sel:[0,0] op_sel_hi:[1,0]
  v_cvt_pk_bf16_f32 v93, v42, v43
  v_mfma_f32_16x16x32_bf16 a[60:63], v[216:219], a[252:255], a[60:63]
  v_exp_f32 v142, v142
  v_mfma_f32_16x16x32_bf16 a[92:95], v[232:235], a[252:255], a[92:95]
  s_add_u32 m0, s30, 51200
  s_xor_b32 s40, s33, 0x13800
  ds_read_b128 a[212:215], v11 offset:20480
  v_cvt_pk_bf16_f32 v136, v136, v137
  v_mfma_f32_16x16x32_bf16 a[92:95], v[224:227], a[248:251], a[92:95]
  s_waitcnt vmcnt(12)
  buffer_load_dwordx4 v24, s[16:19], s40 offen nt lds
  v_mfma_f32_16x16x32_bf16 a[88:91], v[224:227], a[240:243], a[88:91]
  ds_write_b64 v27, v[92:93] offset:1536
  v_accvgpr_read_b32 v40, a18
  v_accvgpr_read_b32 v41, a22
  v_accvgpr_read_b32 v42, a26
  v_accvgpr_read_b32 v43, a30
  v_cvt_pk_bf16_f32 v66, v124, v125
  v_pk_mul_f32 v[36:37], v[36:37], v[114:115] op_sel:[0,0] op_sel_hi:[1,0]
  v_pk_mul_f32 v[38:39], v[38:39], v[114:115] op_sel:[0,0] op_sel_hi:[1,0]
  v_cvt_pk_bf16_f32 v67, v126, v127
  v_mfma_f32_16x16x32_bf16 a[88:91], v[232:235], a[244:247], a[88:91]
  v_exp_f32 v143, v143
  v_mfma_f32_16x16x32_bf16 a[84:87], v[232:235], a[236:239], a[84:87]
  ds_read_b128 a[216:219], v12 offset:20480
  v_exp_f32 v152, v152
  v_mfma_f32_16x16x32_bf16 a[84:87], v[224:227], a[232:235], a[84:87]
  v_exp_f32 v153, v153
  v_mfma_f32_16x16x32_bf16 a[80:83], v[224:227], a[224:227], a[80:83]
  ds_write_b64 v27, v[66:67] offset:4160
  v_accvgpr_read_b32 v124, a19
  v_accvgpr_read_b32 v125, a23
  v_accvgpr_read_b32 v126, a27
  v_accvgpr_read_b32 v127, a31
  v_cvt_pk_bf16_f32 v70, v36, v37
  v_pk_mul_f32 v[40:41], v[40:41], v[116:117] op_sel:[0,0] op_sel_hi:[1,0]
  v_pk_mul_f32 v[42:43], v[42:43], v[116:117] op_sel:[0,0] op_sel_hi:[1,0]
  v_cvt_pk_bf16_f32 v71, v38, v39
  v_mfma_f32_16x16x32_bf16 a[80:83], v[232:235], a[228:231], a[80:83]
  ds_read_b64_tr_b16 v[64:65], v0 offset:2080
  ds_read_b64_tr_b16 v[66:67], v0 offset:2112
  v_mfma_f32_16x16x32_bf16 a[112:115], v[248:251], a[228:231], a[112:115]
  s_add_u32 m0, s30, 52224
  s_xor_b32 s40, s33, 0x13400
  ds_read_b128 a[220:223], v13 offset:20480
  v_exp_f32 v154, v154
  v_mfma_f32_16x16x32_bf16 a[112:115], v[240:243], a[224:227], a[112:115]
  s_waitcnt vmcnt(12)
  buffer_load_dwordx4 v25, s[16:19], s40 offen nt lds
  v_mfma_f32_16x16x32_bf16 a[116:119], v[240:243], a[232:235], a[116:119]
  ds_write_b64 v27, v[70:71] offset:4672
  v_accvgpr_read_b32 v36, a48
  v_accvgpr_read_b32 v37, a52
  v_accvgpr_read_b32 v38, a56
  v_accvgpr_read_b32 v39, a60
  v_cvt_pk_bf16_f32 v74, v40, v41
  v_pk_mul_f32 v[124:125], v[124:125], v[118:119] op_sel:[0,0] op_sel_hi:[1,0]
  v_pk_mul_f32 v[126:127], v[126:127], v[118:119] op_sel:[0,0] op_sel_hi:[1,0]
  v_cvt_pk_bf16_f32 v75, v42, v43
  v_mfma_f32_16x16x32_bf16 a[116:119], v[248:251], a[236:239], a[116:119]
  ds_read_b64_tr_b16 v[68:69], v0 offset:2592
  ds_read_b64_tr_b16 v[70:71], v0 offset:2624
  v_mfma_f32_16x16x32_bf16 a[120:123], v[248:251], a[244:247], a[120:123]
  v_exp_f32 v155, v155
  v_mfma_f32_16x16x32_bf16 a[120:123], v[240:243], a[240:243], a[120:123]
  v_exp_f32 v156, v156
  v_mfma_f32_16x16x32_bf16 a[124:127], v[240:243], a[248:251], a[124:127]
  ds_write_b64 v27, v[74:75] offset:5184
  v_accvgpr_read_b32 v40, a49
  v_accvgpr_read_b32 v41, a53
  v_accvgpr_read_b32 v42, a57
  v_accvgpr_read_b32 v43, a61
  v_cvt_pk_bf16_f32 v78, v124, v125
  v_pk_mul_f32 v[36:37], v[36:37], v[112:113] op_sel:[0,1] op_sel_hi:[1,1]
  v_pk_mul_f32 v[38:39], v[38:39], v[112:113] op_sel:[0,1] op_sel_hi:[1,1]
  v_cvt_pk_bf16_f32 v79, v126, v127
  v_mfma_f32_16x16x32_bf16 a[124:127], v[248:251], a[252:255], a[124:127]
  s_waitcnt lgkmcnt(4)
  v_exp_f32 v157, v157
  v_cvt_pk_bf16_f32 v137, v138, v139
  s_nop 4
  s_cmp_eq_u64 vcc, -1
  s_cselect_b32 s41, 0, s37
  s_or_b32 s36, s36, s41
  v_cvt_pk_bf16_f32 v138, v140, v141
  v_cvt_pk_bf16_f32 v139, v142, v143
  v_cvt_pk_bf16_f32 v152, v152, v153
  v_cvt_pk_bf16_f32 v153, v154, v155
  v_exp_f32 v158, v158
  v_cvt_pk_bf16_f32 v154, v156, v157
  v_exp_f32 v159, v159
  s_nop 0
  v_cvt_pk_bf16_f32 v155, v158, v159
  s_mov_b32 s48, s35
  s_lshl_b32 s37, s37, 1
  s_mov_b32 s32, s33
  s_mov_b32 s35, s34
  s_xor_b32 s33, s46, 0x3046c00
  s_xor_b32 s34, s47, 0x1829000
L_blk2:
  v_mfma_f32_16x16x32_bf16 v[240:243], a[192:195], a[176:179], 0
  ds_read_b64_tr_b16 v[72:73], v0 offset:3104
  ds_read_b64_tr_b16 v[74:75], v0 offset:3136
  v_mfma_f32_16x16x32_bf16 v[240:243], a[196:199], a[180:183], v[240:243]
  ds_read_b128 a[224:227], v10 offset:24576
  v_mfma_f32_16x16x32_bf16 v[240:243], a[200:203], a[184:187], v[240:243]
  ds_write_b64 v27, v[78:79] offset:5696
  v_accvgpr_read_b32 v124, a50
  v_accvgpr_read_b32 v125, a54
  v_accvgpr_read_b32 v126, a58
  v_accvgpr_read_b32 v127, a62
  v_cvt_pk_bf16_f32 v82, v36, v37
  v_pk_mul_f32 v[40:41], v[40:41], v[114:115] op_sel:[0,1] op_sel_hi:[1,1]
  v_pk_mul_f32 v[42:43], v[42:43], v[114:115] op_sel:[0,1] op_sel_hi:[1,1]
  v_cvt_pk_bf16_f32 v83, v38, v39
  v_mfma_f32_16x16x32_bf16 v[240:243], a[204:207], a[188:191], v[240:243]
  ds_read_b64_tr_b16 v[76:77], v0 offset:3616
  ds_read_b64_tr_b16 v[78:79], v0 offset:3648
  v_mfma_f32_16x16x32_bf16 v[224:227], a[204:207], a[172:175], 0
  s_add_u32 m0, s30, 98304
  s_xor_b32 s40, s32, 0x3800
  ds_read_b128 a[228:231], v11 offset:24576
  v_exp_f32 v168, v168
  v_mfma_f32_16x16x32_bf16 v[224:227], a[200:203], a[168:171], v[224:227]
  s_waitcnt vmcnt(12)
  buffer_load_dwordx4 v22, s[20:23], s40 offen nt lds
  v_mfma_f32_16x16x32_bf16 v[224:227], a[196:199], a[164:167], v[224:227]
  ds_write_b64 v27, v[82:83] offset:2080
  v_accvgpr_read_b32 v36, a51
  v_accvgpr_read_b32 v37, a55
  v_accvgpr_read_b32 v38, a59
  v_accvgpr_read_b32 v39, a63
  v_cvt_pk_bf16_f32 v86, v40, v41
  v_pk_mul_f32 v[124:125], v[124:125], v[116:117] op_sel:[0,1] op_sel_hi:[1,1]
  v_pk_mul_f32 v[126:127], v[126:127], v[116:117] op_sel:[0,1] op_sel_hi:[1,1]
  v_cvt_pk_bf16_f32 v87, v42, v43
  v_mfma_f32_16x16x32_bf16 v[224:227], a[192:195], a[160:163], v[224:227]
  ds_read_b128 a[232:235], v12 offset:24576
  ds_read_b64_tr_b16 v[80:81], v0
  v_mfma_f32_16x16x32_bf16 v[208:211], a[192:195], a[144:147], 0
  ds_read_b64_tr_b16 v[82:83], v0 offset:32
  v_mfma_f32_16x16x32_bf16 v[208:211], a[196:199], a[148:151], v[208:211]
  v_exp_f32 v169, v169
  v_mfma_f32_16x16x32_bf16 v[208:211], a[200:203], a[152:155], v[208:211]
  ds_read_b128 a[236:239], v13 offset:24576
  v_exp_f32 v170, v170
  v_mfma_f32_16x16x32_bf16 v[208:211], a[204:207], a[156:159], v[208:211]
  ds_write_b64 v27, v[86:87] offset:2592
  v_accvgpr_read_b32 v40, a64
  v_accvgpr_read_b32 v41, a68
  v_accvgpr_read_b32 v42, a72
  v_accvgpr_read_b32 v43, a76
  v_cvt_pk_bf16_f32 v90, v124, v125
  v_pk_mul_f32 v[36:37], v[36:37], v[118:119] op_sel:[0,1] op_sel_hi:[1,1]
  v_pk_mul_f32 v[38:39], v[38:39], v[118:119] op_sel:[0,1] op_sel_hi:[1,1]
  v_cvt_pk_bf16_f32 v91, v126, v127
  v_mfma_f32_16x16x32_bf16 v[192:195], a[204:207], a[140:143], 0
  ds_read_b64_tr_b16 v[84:85], v0 offset:512
  ds_read_b64_tr_b16 v[86:87], v0 offset:544
  v_mfma_f32_16x16x32_bf16 v[192:195], a[200:203], a[136:139], v[192:195]
  s_add_u32 m0, s30, 99328
  s_xor_b32 s40, s32, 0x3400
  ds_read_b128 a[240:243], v10 offset:28672
  v_exp_f32 v171, v171
  v_mfma_f32_16x16x32_bf16 v[192:195], a[196:199], a[132:135], v[192:195]
  s_waitcnt vmcnt(12)
  buffer_load_dwordx4 v23, s[20:23], s40 offen nt lds
  v_mfma_f32_16x16x32_bf16 v[192:195], a[192:195], a[128:131], v[192:195]
  v_cvt_pk_bf16_f32 v168, v168, v169
  v_mfma_f32_16x16x32_bf16 v[196:199], a[208:211], a[128:131], 0
  ds_read_b128 a[244:247], v11 offset:28672
  v_exp_f32 v172, v172
  v_mfma_f32_16x16x32_bf16 v[196:199], a[212:215], a[132:135], v[196:199]
  ds_write_b64 v27, v[90:91] offset:3104
  v_accvgpr_read_b32 v124, a65
  v_accvgpr_read_b32 v125, a69
  v_accvgpr_read_b32 v126, a73
  v_accvgpr_read_b32 v127, a77
  v_cvt_pk_bf16_f32 v94, v36, v37
  v_pk_mul_f32 v[40:41], v[40:41], v[2:3] op_sel:[0,0] op_sel_hi:[1,0]
  v_pk_mul_f32 v[42:43], v[42:43], v[2:3] op_sel:[0,0] op_sel_hi:[1,0]
  v_cvt_pk_bf16_f32 v95, v38, v39
  v_mfma_f32_16x16x32_bf16 v[196:199], a[216:219], a[136:139], v[196:199]
  ds_read_b64_tr_b16 v[88:89], v0 offset:1024
  ds_read_b64_tr_b16 v[90:91], v0 offset:1056
  v_mfma_f32_16x16x32_bf16 v[196:199], a[220:223], a[140:143], v[196:199]
  ds_read_b128 a[248:251], v12 offset:28672
  v_cvt_pk_bf16_f32 v169, v170, v171
  v_mfma_f32_16x16x32_bf16 v[212:215], a[220:223], a[156:159], 0
  v_exp_f32 v173, v173
  v_mfma_f32_16x16x32_bf16 v[212:215], a[216:219], a[152:155], v[212:215]
  ds_write_b64 v27, v[94:95] offset:3616
  v_accvgpr_read_b32 v36, a66
  v_accvgpr_read_b32 v37, a70
  v_accvgpr_read_b32 v38, a74
  v_accvgpr_read_b32 v39, a78
  v_cvt_pk_bf16_f32 v96, v40, v41
  v_pk_mul_f32 v[124:125], v[124:125], v[4:5] op_sel:[0,0] op_sel_hi:[1,0]
  v_pk_mul_f32 v[126:127], v[126:127], v[4:5] op_sel:[0,0] op_sel_hi:[1,0]
  v_cvt_pk_bf16_f32 v97, v42, v43
  v_mfma_f32_16x16x32_bf16 v[212:215], a[212:215], a[148:151], v[212:215]
  ds_read_b128 a[252:255], v13 offset:28672
  ds_read_b64_tr_b16 v[92:93], v0 offset:1536
  v_cvt_pk_bf16_f32 v170, v172, v173
  v_mfma_f32_16x16x32_bf16 v[212:215], a[208:211], a[144:147], v[212:215]
  s_add_u32 m0, s30, 100352
  s_xor_b32 s40, s32, 0x13c00
  ds_read_b64_tr_b16 v[94:95], v0 offset:1568
  v_mfma_f32_16x16x32_bf16 v[228:231], a[208:211], a[160:163], 0
  s_waitcnt vmcnt(12)
  buffer_load_dwordx4 v24, s[20:23], s40 offen nt lds
  v_mfma_f32_16x16x32_bf16 v[228:231], a[212:215], a[164:167], v[228:231]
  v_exp_f32 v174, v174
  v_mfma_f32_16x16x32_bf16 v[228:231], a[216:219], a[168:171], v[228:231]
  ds_write_b64 v27, v[96:97] offset:2080
  v_accvgpr_read_b32 v40, a67
  v_accvgpr_read_b32 v41, a71
  v_accvgpr_read_b32 v42, a75
  v_accvgpr_read_b32 v43, a79
  v_cvt_pk_bf16_f32 v100, v124, v125
  v_pk_mul_f32 v[36:37], v[36:37], v[6:7] op_sel:[0,0] op_sel_hi:[1,0]
  v_pk_mul_f32 v[38:39], v[38:39], v[6:7] op_sel:[0,0] op_sel_hi:[1,0]
  v_cvt_pk_bf16_f32 v101, v126, v127
  v_mfma_f32_16x16x32_bf16 v[228:231], a[220:223], a[172:175], v[228:231]
  v_exp_f32 v175, v175
  v_mfma_f32_16x16x32_bf16 v[244:247], a[220:223], a[188:191], 0
  v_exp_f32 v184, v184
  v_cvt_pk_bf16_f32 v171, v174, v175
  v_mfma_f32_16x16x32_bf16 v[244:247], a[216:219], a[184:187], v[244:247]
  v_exp_f32 v185, v185
  v_mfma_f32_16x16x32_bf16 v[244:247], a[212:215], a[180:183], v[244:247]
  v_exp_f32 v186, v186
  v_cvt_pk_bf16_f32 v184, v184, v185
  v_mfma_f32_16x16x32_bf16 v[244:247], a[208:211], a[176:179], v[244:247]
  s_waitcnt vmcnt(7) lgkmcnt(0)
  s_cmpk_lt_i32 s8, 0x0
  s_cbranch_scc0 L_fb2_0
  s_waitcnt vmcnt(3)
L_fb2_0:
  s_barrier
  v_mfma_f32_16x16x32_bf16 v[248:251], a[224:227], a[176:179], 0
  ds_read_b64_tr_b16 a[192:193], v14
  v_mfma_f32_16x16x32_bf16 v[248:251], a[228:231], a[180:183], v[248:251]
  ds_write_b64 v27, v[100:101] offset:2592
  v_accvgpr_read_b32 v132, a96
  v_accvgpr_read_b32 v133, a100
  v_accvgpr_read_b32 v134, a104
  v_accvgpr_read_b32 v135, a108
  v_cvt_pk_bf16_f32 v104, v36, v37
  v_pk_mul_f32 v[40:41], v[40:41], v[8:9] op_sel:[0,0] op_sel_hi:[1,0]
  v_pk_mul_f32 v[42:43], v[42:43], v[8:9] op_sel:[0,0] op_sel_hi:[1,0]
  v_cvt_pk_bf16_f32 v105, v38, v39
  v_mfma_f32_16x16x32_bf16 v[248:251], a[232:235], a[184:187], v[248:251]
  s_add_u32 m0, s30, 101376
  s_xor_b32 s40, s32, 0x13000
  ds_read_b64_tr_b16 a[194:195], v14 offset:4096
  v_exp_f32 v187, v187
  v_mfma_f32_16x16x32_bf16 v[248:251], a[236:239], a[188:191], v[248:251]
  s_waitcnt vmcnt(12)
  buffer_load_dwordx4 v25, s[20:23], s40 offen nt lds
  v_mfma_f32_16x16x32_bf16 v[232:235], a[236:239], a[172:175], 0
  ds_read_b64_tr_b16 a[196:197], v14 offset:8192
  v_cvt_pk_bf16_f32 v185, v186, v187
  v_mfma_f32_16x16x32_bf16 v[232:235], a[232:235], a[168:171], v[232:235]
  ds_write_b64 v27, v[104:105] offset:3104
  v_accvgpr_read_b32 v36, a97
  v_accvgpr_read_b32 v37, a101
  v_accvgpr_read_b32 v38, a105
  v_accvgpr_read_b32 v39, a109
  v_cvt_pk_bf16_f32 v108, v40, v41
  v_pk_mul_f32 v[132:133], v[132:133], v[2:3] op_sel:[0,1] op_sel_hi:[1,1]
  v_pk_mul_f32 v[134:135], v[134:135], v[2:3] op_sel:[0,1] op_sel_hi:[1,1]
  v_cvt_pk_bf16_f32 v109, v42, v43
  v_mfma_f32_16x16x32_bf16 v[232:235], a[228:231], a[164:167], v[232:235]
  ds_read_b64_tr_b16 a[198:199], v14 offset:12288
  v_mfma_f32_16x16x32_bf16 v[232:235], a[224:227], a[160:163], v[232:235]
  v_exp_f32 v188, v188
  v_mfma_f32_16x16x32_bf16 v[216:219], a[224:227], a[144:147], 0
  ds_read_b64_tr_b16 a[200:201], v15
  v_exp_f32 v189, v189
  v_mfma_f32_16x16x32_bf16 v[216:219], a[228:231], a[148:151], v[216:219]
  ds_write_b64 v27, v[108:109] offset:3616
  v_accvgpr_read_b32 v40, a98
  v_accvgpr_read_b32 v41, a102
  v_accvgpr_read_b32 v42, a106
  v_accvgpr_read_b32 v43, a110
  v_cvt_pk_bf16_f32 v112, v132, v133
  v_pk_mul_f32 v[36:37], v[36:37], v[4:5] op_sel:[0,1] op_sel_hi:[1,1]
  v_pk_mul_f32 v[38:39], v[38:39], v[4:5] op_sel:[0,1] op_sel_hi:[1,1]
  v_cvt_pk_bf16_f32 v113, v134, v135
  v_mfma_f32_16x16x32_bf16 v[216:219], a[232:235], a[152:155], v[216:219]
  s_add_u32 m0, s30, 0
  s_xor_b32 s40, s32, 0x12000
  ds_read_b64_tr_b16 a[202:203], v15 offset:4096
  v_cvt_pk_bf16_f32 v186, v188, v189
  v_mfma_f32_16x16x32_bf16 v[216:219], a[236:239], a[156:159], v[216:219]
  s_waitcnt vmcnt(12)
  buffer_load_dwordx4 v22, s[16:19], s40 offen nt lds
  v_mfma_f32_16x16x32_bf16 v[200:203], a[236:239], a[140:143], 0
  ds_read_b64_tr_b16 a[204:205], v15 offset:8192
  v_mfma_f32_16x16x32_bf16 v[200:203], a[232:235], a[136:139], v[200:203]
  v_exp_f32 v190, v190
  v_mfma_f32_16x16x32_bf16 v[200:203], a[228:231], a[132:135], v[200:203]
  ds_read_b64_tr_b16 a[206:207], v15 offset:12288
  v_exp_f32 v191, v191
  v_mfma_f32_16x16x32_bf16 v[200:203], a[224:227], a[128:131], v[200:203]
  ds_write_b64 v27, v[112:113]
  v_accvgpr_read_b32 v132, a99
  v_accvgpr_read_b32 v133, a103
  v_accvgpr_read_b32 v134, a107
  v_accvgpr_read_b32 v135, a111
  v_cvt_pk_bf16_f32 v116, v36, v37
  v_pk_mul_f32 v[40:41], v[40:41], v[6:7] op_sel:[0,1] op_sel_hi:[1,1]
  v_pk_mul_f32 v[42:43], v[42:43], v[6:7] op_sel:[0,1] op_sel_hi:[1,1]
  v_cvt_pk_bf16_f32 v117, v38, v39
  v_mfma_f32_16x16x32_bf16 v[204:207], a[240:243], a[128:131], 0
  ds_read_b64_tr_b16 a[208:209], v16
  v_cvt_pk_bf16_f32 v187, v190, v191
  v_mfma_f32_16x16x32_bf16 v[204:207], a[244:247], a[132:135], v[204:207]
  v_exp_f32 v192, v192
  v_mfma_f32_16x16x32_bf16 v[204:207], a[248:251], a[136:139], v[204:207]
  ds_read_b64_tr_b16 a[210:211], v16 offset:4096
  v_exp_f32 v193, v193
  v_mfma_f32_16x16x32_bf16 v[204:207], a[252:255], a[140:143], v[204:207]
  ds_write_b64 v27, v[116:117] offset:512
  v_accvgpr_read_b32 v36, a80
  v_accvgpr_read_b32 v37, a84
  v_accvgpr_read_b32 v38, a88
  v_accvgpr_read_b32 v39, a92
  v_cvt_pk_bf16_f32 v120, v40, v41
  v_pk_mul_f32 v[132:133], v[132:133], v[8:9] op_sel:[0,1] op_sel_hi:[1,1]
  v_pk_mul_f32 v[134:135], v[134:135], v[8:9] op_sel:[0,1] op_sel_hi:[1,1]
  v_cvt_pk_bf16_f32 v121, v42, v43
  v_mfma_f32_16x16x32_bf16 v[220:223], a[252:255], a[156:159], 0
  s_xor_b32 s43, s48, 0x0
  ds_read_b64_tr_b16 a[212:213], v16 offset:8192
  v_cvt_pk_bf16_f32 v192, v192, v193
  v_mfma_f32_16x16x32_bf16 v[220:223], a[248:251], a[152:155], v[220:223]
  s_waitcnt vmcnt(12)
  buffer_store_dwordx4 v[64:67], v26, s[24:27], s43 offen sc1
  v_mfma_f32_16x16x32_bf16 v[220:223], a[244:247], a[148:151], v[220:223]
  ds_read_b64_tr_b16 a[214:215], v16 offset:12288
  v_mfma_f32_16x16x32_bf16 v[220:223], a[240:243], a[144:147], v[220:223]
  v_exp_f32 v194, v194
  v_mfma_f32_16x16x32_bf16 v[236:239], a[240:243], a[160:163], 0
  ds_read_b64_tr_b16 a[216:217], v17
  v_exp_f32 v195, v195
  v_mfma_f32_16x16x32_bf16 v[236:239], a[244:247], a[164:167], v[236:239]
  ds_write_b64 v27, v[120:121] offset:1024
  v_accvgpr_read_b32 v40, a81
  v_accvgpr_read_b32 v41, a85
  v_accvgpr_read_b32 v42, a89
  v_accvgpr_read_b32 v43, a93
  v_cvt_pk_bf16_f32 v124, v132, v133
  v_pk_mul_f32 v[36:37], v[36:37], v[2:3] op_sel:[0,0] op_sel_hi:[1,0]
  v_pk_mul_f32 v[38:39], v[38:39], v[2:3] op_sel:[0,0] op_sel_hi:[1,0]
  v_cvt_pk_bf16_f32 v125, v134, v135
  v_mfma_f32_16x16x32_bf16 v[236:239], a[248:251], a[168:171], v[236:239]
  ds_read_b64_tr_b16 a[218:219], v17 offset:4096
  v_cvt_pk_bf16_f32 v193, v194, v195
  v_mfma_f32_16x16x32_bf16 v[236:239], a[252:255], a[172:175], v[236:239]
  v_exp_f32 v196, v196
  v_mfma_f32_16x16x32_bf16 v[252:255], a[252:255], a[188:191], 0
  ds_read_b64_tr_b16 a[220:221], v17 offset:8192
  v_exp_f32 v197, v197
  v_mfma_f32_16x16x32_bf16 v[252:255], a[248:251], a[184:187], v[252:255]
  ds_write_b64 v27, v[124:125] offset:1536
  v_accvgpr_read_b32 v132, a82
  v_accvgpr_read_b32 v133, a86
  v_accvgpr_read_b32 v134, a90
  v_accvgpr_read_b32 v135, a94
  v_cvt_pk_bf16_f32 v98, v36, v37
  v_pk_mul_f32 v[40:41], v[40:41], v[4:5] op_sel:[0,0] op_sel_hi:[1,0]
  v_pk_mul_f32 v[42:43], v[42:43], v[4:5] op_sel:[0,0] op_sel_hi:[1,0]
  v_cvt_pk_bf16_f32 v99, v38, v39
  v_mfma_f32_16x16x32_bf16 v[252:255], a[244:247], a[180:183], v[252:255]
  s_add_u32 m0, s30, 1024
  s_xor_b32 s40, s32, 0x12c00
  ds_read_b64_tr_b16 a[222:223], v17 offset:12288
  v_cvt_pk_bf16_f32 v194, v196, v197
  v_mfma_f32_16x16x32_bf16 v[252:255], a[240:243], a[176:179], v[252:255]
  s_waitcnt vmcnt(12)
  buffer_load_dwordx4 v23, s[16:19], s40 offen nt lds
  v_mfma_f32_16x16x32_bf16 v[48:51], v[44:47], v[128:131], 0
  ds_read_b64_tr_b16 a[224:225], v18
  v_mfma_f32_16x16x32_bf16 v[48:51], v[44:47], v[136:139], v[48:51]
  v_exp_f32 v198, v198
  v_mfma_f32_16x16x32_bf16 v[52:55], v[44:47], v[144:147], 0
  ds_read_b64_tr_b16 a[226:227], v18 offset:4096
  v_exp_f32 v199, v199
  v_mfma_f32_16x16x32_bf16 v[52:55], v[44:47], v[152:155], v[52:55]
  ds_write_b64 v27, v[98:99] offset:4160
  v_accvgpr_read_b32 v36, a83
  v_accvgpr_read_b32 v37, a87
  v_accvgpr_read_b32 v38, a91
  v_accvgpr_read_b32 v39, a95
  v_cvt_pk_bf16_f32 v102, v40, v41
  v_pk_mul_f32 v[132:133], v[132:133], v[6:7] op_sel:[0,0] op_sel_hi:[1,0]
  v_pk_mul_f32 v[134:135], v[134:135], v[6:7] op_sel:[0,0] op_sel_hi:[1,0]
  v_cvt_pk_bf16_f32 v103, v42, v43
  v_mfma_f32_16x16x32_bf16 v[56:59], v[44:47], v[160:163], 0
  ds_read_b64_tr_b16 a[228:229], v18 offset:8192
  ds_read_b64_tr_b16 v[96:97], v0 offset:2080
  v_mfma_f32_16x16x32_bf16 v[56:59], v[44:47], v[168:171], v[56:59]
  ds_read_b64_tr_b16 v[98:99], v0 offset:2112
  v_exp_f32 v208, v208
  v_mfma_f32_16x16x32_bf16 v[60:63], v[44:47], v[176:179], 0
  ds_read_b64_tr_b16 a[230:231], v18 offset:12288
  v_cvt_pk_bf16_f32 v195, v198, v199
  v_mfma_f32_16x16x32_bf16 v[60:63], v[44:47], v[184:187], v[60:63]
  s_waitcnt lgkmcnt(7)
  ds_write_b64 v27, v[102:103] offset:4672
  v_accvgpr_read_b32 v40, a112
  v_accvgpr_read_b32 v41, a116
  v_accvgpr_read_b32 v42, a120
  v_accvgpr_read_b32 v43, a124
  v_cvt_pk_bf16_f32 v106, v132, v133
  v_pk_mul_f32 v[36:37], v[36:37], v[8:9] op_sel:[0,0] op_sel_hi:[1,0]
  v_pk_mul_f32 v[38:39], v[38:39], v[8:9] op_sel:[0,0] op_sel_hi:[1,0]
  v_cvt_pk_bf16_f32 v107, v134, v135
  v_mfma_f32_16x16x32_bf16 a[12:15], v[136:139], a[220:223], 0
  ds_read_b64_tr_b16 a[232:233], v19
  ds_read_b64_tr_b16 v[100:101], v0 offset:2592
  v_mfma_f32_16x16x32_bf16 a[12:15], v[128:131], a[216:219], a[12:15]
  ds_read_b64_tr_b16 v[102:103], v0 offset:2624
  v_exp_f32 v209, v209
  v_mfma_f32_16x16x32_bf16 a[8:11], v[128:131], a[208:211], 0
  s_add_u32 m0, s30, 2048
  s_xor_b32 s40, s32, 0x2400
  ds_read_b64_tr_b16 a[234:235], v19 offset:4096
  v_cvt_pk_bf16_f32 v208, v208, v209
  v_mfma_f32_16x16x32_bf16 a[8:11], v[136:139], a[212:215], a[8:11]
  s_waitcnt vmcnt(12)
  buffer_load_dwordx4 v24, s[16:19], s40 offen nt lds
  v_mfma_f32_16x16x32_bf16 a[4:7], v[136:139], a[204:207], 0
  ds_read_b64_tr_b16 a[236:237], v19 offset:8192
  v_mfma_f32_16x16x32_bf16 a[4:7], v[128:131], a[200:203], a[4:7]
  ds_write_b64 v27, v[106:107] offset:5184
  v_accvgpr_read_b32 v132, a113
  v_accvgpr_read_b32 v133, a117
  v_accvgpr_read_b32 v134, a121
  v_accvgpr_read_b32 v135, a125
  v_cvt_pk_bf16_f32 v110, v36, v37
  v_pk_mul_f32 v[40:41], v[40:41], v[2:3] op_sel:[0,1] op_sel_hi:[1,1]
  v_pk_mul_f32 v[42:43], v[42:43], v[2:3] op_sel:[0,1] op_sel_hi:[1,1]
  v_cvt_pk_bf16_f32 v111, v38, v39
  v_mfma_f32_16x16x32_bf16 a[0:3], v[128:131], a[192:195], 0
  ds_read_b64_tr_b16 a[238:239], v19 offset:12288
  ds_read_b64_tr_b16 v[104:105], v0 offset:3104
  v_mfma_f32_16x16x32_bf16 a[0:3], v[136:139], a[196:199], a[0:3]
  ds_read_b64_tr_b16 v[106:107], v0 offset:3136
  v_exp_f32 v210, v210
  v_mfma_f32_16x16x32_bf16 a[32:35], v[152:155], a[196:199], 0
  ds_read_b64_tr_b16 a[240:241], v20
  v_mfma_f32_16x16x32_bf16 a[32:35], v[144:147], a[192:195], a[32:35]
  ds_write_b64 v27, v[110:111] offset:5696
  v_accvgpr_read_b32 v36, a114
  v_accvgpr_read_b32 v37, a118
  v_accvgpr_read_b32 v38, a122
  v_accvgpr_read_b32 v39, a126
  v_cvt_pk_bf16_f32 v114, v40, v41
  v_pk_mul_f32 v[132:133], v[132:133], v[4:5] op_sel:[0,1] op_sel_hi:[1,1]
  v_pk_mul_f32 v[134:135], v[134:135], v[4:5] op_sel:[0,1] op_sel_hi:[1,1]
  v_cvt_pk_bf16_f32 v115, v42, v43
  v_mfma_f32_16x16x32_bf16 a[36:39], v[144:147], a[200:203], 0
  ds_read_b64_tr_b16 a[242:243], v20 offset:4096
  ds_read_b64_tr_b16 v[108:109], v0 offset:3616
  v_mfma_f32_16x16x32_bf16 a[36:39], v[152:155], a[204:207], a[36:39]
  ds_read_b64_tr_b16 v[110:111], v0 offset:3648
  v_exp_f32 v211, v211
  v_mfma_f32_16x16x32_bf16 a[40:43], v[152:155], a[212:215], 0
  s_add_u32 m0, s30, 3072
  s_xor_b32 s40, s32, 0x2800
  ds_read_b64_tr_b16 a[244:245], v20 offset:8192
  v_cvt_pk_bf16_f32 v209, v210, v211
L_pg13:
  s_cbranch_execz L_rt2
  v_mfma_f32_16x16x32_bf16 a[40:43], v[144:147], a[208:211], a[40:43]
  s_waitcnt vmcnt(12)
  buffer_load_dwordx4 v25, s[16:19], s40 offen nt lds
  v_mfma_f32_16x16x32_bf16 a[44:47], v[144:147], a[216:219], 0
  ds_read_b64_tr_b16 a[246:247], v20 offset:12288
  v_mfma_f32_16x16x32_bf16 a[44:47], v[152:155], a[220:223], a[44:47]
  ds_write_b64 v27, v[114:115] offset:2080
  v_accvgpr_read_b32 v40, a115
  v_accvgpr_read_b32 v41, a119
  v_accvgpr_read_b32 v42, a123
  v_accvgpr_read_b32 v43, a127
  v_cvt_pk_bf16_f32 v118, v132, v133
  v_pk_mul_f32 v[36:37], v[36:37], v[6:7] op_sel:[0,1] op_sel_hi:[1,1]
  v_pk_mul_f32 v[38:39], v[38:39], v[6:7] op_sel:[0,1] op_sel_hi:[1,1]
  v_cvt_pk_bf16_f32 v119, v134, v135
  v_mfma_f32_16x16x32_bf16 a[76:79], v[168:171], a[220:223], 0
  ds_read_b64_tr_b16 a[248:249], v21
  ds_read_b64_tr_b16 v[112:113], v0
  v_mfma_f32_16x16x32_bf16 a[76:79], v[160:163], a[216:219], a[76:79]
  ds_read_b64_tr_b16 v[114:115], v0 offset:32
  v_exp_f32 v212, v212
  v_mfma_f32_16x16x32_bf16 a[72:75], v[160:163], a[208:211], 0
  ds_read_b64_tr_b16 a[250:251], v21 offset:4096
  v_mfma_f32_16x16x32_bf16 a[72:75], v[168:171], a[212:215], a[72:75]
  ds_write_b64 v27, v[118:119] offset:2592
  v_cvt_pk_bf16_f32 v122, v36, v37
  v_pk_mul_f32 v[40:41], v[40:41], v[8:9] op_sel:[0,1] op_sel_hi:[1,1]
  v_pk_mul_f32 v[42:43], v[42:43], v[8:9] op_sel:[0,1] op_sel_hi:[1,1]
  v_cvt_pk_bf16_f32 v123, v38, v39
  v_mfma_f32_16x16x32_bf16 a[68:71], v[168:171], a[204:207], 0
  ds_read_b64_tr_b16 a[252:253], v21 offset:8192
  ds_read_b64_tr_b16 v[116:117], v0 offset:512
  v_mfma_f32_16x16x32_bf16 a[68:71], v[160:163], a[200:203], a[68:71]
  ds_read_b64_tr_b16 v[118:119], v0 offset:544
  v_exp_f32 v213, v213
  v_mfma_f32_16x16x32_bf16 a[64:67], v[160:163], a[192:195], 0
  s_xor_b32 s43, s48, 0x6000
  ds_read_b64_tr_b16 a[254:255], v21 offset:12288
  v_cvt_pk_bf16_f32 v210, v212, v213
  v_mfma_f32_16x16x32_bf16 a[64:67], v[168:171], a[196:199], a[64:67]
  s_waitcnt vmcnt(12)
  buffer_store_dwordx4 v[68:71], v26, s[24:27], s43 offen sc1
  v_mfma_f32_16x16x32_bf16 a[96:99], v[184:187], a[196:199], 0
  ds_write_b64 v27, v[122:123] offset:3104
  v_cvt_pk_bf16_f32 v126, v40, v41
  v_cvt_pk_bf16_f32 v127, v42, v43
  v_mfma_f32_16x16x32_bf16 a[96:99], v[176:179], a[192:195], a[96:99]
  s_add_u32 m0, s30, 114688
  s_xor_b32 s40, s32, 0x3c00
  ds_read_b64_tr_b16 v[120:121], v0 offset:1024
  ds_read_b64_tr_b16 v[122:123], v0 offset:1056
  v_mfma_f32_16x16x32_bf16 a[100:103], v[176:179], a[200:203], 0
  s_waitcnt vmcnt(12)
  buffer_load_dwordx4 v22, s[20:23], s40 offen nt lds
  v_mfma_f32_16x16x32_bf16 a[100:103], v[184:187], a[204:207], a[100:103]
  s_waitcnt vmcnt(7) lgkmcnt(0)
  s_cmpk_lt_i32 s9, 0x0
  s_cbranch_scc0 L_fb2_1
  s_waitcnt vmcnt(4)
L_fb2_1:
  s_barrier
  v_mfma_f32_16x16x32_bf16 a[104:107], v[184:187], a[212:215], 0
  ds_read_b128 a[192:195], v10 offset:32768
  v_mfma_f32_16x16x32_bf16 a[104:107], v[176:179], a[208:211], a[104:107]
  ds_write_b64 v27, v[126:127] offset:3616
  v_mfma_f32_16x16x32_bf16 a[108:111], v[176:179], a[216:219], 0
  ds_read_b64_tr_b16 v[124:125], v0 offset:1536
  ds_read_b64_tr_b16 v[126:127], v0 offset:1568
  v_mfma_f32_16x16x32_bf16 a[108:111], v[184:187], a[220:223], a[108:111]
  v_exp_f32 v214, v214
  v_mfma_f32_16x16x32_bf16 a[28:31], v[136:139], a[252:255], 0
  ds_read_b128 a[196:199], v11 offset:32768
  v_exp_f32 v215, v215
  v_mfma_f32_16x16x32_bf16 a[28:31], v[128:131], a[248:251], a[28:31]
  v_exp_f32 v224, v224
  v_mfma_f32_16x16x32_bf16 a[24:27], v[128:131], a[240:243], 0
  v_exp_f32 v225, v225
  v_cvt_pk_bf16_f32 v211, v214, v215
  v_mfma_f32_16x16x32_bf16 a[24:27], v[136:139], a[244:247], a[24:27]
  v_exp_f32 v226, v226
  v_mfma_f32_16x16x32_bf16 a[20:23], v[136:139], a[236:239], 0
  s_waitcnt lgkmcnt(1)
  s_add_u32 m0, s30, 115712
  s_xor_b32 s40, s32, 0x3000
  ds_read_b128 a[200:203], v12 offset:32768
  v_cvt_pk_bf16_f32 v224, v224, v225
  v_mfma_f32_16x16x32_bf16 a[20:23], v[128:131], a[232:235], a[20:23]
  s_waitcnt vmcnt(12)
  buffer_load_dwordx4 v23, s[20:23], s40 offen nt lds
  v_mfma_f32_16x16x32_bf16 a[16:19], v[128:131], a[224:227], 0
  v_exp_f32 v227, v227
  v_mfma_f32_16x16x32_bf16 a[16:19], v[136:139], a[228:231], a[16:19]
  v_exp_f32 v228, v228
  v_mfma_f32_16x16x32_bf16 a[48:51], v[152:155], a[228:231], 0
  ds_read_b128 a[204:207], v13 offset:32768
  v_exp_f32 v229, v229
  v_mfma_f32_16x16x32_bf16 a[48:51], v[144:147], a[224:227], a[48:51]
  v_exp_f32 v230, v230
  v_mfma_f32_16x16x32_bf16 a[52:55], v[144:147], a[232:235], 0
  v_exp_f32 v231, v231
  v_mfma_f32_16x16x32_bf16 a[52:55], v[152:155], a[236:239], a[52:55]
  v_exp_f32 v240, v240
  v_cvt_pk_bf16_f32 v225, v226, v227
  v_mfma_f32_16x16x32_bf16 a[56:59], v[152:155], a[244:247], 0
  ds_read_b128 a[208:211], v10 offset:36864
  v_cvt_pk_bf16_f32 v226, v228, v229
  v_mfma_f32_16x16x32_bf16 a[56:59], v[144:147], a[240:243], a[56:59]
  v_exp_f32 v241, v241
  v_mfma_f32_16x16x32_bf16 a[60:63], v[144:147], a[248:251], 0
  v_exp_f32 v242, v242
  v_cvt_pk_bf16_f32 v227, v230, v231
  v_mfma_f32_16x16x32_bf16 a[60:63], v[152:155], a[252:255], a[60:63]
  v_exp_f32 v243, v243
  v_mfma_f32_16x16x32_bf16 a[92:95], v[168:171], a[252:255], 0
  s_add_u32 m0, s31, 0
  s_xor_b32 s42, s34, 0x0
  ds_read_b128 a[212:215], v11 offset:36864
  v_cvt_pk_bf16_f32 v240, v240, v241
  v_mfma_f32_16x16x32_bf16 a[92:95], v[160:163], a[248:251], a[92:95]
  s_waitcnt vmcnt(12)
  buffer_load_dwordx4 v22, s[12:15], s42 offen nt lds
  v_mfma_f32_16x16x32_bf16 a[88:91], v[160:163], a[240:243], 0
  v_exp_f32 v244, v244
  v_mfma_f32_16x16x32_bf16 a[88:91], v[168:171], a[244:247], a[88:91]
  v_exp_f32 v245, v245
  v_mfma_f32_16x16x32_bf16 a[84:87], v[168:171], a[236:239], 0
  ds_read_b128 a[216:219], v12 offset:36864
  v_exp_f32 v246, v246
  v_mfma_f32_16x16x32_bf16 a[84:87], v[160:163], a[232:235], a[84:87]
  v_exp_f32 v247, v247
  v_mfma_f32_16x16x32_bf16 a[80:83], v[160:163], a[224:227], 0
  v_exp_f32 v200, v200
  v_mfma_f32_16x16x32_bf16 a[80:83], v[168:171], a[228:231], a[80:83]
  v_exp_f32 v201, v201
  v_cvt_pk_bf16_f32 v241, v242, v243
  v_mfma_f32_16x16x32_bf16 a[112:115], v[184:187], a[228:231], 0
  ds_read_b128 a[220:223], v13 offset:36864
  v_cvt_pk_bf16_f32 v242, v244, v245
  v_mfma_f32_16x16x32_bf16 a[112:115], v[176:179], a[224:227], a[112:115]
  v_exp_f32 v202, v202
  v_mfma_f32_16x16x32_bf16 a[116:119], v[176:179], a[232:235], 0
  v_exp_f32 v203, v203
  v_cvt_pk_bf16_f32 v243, v246, v247
  v_mfma_f32_16x16x32_bf16 a[116:119], v[184:187], a[236:239], a[116:119]
  s_add_u32 m0, s31, 1024
  s_xor_b32 s42, s34, 0x6000
  v_exp_f32 v204, v204
  v_mfma_f32_16x16x32_bf16 a[120:123], v[184:187], a[244:247], 0
  s_waitcnt vmcnt(12)
  buffer_load_dwordx4 v23, s[12:15], s42 offen nt lds
  v_mfma_f32_16x16x32_bf16 a[120:123], v[176:179], a[240:243], a[120:123]
  v_exp_f32 v205, v205
  v_mfma_f32_16x16x32_bf16 a[124:127], v[176:179], a[248:251], 0
  v_exp_f32 v206, v206
  v_mfma_f32_16x16x32_bf16 a[124:127], v[184:187], a[252:255], a[124:127]
  s_waitcnt lgkmcnt(0)
  v_exp_f32 v207, v207
  v_cvt_pk_bf16_f32 v200, v200, v201
  v_mfma_f32_16x16x32_bf16 v[176:179], a[192:195], a[176:179], 0
  v_exp_f32 v216, v216
  v_mfma_f32_16x16x32_bf16 v[176:179], a[196:199], a[180:183], v[176:179]
  ds_read_b128 a[224:227], v10 offset:40960
  v_cvt_pk_bf16_f32 v201, v202, v203
  v_mfma_f32_16x16x32_bf16 v[176:179], a[200:203], a[184:187], v[176:179]
  v_exp_f32 v217, v217
  v_cvt_pk_bf16_f32 v202, v204, v205
  v_mfma_f32_16x16x32_bf16 v[176:179], a[204:207], a[188:191], v[176:179]
  v_exp_f32 v218, v218
  v_mfma_f32_16x16x32_bf16 v[160:163], a[204:207], a[172:175], 0
  ds_read_b128 a[228:231], v11 offset:40960
  v_cvt_pk_bf16_f32 v203, v206, v207
  v_mfma_f32_16x16x32_bf16 v[160:163], a[200:203], a[168:171], v[160:163]
  v_exp_f32 v219, v219
  v_cvt_pk_bf16_f32 v216, v216, v217
  v_mfma_f32_16x16x32_bf16 v[160:163], a[196:199], a[164:167], v[160:163]
  v_exp_f32 v220, v220
  v_mfma_f32_16x16x32_bf16 v[160:163], a[192:195], a[160:163], v[160:163]
  s_add_u32 m0, s31, 2048
  s_xor_b32 s42, s34, 0x400
  ds_read_b128 a[232:235], v12 offset:40960
  v_cvt_pk_bf16_f32 v217, v218, v219
  v_mfma_f32_16x16x32_bf16 v[144:147], a[192:195], a[144:147], 0
  s_waitcnt vmcnt(12)
  buffer_load_dwordx4 v24, s[12:15], s42 offen nt lds
  v_mfma_f32_16x16x32_bf16 v[144:147], a[196:199], a[148:151], v[144:147]
  v_exp_f32 v221, v221
  v_mfma_f32_16x16x32_bf16 v[144:147], a[200:203], a[152:155], v[144:147]
  ds_read_b128 a[236:239], v13 offset:40960
  v_cvt_pk_bf16_f32 v218, v220, v221
  v_mfma_f32_16x16x32_bf16 v[144:147], a[204:207], a[156:159], v[144:147]
  v_exp_f32 v222, v222
  v_mfma_f32_16x16x32_bf16 v[128:131], a[204:207], a[140:143], 0
  v_exp_f32 v223, v223
  v_mfma_f32_16x16x32_bf16 v[128:131], a[200:203], a[136:139], v[128:131]
  ds_read_b128 a[240:243], v10 offset:45056
  v_exp_f32 v232, v232
  v_mfma_f32_16x16x32_bf16 v[128:131], a[196:199], a[132:135], v[128:131]
  v_exp_f32 v233, v233
  v_mfma_f32_16x16x32_bf16 v[128:131], a[192:195], a[128:131], v[128:131]
  v_exp_f32 v234, v234
  v_cvt_pk_bf16_f32 v219, v222, v223
  v_mfma_f32_16x16x32_bf16 v[132:135], a[208:211], a[128:131], 0
  ds_read_b128 a[244:247], v11 offset:45056
  v_cvt_pk_bf16_f32 v232, v232, v233
  v_mfma_f32_16x16x32_bf16 v[132:135], a[212:215], a[132:135], v[132:135]
  v_exp_f32 v235, v235
  v_mfma_f32_16x16x32_bf16 v[132:135], a[216:219], a[136:139], v[132:135]
  v_exp_f32 v236, v236
  v_cvt_pk_bf16_f32 v233, v234, v235
  v_mfma_f32_16x16x32_bf16 v[132:135], a[220:223], a[140:143], v[132:135]
  s_add_u32 m0, s31, 3072
  s_xor_b32 s42, s34, 0x6400
  ds_read_b128 a[248:251], v12 offset:45056
  v_mfma_f32_16x16x32_bf16 v[148:151], a[220:223], a[156:159], 0
  s_waitcnt vmcnt(12)
  buffer_load_dwordx4 v25, s[12:15], s42 offen nt lds
  v_mfma_f32_16x16x32_bf16 v[148:151], a[216:219], a[152:155], v[148:151]
  v_exp_f32 v237, v237
  v_mfma_f32_16x16x32_bf16 v[148:151], a[212:215], a[148:151], v[148:151]
  ds_read_b128 a[252:255], v13 offset:45056
  v_exp_f32 v238, v238
  v_mfma_f32_16x16x32_bf16 v[148:151], a[208:211], a[144:147], v[148:151]
  v_exp_f32 v239, v239
  v_mfma_f32_16x16x32_bf16 v[164:167], a[208:211], a[160:163], 0
  v_exp_f32 v248, v248
  v_mfma_f32_16x16x32_bf16 v[164:167], a[212:215], a[164:167], v[164:167]
  v_exp_f32 v249, v249
  v_cvt_pk_bf16_f32 v234, v236, v237
  v_mfma_f32_16x16x32_bf16 v[164:167], a[216:219], a[168:171], v[164:167]
  v_exp_f32 v250, v250
  v_mfma_f32_16x16x32_bf16 v[164:167], a[220:223], a[172:175], v[164:167]
  v_exp_f32 v251, v251
  v_mfma_f32_16x16x32_bf16 v[180:183], a[220:223], a[188:191], 0
  v_exp_f32 v252, v252
  v_cvt_pk_bf16_f32 v235, v238, v239
  v_mfma_f32_16x16x32_bf16 v[180:183], a[216:219], a[184:187], v[180:183]
  v_exp_f32 v253, v253
  v_mfma_f32_16x16x32_bf16 v[180:183], a[212:215], a[180:183], v[180:183]
  v_exp_f32 v254, v254
  v_mfma_f32_16x16x32_bf16 v[180:183], a[208:211], a[176:179], v[180:183]
  s_waitcnt vmcnt(6) lgkmcnt(0)
  s_cmpk_lt_i32 s10, 0x0
  s_cbranch_scc0 L_fb2_2
  s_waitcnt vmcnt(3)
L_fb2_2:
  s_barrier
  v_cvt_pk_bf16_f32 v248, v248, v249
  v_mfma_f32_16x16x32_bf16 v[184:187], a[224:227], a[176:179], 0
  s_add_u32 m0, s31, 4096
  s_xor_b32 s42, s34, 0x5000
  ds_read_b64_tr_b16 a[192:193], v14 offset:16384
  v_cvt_pk_bf16_f32 v249, v250, v251
  v_mfma_f32_16x16x32_bf16 v[184:187], a[228:231], a[180:183], v[184:187]
  s_waitcnt vmcnt(12)
  buffer_load_dwordx4 v22, s[12:15], s42 offen nt lds
  v_mfma_f32_16x16x32_bf16 v[184:187], a[232:235], a[184:187], v[184:187]
  ds_read_b64_tr_b16 a[194:195], v14 offset:20480
  v_cvt_pk_bf16_f32 v250, v252, v253
  v_mfma_f32_16x16x32_bf16 v[184:187], a[236:239], a[188:191], v[184:187]
  v_exp_f32 v255, v255
  v_mfma_f32_16x16x32_bf16 v[168:171], a[236:239], a[172:175], 0
  ds_read_b64_tr_b16 a[196:197], v14 offset:24576
  v_cvt_pk_bf16_f32 v251, v254, v255
  v_mfma_f32_16x16x32_bf16 v[168:171], a[232:235], a[168:171], v[168:171]
  v_exp_f32 v128, v128
  v_mfma_f32_16x16x32_bf16 v[168:171], a[228:231], a[164:167], v[168:171]
  ds_read_b64_tr_b16 a[198:199], v14 offset:28672
  v_exp_f32 v129, v129
  v_mfma_f32_16x16x32_bf16 v[168:171], a[224:227], a[160:163], v[168:171]
  v_exp_f32 v130, v130
  v_mfma_f32_16x16x32_bf16 v[152:155], a[224:227], a[144:147], 0
  ds_read_b64_tr_b16 a[200:201], v15 offset:16384
  v_exp_f32 v131, v131
  v_mfma_f32_16x16x32_bf16 v[152:155], a[228:231], a[148:151], v[152:155]
  v_exp_f32 v132, v132
  v_mfma_f32_16x16x32_bf16 v[152:155], a[232:235], a[152:155], v[152:155]
  ds_read_b64_tr_b16 a[202:203], v15 offset:20480
  v_cvt_pk_bf16_f32 v128, v128, v129
  v_mfma_f32_16x16x32_bf16 v[152:155], a[236:239], a[156:159], v[152:155]
  v_exp_f32 v133, v133
  v_cvt_pk_bf16_f32 v129, v130, v131
  v_mfma_f32_16x16x32_bf16 v[136:139], a[236:239], a[140:143], 0
  s_add_u32 m0, s31, 5120
  s_xor_b32 s42, s34, 0x3000
  ds_read_b64_tr_b16 a[204:205], v15 offset:24576
  v_cvt_pk_bf16_f32 v130, v132, v133
  v_mfma_f32_16x16x32_bf16 v[136:139], a[232:235], a[136:139], v[136:139]
  s_waitcnt vmcnt(12)
  buffer_load_dwordx4 v23, s[12:15], s42 offen nt lds
  v_mfma_f32_16x16x32_bf16 v[136:139], a[228:231], a[132:135], v[136:139]
  ds_read_b64_tr_b16 a[206:207], v15 offset:28672
  v_mfma_f32_16x16x32_bf16 v[136:139], a[224:227], a[128:131], v[136:139]
  v_exp_f32 v134, v134
  v_mfma_f32_16x16x32_bf16 v[140:143], a[240:243], a[128:131], 0
  ds_read_b64_tr_b16 a[208:209], v16 offset:16384
  v_exp_f32 v135, v135
  v_mfma_f32_16x16x32_bf16 v[140:143], a[244:247], a[132:135], v[140:143]
  v_exp_f32 v144, v144
  v_mfma_f32_16x16x32_bf16 v[140:143], a[248:251], a[136:139], v[140:143]
  ds_read_b64_tr_b16 a[210:211], v16 offset:20480
  v_exp_f32 v145, v145
  v_mfma_f32_16x16x32_bf16 v[140:143], a[252:255], a[140:143], v[140:143]
  v_exp_f32 v146, v146
  v_mfma_f32_16x16x32_bf16 v[156:159], a[252:255], a[156:159], 0
  ds_read_b64_tr_b16 a[212:213], v16 offset:24576
  v_cvt_pk_bf16_f32 v131, v134, v135
  v_mfma_f32_16x16x32_bf16 v[156:159], a[248:251], a[152:155], v[156:159]
  v_exp_f32 v147, v147
  v_cvt_pk_bf16_f32 v144, v144, v145
  v_mfma_f32_16x16x32_bf16 v[156:159], a[244:247], a[148:151], v[156:159]
  ds_read_b64_tr_b16 a[214:215], v16 offset:28672
  v_cvt_pk_bf16_f32 v145, v146, v147
  v_mfma_f32_16x16x32_bf16 v[156:159], a[240:243], a[144:147], v[156:159]
  v_exp_f32 v148, v148
  v_mfma_f32_16x16x32_bf16 v[172:175], a[240:243], a[160:163], 0
  s_add_u32 m0, s31, 6144
  s_xor_b32 s42, s34, 0x5400
  ds_read_b64_tr_b16 a[216:217], v17 offset:16384
  v_exp_f32 v149, v149
  v_mfma_f32_16x16x32_bf16 v[172:175], a[244:247], a[164:167], v[172:175]
  s_waitcnt vmcnt(12)
  buffer_load_dwordx4 v24, s[12:15], s42 offen nt lds
  v_mfma_f32_16x16x32_bf16 v[172:175], a[248:251], a[168:171], v[172:175]
  ds_read_b64_tr_b16 a[218:219], v17 offset:20480
  v_mfma_f32_16x16x32_bf16 v[172:175], a[252:255], a[172:175], v[172:175]
  v_exp_f32 v150, v150
  v_cvt_pk_bf16_f32 v146, v148, v149
  v_mfma_f32_16x16x32_bf16 v[188:191], a[252:255], a[188:191], 0
  ds_read_b64_tr_b16 a[220:221], v17 offset:24576
  v_mfma_f32_16x16x32_bf16 v[188:191], a[248:251], a[184:187], v[188:191]
  v_exp_f32 v151, v151
  v_mfma_f32_16x16x32_bf16 v[188:191], a[244:247], a[180:183], v[188:191]
  ds_read_b64_tr_b16 a[222:223], v17 offset:28672
  v_exp_f32 v160, v160
  v_mfma_f32_16x16x32_bf16 v[188:191], a[240:243], a[176:179], v[188:191]
  v_exp_f32 v161, v161
  v_mfma_f32_16x16x32_bf16 v[48:51], v[44:47], v[192:195], v[48:51]
  ds_read_b64_tr_b16 a[224:225], v18 offset:16384
  v_cvt_pk_bf16_f32 v147, v150, v151
  v_mfma_f32_16x16x32_bf16 v[48:51], v[44:47], v[200:203], v[48:51]
  v_exp_f32 v162, v162
  v_mfma_f32_16x16x32_bf16 v[52:55], v[44:47], v[208:211], v[52:55]
  ds_read_b64_tr_b16 a[226:227], v18 offset:20480
  v_cvt_pk_bf16_f32 v160, v160, v161
  v_mfma_f32_16x16x32_bf16 v[52:55], v[44:47], v[216:219], v[52:55]
  v_mov_b32 v252, 1
  v_mfma_f32_16x16x32_bf16 v[56:59], v[44:47], v[224:227], v[56:59]
  ds_read_b64_tr_b16 a[228:229], v18 offset:24576
  v_mfma_f32_16x16x32_bf16 v[56:59], v[44:47], v[232:235], v[56:59]
  s_waitcnt vmcnt(12)
  buffer_atomic_add v252, v26, s[4:7], 0 offen sc0 sc1
  v_mfma_f32_16x16x32_bf16 v[60:63], v[44:47], v[240:243], v[60:63]
  ds_read_b64_tr_b16 a[230:231], v18 offset:28672
  v_mfma_f32_16x16x32_bf16 v[60:63], v[44:47], v[248:251], v[60:63]
  s_waitcnt lgkmcnt(4)
  v_exp_f32 v163, v163
  v_mfma_f32_16x16x32_bf16 a[96:99], v[248:251], a[196:199], a[96:99]
  s_xor_b32 s43, s48, 0x400
  ds_read_b64_tr_b16 a[232:233], v19 offset:16384
  v_cvt_pk_bf16_f32 v161, v162, v163
  v_mfma_f32_16x16x32_bf16 a[96:99], v[240:243], a[192:195], a[96:99]
  s_waitcnt vmcnt(12)
  buffer_store_dwordx4 v[72:75], v26, s[24:27], s43 offen sc1
  v_mfma_f32_16x16x32_bf16 a[64:67], v[224:227], a[192:195], a[64:67]
  ds_read_b64_tr_b16 a[234:235], v19 offset:20480
  v_mfma_f32_16x16x32_bf16 a[64:67], v[232:235], a[196:199], a[64:67]
  v_exp_f32 v164, v164
  v_mfma_f32_16x16x32_bf16 a[32:35], v[216:219], a[196:199], a[32:35]
  ds_read_b64_tr_b16 a[236:237], v19 offset:24576
  v_mfma_f32_16x16x32_bf16 a[32:35], v[208:211], a[192:195], a[32:35]
  v_exp_f32 v165, v165
  v_mfma_f32_16x16x32_bf16 a[0:3], v[192:195], a[192:195], a[0:3]
  ds_read_b64_tr_b16 a[238:239], v19 offset:28672
  v_cvt_pk_bf16_f32 v162, v164, v165
  v_mfma_f32_16x16x32_bf16 a[0:3], v[200:203], a[196:199], a[0:3]
  v_exp_f32 v166, v166
  v_mfma_f32_16x16x32_bf16 a[4:7], v[200:203], a[204:207], a[4:7]
  s_add_u32 m0, s31, 7168
  s_xor_b32 s42, s34, 0x3400
  ds_read_b64_tr_b16 a[240:241], v20 offset:16384
  v_mfma_f32_16x16x32_bf16 a[4:7], v[192:195], a[200:203], a[4:7]
  s_waitcnt vmcnt(12)
  buffer_load_dwordx4 v25, s[12:15], s42 offen nt lds
  v_mfma_f32_16x16x32_bf16 a[36:39], v[208:211], a[200:203], a[36:39]
  ds_read_b64_tr_b16 a[242:243], v20 offset:20480
  v_mfma_f32_16x16x32_bf16 a[36:39], v[216:219], a[204:207], a[36:39]
  v_exp_f32 v167, v167
  v_mfma_f32_16x16x32_bf16 a[68:71], v[232:235], a[204:207], a[68:71]
  ds_read_b64_tr_b16 a[244:245], v20 offset:24576
  v_cvt_pk_bf16_f32 v163, v166, v167
  v_mfma_f32_16x16x32_bf16 a[68:71], v[224:227], a[200:203], a[68:71]
  v_exp_f32 v176, v176
  v_mfma_f32_16x16x32_bf16 a[100:103], v[240:243], a[200:203], a[100:103]
  ds_read_b64_tr_b16 a[246:247], v20 offset:28672
  v_mfma_f32_16x16x32_bf16 a[100:103], v[248:251], a[204:207], a[100:103]
  v_exp_f32 v177, v177
  v_mfma_f32_16x16x32_bf16 a[104:107], v[248:251], a[212:215], a[104:107]
  ds_read_b64_tr_b16 a[248:249], v21 offset:16384
  v_cvt_pk_bf16_f32 v176, v176, v177
  v_mfma_f32_16x16x32_bf16 a[104:107], v[240:243], a[208:211], a[104:107]
  v_exp_f32 v178, v178
  v_mfma_f32_16x16x32_bf16 a[72:75], v[224:227], a[208:211], a[72:75]
  ds_read_b64_tr_b16 a[250:251], v21 offset:20480
  v_mfma_f32_16x16x32_bf16 a[72:75], v[232:235], a[212:215], a[72:75]
  v_exp_f32 v179, v179
  v_mfma_f32_16x16x32_bf16 a[40:43], v[216:219], a[212:215], a[40:43]
  s_add_u32 m0, s30, 116736
  s_xor_b32 s40, s32, 0x13800
  ds_read_b64_tr_b16 a[252:253], v21 offset:24576
  v_cvt_pk_bf16_f32 v177, v178, v179
  v_mfma_f32_16x16x32_bf16 a[40:43], v[208:211], a[208:211], a[40:43]
  s_waitcnt vmcnt(12)
  buffer_load_dwordx4 v24, s[20:23], s40 offen nt lds
  v_mfma_f32_16x16x32_bf16 a[8:11], v[192:195], a[208:211], a[8:11]
  ds_read_b64_tr_b16 a[254:255], v21 offset:28672
  v_mfma_f32_16x16x32_bf16 a[8:11], v[200:203], a[212:215], a[8:11]
  v_exp_f32 v180, v180
  v_mfma_f32_16x16x32_bf16 a[12:15], v[200:203], a[220:223], a[12:15]
  v_exp_f32 v181, v181
  v_mfma_f32_16x16x32_bf16 a[12:15], v[192:195], a[216:219], a[12:15]
  v_exp_f32 v182, v182
  v_mfma_f32_16x16x32_bf16 a[44:47], v[208:211], a[216:219], a[44:47]
  v_exp_f32 v183, v183
  v_mfma_f32_16x16x32_bf16 a[44:47], v[216:219], a[220:223], a[44:47]
  s_waitcnt vmcnt(6) lgkmcnt(0)
  s_cmpk_lt_i32 s11, 0x0
  s_cbranch_scc0 L_fb2_3
  s_waitcnt vmcnt(3)
L_fb2_3:
  s_barrier
  v_mfma_f32_16x16x32_bf16 a[76:79], v[232:235], a[220:223], a[76:79]
  ds_read_b128 a[192:195], v10 offset:49152
  v_cvt_pk_bf16_f32 v178, v180, v181
  v_mfma_f32_16x16x32_bf16 a[76:79], v[224:227], a[216:219], a[76:79]
  v_exp_f32 v136, v136
  v_mfma_f32_16x16x32_bf16 a[108:111], v[240:243], a[216:219], a[108:111]
  v_exp_f32 v137, v137
  v_mfma_f32_16x16x32_bf16 a[108:111], v[248:251], a[220:223], a[108:111]
  v_exp_f32 v138, v138
  v_mfma_f32_16x16x32_bf16 a[112:115], v[248:251], a[228:231], a[112:115]
  s_add_u32 m0, s30, 117760
  s_xor_b32 s40, s32, 0x13400
  ds_read_b128 a[196:199], v11 offset:49152
  v_cvt_pk_bf16_f32 v179, v182, v183
  v_mfma_f32_16x16x32_bf16 a[112:115], v[240:243], a[224:227], a[112:115]
  s_waitcnt vmcnt(12)
  buffer_load_dwordx4 v25, s[20:23], s40 offen nt lds
  v_mfma_f32_16x16x32_bf16 a[80:83], v[224:227], a[224:227], a[80:83]
  v_exp_f32 v139, v139
  v_mfma_f32_16x16x32_bf16 a[80:83], v[232:235], a[228:231], a[80:83]
  v_exp_f32 v140, v140
  v_mfma_f32_16x16x32_bf16 a[48:51], v[216:219], a[228:231], a[48:51]
  ds_read_b128 a[200:203], v12 offset:49152
  v_cvt_pk_bf16_f32 v136, v136, v137
  v_mfma_f32_16x16x32_bf16 a[48:51], v[208:211], a[224:227], a[48:51]
  v_exp_f32 v141, v141
  v_mfma_f32_16x16x32_bf16 a[16:19], v[192:195], a[224:227], a[16:19]
  v_exp_f32 v142, v142
  v_mfma_f32_16x16x32_bf16 a[16:19], v[200:203], a[228:231], a[16:19]
  v_exp_f32 v143, v143
  v_mfma_f32_16x16x32_bf16 a[20:23], v[200:203], a[236:239], a[20:23]
  ds_read_b128 a[204:207], v13 offset:49152
  v_cvt_pk_bf16_f32 v137, v138, v139
  v_mfma_f32_16x16x32_bf16 a[20:23], v[192:195], a[232:235], a[20:23]
  v_exp_f32 v152, v152
  v_mfma_f32_16x16x32_bf16 a[52:55], v[208:211], a[232:235], a[52:55]
  s_waitcnt vmcnt(8)
  ds_read2_b64 v[2:5], v28 offset0:0 offset1:0
  v_cvt_pk_bf16_f32 v138, v140, v141
  v_mfma_f32_16x16x32_bf16 a[52:55], v[216:219], a[236:239], a[52:55]
  v_exp_f32 v153, v153
  v_mfma_f32_16x16x32_bf16 a[84:87], v[232:235], a[236:239], a[84:87]
  s_xor_b32 s43, s48, 0x6400
  ds_read_b128 a[208:211], v10 offset:53248
  v_cvt_pk_bf16_f32 v139, v142, v143
  v_mfma_f32_16x16x32_bf16 a[84:87], v[224:227], a[232:235], a[84:87]
  s_waitcnt vmcnt(12)
  buffer_store_dwordx4 v[76:79], v26, s[24:27], s43 offen sc1
  v_mfma_f32_16x16x32_bf16 a[116:119], v[240:243], a[232:235], a[116:119]
  v_exp_f32 v154, v154
  v_mfma_f32_16x16x32_bf16 a[116:119], v[248:251], a[236:239], a[116:119]
  v_exp_f32 v155, v155
  v_mfma_f32_16x16x32_bf16 a[120:123], v[248:251], a[244:247], a[120:123]
  ds_read_b128 a[212:215], v11 offset:53248
  v_cvt_pk_bf16_f32 v152, v152, v153
  v_mfma_f32_16x16x32_bf16 a[120:123], v[240:243], a[240:243], a[120:123]
  v_exp_f32 v156, v156
  v_mfma_f32_16x16x32_bf16 a[88:91], v[224:227], a[240:243], a[88:91]
  v_exp_f32 v157, v157
  v_mfma_f32_16x16x32_bf16 a[88:91], v[232:235], a[244:247], a[88:91]
  v_exp_f32 v158, v158
  s_waitcnt lgkmcnt(2)
  v_mfma_f32_16x16x32_bf16 v[2:5], v[32:35], v[2:5], 0
  v_exp_f32 v159, v159
  v_mfma_f32_16x16x32_bf16 a[56:59], v[216:219], a[244:247], a[56:59]
  ds_read_b128 a[216:219], v12 offset:53248
  v_cvt_pk_bf16_f32 v153, v154, v155
  v_mfma_f32_16x16x32_bf16 a[56:59], v[208:211], a[240:243], a[56:59]
  v_exp_f32 v168, v168
  v_mfma_f32_16x16x32_bf16 a[24:27], v[192:195], a[240:243], a[24:27]
  v_exp_f32 v169, v169
  v_mfma_f32_16x16x32_bf16 a[24:27], v[200:203], a[244:247], a[24:27]
  v_cvt_pk_bf16_f32 v64, v2, v3
  v_cvt_pk_bf16_f32 v154, v156, v157
  v_mfma_f32_16x16x32_bf16 a[28:31], v[200:203], a[252:255], a[28:31]
  s_add_u32 m0, s30, 16384
  s_xor_b32 s40, s32, 0x12400
  ds_read_b128 a[220:223], v13 offset:53248
  v_cvt_pk_bf16_f32 v65, v4, v5
  v_mfma_f32_16x16x32_bf16 a[28:31], v[192:195], a[248:251], a[28:31]
  s_waitcnt vmcnt(12)
  buffer_load_dwordx4 v22, s[16:19], s40 offen nt lds
  v_mfma_f32_16x16x32_bf16 a[60:63], v[208:211], a[248:251], a[60:63]
  v_exp_f32 v170, v170
  v_mfma_f32_16x16x32_bf16 a[60:63], v[216:219], a[252:255], a[60:63]
  v_exp_f32 v171, v171
  v_mfma_f32_16x16x32_bf16 a[92:95], v[232:235], a[252:255], a[92:95]
  v_exp_f32 v172, v172
  v_mfma_f32_16x16x32_bf16 a[92:95], v[224:227], a[248:251], a[92:95]
  ds_read2_b64 v[6:9], v28 offset0:1 offset1:1
  v_cvt_pk_bf16_f32 v155, v158, v159
  v_mfma_f32_16x16x32_bf16 a[124:127], v[240:243], a[248:251], a[124:127]
  v_xor_b32 v28, 0x1000, v28
  v_cvt_pk_bf16_f32 v168, v168, v169
  v_mfma_f32_16x16x32_bf16 a[124:127], v[248:251], a[252:255], a[124:127]
  s_waitcnt lgkmcnt(1)
  v_exp_f32 v173, v173
  v_mfma_f32_16x16x32_bf16 v[240:243], a[192:195], a[176:179], 0
  v_exp_f32 v174, v174
  v_mfma_f32_16x16x32_bf16 v[240:243], a[196:199], a[180:183], v[240:243]
  ds_read_b128 a[224:227], v10 offset:57344
  v_cvt_pk_bf16_f32 v169, v170, v171
  v_mfma_f32_16x16x32_bf16 v[240:243], a[200:203], a[184:187], v[240:243]
  v_exp_f32 v175, v175
  v_mfma_f32_16x16x32_bf16 v[240:243], a[204:207], a[188:191], v[240:243]
  v_exp_f32 v184, v184
  v_mfma_f32_16x16x32_bf16 v[224:227], a[204:207], a[172:175], 0
  s_add_u32 m0, s30, 17408
  s_xor_b32 s40, s32, 0x12800
  ds_read_b128 a[228:231], v11 offset:57344
  v_cvt_pk_bf16_f32 v170, v172, v173
  v_mfma_f32_16x16x32_bf16 v[224:227], a[200:203], a[168:171], v[224:227]
  s_waitcnt vmcnt(12)
  buffer_load_dwordx4 v23, s[16:19], s40 offen nt lds
  v_mfma_f32_16x16x32_bf16 v[224:227], a[196:199], a[164:167], v[224:227]
  v_exp_f32 v185, v185
  v_mfma_f32_16x16x32_bf16 v[224:227], a[192:195], a[160:163], v[224:227]
  ds_read_b128 a[232:235], v12 offset:57344
  v_cvt_pk_bf16_f32 v171, v174, v175
  s_waitcnt lgkmcnt(3)
  v_mfma_f32_16x16x32_bf16 v[6:9], v[32:35], v[6:9], 0
  v_exp_f32 v186, v186
  v_mfma_f32_16x16x32_bf16 v[208:211], a[192:195], a[144:147], 0
  v_exp_f32 v187, v187
  v_mfma_f32_16x16x32_bf16 v[208:211], a[196:199], a[148:151], v[208:211]
  v_exp_f32 v188, v188
  v_mfma_f32_16x16x32_bf16 v[208:211], a[200:203], a[152:155], v[208:211]
  ds_read_b128 a[236:239], v13 offset:57344
  v_cvt_pk_bf16_f32 v184, v184, v185
  v_mfma_f32_16x16x32_bf16 v[208:211], a[204:207], a[156:159], v[208:211]
  v_cvt_pk_bf16_f32 v66, v6, v7
  v_cvt_pk_bf16_f32 v185, v186, v187
  v_mfma_f32_16x16x32_bf16 v[192:195], a[204:207], a[140:143], 0
  v_cvt_pk_bf16_f32 v67, v8, v9
  v_mfma_f32_16x16x32_bf16 v[192:195], a[200:203], a[136:139], v[192:195]
  ds_read_b128 a[240:243], v10 offset:61440
  v_mfma_f32_16x16x32_bf16 v[192:195], a[196:199], a[132:135], v[192:195]
  v_exp_f32 v189, v189
  v_mfma_f32_16x16x32_bf16 v[192:195], a[192:195], a[128:131], v[192:195]
  v_exp_f32 v190, v190
  v_mfma_f32_16x16x32_bf16 v[196:199], a[208:211], a[128:131], 0
  ds_read_b128 a[244:247], v11 offset:61440
  v_cvt_pk_bf16_f32 v186, v188, v189
  v_mfma_f32_16x16x32_bf16 v[196:199], a[212:215], a[132:135], v[196:199]
  s_add_u32 m0, s30, 18432
  s_xor_b32 s40, s32, 0x2000
  ds_read2_b64 v[2:5], v29 offset0:0 offset1:0
  v_mfma_f32_16x16x32_bf16 v[196:199], a[216:219], a[136:139], v[196:199]
  s_waitcnt vmcnt(12)
  buffer_load_dwordx4 v24, s[16:19], s40 offen nt lds
  v_mfma_f32_16x16x32_bf16 v[196:199], a[220:223], a[140:143], v[196:199]
  ds_read_b128 a[248:251], v12 offset:61440
  v_mfma_f32_16x16x32_bf16 v[212:215], a[220:223], a[156:159], 0
  v_exp_f32 v191, v191
  v_mfma_f32_16x16x32_bf16 v[212:215], a[216:219], a[152:155], v[212:215]
  v_cvt_pk_bf16_f32 v187, v190, v191
  v_mfma_f32_16x16x32_bf16 v[212:215], a[212:215], a[148:151], v[212:215]
  ds_read_b128 a[252:255], v13 offset:61440
  v_mfma_f32_16x16x32_bf16 v[212:215], a[208:211], a[144:147], v[212:215]
  v_mfma_f32_16x16x32_bf16 v[228:231], a[208:211], a[160:163], 0
  v_exp_f32 v192, v192
  v_mfma_f32_16x16x32_bf16 v[228:231], a[212:215], a[164:167], v[228:231]
  v_exp_f32 v193, v193
  v_mfma_f32_16x16x32_bf16 v[228:231], a[216:219], a[168:171], v[228:231]
  s_xor_b32 s43, s48, 0x5000
  v_exp_f32 v194, v194
  v_mfma_f32_16x16x32_bf16 v[228:231], a[220:223], a[172:175], v[228:231]
L_pg14:
  s_cbranch_execz L_rt2
  s_waitcnt vmcnt(12)
  buffer_store_dwordx4 v[80:83], v26, s[24:27], s43 offen sc1
  s_waitcnt lgkmcnt(2)
  v_mfma_f32_16x16x32_bf16 v[2:5], v[32:35], v[2:5], 0
  v_exp_f32 v195, v195
  v_mfma_f32_16x16x32_bf16 v[244:247], a[220:223], a[188:191], 0
  v_exp_f32 v196, v196
  v_mfma_f32_16x16x32_bf16 v[244:247], a[216:219], a[184:187], v[244:247]
  v_exp_f32 v197, v197
  v_mfma_f32_16x16x32_bf16 v[244:247], a[212:215], a[180:183], v[244:247]
  v_exp_f32 v198, v198
  v_mfma_f32_16x16x32_bf16 v[244:247], a[208:211], a[176:179], v[244:247]
  s_waitcnt vmcnt(7) lgkmcnt(0)
  s_cmpk_lt_i32 s8, 0x0
  s_cbranch_scc0 L_fb2_4
  s_waitcnt vmcnt(3)
L_fb2_4:
  s_barrier
  v_mfma_f32_16x16x32_bf16 v[248:251], a[224:227], a[176:179], 0
  ds_read_b64_tr_b16 a[192:193], v14 offset:32768
  v_cvt_pk_bf16_f32 v68, v2, v3
  v_mfma_f32_16x16x32_bf16 v[248:251], a[228:231], a[180:183], v[248:251]
  v_cvt_pk_bf16_f32 v69, v4, v5
  v_cvt_pk_bf16_f32 v192, v192, v193
  v_mfma_f32_16x16x32_bf16 v[248:251], a[232:235], a[184:187], v[248:251]
  ds_read_b64_tr_b16 a[194:195], v14 offset:36864
  v_cvt_pk_bf16_f32 v193, v194, v195
  v_mfma_f32_16x16x32_bf16 v[248:251], a[236:239], a[188:191], v[248:251]
  ds_read2_b64 v[6:9], v29 offset0:1 offset1:1
  v_cvt_pk_bf16_f32 v194, v196, v197
  v_mfma_f32_16x16x32_bf16 v[232:235], a[236:239], a[172:175], 0
  ds_read_b64_tr_b16 a[196:197], v14 offset:40960
  v_xor_b32 v29, 0x1000, v29
  v_mfma_f32_16x16x32_bf16 v[232:235], a[232:235], a[168:171], v[232:235]
  v_exp_f32 v199, v199
  v_mfma_f32_16x16x32_bf16 v[232:235], a[228:231], a[164:167], v[232:235]
  ds_read_b64_tr_b16 a[198:199], v14 offset:45056
  v_cvt_pk_bf16_f32 v195, v198, v199
  v_mfma_f32_16x16x32_bf16 v[232:235], a[224:227], a[160:163], v[232:235]
  v_exp_f32 v208, v208
  v_mfma_f32_16x16x32_bf16 v[216:219], a[224:227], a[144:147], 0
  s_add_u32 m0, s30, 19456
  s_xor_b32 s40, s32, 0x2c00
  ds_read_b64_tr_b16 a[200:201], v15 offset:32768
  v_mfma_f32_16x16x32_bf16 v[216:219], a[228:231], a[148:151], v[216:219]
  s_waitcnt vmcnt(12)
  buffer_load_dwordx4 v25, s[16:19], s40 offen nt lds
  v_mfma_f32_16x16x32_bf16 v[216:219], a[232:235], a[152:155], v[216:219]
  ds_read_b64_tr_b16 a[202:203], v15 offset:36864
  v_mfma_f32_16x16x32_bf16 v[216:219], a[236:239], a[156:159], v[216:219]
  v_exp_f32 v209, v209
  s_waitcnt lgkmcnt(4)
  v_mfma_f32_16x16x32_bf16 v[6:9], v[32:35], v[6:9], 0
  v_exp_f32 v210, v210
  v_mfma_f32_16x16x32_bf16 v[200:203], a[236:239], a[140:143], 0
  ds_read_b64_tr_b16 a[204:205], v15 offset:40960
  v_cvt_pk_bf16_f32 v208, v208, v209
  v_mfma_f32_16x16x32_bf16 v[200:203], a[232:235], a[136:139], v[200:203]
  v_exp_f32 v211, v211
  v_mfma_f32_16x16x32_bf16 v[200:203], a[228:231], a[132:135], v[200:203]
  ds_read_b64_tr_b16 a[206:207], v15 offset:45056
  v_cvt_pk_bf16_f32 v209, v210, v211
  v_mfma_f32_16x16x32_bf16 v[200:203], a[224:227], a[128:131], v[200:203]
  v_cvt_pk_bf16_f32 v70, v6, v7
  v_mfma_f32_16x16x32_bf16 v[204:207], a[240:243], a[128:131], 0
  ds_read_b64_tr_b16 a[208:209], v16 offset:32768
  v_cvt_pk_bf16_f32 v71, v8, v9
  v_mfma_f32_16x16x32_bf16 v[204:207], a[244:247], a[132:135], v[204:207]
  v_exp_f32 v212, v212
  v_mfma_f32_16x16x32_bf16 v[204:207], a[248:251], a[136:139], v[204:207]
  ds_read_b64_tr_b16 a[210:211], v16 offset:36864
  v_mfma_f32_16x16x32_bf16 v[204:207], a[252:255], a[140:143], v[204:207]
  s_waitcnt vmcnt(10)
  v_readfirstlane_b32 s44, v252
  v_mfma_f32_16x16x32_bf16 v[220:223], a[252:255], a[156:159], 0
  s_xor_b32 s43, s48, 0x3000
  ds_read_b64_tr_b16 a[212:213], v16 offset:40960
  v_mfma_f32_16x16x32_bf16 v[220:223], a[248:251], a[152:155], v[220:223]
  s_waitcnt vmcnt(12)
  s_sub_u32 s44, s44, s49
  s_add_u32 s49, s49, 64
  s_sub_i32 s8, s44, s98
  s_sub_i32 s9, s44, s99
  s_sub_i32 s10, s44, s100
  s_sub_i32 s11, s44, s101
  buffer_store_dwordx4 v[84:87], v26, s[24:27], s43 offen sc1
  v_mfma_f32_16x16x32_bf16 v[220:223], a[244:247], a[148:151], v[220:223]
  ds_read_b64_tr_b16 a[214:215], v16 offset:45056
  v_mfma_f32_16x16x32_bf16 v[220:223], a[240:243], a[144:147], v[220:223]
  ds_read2_b64 v[2:5], v30 offset0:0 offset1:0
  v_mfma_f32_16x16x32_bf16 v[236:239], a[240:243], a[160:163], 0
  ds_read_b64_tr_b16 a[216:217], v17 offset:32768
  v_mfma_f32_16x16x32_bf16 v[236:239], a[244:247], a[164:167], v[236:239]
  v_exp_f32 v213, v213
  v_mfma_f32_16x16x32_bf16 v[236:239], a[248:251], a[168:171], v[236:239]
  ds_read_b64_tr_b16 a[218:219], v17 offset:36864
  v_cvt_pk_bf16_f32 v210, v212, v213
  v_mfma_f32_16x16x32_bf16 v[236:239], a[252:255], a[172:175], v[236:239]
  v_exp_f32 v214, v214
  v_mfma_f32_16x16x32_bf16 v[252:255], a[252:255], a[188:191], 0
  ds_read_b64_tr_b16 a[220:221], v17 offset:40960
  v_mfma_f32_16x16x32_bf16 v[252:255], a[248:251], a[184:187], v[252:255]
  v_exp_f32 v215, v215
  v_mfma_f32_16x16x32_bf16 v[252:255], a[244:247], a[180:183], v[252:255]
  s_add_u32 m0, s30, 65536
  s_xor_b32 s40, s32, 0x12000
  ds_read_b64_tr_b16 a[222:223], v17 offset:45056
  v_cvt_pk_bf16_f32 v211, v214, v215
  v_mfma_f32_16x16x32_bf16 v[252:255], a[240:243], a[176:179], v[252:255]
  s_waitcnt vmcnt(12)
  buffer_load_dwordx4 v22, s[20:23], s40 offen nt lds
  s_waitcnt lgkmcnt(4)
  v_mfma_f32_16x16x32_bf16 v[2:5], v[32:35], v[2:5], 0
  v_exp_f32 v224, v224
  v_mfma_f32_16x16x32_bf16 v[48:51], v[44:47], v[128:131], v[48:51]
  ds_read_b64_tr_b16 a[224:225], v18 offset:32768
  v_mfma_f32_16x16x32_bf16 v[48:51], v[44:47], v[136:139], v[48:51]
  v_exp_f32 v225, v225
  v_mfma_f32_16x16x32_bf16 v[52:55], v[44:47], v[144:147], v[52:55]
  ds_read_b64_tr_b16 a[226:227], v18 offset:36864
  v_cvt_pk_bf16_f32 v224, v224, v225
  v_mfma_f32_16x16x32_bf16 v[52:55], v[44:47], v[152:155], v[52:55]
  v_cvt_pk_bf16_f32 v72, v2, v3
  v_mfma_f32_16x16x32_bf16 v[56:59], v[44:47], v[160:163], v[56:59]
  ds_read_b64_tr_b16 a[228:229], v18 offset:40960
  v_cvt_pk_bf16_f32 v73, v4, v5
  v_mfma_f32_16x16x32_bf16 v[56:59], v[44:47], v[168:171], v[56:59]
  v_exp_f32 v226, v226
  v_mfma_f32_16x16x32_bf16 v[60:63], v[44:47], v[176:179], v[60:63]
  ds_read_b64_tr_b16 a[230:231], v18 offset:45056
  v_mfma_f32_16x16x32_bf16 v[60:63], v[44:47], v[184:187], v[60:63]
  s_waitcnt lgkmcnt(4)
  v_exp_f32 v227, v227
  v_mfma_f32_16x16x32_bf16 a[96:99], v[184:187], a[196:199], a[96:99]
  ds_read_b64_tr_b16 a[232:233], v19 offset:32768
  v_cvt_pk_bf16_f32 v225, v226, v227
  v_mfma_f32_16x16x32_bf16 a[96:99], v[176:179], a[192:195], a[96:99]
  v_exp_f32 v228, v228
  v_mfma_f32_16x16x32_bf16 a[64:67], v[160:163], a[192:195], a[64:67]
  ds_read_b64_tr_b16 a[234:235], v19 offset:36864
  v_mfma_f32_16x16x32_bf16 a[64:67], v[168:171], a[196:199], a[64:67]
  ds_read2_b64 v[6:9], v30 offset0:1 offset1:1
  v_mfma_f32_16x16x32_bf16 a[32:35], v[152:155], a[196:199], a[32:35]
  s_add_u32 m0, s30, 66560
  s_xor_b32 s40, s32, 0x12c00
  ds_read_b64_tr_b16 a[236:237], v19 offset:40960
  v_xor_b32 v30, 0x1000, v30
  v_mfma_f32_16x16x32_bf16 a[32:35], v[144:147], a[192:195], a[32:35]
  s_waitcnt vmcnt(12)
  buffer_load_dwordx4 v23, s[20:23], s40 offen nt lds
  v_mfma_f32_16x16x32_bf16 a[0:3], v[128:131], a[192:195], a[0:3]
  ds_read_b64_tr_b16 a[238:239], v19 offset:45056
  v_mfma_f32_16x16x32_bf16 a[0:3], v[136:139], a[196:199], a[0:3]
  v_exp_f32 v229, v229
  v_mfma_f32_16x16x32_bf16 a[4:7], v[136:139], a[204:207], a[4:7]
  ds_read_b64_tr_b16 a[240:241], v20 offset:32768
  v_cvt_pk_bf16_f32 v226, v228, v229
  v_mfma_f32_16x16x32_bf16 a[4:7], v[128:131], a[200:203], a[4:7]
  v_exp_f32 v230, v230
  v_mfma_f32_16x16x32_bf16 a[36:39], v[144:147], a[200:203], a[36:39]
  ds_read_b64_tr_b16 a[242:243], v20 offset:36864
  v_mfma_f32_16x16x32_bf16 a[36:39], v[152:155], a[204:207], a[36:39]
  v_exp_f32 v231, v231
  s_waitcnt lgkmcnt(4)
  v_mfma_f32_16x16x32_bf16 v[6:9], v[32:35], v[6:9], 0
  v_exp_f32 v240, v240
  v_mfma_f32_16x16x32_bf16 a[68:71], v[168:171], a[204:207], a[68:71]
  ds_read_b64_tr_b16 a[244:245], v20 offset:40960
  v_cvt_pk_bf16_f32 v227, v230, v231
  v_mfma_f32_16x16x32_bf16 a[68:71], v[160:163], a[200:203], a[68:71]
  v_exp_f32 v241, v241
  v_mfma_f32_16x16x32_bf16 a[100:103], v[176:179], a[200:203], a[100:103]
  ds_read_b64_tr_b16 a[246:247], v20 offset:45056
  v_cvt_pk_bf16_f32 v240, v240, v241
  v_mfma_f32_16x16x32_bf16 a[100:103], v[184:187], a[204:207], a[100:103]
  v_cvt_pk_bf16_f32 v74, v6, v7
  v_mfma_f32_16x16x32_bf16 a[104:107], v[184:187], a[212:215], a[104:107]
  s_add_u32 m0, s30, 67584
  s_xor_b32 s40, s32, 0x2400
  ds_read_b64_tr_b16 a[248:249], v21 offset:32768
  v_cvt_pk_bf16_f32 v75, v8, v9
  v_mfma_f32_16x16x32_bf16 a[104:107], v[176:179], a[208:211], a[104:107]
  s_waitcnt vmcnt(12)
  buffer_load_dwordx4 v24, s[20:23], s40 offen nt lds
  v_mfma_f32_16x16x32_bf16 a[72:75], v[160:163], a[208:211], a[72:75]
  ds_read_b64_tr_b16 a[250:251], v21 offset:36864
  v_mfma_f32_16x16x32_bf16 a[72:75], v[168:171], a[212:215], a[72:75]
  v_exp_f32 v242, v242
  v_mfma_f32_16x16x32_bf16 a[40:43], v[152:155], a[212:215], a[40:43]
  ds_read_b64_tr_b16 a[252:253], v21 offset:40960
  v_mfma_f32_16x16x32_bf16 a[40:43], v[144:147], a[208:211], a[40:43]
  ds_read2_b64 v[2:5], v31 offset0:0 offset1:0
  v_mfma_f32_16x16x32_bf16 a[8:11], v[128:131], a[208:211], a[8:11]
  ds_read_b64_tr_b16 a[254:255], v21 offset:45056
  v_mfma_f32_16x16x32_bf16 a[8:11], v[136:139], a[212:215], a[8:11]
  v_exp_f32 v243, v243
  v_mfma_f32_16x16x32_bf16 a[12:15], v[136:139], a[220:223], a[12:15]
  v_exp_f32 v244, v244
  v_mfma_f32_16x16x32_bf16 a[12:15], v[128:131], a[216:219], a[12:15]
  v_exp_f32 v245, v245
  v_mfma_f32_16x16x32_bf16 a[44:47], v[144:147], a[216:219], a[44:47]
  v_exp_f32 v246, v246
  v_mfma_f32_16x16x32_bf16 a[44:47], v[152:155], a[220:223], a[44:47]
  s_waitcnt vmcnt(7) lgkmcnt(0)
  s_cmpk_lt_i32 s9, 0x0
  s_cbranch_scc0 L_fb2_5
  s_waitcnt vmcnt(3)
L_fb2_5:
  s_barrier
  v_mfma_f32_16x16x32_bf16 a[76:79], v[168:171], a[220:223], a[76:79]
  s_xor_b32 s43, s48, 0x5400
  ds_read_b128 a[192:195], v10
  v_cvt_pk_bf16_f32 v241, v242, v243
  v_mfma_f32_16x16x32_bf16 a[76:79], v[160:163], a[216:219], a[76:79]
  s_waitcnt vmcnt(12)
  buffer_store_dwordx4 v[88:91], v26, s[24:27], s43 offen sc1
  v_mfma_f32_16x16x32_bf16 a[108:111], v[176:179], a[216:219], a[108:111]
  v_exp_f32 v247, v247
  v_mfma_f32_16x16x32_bf16 a[108:111], v[184:187], a[220:223], a[108:111]
  v_exp_f32 v200, v200
  v_mfma_f32_16x16x32_bf16 v[2:5], v[32:35], v[2:5], 0
  v_exp_f32 v201, v201
  v_mfma_f32_16x16x32_bf16 a[112:115], v[184:187], a[228:231], a[112:115]
  ds_read_b128 a[196:199], v11
  v_cvt_pk_bf16_f32 v242, v244, v245
  v_mfma_f32_16x16x32_bf16 a[112:115], v[176:179], a[224:227], a[112:115]
  v_exp_f32 v202, v202
  v_mfma_f32_16x16x32_bf16 a[80:83], v[160:163], a[224:227], a[80:83]
  v_exp_f32 v203, v203
  v_mfma_f32_16x16x32_bf16 a[80:83], v[168:171], a[228:231], a[80:83]
  v_cvt_pk_bf16_f32 v76, v2, v3
  v_cvt_pk_bf16_f32 v243, v246, v247
  v_mfma_f32_16x16x32_bf16 a[48:51], v[152:155], a[228:231], a[48:51]
  ds_read_b128 a[200:203], v12
  v_cvt_pk_bf16_f32 v77, v4, v5
  v_mfma_f32_16x16x32_bf16 a[48:51], v[144:147], a[224:227], a[48:51]
  v_exp_f32 v204, v204
  v_mfma_f32_16x16x32_bf16 a[16:19], v[128:131], a[224:227], a[16:19]
  s_add_u32 m0, s30, 68608
  s_xor_b32 s40, s32, 0x2800
  v_exp_f32 v205, v205
  v_mfma_f32_16x16x32_bf16 a[16:19], v[136:139], a[228:231], a[16:19]
  s_waitcnt vmcnt(12)
  buffer_load_dwordx4 v25, s[20:23], s40 offen nt lds
  v_mfma_f32_16x16x32_bf16 a[20:23], v[136:139], a[236:239], a[20:23]
  ds_read_b128 a[204:207], v13
  v_cvt_pk_bf16_f32 v200, v200, v201
  v_mfma_f32_16x16x32_bf16 a[20:23], v[128:131], a[232:235], a[20:23]
  ds_read2_b64 v[6:9], v31 offset0:1 offset1:1
  v_cvt_pk_bf16_f32 v201, v202, v203
  v_mfma_f32_16x16x32_bf16 a[52:55], v[144:147], a[232:235], a[52:55]
  v_xor_b32 v31, 0x1000, v31
  v_cvt_pk_bf16_f32 v202, v204, v205
  v_mfma_f32_16x16x32_bf16 a[52:55], v[152:155], a[236:239], a[52:55]
  v_exp_f32 v206, v206
  v_mfma_f32_16x16x32_bf16 a[84:87], v[168:171], a[236:239], a[84:87]
  ds_read_b128 a[208:211], v10 offset:4096
  v_mfma_f32_16x16x32_bf16 a[84:87], v[160:163], a[232:235], a[84:87]
  v_exp_f32 v207, v207
  v_mfma_f32_16x16x32_bf16 a[116:119], v[176:179], a[232:235], a[116:119]
  v_exp_f32 v216, v216
  v_mfma_f32_16x16x32_bf16 a[116:119], v[184:187], a[236:239], a[116:119]
  v_exp_f32 v217, v217
  v_mfma_f32_16x16x32_bf16 a[120:123], v[184:187], a[244:247], a[120:123]
  ds_read_b128 a[212:215], v11 offset:4096
  v_cvt_pk_bf16_f32 v203, v206, v207
  v_mfma_f32_16x16x32_bf16 a[120:123], v[176:179], a[240:243], a[120:123]
  v_exp_f32 v218, v218
  v_mfma_f32_16x16x32_bf16 a[88:91], v[160:163], a[240:243], a[88:91]
  s_add_u32 m0, s30, 32768
  s_xor_b32 s40, s32, 0x11800
  v_exp_f32 v219, v219
  v_mfma_f32_16x16x32_bf16 a[88:91], v[168:171], a[244:247], a[88:91]
  s_waitcnt vmcnt(12)
  buffer_load_dwordx4 v22, s[16:19], s40 offen nt lds
  s_waitcnt lgkmcnt(2)
  v_mfma_f32_16x16x32_bf16 v[6:9], v[32:35], v[6:9], 0
  v_exp_f32 v220, v220
  v_mfma_f32_16x16x32_bf16 a[56:59], v[152:155], a[244:247], a[56:59]
  ds_read_b128 a[216:219], v12 offset:4096
  v_cvt_pk_bf16_f32 v216, v216, v217
  v_mfma_f32_16x16x32_bf16 a[56:59], v[144:147], a[240:243], a[56:59]
  v_exp_f32 v221, v221
  v_mfma_f32_16x16x32_bf16 a[24:27], v[128:131], a[240:243], a[24:27]
  v_exp_f32 v222, v222
  v_mfma_f32_16x16x32_bf16 a[24:27], v[136:139], a[244:247], a[24:27]
  v_cvt_pk_bf16_f32 v78, v6, v7
  v_cvt_pk_bf16_f32 v217, v218, v219
  v_mfma_f32_16x16x32_bf16 a[28:31], v[136:139], a[252:255], a[28:31]
  ds_read_b128 a[220:223], v13 offset:4096
  v_cvt_pk_bf16_f32 v79, v8, v9
  v_mfma_f32_16x16x32_bf16 a[28:31], v[128:131], a[248:251], a[28:31]
  v_exp_f32 v223, v223
  v_mfma_f32_16x16x32_bf16 a[60:63], v[144:147], a[248:251], a[60:63]
  v_exp_f32 v232, v232
  v_mfma_f32_16x16x32_bf16 a[60:63], v[152:155], a[252:255], a[60:63]
  v_exp_f32 v233, v233
  v_mfma_f32_16x16x32_bf16 a[92:95], v[168:171], a[252:255], a[92:95]
  s_waitcnt vmcnt(15)
  ds_read2_b64 v[2:5], v28 offset0:0 offset1:0
  v_cvt_pk_bf16_f32 v218, v220, v221
  v_mfma_f32_16x16x32_bf16 a[92:95], v[160:163], a[248:251], a[92:95]
  v_exp_f32 v234, v234
  v_mfma_f32_16x16x32_bf16 a[124:127], v[176:179], a[248:251], a[124:127]
  s_add_u32 m0, s31, 0
  s_xor_b32 s42, s34, 0xe800
  v_exp_f32 v235, v235
  v_mfma_f32_16x16x32_bf16 a[124:127], v[184:187], a[252:255], a[124:127]
  s_waitcnt lgkmcnt(1)
  s_waitcnt vmcnt(12)
  buffer_load_dwordx4 v22, s[12:15], s42 offen nt lds
  v_mfma_f32_16x16x32_bf16 v[176:179], a[192:195], a[176:179], 0
  v_exp_f32 v236, v236
  v_mfma_f32_16x16x32_bf16 v[176:179], a[196:199], a[180:183], v[176:179]
  ds_read_b128 a[224:227], v10 offset:8192
  v_cvt_pk_bf16_f32 v219, v222, v223
  v_mfma_f32_16x16x32_bf16 v[176:179], a[200:203], a[184:187], v[176:179]
  v_exp_f32 v237, v237
  v_mfma_f32_16x16x32_bf16 v[176:179], a[204:207], a[188:191], v[176:179]
  v_exp_f32 v238, v238
  v_mfma_f32_16x16x32_bf16 v[160:163], a[204:207], a[172:175], 0
  ds_read_b128 a[228:231], v11 offset:8192
  v_cvt_pk_bf16_f32 v232, v232, v233
  v_mfma_f32_16x16x32_bf16 v[160:163], a[200:203], a[168:171], v[160:163]
  v_exp_f32 v239, v239
  v_mfma_f32_16x16x32_bf16 v[160:163], a[196:199], a[164:167], v[160:163]
  v_exp_f32 v248, v248
  v_mfma_f32_16x16x32_bf16 v[160:163], a[192:195], a[160:163], v[160:163]
  ds_read_b128 a[232:235], v12 offset:8192
  v_cvt_pk_bf16_f32 v233, v234, v235
  s_waitcnt lgkmcnt(3)
  v_mfma_f32_16x16x32_bf16 v[2:5], v[32:35], v[2:5], 0
  v_exp_f32 v249, v249
  v_mfma_f32_16x16x32_bf16 v[144:147], a[192:195], a[144:147], 0
  v_exp_f32 v250, v250
  v_mfma_f32_16x16x32_bf16 v[144:147], a[196:199], a[148:151], v[144:147]
  v_exp_f32 v251, v251
  v_mfma_f32_16x16x32_bf16 v[144:147], a[200:203], a[152:155], v[144:147]
  ds_read_b128 a[236:239], v13 offset:8192
  v_cvt_pk_bf16_f32 v234, v236, v237
  v_mfma_f32_16x16x32_bf16 v[144:147], a[204:207], a[156:159], v[144:147]
  v_cvt_pk_bf16_f32 v80, v2, v3
  v_cvt_pk_bf16_f32 v235, v238, v239
  v_mfma_f32_16x16x32_bf16 v[128:131], a[204:207], a[140:143], 0
  v_cvt_pk_bf16_f32 v81, v4, v5
  v_cvt_pk_bf16_f32 v248, v248, v249
  v_mfma_f32_16x16x32_bf16 v[128:131], a[200:203], a[136:139], v[128:131]
  s_add_u32 m0, s31, 1024
  s_xor_b32 s42, s34, 0x8800
  ds_read_b128 a[240:243], v10 offset:12288
  v_cvt_pk_bf16_f32 v249, v250, v251
  v_mfma_f32_16x16x32_bf16 v[128:131], a[196:199], a[132:135], v[128:131]
  s_waitcnt vmcnt(12)
  buffer_load_dwordx4 v23, s[12:15], s42 offen nt lds
  v_mfma_f32_16x16x32_bf16 v[128:131], a[192:195], a[128:131], v[128:131]
  ds_read2_b64 v[6:9], v28 offset0:1 offset1:1
  v_mfma_f32_16x16x32_bf16 v[132:135], a[208:211], a[128:131], 0
  ds_read_b128 a[244:247], v11 offset:12288
  v_xor_b32 v28, 0x1000, v28
  v_mfma_f32_16x16x32_bf16 v[132:135], a[212:215], a[132:135], v[132:135]
  v_exp_f32 v252, v252
  v_mfma_f32_16x16x32_bf16 v[132:135], a[216:219], a[136:139], v[132:135]
  v_exp_f32 v253, v253
  v_mfma_f32_16x16x32_bf16 v[132:135], a[220:223], a[140:143], v[132:135]
  ds_read_b128 a[248:251], v12 offset:12288
  v_cvt_pk_bf16_f32 v250, v252, v253
  v_mfma_f32_16x16x32_bf16 v[148:151], a[220:223], a[156:159], 0
  v_exp_f32 v254, v254
  v_mfma_f32_16x16x32_bf16 v[148:151], a[216:219], a[152:155], v[148:151]
  v_exp_f32 v255, v255
  v_mfma_f32_16x16x32_bf16 v[148:151], a[212:215], a[148:151], v[148:151]
  s_add_u32 m0, s31, 2048
  s_xor_b32 s42, s34, 0xec00
  ds_read_b128 a[252:255], v13 offset:12288
  v_cvt_pk_bf16_f32 v251, v254, v255
  v_mfma_f32_16x16x32_bf16 v[148:151], a[208:211], a[144:147], v[148:151]
  s_waitcnt vmcnt(12)
  buffer_load_dwordx4 v24, s[12:15], s42 offen nt lds
  s_waitcnt lgkmcnt(3)
  v_mfma_f32_16x16x32_bf16 v[6:9], v[32:35], v[6:9], 0
  v_mfma_f32_16x16x32_bf16 v[164:167], a[208:211], a[160:163], 0
  v_exp_f32 v128, v128
  v_mfma_f32_16x16x32_bf16 v[164:167], a[212:215], a[164:167], v[164:167]
  v_exp_f32 v129, v129
  v_mfma_f32_16x16x32_bf16 v[164:167], a[216:219], a[168:171], v[164:167]
  v_exp_f32 v130, v130
  v_mfma_f32_16x16x32_bf16 v[164:167], a[220:223], a[172:175], v[164:167]
  s_nop 0
  v_cvt_pk_bf16_f32 v82, v6, v7
  v_cvt_pk_bf16_f32 v128, v128, v129
  v_mfma_f32_16x16x32_bf16 v[180:183], a[220:223], a[188:191], 0
  v_cvt_pk_bf16_f32 v83, v8, v9
  v_mfma_f32_16x16x32_bf16 v[180:183], a[216:219], a[184:187], v[180:183]
  v_exp_f32 v131, v131
  v_mfma_f32_16x16x32_bf16 v[180:183], a[212:215], a[180:183], v[180:183]
  v_exp_f32 v132, v132
  v_mfma_f32_16x16x32_bf16 v[180:183], a[208:211], a[176:179], v[180:183]
  s_mov_b64 exec, 0
  s_cmp_eq_u32 s45, 0
  s_cbranch_scc1 L_pg16
  s_cmp_eq_u32 s45, 1
  s_cbranch_scc1 L_pg17
  s_cmp_eq_u32 s45, 2
  s_cbranch_scc1 L_pg18
  s_branch L_pg19
L_rt3:
  s_mov_b64 exec, -1
  s_waitcnt vmcnt(7) lgkmcnt(0)
  s_cmpk_lt_i32 s10, 0x0
  s_cbranch_scc0 L_fb2_6
  s_waitcnt vmcnt(2)
L_fb2_6:
  s_barrier
  v_mfma_f32_16x16x32_bf16 v[184:187], a[224:227], a[176:179], 0
  ds_read_b64_tr_b16 a[192:193], v14 offset:49152
  v_cvt_pk_bf16_f32 v129, v130, v131
  v_mfma_f32_16x16x32_bf16 v[184:187], a[228:231], a[180:183], v[184:187]
  v_exp_f32 v133, v133
  v_mfma_f32_16x16x32_bf16 v[184:187], a[232:235], a[184:187], v[184:187]
  ds_read_b64_tr_b16 a[194:195], v14 offset:53248
  v_cvt_pk_bf16_f32 v130, v132, v133
  v_mfma_f32_16x16x32_bf16 v[184:187], a[236:239], a[188:191], v[184:187]
  ds_read2_b64 v[2:5], v29 offset0:0 offset1:0
  v_mfma_f32_16x16x32_bf16 v[168:171], a[236:239], a[172:175], 0
  s_add_u32 m0, s31, 3072
  s_xor_b32 s42, s34, 0x8c00
  ds_read_b64_tr_b16 a[196:197], v14 offset:57344
  v_mfma_f32_16x16x32_bf16 v[168:171], a[232:235], a[168:171], v[168:171]
  s_waitcnt vmcnt(12)
  buffer_load_dwordx4 v25, s[12:15], s42 offen nt lds
  v_mfma_f32_16x16x32_bf16 v[168:171], a[228:231], a[164:167], v[168:171]
  ds_read_b64_tr_b16 a[198:199], v14 offset:61440
  v_mfma_f32_16x16x32_bf16 v[168:171], a[224:227], a[160:163], v[168:171]
  v_exp_f32 v134, v134
  v_mfma_f32_16x16x32_bf16 v[152:155], a[224:227], a[144:147], 0
  ds_read_b64_tr_b16 a[200:201], v15 offset:49152
  v_mfma_f32_16x16x32_bf16 v[152:155], a[228:231], a[148:151], v[152:155]
  v_exp_f32 v135, v135
  v_mfma_f32_16x16x32_bf16 v[152:155], a[232:235], a[152:155], v[152:155]
  ds_read_b64_tr_b16 a[202:203], v15 offset:53248
  v_cvt_pk_bf16_f32 v131, v134, v135
  v_mfma_f32_16x16x32_bf16 v[152:155], a[236:239], a[156:159], v[152:155]
  v_exp_f32 v144, v144
  s_waitcnt lgkmcnt(4)
  v_mfma_f32_16x16x32_bf16 v[2:5], v[32:35], v[2:5], 0
  v_exp_f32 v145, v145
  v_mfma_f32_16x16x32_bf16 v[136:139], a[236:239], a[140:143], 0
  ds_read_b64_tr_b16 a[204:205], v15 offset:57344
  v_cvt_pk_bf16_f32 v144, v144, v145
  v_mfma_f32_16x16x32_bf16 v[136:139], a[232:235], a[136:139], v[136:139]
  v_exp_f32 v146, v146
  v_mfma_f32_16x16x32_bf16 v[136:139], a[228:231], a[132:135], v[136:139]
  ds_read_b64_tr_b16 a[206:207], v15 offset:61440
  v_mfma_f32_16x16x32_bf16 v[136:139], a[224:227], a[128:131], v[136:139]
  v_cvt_pk_bf16_f32 v84, v2, v3
  v_mfma_f32_16x16x32_bf16 v[140:143], a[240:243], a[128:131], 0
  s_xor_b32 s43, s48, 0x3400
  ds_read_b64_tr_b16 a[208:209], v16 offset:49152
  v_cvt_pk_bf16_f32 v85, v4, v5
  v_mfma_f32_16x16x32_bf16 v[140:143], a[244:247], a[132:135], v[140:143]
  s_waitcnt vmcnt(12)
  buffer_store_dwordx4 v[92:95], v26, s[24:27], s43 offen sc1
  v_mfma_f32_16x16x32_bf16 v[140:143], a[248:251], a[136:139], v[140:143]
  ds_read_b64_tr_b16 a[210:211], v16 offset:53248
  v_mfma_f32_16x16x32_bf16 v[140:143], a[252:255], a[140:143], v[140:143]
  v_exp_f32 v147, v147
  v_mfma_f32_16x16x32_bf16 v[156:159], a[252:255], a[156:159], 0
  ds_read_b64_tr_b16 a[212:213], v16 offset:57344
  v_cvt_pk_bf16_f32 v145, v146, v147
  v_mfma_f32_16x16x32_bf16 v[156:159], a[248:251], a[152:155], v[156:159]
  ds_read2_b64 v[6:9], v29 offset0:1 offset1:1
  v_mfma_f32_16x16x32_bf16 v[156:159], a[244:247], a[148:151], v[156:159]
  ds_read_b64_tr_b16 a[214:215], v16 offset:61440
  v_xor_b32 v29, 0x1000, v29
  v_mfma_f32_16x16x32_bf16 v[156:159], a[240:243], a[144:147], v[156:159]
  v_exp_f32 v148, v148
  v_mfma_f32_16x16x32_bf16 v[172:175], a[240:243], a[160:163], 0
  ds_read_b64_tr_b16 a[216:217], v17 offset:49152
  v_mfma_f32_16x16x32_bf16 v[172:175], a[244:247], a[164:167], v[172:175]
  v_exp_f32 v149, v149
  v_mfma_f32_16x16x32_bf16 v[172:175], a[248:251], a[168:171], v[172:175]
  s_add_u32 m0, s30, 33792
  s_xor_b32 s40, s32, 0x11400
  ds_read_b64_tr_b16 a[218:219], v17 offset:53248
  v_cvt_pk_bf16_f32 v146, v148, v149
  v_mfma_f32_16x16x32_bf16 v[172:175], a[252:255], a[172:175], v[172:175]
  s_waitcnt vmcnt(12)
  buffer_load_dwordx4 v23, s[16:19], s40 offen nt lds
  v_mfma_f32_16x16x32_bf16 v[188:191], a[252:255], a[188:191], 0
  ds_read_b64_tr_b16 a[220:221], v17 offset:57344
  v_mfma_f32_16x16x32_bf16 v[188:191], a[248:251], a[184:187], v[188:191]
  v_exp_f32 v150, v150
  v_mfma_f32_16x16x32_bf16 v[188:191], a[244:247], a[180:183], v[188:191]
  ds_read_b64_tr_b16 a[222:223], v17 offset:61440
  v_mfma_f32_16x16x32_bf16 v[188:191], a[240:243], a[176:179], v[188:191]
  v_exp_f32 v151, v151
  s_waitcnt lgkmcnt(5)
  v_mfma_f32_16x16x32_bf16 v[6:9], v[32:35], v[6:9], 0
  v_exp_f32 v160, v160
  v_mfma_f32_16x16x32_bf16 v[48:51], v[44:47], v[192:195], v[48:51]
  ds_read_b64_tr_b16 a[224:225], v18 offset:49152
  v_cvt_pk_bf16_f32 v147, v150, v151
  v_mfma_f32_16x16x32_bf16 v[48:51], v[44:47], v[200:203], v[48:51]
  v_exp_f32 v161, v161
  v_mfma_f32_16x16x32_bf16 v[52:55], v[44:47], v[208:211], v[52:55]
  ds_read_b64_tr_b16 a[226:227], v18 offset:53248
  v_cvt_pk_bf16_f32 v160, v160, v161
  v_mfma_f32_16x16x32_bf16 v[52:55], v[44:47], v[216:219], v[52:55]
  v_cvt_pk_bf16_f32 v86, v6, v7
  v_mfma_f32_16x16x32_bf16 v[56:59], v[44:47], v[224:227], v[56:59]
  ds_read_b64_tr_b16 a[228:229], v18 offset:57344
  v_cvt_pk_bf16_f32 v87, v8, v9
  v_mfma_f32_16x16x32_bf16 v[56:59], v[44:47], v[232:235], v[56:59]
  v_mov_b32 v252, 1
  v_mfma_f32_16x16x32_bf16 v[60:63], v[44:47], v[240:243], v[60:63]
  ds_read_b64_tr_b16 a[230:231], v18 offset:61440
  v_mfma_f32_16x16x32_bf16 v[60:63], v[44:47], v[248:251], v[60:63]
  s_waitcnt lgkmcnt(4)
  s_waitcnt vmcnt(12)
  buffer_atomic_add v252, v26, s[4:7], 0 offen sc0 sc1
  v_mfma_f32_16x16x32_bf16 a[96:99], v[248:251], a[196:199], a[96:99]
  ds_read_b64_tr_b16 a[232:233], v19 offset:49152
  v_mfma_f32_16x16x32_bf16 a[96:99], v[240:243], a[192:195], a[96:99]
  ds_read2_b64 v[2:5], v30 offset0:0 offset1:0
  v_mfma_f32_16x16x32_bf16 a[64:67], v[224:227], a[192:195], a[64:67]
  s_add_u32 m0, s30, 34816
  s_xor_b32 s40, s32, 0x1c00
  ds_read_b64_tr_b16 a[234:235], v19 offset:53248
  v_mfma_f32_16x16x32_bf16 a[64:67], v[232:235], a[196:199], a[64:67]
  s_waitcnt vmcnt(12)
  buffer_load_dwordx4 v24, s[16:19], s40 offen nt lds
  v_mfma_f32_16x16x32_bf16 a[32:35], v[216:219], a[196:199], a[32:35]
  ds_read_b64_tr_b16 a[236:237], v19 offset:57344
  v_mfma_f32_16x16x32_bf16 a[32:35], v[208:211], a[192:195], a[32:35]
  v_exp_f32 v162, v162
  v_mfma_f32_16x16x32_bf16 a[0:3], v[192:195], a[192:195], a[0:3]
  ds_read_b64_tr_b16 a[238:239], v19 offset:61440
  v_mfma_f32_16x16x32_bf16 a[0:3], v[200:203], a[196:199], a[0:3]
  v_exp_f32 v163, v163
  v_mfma_f32_16x16x32_bf16 a[4:7], v[200:203], a[204:207], a[4:7]
  ds_read_b64_tr_b16 a[240:241], v20 offset:49152
  v_cvt_pk_bf16_f32 v161, v162, v163
  v_mfma_f32_16x16x32_bf16 a[4:7], v[192:195], a[200:203], a[4:7]
  v_exp_f32 v164, v164
  v_mfma_f32_16x16x32_bf16 a[36:39], v[208:211], a[200:203], a[36:39]
  s_add_u32 m0, s30, 35840
  s_xor_b32 s40, s32, 0x1000
  ds_read_b64_tr_b16 a[242:243], v20 offset:53248
  v_mfma_f32_16x16x32_bf16 a[36:39], v[216:219], a[204:207], a[36:39]
  s_waitcnt vmcnt(12)
  buffer_load_dwordx4 v25, s[16:19], s40 offen nt lds
  s_waitcnt lgkmcnt(5)
  v_mfma_f32_16x16x32_bf16 v[2:5], v[32:35], v[2:5], 0
  v_exp_f32 v165, v165
  v_mfma_f32_16x16x32_bf16 a[68:71], v[232:235], a[204:207], a[68:71]
  ds_read_b64_tr_b16 a[244:245], v20 offset:57344
  v_cvt_pk_bf16_f32 v162, v164, v165
  v_mfma_f32_16x16x32_bf16 a[68:71], v[224:227], a[200:203], a[68:71]
  v_exp_f32 v166, v166
  v_mfma_f32_16x16x32_bf16 a[100:103], v[240:243], a[200:203], a[100:103]
  ds_read_b64_tr_b16 a[246:247], v20 offset:61440
  v_mfma_f32_16x16x32_bf16 a[100:103], v[248:251], a[204:207], a[100:103]
  v_cvt_pk_bf16_f32 v88, v2, v3
  v_mfma_f32_16x16x32_bf16 a[104:107], v[248:251], a[212:215], a[104:107]
  ds_read_b64_tr_b16 a[248:249], v21 offset:49152
  v_cvt_pk_bf16_f32 v89, v4, v5
  v_mfma_f32_16x16x32_bf16 a[104:107], v[240:243], a[208:211], a[104:107]
  v_exp_f32 v167, v167
  v_mfma_f32_16x16x32_bf16 a[72:75], v[224:227], a[208:211], a[72:75]
  ds_read_b64_tr_b16 a[250:251], v21 offset:53248
  v_cvt_pk_bf16_f32 v163, v166, v167
  v_mfma_f32_16x16x32_bf16 a[72:75], v[232:235], a[212:215], a[72:75]
  v_exp_f32 v176, v176
  v_mfma_f32_16x16x32_bf16 a[40:43], v[216:219], a[212:215], a[40:43]
  ds_read_b64_tr_b16 a[252:253], v21 offset:57344
  v_mfma_f32_16x16x32_bf16 a[40:43], v[208:211], a[208:211], a[40:43]
  ds_read2_b64 v[6:9], v30 offset0:1 offset1:1
  v_mfma_f32_16x16x32_bf16 a[8:11], v[192:195], a[208:211], a[8:11]
  s_xor_b32 s43, s48, 0xe800
  ds_read_b64_tr_b16 a[254:255], v21 offset:61440
  v_xor_b32 v30, 0x1000, v30
  v_mfma_f32_16x16x32_bf16 a[8:11], v[200:203], a[212:215], a[8:11]
  s_waitcnt vmcnt(12)
  buffer_store_dwordx4 v[96:99], v26, s[24:27], s43 offen sc1
  v_mfma_f32_16x16x32_bf16 a[12:15], v[200:203], a[220:223], a[12:15]
  v_exp_f32 v177, v177
  v_mfma_f32_16x16x32_bf16 a[12:15], v[192:195], a[216:219], a[12:15]
  v_exp_f32 v178, v178
  v_mfma_f32_16x16x32_bf16 a[44:47], v[208:211], a[216:219], a[44:47]
  v_exp_f32 v179, v179
  v_mfma_f32_16x16x32_bf16 a[44:47], v[216:219], a[220:223], a[44:47]
  s_waitcnt vmcnt(7) lgkmcnt(0)
  s_cmpk_lt_i32 s11, 0xfffa
  s_cbranch_scc0 L_fb2_7
  s_waitcnt vmcnt(3)
L_fb2_7:
  s_barrier
L_pg15:
  s_cbranch_execz L_rt2
  v_mfma_f32_16x16x32_bf16 a[76:79], v[232:235], a[220:223], a[76:79]
  ds_read_b128 a[192:195], v10 offset:16384
  v_cvt_pk_bf16_f32 v176, v176, v177
  v_mfma_f32_16x16x32_bf16 a[76:79], v[224:227], a[216:219], a[76:79]
  v_exp_f32 v180, v180
  v_mfma_f32_16x16x32_bf16 a[108:111], v[240:243], a[216:219], a[108:111]
  v_exp_f32 v181, v181
  v_mfma_f32_16x16x32_bf16 a[108:111], v[248:251], a[220:223], a[108:111]
  v_exp_f32 v182, v182
  v_mfma_f32_16x16x32_bf16 v[6:9], v[32:35], v[6:9], 0
  v_exp_f32 v183, v183
  v_mfma_f32_16x16x32_bf16 a[112:115], v[248:251], a[228:231], a[112:115]
  ds_read_b128 a[196:199], v11 offset:16384
  v_cvt_pk_bf16_f32 v177, v178, v179
  v_mfma_f32_16x16x32_bf16 a[112:115], v[240:243], a[224:227], a[112:115]
  s_add_u32 m0, s30, 81920
  s_xor_b32 s40, s32, 0x12400
  v_exp_f32 v136, v136
  v_mfma_f32_16x16x32_bf16 a[80:83], v[224:227], a[224:227], a[80:83]
  s_waitcnt vmcnt(12)
  buffer_load_dwordx4 v22, s[20:23], s40 offen nt lds
  v_mfma_f32_16x16x32_bf16 a[80:83], v[232:235], a[228:231], a[80:83]
  v_cvt_pk_bf16_f32 v90, v6, v7
  v_cvt_pk_bf16_f32 v178, v180, v181
  v_mfma_f32_16x16x32_bf16 a[48:51], v[216:219], a[228:231], a[48:51]
  ds_read_b128 a[200:203], v12 offset:16384
  v_cvt_pk_bf16_f32 v91, v8, v9
  v_mfma_f32_16x16x32_bf16 a[48:51], v[208:211], a[224:227], a[48:51]
  v_exp_f32 v137, v137
  v_mfma_f32_16x16x32_bf16 a[16:19], v[192:195], a[224:227], a[16:19]
  v_exp_f32 v138, v138
  v_mfma_f32_16x16x32_bf16 a[16:19], v[200:203], a[228:231], a[16:19]
  ds_read2_b64 v[2:5], v31 offset0:0 offset1:0
  v_cvt_pk_bf16_f32 v179, v182, v183
  v_mfma_f32_16x16x32_bf16 a[20:23], v[200:203], a[236:239], a[20:23]
  ds_read_b128 a[204:207], v13 offset:16384
  v_cvt_pk_bf16_f32 v136, v136, v137
  v_mfma_f32_16x16x32_bf16 a[20:23], v[192:195], a[232:235], a[20:23]
  v_exp_f32 v139, v139
  v_mfma_f32_16x16x32_bf16 a[52:55], v[208:211], a[232:235], a[52:55]
  v_exp_f32 v140, v140
  v_mfma_f32_16x16x32_bf16 a[52:55], v[216:219], a[236:239], a[52:55]
  v_exp_f32 v141, v141
  v_mfma_f32_16x16x32_bf16 a[84:87], v[232:235], a[236:239], a[84:87]
  ds_read_b128 a[208:211], v10 offset:20480
  v_cvt_pk_bf16_f32 v137, v138, v139
  v_mfma_f32_16x16x32_bf16 a[84:87], v[224:227], a[232:235], a[84:87]
  s_add_u32 m0, s30, 82944
  s_xor_b32 s40, s32, 0x12800
  v_exp_f32 v142, v142
  v_mfma_f32_16x16x32_bf16 a[116:119], v[240:243], a[232:235], a[116:119]
  s_waitcnt vmcnt(12)
  buffer_load_dwordx4 v23, s[20:23], s40 offen nt lds
  v_mfma_f32_16x16x32_bf16 a[116:119], v[248:251], a[236:239], a[116:119]
  v_exp_f32 v143, v143
  s_waitcnt lgkmcnt(2)
  v_mfma_f32_16x16x32_bf16 v[2:5], v[32:35], v[2:5], 0
  v_exp_f32 v152, v152
  v_mfma_f32_16x16x32_bf16 a[120:123], v[248:251], a[244:247], a[120:123]
  ds_read_b128 a[212:215], v11 offset:20480
  v_cvt_pk_bf16_f32 v138, v140, v141
  v_mfma_f32_16x16x32_bf16 a[120:123], v[240:243], a[240:243], a[120:123]
  v_exp_f32 v153, v153
  v_mfma_f32_16x16x32_bf16 a[88:91], v[224:227], a[240:243], a[88:91]
  v_exp_f32 v154, v154
  v_mfma_f32_16x16x32_bf16 a[88:91], v[232:235], a[244:247], a[88:91]
  v_cvt_pk_bf16_f32 v92, v2, v3
  v_cvt_pk_bf16_f32 v139, v142, v143
  v_mfma_f32_16x16x32_bf16 a[56:59], v[216:219], a[244:247], a[56:59]
  ds_read_b128 a[216:219], v12 offset:20480
  v_cvt_pk_bf16_f32 v93, v4, v5
  v_mfma_f32_16x16x32_bf16 a[56:59], v[208:211], a[240:243], a[56:59]
  v_exp_f32 v155, v155
  v_mfma_f32_16x16x32_bf16 a[24:27], v[192:195], a[240:243], a[24:27]
  v_exp_f32 v156, v156
  v_mfma_f32_16x16x32_bf16 a[24:27], v[200:203], a[244:247], a[24:27]
  v_exp_f32 v157, v157
  v_mfma_f32_16x16x32_bf16 a[28:31], v[200:203], a[252:255], a[28:31]
  ds_read_b128 a[220:223], v13 offset:20480
  v_cvt_pk_bf16_f32 v152, v152, v153
  v_mfma_f32_16x16x32_bf16 a[28:31], v[192:195], a[248:251], a[28:31]
  v_exp_f32 v158, v158
  v_mfma_f32_16x16x32_bf16 a[60:63], v[208:211], a[248:251], a[60:63]
  ds_read2_b64 v[6:9], v31 offset0:1 offset1:1
  v_cvt_pk_bf16_f32 v153, v154, v155
  v_mfma_f32_16x16x32_bf16 a[60:63], v[216:219], a[252:255], a[60:63]
  s_xor_b32 s43, s48, 0x8800
  v_xor_b32 v31, 0x1000, v31
  v_cvt_pk_bf16_f32 v154, v156, v157
  v_mfma_f32_16x16x32_bf16 a[92:95], v[232:235], a[252:255], a[92:95]
  s_waitcnt vmcnt(12)
  buffer_store_dwordx4 v[100:103], v26, s[24:27], s43 offen sc1
  v_mfma_f32_16x16x32_bf16 a[92:95], v[224:227], a[248:251], a[92:95]
  v_exp_f32 v159, v159
  v_mfma_f32_16x16x32_bf16 a[124:127], v[240:243], a[248:251], a[124:127]
  v_exp_f32 v168, v168
  v_mfma_f32_16x16x32_bf16 a[124:127], v[248:251], a[252:255], a[124:127]
  s_waitcnt lgkmcnt(1)
  v_exp_f32 v169, v169
  v_mfma_f32_16x16x32_bf16 v[240:243], a[192:195], a[176:179], 0
  v_exp_f32 v170, v170
  v_mfma_f32_16x16x32_bf16 v[240:243], a[196:199], a[180:183], v[240:243]
  ds_read_b128 a[224:227], v10 offset:24576
  v_cvt_pk_bf16_f32 v155, v158, v159
  v_mfma_f32_16x16x32_bf16 v[240:243], a[200:203], a[184:187], v[240:243]
  v_exp_f32 v171, v171
  v_mfma_f32_16x16x32_bf16 v[240:243], a[204:207], a[188:191], v[240:243]
  v_exp_f32 v172, v172
  s_waitcnt lgkmcnt(1)
  v_mfma_f32_16x16x32_bf16 v[6:9], v[32:35], v[6:9], 0
  v_exp_f32 v173, v173
  v_mfma_f32_16x16x32_bf16 v[224:227], a[204:207], a[172:175], 0
  s_add_u32 m0, s31, 4096
  s_xor_b32 s42, s34, 0xb800
  ds_read_b128 a[228:231], v11 offset:24576
  v_cvt_pk_bf16_f32 v168, v168, v169
  v_mfma_f32_16x16x32_bf16 v[224:227], a[200:203], a[168:171], v[224:227]
  s_waitcnt vmcnt(12)
  buffer_load_dwordx4 v22, s[12:15], s42 offen nt lds
  v_mfma_f32_16x16x32_bf16 v[224:227], a[196:199], a[164:167], v[224:227]
  v_exp_f32 v174, v174
  v_mfma_f32_16x16x32_bf16 v[224:227], a[192:195], a[160:163], v[224:227]
  ds_read_b128 a[232:235], v12 offset:24576
  v_cvt_pk_bf16_f32 v94, v6, v7
  v_mfma_f32_16x16x32_bf16 v[208:211], a[192:195], a[144:147], 0
  v_cvt_pk_bf16_f32 v95, v8, v9
  v_cvt_pk_bf16_f32 v169, v170, v171
  v_mfma_f32_16x16x32_bf16 v[208:211], a[196:199], a[148:151], v[208:211]
  v_exp_f32 v175, v175
  v_mfma_f32_16x16x32_bf16 v[208:211], a[200:203], a[152:155], v[208:211]
  ds_read_b128 a[236:239], v13 offset:24576
  v_cvt_pk_bf16_f32 v170, v172, v173
  v_mfma_f32_16x16x32_bf16 v[208:211], a[204:207], a[156:159], v[208:211]
  v_exp_f32 v184, v184
  v_mfma_f32_16x16x32_bf16 v[192:195], a[204:207], a[140:143], 0
  v_exp_f32 v185, v185
  v_mfma_f32_16x16x32_bf16 v[192:195], a[200:203], a[136:139], v[192:195]
  ds_read_b128 a[240:243], v10 offset:28672
  v_cvt_pk_bf16_f32 v171, v174, v175
  v_mfma_f32_16x16x32_bf16 v[192:195], a[196:199], a[132:135], v[192:195]
  s_waitcnt vmcnt(10)
  ds_read2_b64 v[2:5], v28 offset0:0 offset1:0
  v_cvt_pk_bf16_f32 v184, v184, v185
  v_mfma_f32_16x16x32_bf16 v[192:195], a[192:195], a[128:131], v[192:195]
  v_exp_f32 v186, v186
  v_mfma_f32_16x16x32_bf16 v[196:199], a[208:211], a[128:131], 0
  ds_read_b128 a[244:247], v11 offset:28672
  v_mfma_f32_16x16x32_bf16 v[196:199], a[212:215], a[132:135], v[196:199]
  s_add_u32 m0, s30, 83968
  s_xor_b32 s40, s32, 0x2000
  v_exp_f32 v187, v187
  v_mfma_f32_16x16x32_bf16 v[196:199], a[216:219], a[136:139], v[196:199]
  s_waitcnt vmcnt(12)
  buffer_load_dwordx4 v24, s[20:23], s40 offen nt lds
  v_mfma_f32_16x16x32_bf16 v[196:199], a[220:223], a[140:143], v[196:199]
  ds_read_b128 a[248:251], v12 offset:28672
  v_cvt_pk_bf16_f32 v185, v186, v187
  v_mfma_f32_16x16x32_bf16 v[212:215], a[220:223], a[156:159], 0
  v_exp_f32 v188, v188
  v_mfma_f32_16x16x32_bf16 v[212:215], a[216:219], a[152:155], v[212:215]
  v_exp_f32 v189, v189
  v_mfma_f32_16x16x32_bf16 v[212:215], a[212:215], a[148:151], v[212:215]
  ds_read_b128 a[252:255], v13 offset:28672
  v_cvt_pk_bf16_f32 v186, v188, v189
  v_mfma_f32_16x16x32_bf16 v[212:215], a[208:211], a[144:147], v[212:215]
  v_exp_f32 v190, v190
  s_waitcnt lgkmcnt(3)
  v_mfma_f32_16x16x32_bf16 v[2:5], v[32:35], v[2:5], 0
  v_exp_f32 v191, v191
  v_mfma_f32_16x16x32_bf16 v[228:231], a[208:211], a[160:163], 0
  v_exp_f32 v192, v192
  v_mfma_f32_16x16x32_bf16 v[228:231], a[212:215], a[164:167], v[228:231]
  v_exp_f32 v193, v193
  v_mfma_f32_16x16x32_bf16 v[228:231], a[216:219], a[168:171], v[228:231]
  v_exp_f32 v194, v194
  v_mfma_f32_16x16x32_bf16 v[228:231], a[220:223], a[172:175], v[228:231]
  v_cvt_pk_bf16_f32 v96, v2, v3
  v_cvt_pk_bf16_f32 v187, v190, v191
  v_mfma_f32_16x16x32_bf16 v[244:247], a[220:223], a[188:191], 0
  s_add_u32 m0, s31, 5120
  s_xor_b32 s42, s34, 0xd800
  v_cvt_pk_bf16_f32 v97, v4, v5
  v_cvt_pk_bf16_f32 v192, v192, v193
  v_mfma_f32_16x16x32_bf16 v[244:247], a[216:219], a[184:187], v[244:247]
  s_waitcnt vmcnt(12)
  buffer_load_dwordx4 v23, s[12:15], s42 offen nt lds
  v_mfma_f32_16x16x32_bf16 v[244:247], a[212:215], a[180:183], v[244:247]
  v_exp_f32 v195, v195
  v_mfma_f32_16x16x32_bf16 v[244:247], a[208:211], a[176:179], v[244:247]
  s_waitcnt vmcnt(7) lgkmcnt(0)
  s_cmpk_lt_i32 s8, 0x0
  s_cbranch_scc0 L_fb2_8
  s_waitcnt vmcnt(3)
L_fb2_8:
  s_barrier
  v_mfma_f32_16x16x32_bf16 v[248:251], a[224:227], a[176:179], 0
  ds_read_b64_tr_b16 a[192:193], v14
  v_cvt_pk_bf16_f32 v193, v194, v195
  v_mfma_f32_16x16x32_bf16 v[248:251], a[228:231], a[180:183], v[248:251]
  ds_read2_b64 v[6:9], v28 offset0:1 offset1:1
  v_mfma_f32_16x16x32_bf16 v[248:251], a[232:235], a[184:187], v[248:251]
  ds_read_b64_tr_b16 a[194:195], v14 offset:4096
  v_xor_b32 v28, 0x1000, v28
  v_mfma_f32_16x16x32_bf16 v[248:251], a[236:239], a[188:191], v[248:251]
  v_exp_f32 v196, v196
  v_mfma_f32_16x16x32_bf16 v[232:235], a[236:239], a[172:175], 0
  ds_read_b64_tr_b16 a[196:197], v14 offset:8192
  v_mfma_f32_16x16x32_bf16 v[232:235], a[232:235], a[168:171], v[232:235]
  v_exp_f32 v197, v197
  v_mfma_f32_16x16x32_bf16 v[232:235], a[228:231], a[164:167], v[232:235]
  ds_read_b64_tr_b16 a[198:199], v14 offset:12288
  v_cvt_pk_bf16_f32 v194, v196, v197
  v_mfma_f32_16x16x32_bf16 v[232:235], a[224:227], a[160:163], v[232:235]
  v_exp_f32 v198, v198
  v_mfma_f32_16x16x32_bf16 v[216:219], a[224:227], a[144:147], 0
  ds_read_b64_tr_b16 a[200:201], v15
  v_mfma_f32_16x16x32_bf16 v[216:219], a[228:231], a[148:151], v[216:219]
  v_exp_f32 v199, v199
  v_mfma_f32_16x16x32_bf16 v[216:219], a[232:235], a[152:155], v[216:219]
  s_add_u32 m0, s30, 84992
  s_xor_b32 s40, s32, 0x2c00
  ds_read_b64_tr_b16 a[202:203], v15 offset:4096
  v_cvt_pk_bf16_f32 v195, v198, v199
  v_mfma_f32_16x16x32_bf16 v[216:219], a[236:239], a[156:159], v[216:219]
  s_waitcnt vmcnt(12)
  buffer_load_dwordx4 v25, s[20:23], s40 offen nt lds
  s_waitcnt lgkmcnt(5)
  v_mfma_f32_16x16x32_bf16 v[6:9], v[32:35], v[6:9], 0
  v_exp_f32 v208, v208
  v_mfma_f32_16x16x32_bf16 v[200:203], a[236:239], a[140:143], 0
  ds_read_b64_tr_b16 a[204:205], v15 offset:8192
  v_mfma_f32_16x16x32_bf16 v[200:203], a[232:235], a[136:139], v[200:203]
  v_exp_f32 v209, v209
  v_mfma_f32_16x16x32_bf16 v[200:203], a[228:231], a[132:135], v[200:203]
  ds_read_b64_tr_b16 a[206:207], v15 offset:12288
  v_cvt_pk_bf16_f32 v208, v208, v209
  v_mfma_f32_16x16x32_bf16 v[200:203], a[224:227], a[128:131], v[200:203]
  v_cvt_pk_bf16_f32 v98, v6, v7
  v_mfma_f32_16x16x32_bf16 v[204:207], a[240:243], a[128:131], 0
  ds_read_b64_tr_b16 a[208:209], v16
  v_cvt_pk_bf16_f32 v99, v8, v9
  v_mfma_f32_16x16x32_bf16 v[204:207], a[244:247], a[132:135], v[204:207]
  v_exp_f32 v210, v210
  v_mfma_f32_16x16x32_bf16 v[204:207], a[248:251], a[136:139], v[204:207]
  ds_read_b64_tr_b16 a[210:211], v16 offset:4096
  v_mfma_f32_16x16x32_bf16 v[204:207], a[252:255], a[140:143], v[204:207]
  s_waitcnt vmcnt(10)
  v_readfirstlane_b32 s44, v252
  v_mfma_f32_16x16x32_bf16 v[220:223], a[252:255], a[156:159], 0
  ds_read_b64_tr_b16 a[212:213], v16 offset:8192
  v_mfma_f32_16x16x32_bf16 v[220:223], a[248:251], a[152:155], v[220:223]
  s_sub_u32 s44, s44, s49
  s_add_u32 s49, s49, 64
  s_sub_i32 s8, s44, s98
  s_sub_i32 s9, s44, s99
  s_sub_i32 s10, s44, s100
  s_sub_i32 s11, s44, s101
  ds_read2_b64 v[2:5], v29 offset0:0 offset1:0
  v_mfma_f32_16x16x32_bf16 v[220:223], a[244:247], a[148:151], v[220:223]
  s_add_u32 m0, s31, 6144
  s_xor_b32 s42, s34, 0xbc00
  ds_read_b64_tr_b16 a[214:215], v16 offset:12288
  v_mfma_f32_16x16x32_bf16 v[220:223], a[240:243], a[144:147], v[220:223]
  s_waitcnt vmcnt(12)
  buffer_load_dwordx4 v24, s[12:15], s42 offen nt lds
  v_mfma_f32_16x16x32_bf16 v[236:239], a[240:243], a[160:163], 0
  ds_read_b64_tr_b16 a[216:217], v17
  v_mfma_f32_16x16x32_bf16 v[236:239], a[244:247], a[164:167], v[236:239]
  v_exp_f32 v211, v211
  v_mfma_f32_16x16x32_bf16 v[236:239], a[248:251], a[168:171], v[236:239]
  ds_read_b64_tr_b16 a[218:219], v17 offset:4096
  v_cvt_pk_bf16_f32 v209, v210, v211
  v_mfma_f32_16x16x32_bf16 v[236:239], a[252:255], a[172:175], v[236:239]
  v_exp_f32 v212, v212
  v_mfma_f32_16x16x32_bf16 v[252:255], a[252:255], a[188:191], 0
  ds_read_b64_tr_b16 a[220:221], v17 offset:8192
  v_mfma_f32_16x16x32_bf16 v[252:255], a[248:251], a[184:187], v[252:255]
  v_exp_f32 v213, v213
  v_mfma_f32_16x16x32_bf16 v[252:255], a[244:247], a[180:183], v[252:255]
  ds_read_b64_tr_b16 a[222:223], v17 offset:12288
  v_cvt_pk_bf16_f32 v210, v212, v213
  v_mfma_f32_16x16x32_bf16 v[252:255], a[240:243], a[176:179], v[252:255]
  v_exp_f32 v214, v214
  s_waitcnt lgkmcnt(5)
  v_mfma_f32_16x16x32_bf16 v[2:5], v[32:35], v[2:5], 0
  v_exp_f32 v215, v215
  v_mfma_f32_16x16x32_bf16 v[48:51], v[44:47], v[128:131], v[48:51]
  s_xor_b32 s43, s48, 0xec00
  ds_read_b64_tr_b16 a[224:225], v18
  v_cvt_pk_bf16_f32 v211, v214, v215
  v_mfma_f32_16x16x32_bf16 v[48:51], v[44:47], v[136:139], v[48:51]
  s_waitcnt vmcnt(12)
  buffer_store_dwordx4 v[104:107], v26, s[24:27], s43 offen sc1
  v_mfma_f32_16x16x32_bf16 v[52:55], v[44:47], v[144:147], v[52:55]
  ds_read_b64_tr_b16 a[226:227], v18 offset:4096
  v_mfma_f32_16x16x32_bf16 v[52:55], v[44:47], v[152:155], v[52:55]
  v_cvt_pk_bf16_f32 v100, v2, v3
  v_mfma_f32_16x16x32_bf16 v[56:59], v[44:47], v[160:163], v[56:59]
  ds_read_b64_tr_b16 a[228:229], v18 offset:8192
  v_cvt_pk_bf16_f32 v101, v4, v5
  v_mfma_f32_16x16x32_bf16 v[56:59], v[44:47], v[168:171], v[56:59]
  v_exp_f32 v224, v224
  v_mfma_f32_16x16x32_bf16 v[60:63], v[44:47], v[176:179], v[60:63]
  ds_read_b64_tr_b16 a[230:231], v18 offset:12288
  v_mfma_f32_16x16x32_bf16 v[60:63], v[44:47], v[184:187], v[60:63]
  s_waitcnt lgkmcnt(4)
  ds_read2_b64 v[6:9], v29 offset0:1 offset1:1
  v_mfma_f32_16x16x32_bf16 a[96:99], v[184:187], a[196:199], a[96:99]
  ds_read_b64_tr_b16 a[232:233], v19
  v_xor_b32 v29, 0x1000, v29
  v_mfma_f32_16x16x32_bf16 a[96:99], v[176:179], a[192:195], a[96:99]
  v_exp_f32 v225, v225
  v_mfma_f32_16x16x32_bf16 a[64:67], v[160:163], a[192:195], a[64:67]
  ds_read_b64_tr_b16 a[234:235], v19 offset:4096
  v_cvt_pk_bf16_f32 v224, v224, v225
  v_mfma_f32_16x16x32_bf16 a[64:67], v[168:171], a[196:199], a[64:67]
  v_exp_f32 v226, v226
  v_mfma_f32_16x16x32_bf16 a[32:35], v[152:155], a[196:199], a[32:35]
  s_add_u32 m0, s31, 7168
  s_xor_b32 s42, s34, 0xdc00
  ds_read_b64_tr_b16 a[236:237], v19 offset:8192
  v_mfma_f32_16x16x32_bf16 a[32:35], v[144:147], a[192:195], a[32:35]
  s_waitcnt vmcnt(12)
  buffer_load_dwordx4 v25, s[12:15], s42 offen nt lds
  v_mfma_f32_16x16x32_bf16 a[0:3], v[128:131], a[192:195], a[0:3]
  ds_read_b64_tr_b16 a[238:239], v19 offset:12288
  v_mfma_f32_16x16x32_bf16 a[0:3], v[136:139], a[196:199], a[0:3]
  v_exp_f32 v227, v227
  s_waitcnt lgkmcnt(4)
  v_mfma_f32_16x16x32_bf16 v[6:9], v[32:35], v[6:9], 0
  v_exp_f32 v228, v228
  v_mfma_f32_16x16x32_bf16 a[4:7], v[136:139], a[204:207], a[4:7]
  ds_read_b64_tr_b16 a[240:241], v20
  v_cvt_pk_bf16_f32 v225, v226, v227
  v_mfma_f32_16x16x32_bf16 a[4:7], v[128:131], a[200:203], a[4:7]
  v_exp_f32 v229, v229
  v_mfma_f32_16x16x32_bf16 a[36:39], v[144:147], a[200:203], a[36:39]
  ds_read_b64_tr_b16 a[242:243], v20 offset:4096
  v_cvt_pk_bf16_f32 v226, v228, v229
  v_mfma_f32_16x16x32_bf16 a[36:39], v[152:155], a[204:207], a[36:39]
  v_cvt_pk_bf16_f32 v102, v6, v7
  v_mfma_f32_16x16x32_bf16 a[68:71], v[168:171], a[204:207], a[68:71]
  ds_read_b64_tr_b16 a[244:245], v20 offset:8192
  v_cvt_pk_bf16_f32 v103, v8, v9
  v_mfma_f32_16x16x32_bf16 a[68:71], v[160:163], a[200:203], a[68:71]
  v_exp_f32 v230, v230
  v_mfma_f32_16x16x32_bf16 a[100:103], v[176:179], a[200:203], a[100:103]
  ds_read_b64_tr_b16 a[246:247], v20 offset:12288
  v_mfma_f32_16x16x32_bf16 a[100:103], v[184:187], a[204:207], a[100:103]
  v_exp_f32 v231, v231
  v_mfma_f32_16x16x32_bf16 a[104:107], v[184:187], a[212:215], a[104:107]
  s_add_u32 m0, s30, 49152
  s_xor_b32 s40, s32, 0x11c00
  ds_read_b64_tr_b16 a[248:249], v21
  v_cvt_pk_bf16_f32 v227, v230, v231
  v_mfma_f32_16x16x32_bf16 a[104:107], v[176:179], a[208:211], a[104:107]
  s_waitcnt vmcnt(12)
  buffer_load_dwordx4 v22, s[16:19], s40 offen nt lds
  v_mfma_f32_16x16x32_bf16 a[72:75], v[160:163], a[208:211], a[72:75]
  ds_read_b64_tr_b16 a[250:251], v21 offset:4096
  v_mfma_f32_16x16x32_bf16 a[72:75], v[168:171], a[212:215], a[72:75]
  ds_read2_b64 v[2:5], v30 offset0:0 offset1:0
  v_mfma_f32_16x16x32_bf16 a[40:43], v[152:155], a[212:215], a[40:43]
  ds_read_b64_tr_b16 a[252:253], v21 offset:8192
  v_mfma_f32_16x16x32_bf16 a[40:43], v[144:147], a[208:211], a[40:43]
  v_exp_f32 v240, v240
  v_mfma_f32_16x16x32_bf16 a[8:11], v[128:131], a[208:211], a[8:11]
  ds_read_b64_tr_b16 a[254:255], v21 offset:12288
  v_mfma_f32_16x16x32_bf16 a[8:11], v[136:139], a[212:215], a[8:11]
  v_exp_f32 v241, v241
  v_mfma_f32_16x16x32_bf16 a[12:15], v[136:139], a[220:223], a[12:15]
  v_exp_f32 v242, v242
  v_mfma_f32_16x16x32_bf16 a[12:15], v[128:131], a[216:219], a[12:15]
  v_exp_f32 v243, v243
  v_mfma_f32_16x16x32_bf16 a[44:47], v[144:147], a[216:219], a[44:47]
  v_exp_f32 v244, v244
  v_mfma_f32_16x16x32_bf16 a[44:47], v[152:155], a[220:223], a[44:47]
  s_waitcnt vmcnt(7) lgkmcnt(0)
  s_cmpk_lt_i32 s9, 0x0
  s_cbranch_scc0 L_fb2_9
  s_waitcnt vmcnt(3)
L_fb2_9:
  s_barrier
  v_mfma_f32_16x16x32_bf16 a[76:79], v[168:171], a[220:223], a[76:79]
  s_add_u32 m0, s30, 50176
  s_xor_b32 s40, s32, 0x11000
  ds_read_b128 a[192:195], v10 offset:32768
  v_cvt_pk_bf16_f32 v240, v240, v241
  v_mfma_f32_16x16x32_bf16 a[76:79], v[160:163], a[216:219], a[76:79]
  s_waitcnt vmcnt(12)
  buffer_load_dwordx4 v23, s[16:19], s40 offen nt lds
  v_mfma_f32_16x16x32_bf16 a[108:111], v[176:179], a[216:219], a[108:111]
  v_exp_f32 v245, v245
  v_mfma_f32_16x16x32_bf16 a[108:111], v[184:187], a[220:223], a[108:111]
  v_exp_f32 v246, v246
  v_mfma_f32_16x16x32_bf16 v[2:5], v[32:35], v[2:5], 0
  v_exp_f32 v247, v247
  v_mfma_f32_16x16x32_bf16 a[112:115], v[184:187], a[228:231], a[112:115]
  ds_read_b128 a[196:199], v11 offset:32768
  v_cvt_pk_bf16_f32 v241, v242, v243
  v_mfma_f32_16x16x32_bf16 a[112:115], v[176:179], a[224:227], a[112:115]
  v_exp_f32 v200, v200
  v_mfma_f32_16x16x32_bf16 a[80:83], v[160:163], a[224:227], a[80:83]
  v_exp_f32 v201, v201
  v_mfma_f32_16x16x32_bf16 a[80:83], v[168:171], a[228:231], a[80:83]
  v_cvt_pk_bf16_f32 v104, v2, v3
  v_cvt_pk_bf16_f32 v242, v244, v245
  v_mfma_f32_16x16x32_bf16 a[48:51], v[152:155], a[228:231], a[48:51]
  ds_read_b128 a[200:203], v12 offset:32768
  v_cvt_pk_bf16_f32 v105, v4, v5
  v_mfma_f32_16x16x32_bf16 a[48:51], v[144:147], a[224:227], a[48:51]
  v_exp_f32 v202, v202
  v_mfma_f32_16x16x32_bf16 a[16:19], v[128:131], a[224:227], a[16:19]
  ds_read2_b64 v[6:9], v30 offset0:1 offset1:1
  v_cvt_pk_bf16_f32 v243, v246, v247
  v_mfma_f32_16x16x32_bf16 a[16:19], v[136:139], a[228:231], a[16:19]
  v_xor_b32 v30, 0x1000, v30
  v_cvt_pk_bf16_f32 v200, v200, v201
  v_mfma_f32_16x16x32_bf16 a[20:23], v[136:139], a[236:239], a[20:23]
  s_xor_b32 s43, s48, 0x8c00
  ds_read_b128 a[204:207], v13 offset:32768
  v_mfma_f32_16x16x32_bf16 a[20:23], v[128:131], a[232:235], a[20:23]
  s_waitcnt vmcnt(12)
  buffer_store_dwordx4 v[108:111], v26, s[24:27], s43 offen sc1
  v_mfma_f32_16x16x32_bf16 a[52:55], v[144:147], a[232:235], a[52:55]
  v_exp_f32 v203, v203
  v_mfma_f32_16x16x32_bf16 a[52:55], v[152:155], a[236:239], a[52:55]
  v_exp_f32 v204, v204
  v_mfma_f32_16x16x32_bf16 a[84:87], v[168:171], a[236:239], a[84:87]
  ds_read_b128 a[208:211], v10 offset:36864
  v_cvt_pk_bf16_f32 v201, v202, v203
  v_mfma_f32_16x16x32_bf16 a[84:87], v[160:163], a[232:235], a[84:87]
  v_exp_f32 v205, v205
  v_mfma_f32_16x16x32_bf16 a[116:119], v[176:179], a[232:235], a[116:119]
  v_exp_f32 v206, v206
  v_mfma_f32_16x16x32_bf16 a[116:119], v[184:187], a[236:239], a[116:119]
  v_exp_f32 v207, v207
  s_waitcnt lgkmcnt(2)
  v_mfma_f32_16x16x32_bf16 v[6:9], v[32:35], v[6:9], 0
  v_exp_f32 v216, v216
  v_mfma_f32_16x16x32_bf16 a[120:123], v[184:187], a[244:247], a[120:123]
  ds_read_b128 a[212:215], v11 offset:36864
  v_cvt_pk_bf16_f32 v202, v204, v205
  v_mfma_f32_16x16x32_bf16 a[120:123], v[176:179], a[240:243], a[120:123]
  v_exp_f32 v217, v217
  v_mfma_f32_16x16x32_bf16 a[88:91], v[160:163], a[240:243], a[88:91]
  v_exp_f32 v218, v218
  v_mfma_f32_16x16x32_bf16 a[88:91], v[168:171], a[244:247], a[88:91]
  v_cvt_pk_bf16_f32 v106, v6, v7
  v_cvt_pk_bf16_f32 v203, v206, v207
  v_mfma_f32_16x16x32_bf16 a[56:59], v[152:155], a[244:247], a[56:59]
  s_add_u32 m0, s30, 51200
  s_xor_b32 s40, s32, 0x1800
  ds_read_b128 a[216:219], v12 offset:36864
  v_cvt_pk_bf16_f32 v107, v8, v9
  v_mfma_f32_16x16x32_bf16 a[56:59], v[144:147], a[240:243], a[56:59]
  s_waitcnt vmcnt(12)
  buffer_load_dwordx4 v24, s[16:19], s40 offen nt lds
  v_mfma_f32_16x16x32_bf16 a[24:27], v[128:131], a[240:243], a[24:27]
  v_exp_f32 v219, v219
  v_mfma_f32_16x16x32_bf16 a[24:27], v[136:139], a[244:247], a[24:27]
  v_exp_f32 v220, v220
  v_mfma_f32_16x16x32_bf16 a[28:31], v[136:139], a[252:255], a[28:31]
  ds_read_b128 a[220:223], v13 offset:36864
  v_cvt_pk_bf16_f32 v216, v216, v217
  v_mfma_f32_16x16x32_bf16 a[28:31], v[128:131], a[248:251], a[28:31]
  ds_read2_b64 v[2:5], v31 offset0:0 offset1:0
  v_cvt_pk_bf16_f32 v217, v218, v219
  v_mfma_f32_16x16x32_bf16 a[60:63], v[144:147], a[248:251], a[60:63]
  v_exp_f32 v221, v221
  v_mfma_f32_16x16x32_bf16 a[60:63], v[152:155], a[252:255], a[60:63]
  v_exp_f32 v222, v222
  v_mfma_f32_16x16x32_bf16 a[92:95], v[168:171], a[252:255], a[92:95]
  v_exp_f32 v223, v223
  v_mfma_f32_16x16x32_bf16 a[92:95], v[160:163], a[248:251], a[92:95]
  v_exp_f32 v232, v232
  v_mfma_f32_16x16x32_bf16 a[124:127], v[176:179], a[248:251], a[124:127]
  v_exp_f32 v233, v233
  v_mfma_f32_16x16x32_bf16 a[124:127], v[184:187], a[252:255], a[124:127]
  s_waitcnt lgkmcnt(1)
  v_exp_f32 v234, v234
  v_mfma_f32_16x16x32_bf16 v[176:179], a[192:195], a[176:179], 0
  v_exp_f32 v235, v235
  v_mfma_f32_16x16x32_bf16 v[176:179], a[196:199], a[180:183], v[176:179]
  s_add_u32 m0, s30, 52224
  s_xor_b32 s40, s32, 0x1400
  ds_read_b128 a[224:227], v10 offset:40960
  v_cvt_pk_bf16_f32 v218, v220, v221
  v_mfma_f32_16x16x32_bf16 v[176:179], a[200:203], a[184:187], v[176:179]
  s_waitcnt vmcnt(12)
  buffer_load_dwordx4 v25, s[16:19], s40 offen nt lds
  v_mfma_f32_16x16x32_bf16 v[176:179], a[204:207], a[188:191], v[176:179]
  v_exp_f32 v236, v236
  s_waitcnt lgkmcnt(1)
  v_mfma_f32_16x16x32_bf16 v[2:5], v[32:35], v[2:5], 0
  v_exp_f32 v237, v237
  v_mfma_f32_16x16x32_bf16 v[160:163], a[204:207], a[172:175], 0
  ds_read_b128 a[228:231], v11 offset:40960
  v_cvt_pk_bf16_f32 v219, v222, v223
  v_mfma_f32_16x16x32_bf16 v[160:163], a[200:203], a[168:171], v[160:163]
  v_exp_f32 v238, v238
  v_mfma_f32_16x16x32_bf16 v[160:163], a[196:199], a[164:167], v[160:163]
  v_exp_f32 v239, v239
  v_mfma_f32_16x16x32_bf16 v[160:163], a[192:195], a[160:163], v[160:163]
  ds_read_b128 a[232:235], v12 offset:40960
  v_cvt_pk_bf16_f32 v108, v2, v3
  v_mfma_f32_16x16x32_bf16 v[144:147], a[192:195], a[144:147], 0
  v_cvt_pk_bf16_f32 v109, v4, v5
  v_cvt_pk_bf16_f32 v232, v232, v233
  v_mfma_f32_16x16x32_bf16 v[144:147], a[196:199], a[148:151], v[144:147]
  v_exp_f32 v248, v248
  v_mfma_f32_16x16x32_bf16 v[144:147], a[200:203], a[152:155], v[144:147]
  ds_read_b128 a[236:239], v13 offset:40960
  v_cvt_pk_bf16_f32 v233, v234, v235
  v_mfma_f32_16x16x32_bf16 v[144:147], a[204:207], a[156:159], v[144:147]
  v_exp_f32 v249, v249
  v_mfma_f32_16x16x32_bf16 v[128:131], a[204:207], a[140:143], 0
  ds_read2_b64 v[6:9], v31 offset0:1 offset1:1
  v_cvt_pk_bf16_f32 v234, v236, v237
  v_mfma_f32_16x16x32_bf16 v[128:131], a[200:203], a[136:139], v[128:131]
  s_xor_b32 s43, s48, 0xb800
  ds_read_b128 a[240:243], v10 offset:45056
  v_xor_b32 v31, 0x1000, v31
  v_mfma_f32_16x16x32_bf16 v[128:131], a[196:199], a[132:135], v[128:131]
  s_waitcnt vmcnt(12)
  buffer_store_dwordx4 v[112:115], v26, s[24:27], s43 offen sc1
  v_mfma_f32_16x16x32_bf16 v[128:131], a[192:195], a[128:131], v[128:131]
  v_exp_f32 v250, v250
  v_mfma_f32_16x16x32_bf16 v[132:135], a[208:211], a[128:131], 0
  ds_read_b128 a[244:247], v11 offset:45056
  v_cvt_pk_bf16_f32 v235, v238, v239
  v_mfma_f32_16x16x32_bf16 v[132:135], a[212:215], a[132:135], v[132:135]
  v_exp_f32 v251, v251
  v_mfma_f32_16x16x32_bf16 v[132:135], a[216:219], a[136:139], v[132:135]
  v_exp_f32 v252, v252
  v_mfma_f32_16x16x32_bf16 v[132:135], a[220:223], a[140:143], v[132:135]
  ds_read_b128 a[248:251], v12 offset:45056
  v_cvt_pk_bf16_f32 v248, v248, v249
  v_mfma_f32_16x16x32_bf16 v[148:151], a[220:223], a[156:159], 0
  v_exp_f32 v253, v253
  v_mfma_f32_16x16x32_bf16 v[148:151], a[216:219], a[152:155], v[148:151]
  v_exp_f32 v254, v254
  v_mfma_f32_16x16x32_bf16 v[148:151], a[212:215], a[148:151], v[148:151]
  ds_read_b128 a[252:255], v13 offset:45056
  v_cvt_pk_bf16_f32 v249, v250, v251
  v_mfma_f32_16x16x32_bf16 v[148:151], a[208:211], a[144:147], v[148:151]
  s_add_u32 m0, s30, 98304
  s_xor_b32 s40, s32, 0x11800
  v_exp_f32 v255, v255
  s_waitcnt lgkmcnt(4)
  v_mfma_f32_16x16x32_bf16 v[6:9], v[32:35], v[6:9], 0
  v_cvt_pk_bf16_f32 v250, v252, v253
  v_cvt_pk_bf16_f32 v251, v254, v255
  v_mfma_f32_16x16x32_bf16 v[164:167], a[208:211], a[160:163], 0
  s_waitcnt vmcnt(12)
  buffer_load_dwordx4 v22, s[20:23], s40 offen nt lds
  v_mfma_f32_16x16x32_bf16 v[164:167], a[212:215], a[164:167], v[164:167]
  v_exp_f32 v128, v128
  v_mfma_f32_16x16x32_bf16 v[164:167], a[216:219], a[168:171], v[164:167]
  v_exp_f32 v129, v129
  v_mfma_f32_16x16x32_bf16 v[164:167], a[220:223], a[172:175], v[164:167]
  v_cvt_pk_bf16_f32 v110, v6, v7
  v_cvt_pk_bf16_f32 v128, v128, v129
  v_mfma_f32_16x16x32_bf16 v[180:183], a[220:223], a[188:191], 0
  v_cvt_pk_bf16_f32 v111, v8, v9
  v_mfma_f32_16x16x32_bf16 v[180:183], a[216:219], a[184:187], v[180:183]
  v_exp_f32 v130, v130
  v_mfma_f32_16x16x32_bf16 v[180:183], a[212:215], a[180:183], v[180:183]
  v_exp_f32 v131, v131
  v_mfma_f32_16x16x32_bf16 v[180:183], a[208:211], a[176:179], v[180:183]
  s_waitcnt vmcnt(7) lgkmcnt(0)
  s_cmpk_lt_i32 s10, 0x0
  s_cbranch_scc0 L_fb2_10
  s_waitcnt vmcnt(3)
L_fb2_10:
  s_barrier
  v_mfma_f32_16x16x32_bf16 v[184:187], a[224:227], a[176:179], 0
  ds_read_b64_tr_b16 a[192:193], v14 offset:16384
  v_cvt_pk_bf16_f32 v129, v130, v131
  v_mfma_f32_16x16x32_bf16 v[184:187], a[228:231], a[180:183], v[184:187]
  s_waitcnt vmcnt(7)
  ds_read2_b64 v[2:5], v28 offset0:0 offset1:0
  v_mfma_f32_16x16x32_bf16 v[184:187], a[232:235], a[184:187], v[184:187]
  ds_read_b64_tr_b16 a[194:195], v14 offset:20480
  v_mfma_f32_16x16x32_bf16 v[184:187], a[236:239], a[188:191], v[184:187]
  v_exp_f32 v132, v132
  v_mfma_f32_16x16x32_bf16 v[168:171], a[236:239], a[172:175], 0
  s_add_u32 m0, s30, 99328
  s_xor_b32 s40, s32, 0x11400
  ds_read_b64_tr_b16 a[196:197], v14 offset:24576
  v_mfma_f32_16x16x32_bf16 v[168:171], a[232:235], a[168:171], v[168:171]
  s_waitcnt vmcnt(12)
  buffer_load_dwordx4 v23, s[20:23], s40 offen nt lds
  v_mfma_f32_16x16x32_bf16 v[168:171], a[228:231], a[164:167], v[168:171]
  ds_read_b64_tr_b16 a[198:199], v14 offset:28672
L_pg16:
  s_cbranch_execz L_rt3
  v_mfma_f32_16x16x32_bf16 v[168:171], a[224:227], a[160:163], v[168:171]
  v_exp_f32 v133, v133
  v_mfma_f32_16x16x32_bf16 v[152:155], a[224:227], a[144:147], 0
  ds_read_b64_tr_b16 a[200:201], v15 offset:16384
  v_cvt_pk_bf16_f32 v130, v132, v133
  v_mfma_f32_16x16x32_bf16 v[152:155], a[228:231], a[148:151], v[152:155]
  v_exp_f32 v134, v134
  v_mfma_f32_16x16x32_bf16 v[152:155], a[232:235], a[152:155], v[152:155]
  ds_read_b64_tr_b16 a[202:203], v15 offset:20480
  v_mfma_f32_16x16x32_bf16 v[152:155], a[236:239], a[156:159], v[152:155]
  v_exp_f32 v135, v135
  s_waitcnt lgkmcnt(5)
  v_mfma_f32_16x16x32_bf16 v[2:5], v[32:35], v[2:5], 0
  v_exp_f32 v144, v144
  v_mfma_f32_16x16x32_bf16 v[136:139], a[236:239], a[140:143], 0
  ds_read_b64_tr_b16 a[204:205], v15 offset:24576
  v_cvt_pk_bf16_f32 v131, v134, v135
  v_mfma_f32_16x16x32_bf16 v[136:139], a[232:235], a[136:139], v[136:139]
  v_exp_f32 v145, v145
  v_mfma_f32_16x16x32_bf16 v[136:139], a[228:231], a[132:135], v[136:139]
  ds_read_b64_tr_b16 a[206:207], v15 offset:28672
  v_cvt_pk_bf16_f32 v144, v144, v145
  v_mfma_f32_16x16x32_bf16 v[136:139], a[224:227], a[128:131], v[136:139]
  v_cvt_pk_bf16_f32 v112, v2, v3
  v_mfma_f32_16x16x32_bf16 v[140:143], a[240:243], a[128:131], 0
  s_add_u32 m0, s30, 100352
  s_xor_b32 s40, s32, 0x1c00
  ds_read_b64_tr_b16 a[208:209], v16 offset:16384
  v_cvt_pk_bf16_f32 v113, v4, v5
  v_mfma_f32_16x16x32_bf16 v[140:143], a[244:247], a[132:135], v[140:143]
  s_waitcnt vmcnt(12)
  buffer_load_dwordx4 v24, s[20:23], s40 offen nt lds
  v_mfma_f32_16x16x32_bf16 v[140:143], a[248:251], a[136:139], v[140:143]
  ds_read_b64_tr_b16 a[210:211], v16 offset:20480
  v_mfma_f32_16x16x32_bf16 v[140:143], a[252:255], a[140:143], v[140:143]
  ds_read2_b64 v[6:9], v28 offset0:1 offset1:1
  v_mfma_f32_16x16x32_bf16 v[156:159], a[252:255], a[156:159], 0
  ds_read_b64_tr_b16 a[212:213], v16 offset:24576
  v_xor_b32 v28, 0x1000, v28
  v_mfma_f32_16x16x32_bf16 v[156:159], a[248:251], a[152:155], v[156:159]
  v_exp_f32 v146, v146
  v_mfma_f32_16x16x32_bf16 v[156:159], a[244:247], a[148:151], v[156:159]
  ds_read_b64_tr_b16 a[214:215], v16 offset:28672
  v_mfma_f32_16x16x32_bf16 v[156:159], a[240:243], a[144:147], v[156:159]
  v_exp_f32 v147, v147
  v_mfma_f32_16x16x32_bf16 v[172:175], a[240:243], a[160:163], 0
  ds_read_b64_tr_b16 a[216:217], v17 offset:16384
  v_cvt_pk_bf16_f32 v145, v146, v147
  v_mfma_f32_16x16x32_bf16 v[172:175], a[244:247], a[164:167], v[172:175]
  v_exp_f32 v148, v148
  v_mfma_f32_16x16x32_bf16 v[172:175], a[248:251], a[168:171], v[172:175]
  s_xor_b32 s43, s48, 0xd800
  ds_read_b64_tr_b16 a[218:219], v17 offset:20480
  v_mfma_f32_16x16x32_bf16 v[172:175], a[252:255], a[172:175], v[172:175]
  s_waitcnt vmcnt(12)
  buffer_store_dwordx4 v[116:119], v26, s[24:27], s43 offen sc1
  s_waitcnt lgkmcnt(4)
  v_mfma_f32_16x16x32_bf16 v[6:9], v[32:35], v[6:9], 0
  v_exp_f32 v149, v149
  v_mfma_f32_16x16x32_bf16 v[188:191], a[252:255], a[188:191], 0
  ds_read_b64_tr_b16 a[220:221], v17 offset:24576
  v_cvt_pk_bf16_f32 v146, v148, v149
  v_mfma_f32_16x16x32_bf16 v[188:191], a[248:251], a[184:187], v[188:191]
  v_exp_f32 v150, v150
  v_mfma_f32_16x16x32_bf16 v[188:191], a[244:247], a[180:183], v[188:191]
  ds_read_b64_tr_b16 a[222:223], v17 offset:28672
  v_mfma_f32_16x16x32_bf16 v[188:191], a[240:243], a[176:179], v[188:191]
  v_cvt_pk_bf16_f32 v114, v6, v7
  v_mfma_f32_16x16x32_bf16 v[48:51], v[44:47], v[192:195], v[48:51]
  ds_read_b64_tr_b16 a[224:225], v18 offset:16384
  v_cvt_pk_bf16_f32 v115, v8, v9
  v_mfma_f32_16x16x32_bf16 v[48:51], v[44:47], v[200:203], v[48:51]
  v_exp_f32 v151, v151
  v_mfma_f32_16x16x32_bf16 v[52:55], v[44:47], v[208:211], v[52:55]
  ds_read_b64_tr_b16 a[226:227], v18 offset:20480
  v_cvt_pk_bf16_f32 v147, v150, v151
  v_mfma_f32_16x16x32_bf16 v[52:55], v[44:47], v[216:219], v[52:55]
  v_mov_b32 v252, 1
  v_mfma_f32_16x16x32_bf16 v[56:59], v[44:47], v[224:227], v[56:59]
  ds_read_b64_tr_b16 a[228:229], v18 offset:24576
  v_mfma_f32_16x16x32_bf16 v[56:59], v[44:47], v[232:235], v[56:59]
  s_waitcnt vmcnt(12)
  buffer_atomic_add v252, v26, s[4:7], 0 offen sc0 sc1
  v_mfma_f32_16x16x32_bf16 v[60:63], v[44:47], v[240:243], v[60:63]
  ds_read_b64_tr_b16 a[230:231], v18 offset:28672
  v_mfma_f32_16x16x32_bf16 v[60:63], v[44:47], v[248:251], v[60:63]
  s_waitcnt lgkmcnt(4)
  ds_read2_b64 v[2:5], v29 offset0:0 offset1:0
  v_mfma_f32_16x16x32_bf16 a[96:99], v[248:251], a[196:199], a[96:99]
  s_add_u32 m0, s30, 101376
  s_xor_b32 s40, s32, 0x1000
  ds_read_b64_tr_b16 a[232:233], v19 offset:16384
  v_mfma_f32_16x16x32_bf16 a[96:99], v[240:243], a[192:195], a[96:99]
  s_waitcnt vmcnt(12)
  buffer_load_dwordx4 v25, s[20:23], s40 offen nt lds
  v_mfma_f32_16x16x32_bf16 a[64:67], v[224:227], a[192:195], a[64:67]
  ds_read_b64_tr_b16 a[234:235], v19 offset:20480
  v_mfma_f32_16x16x32_bf16 a[64:67], v[232:235], a[196:199], a[64:67]
  v_exp_f32 v160, v160
  v_mfma_f32_16x16x32_bf16 a[32:35], v[216:219], a[196:199], a[32:35]
  ds_read_b64_tr_b16 a[236:237], v19 offset:24576
  v_mfma_f32_16x16x32_bf16 a[32:35], v[208:211], a[192:195], a[32:35]
  v_exp_f32 v161, v161
  v_mfma_f32_16x16x32_bf16 a[0:3], v[192:195], a[192:195], a[0:3]
  ds_read_b64_tr_b16 a[238:239], v19 offset:28672
  v_cvt_pk_bf16_f32 v160, v160, v161
  v_mfma_f32_16x16x32_bf16 a[0:3], v[200:203], a[196:199], a[0:3]
  v_exp_f32 v162, v162
  s_waitcnt lgkmcnt(4)
  v_mfma_f32_16x16x32_bf16 v[2:5], v[32:35], v[2:5], 0
  v_exp_f32 v163, v163
  v_mfma_f32_16x16x32_bf16 a[4:7], v[200:203], a[204:207], a[4:7]
  ds_read_b64_tr_b16 a[240:241], v20 offset:16384
  v_cvt_pk_bf16_f32 v161, v162, v163
  v_mfma_f32_16x16x32_bf16 a[4:7], v[192:195], a[200:203], a[4:7]
  v_exp_f32 v164, v164
  v_mfma_f32_16x16x32_bf16 a[36:39], v[208:211], a[200:203], a[36:39]
  ds_read_b64_tr_b16 a[242:243], v20 offset:20480
  v_mfma_f32_16x16x32_bf16 a[36:39], v[216:219], a[204:207], a[36:39]
  v_cvt_pk_bf16_f32 v116, v2, v3
  v_mfma_f32_16x16x32_bf16 a[68:71], v[232:235], a[204:207], a[68:71]
  ds_read_b64_tr_b16 a[244:245], v20 offset:24576
  v_cvt_pk_bf16_f32 v117, v4, v5
  v_mfma_f32_16x16x32_bf16 a[68:71], v[224:227], a[200:203], a[68:71]
  v_exp_f32 v165, v165
  v_mfma_f32_16x16x32_bf16 a[100:103], v[240:243], a[200:203], a[100:103]
  s_add_u32 m0, s30, 0
  s_xor_b32 s40, s33, 0x0
  ds_read_b64_tr_b16 a[246:247], v20 offset:28672
  v_cvt_pk_bf16_f32 v162, v164, v165
  v_mfma_f32_16x16x32_bf16 a[100:103], v[248:251], a[204:207], a[100:103]
  s_waitcnt vmcnt(12)
  buffer_load_dwordx4 v22, s[16:19], s40 offen nt lds
  v_mfma_f32_16x16x32_bf16 a[104:107], v[248:251], a[212:215], a[104:107]
  ds_read_b64_tr_b16 a[248:249], v21 offset:16384
  v_mfma_f32_16x16x32_bf16 a[104:107], v[240:243], a[208:211], a[104:107]
  ds_read2_b64 v[6:9], v29 offset0:1 offset1:1
  v_mfma_f32_16x16x32_bf16 a[72:75], v[224:227], a[208:211], a[72:75]
  ds_read_b64_tr_b16 a[250:251], v21 offset:20480
  v_xor_b32 v29, 0x1000, v29
  v_mfma_f32_16x16x32_bf16 a[72:75], v[232:235], a[212:215], a[72:75]
  v_exp_f32 v166, v166
  v_mfma_f32_16x16x32_bf16 a[40:43], v[216:219], a[212:215], a[40:43]
  ds_read_b64_tr_b16 a[252:253], v21 offset:24576
  v_mfma_f32_16x16x32_bf16 a[40:43], v[208:211], a[208:211], a[40:43]
  v_exp_f32 v167, v167
  v_mfma_f32_16x16x32_bf16 a[8:11], v[192:195], a[208:211], a[8:11]
  ds_read_b64_tr_b16 a[254:255], v21 offset:28672
  v_cvt_pk_bf16_f32 v163, v166, v167
  v_mfma_f32_16x16x32_bf16 a[8:11], v[200:203], a[212:215], a[8:11]
  v_exp_f32 v176, v176
  v_mfma_f32_16x16x32_bf16 a[12:15], v[200:203], a[220:223], a[12:15]
  v_exp_f32 v177, v177
  v_mfma_f32_16x16x32_bf16 a[12:15], v[192:195], a[216:219], a[12:15]
  v_exp_f32 v178, v178
  v_mfma_f32_16x16x32_bf16 a[44:47], v[208:211], a[216:219], a[44:47]
  v_exp_f32 v179, v179
  v_mfma_f32_16x16x32_bf16 a[44:47], v[216:219], a[220:223], a[44:47]
  s_mov_b64 exec, 0
  s_cmp_eq_u32 s45, 0
  s_cbranch_scc1 L_pg20
  s_cmp_eq_u32 s45, 1
  s_cbranch_scc1 L_pg21
  s_cmp_eq_u32 s45, 2
  s_cbranch_scc1 L_pg22
  s_branch L_pg23
L_rt4:
  s_mov_b64 exec, -1
  s_waitcnt vmcnt(7) lgkmcnt(0)
  s_cmpk_lt_i32 s11, 0xfff6
  s_cbranch_scc0 L_fb2_11
  s_waitcnt vmcnt(3)
L_fb2_11:
  s_barrier
  v_mfma_f32_16x16x32_bf16 a[76:79], v[232:235], a[220:223], a[76:79]
  s_xor_b32 s43, s48, 0xbc00
  ds_read_b128 a[192:195], v10 offset:49152
  v_cvt_pk_bf16_f32 v176, v176, v177
  v_mfma_f32_16x16x32_bf16 a[76:79], v[224:227], a[216:219], a[76:79]
  s_waitcnt vmcnt(12)
  buffer_store_dwordx4 v[120:123], v26, s[24:27], s43 offen sc1
  v_mfma_f32_16x16x32_bf16 a[108:111], v[240:243], a[216:219], a[108:111]
  v_exp_f32 v180, v180
  v_mfma_f32_16x16x32_bf16 a[108:111], v[248:251], a[220:223], a[108:111]
  v_exp_f32 v181, v181
  v_mfma_f32_16x16x32_bf16 v[6:9], v[32:35], v[6:9], 0
  v_exp_f32 v182, v182
  v_mfma_f32_16x16x32_bf16 a[112:115], v[248:251], a[228:231], a[112:115]
  ds_read_b128 a[196:199], v11 offset:49152
  v_cvt_pk_bf16_f32 v177, v178, v179
  v_mfma_f32_16x16x32_bf16 a[112:115], v[240:243], a[224:227], a[112:115]
  v_exp_f32 v183, v183
  v_mfma_f32_16x16x32_bf16 a[80:83], v[224:227], a[224:227], a[80:83]
  v_exp_f32 v136, v136
  v_mfma_f32_16x16x32_bf16 a[80:83], v[232:235], a[228:231], a[80:83]
  v_cvt_pk_bf16_f32 v118, v6, v7
  v_cvt_pk_bf16_f32 v178, v180, v181
  v_mfma_f32_16x16x32_bf16 a[48:51], v[216:219], a[228:231], a[48:51]
  ds_read_b128 a[200:203], v12 offset:49152
  v_cvt_pk_bf16_f32 v119, v8, v9
  v_mfma_f32_16x16x32_bf16 a[48:51], v[208:211], a[224:227], a[48:51]
  ds_read2_b64 v[2:5], v30 offset0:0 offset1:0
  v_cvt_pk_bf16_f32 v179, v182, v183
  v_mfma_f32_16x16x32_bf16 a[16:19], v[192:195], a[224:227], a[16:19]
  v_exp_f32 v137, v137
  v_mfma_f32_16x16x32_bf16 a[16:19], v[200:203], a[228:231], a[16:19]
  v_exp_f32 v138, v138
  v_mfma_f32_16x16x32_bf16 a[20:23], v[200:203], a[236:239], a[20:23]
  ds_read_b128 a[204:207], v13 offset:49152
  v_cvt_pk_bf16_f32 v136, v136, v137
  v_mfma_f32_16x16x32_bf16 a[20:23], v[192:195], a[232:235], a[20:23]
  v_exp_f32 v139, v139
  v_mfma_f32_16x16x32_bf16 a[52:55], v[208:211], a[232:235], a[52:55]
  s_add_u32 m0, s30, 1024
  s_xor_b32 s40, s33, 0xc00
  v_exp_f32 v140, v140
  v_mfma_f32_16x16x32_bf16 a[52:55], v[216:219], a[236:239], a[52:55]
  s_waitcnt vmcnt(12)
  buffer_load_dwordx4 v23, s[16:19], s40 offen nt lds
  v_mfma_f32_16x16x32_bf16 a[84:87], v[232:235], a[236:239], a[84:87]
  ds_read_b128 a[208:211], v10 offset:53248
  v_cvt_pk_bf16_f32 v137, v138, v139
  v_mfma_f32_16x16x32_bf16 a[84:87], v[224:227], a[232:235], a[84:87]
  v_exp_f32 v141, v141
  v_mfma_f32_16x16x32_bf16 a[116:119], v[240:243], a[232:235], a[116:119]
  v_exp_f32 v142, v142
  v_mfma_f32_16x16x32_bf16 a[116:119], v[248:251], a[236:239], a[116:119]
  v_exp_f32 v143, v143
  s_waitcnt lgkmcnt(2)
  v_mfma_f32_16x16x32_bf16 v[2:5], v[32:35], v[2:5], 0
  v_exp_f32 v152, v152
  v_mfma_f32_16x16x32_bf16 a[120:123], v[248:251], a[244:247], a[120:123]
  ds_read_b128 a[212:215], v11 offset:53248
  v_cvt_pk_bf16_f32 v138, v140, v141
  v_mfma_f32_16x16x32_bf16 a[120:123], v[240:243], a[240:243], a[120:123]
  v_exp_f32 v153, v153
  v_mfma_f32_16x16x32_bf16 a[88:91], v[224:227], a[240:243], a[88:91]
  v_exp_f32 v154, v154
  v_mfma_f32_16x16x32_bf16 a[88:91], v[232:235], a[244:247], a[88:91]
  v_cvt_pk_bf16_f32 v120, v2, v3
  v_cvt_pk_bf16_f32 v139, v142, v143
  v_mfma_f32_16x16x32_bf16 a[56:59], v[216:219], a[244:247], a[56:59]
  ds_read_b128 a[216:219], v12 offset:53248
  v_cvt_pk_bf16_f32 v121, v4, v5
  v_mfma_f32_16x16x32_bf16 a[56:59], v[208:211], a[240:243], a[56:59]
  v_exp_f32 v155, v155
  v_mfma_f32_16x16x32_bf16 a[24:27], v[192:195], a[240:243], a[24:27]
  v_exp_f32 v156, v156
  v_mfma_f32_16x16x32_bf16 a[24:27], v[200:203], a[244:247], a[24:27]
  v_exp_f32 v157, v157
  v_mfma_f32_16x16x32_bf16 a[28:31], v[200:203], a[252:255], a[28:31]
  ds_read_b128 a[220:223], v13 offset:53248
  v_cvt_pk_bf16_f32 v152, v152, v153
  v_mfma_f32_16x16x32_bf16 a[28:31], v[192:195], a[248:251], a[28:31]
  ds_read2_b64 v[6:9], v30 offset0:1 offset1:1
  v_cvt_pk_bf16_f32 v153, v154, v155
  v_mfma_f32_16x16x32_bf16 a[60:63], v[208:211], a[248:251], a[60:63]
  s_add_u32 m0, s30, 2048
  s_xor_b32 s40, s33, 0x10400
  v_xor_b32 v30, 0x1000, v30
  v_cvt_pk_bf16_f32 v154, v156, v157
  v_mfma_f32_16x16x32_bf16 a[60:63], v[216:219], a[252:255], a[60:63]
  s_waitcnt vmcnt(12)
  buffer_load_dwordx4 v24, s[16:19], s40 offen nt lds
  v_mfma_f32_16x16x32_bf16 a[92:95], v[232:235], a[252:255], a[92:95]
  v_exp_f32 v158, v158
  v_mfma_f32_16x16x32_bf16 a[92:95], v[224:227], a[248:251], a[92:95]
  v_exp_f32 v159, v159
  v_mfma_f32_16x16x32_bf16 a[124:127], v[240:243], a[248:251], a[124:127]
  v_exp_f32 v168, v168
  v_mfma_f32_16x16x32_bf16 a[124:127], v[248:251], a[252:255], a[124:127]
  s_waitcnt lgkmcnt(1)
  v_exp_f32 v169, v169
  v_mfma_f32_16x16x32_bf16 v[240:243], a[192:195], a[176:179], 0
  v_exp_f32 v170, v170
  v_mfma_f32_16x16x32_bf16 v[240:243], a[196:199], a[180:183], v[240:243]
  ds_read_b128 a[224:227], v10 offset:57344
  v_cvt_pk_bf16_f32 v155, v158, v159
  v_mfma_f32_16x16x32_bf16 v[240:243], a[200:203], a[184:187], v[240:243]
  v_exp_f32 v171, v171
  v_mfma_f32_16x16x32_bf16 v[240:243], a[204:207], a[188:191], v[240:243]
  v_exp_f32 v172, v172
  s_waitcnt lgkmcnt(1)
  v_mfma_f32_16x16x32_bf16 v[6:9], v[32:35], v[6:9], 0
  v_exp_f32 v173, v173
  v_mfma_f32_16x16x32_bf16 v[224:227], a[204:207], a[172:175], 0
  ds_read_b128 a[228:231], v11 offset:57344
  v_cvt_pk_bf16_f32 v168, v168, v169
  v_mfma_f32_16x16x32_bf16 v[224:227], a[200:203], a[168:171], v[224:227]
  v_exp_f32 v174, v174
  v_mfma_f32_16x16x32_bf16 v[224:227], a[196:199], a[164:167], v[224:227]
  v_exp_f32 v175, v175
  v_mfma_f32_16x16x32_bf16 v[224:227], a[192:195], a[160:163], v[224:227]
  ds_read_b128 a[232:235], v12 offset:57344
  v_cvt_pk_bf16_f32 v122, v6, v7
  v_mfma_f32_16x16x32_bf16 v[208:211], a[192:195], a[144:147], 0
  s_xor_b32 s43, s48, 0xdc00
  v_cvt_pk_bf16_f32 v123, v8, v9
  v_cvt_pk_bf16_f32 v169, v170, v171
  v_mfma_f32_16x16x32_bf16 v[208:211], a[196:199], a[148:151], v[208:211]
  s_waitcnt vmcnt(12)
  buffer_store_dwordx4 v[124:127], v26, s[24:27], s43 offen sc1
  v_mfma_f32_16x16x32_bf16 v[208:211], a[200:203], a[152:155], v[208:211]
  ds_read_b128 a[236:239], v13 offset:57344
  v_cvt_pk_bf16_f32 v170, v172, v173
  v_mfma_f32_16x16x32_bf16 v[208:211], a[204:207], a[156:159], v[208:211]
  ds_read2_b64 v[2:5], v31 offset0:0 offset1:0
  v_cvt_pk_bf16_f32 v171, v174, v175
  v_mfma_f32_16x16x32_bf16 v[192:195], a[204:207], a[140:143], 0
  v_exp_f32 v184, v184
  v_mfma_f32_16x16x32_bf16 v[192:195], a[200:203], a[136:139], v[192:195]
  ds_read_b128 a[240:243], v10 offset:61440
  v_mfma_f32_16x16x32_bf16 v[192:195], a[196:199], a[132:135], v[192:195]
  v_exp_f32 v185, v185
  v_mfma_f32_16x16x32_bf16 v[192:195], a[192:195], a[128:131], v[192:195]
  v_exp_f32 v186, v186
  v_mfma_f32_16x16x32_bf16 v[196:199], a[208:211], a[128:131], 0
  ds_read_b128 a[244:247], v11 offset:61440
  v_cvt_pk_bf16_f32 v184, v184, v185
  v_mfma_f32_16x16x32_bf16 v[196:199], a[212:215], a[132:135], v[196:199]
  v_exp_f32 v187, v187
  v_mfma_f32_16x16x32_bf16 v[196:199], a[216:219], a[136:139], v[196:199]
  v_exp_f32 v188, v188
  v_mfma_f32_16x16x32_bf16 v[196:199], a[220:223], a[140:143], v[196:199]
  ds_read_b128 a[248:251], v12 offset:61440
  v_cvt_pk_bf16_f32 v185, v186, v187
  s_waitcnt lgkmcnt(3)
  v_mfma_f32_16x16x32_bf16 v[2:5], v[32:35], v[2:5], 0
  v_exp_f32 v189, v189
  v_mfma_f32_16x16x32_bf16 v[212:215], a[220:223], a[156:159], 0
  v_exp_f32 v190, v190
  v_mfma_f32_16x16x32_bf16 v[212:215], a[216:219], a[152:155], v[212:215]
  v_exp_f32 v191, v191
  v_mfma_f32_16x16x32_bf16 v[212:215], a[212:215], a[148:151], v[212:215]
  ds_read_b128 a[252:255], v13 offset:61440
  v_cvt_pk_bf16_f32 v186, v188, v189
  v_mfma_f32_16x16x32_bf16 v[212:215], a[208:211], a[144:147], v[212:215]
  v_cvt_pk_bf16_f32 v124, v2, v3
  v_cvt_pk_bf16_f32 v187, v190, v191
  v_mfma_f32_16x16x32_bf16 v[228:231], a[208:211], a[160:163], 0
  s_add_u32 m0, s30, 3072
  s_xor_b32 s40, s33, 0x10800
  v_cvt_pk_bf16_f32 v125, v4, v5
  v_mfma_f32_16x16x32_bf16 v[228:231], a[212:215], a[164:167], v[228:231]
  s_waitcnt vmcnt(12)
  buffer_load_dwordx4 v25, s[16:19], s40 offen nt lds
  v_mfma_f32_16x16x32_bf16 v[228:231], a[216:219], a[168:171], v[228:231]
  v_exp_f32 v192, v192
  v_mfma_f32_16x16x32_bf16 v[228:231], a[220:223], a[172:175], v[228:231]
  v_exp_f32 v193, v193
  v_mfma_f32_16x16x32_bf16 v[244:247], a[220:223], a[188:191], 0
  v_exp_f32 v194, v194
  v_mfma_f32_16x16x32_bf16 v[244:247], a[216:219], a[184:187], v[244:247]
  v_exp_f32 v195, v195
  v_mfma_f32_16x16x32_bf16 v[244:247], a[212:215], a[180:183], v[244:247]
  ds_read2_b64 v[6:9], v31 offset0:1 offset1:1
  v_cvt_pk_bf16_f32 v192, v192, v193
  v_mfma_f32_16x16x32_bf16 v[244:247], a[208:211], a[176:179], v[244:247]
  s_waitcnt vmcnt(6) lgkmcnt(0)
  s_cmpk_lt_i32 s8, 0x0
  s_cbranch_scc0 L_fb2_12
  s_waitcnt vmcnt(3)
L_fb2_12:
  s_barrier
  v_mfma_f32_16x16x32_bf16 v[248:251], a[224:227], a[176:179], 0
  ds_read_b64_tr_b16 a[192:193], v14 offset:32768
  v_xor_b32 v31, 0x1000, v31
  v_mfma_f32_16x16x32_bf16 v[248:251], a[228:231], a[180:183], v[248:251]
  v_exp_f32 v196, v196
  v_mfma_f32_16x16x32_bf16 v[248:251], a[232:235], a[184:187], v[248:251]
  ds_read_b64_tr_b16 a[194:195], v14 offset:36864
  v_cvt_pk_bf16_f32 v193, v194, v195
  v_mfma_f32_16x16x32_bf16 v[248:251], a[236:239], a[188:191], v[248:251]
  v_exp_f32 v197, v197
  v_mfma_f32_16x16x32_bf16 v[232:235], a[236:239], a[172:175], 0
  ds_read_b64_tr_b16 a[196:197], v14 offset:40960
  v_cvt_pk_bf16_f32 v194, v196, v197
  v_mfma_f32_16x16x32_bf16 v[232:235], a[232:235], a[168:171], v[232:235]
  v_exp_f32 v198, v198
  v_mfma_f32_16x16x32_bf16 v[232:235], a[228:231], a[164:167], v[232:235]
  ds_read_b64_tr_b16 a[198:199], v14 offset:45056
  v_mfma_f32_16x16x32_bf16 v[232:235], a[224:227], a[160:163], v[232:235]
  v_exp_f32 v199, v199
  v_mfma_f32_16x16x32_bf16 v[6:9], v[32:35], v[6:9], 0
  v_exp_f32 v208, v208
  v_mfma_f32_16x16x32_bf16 v[216:219], a[224:227], a[144:147], 0
  s_add_u32 m0, s30, 114688
  s_xor_b32 s40, s32, 0x11c00
  ds_read_b64_tr_b16 a[200:201], v15 offset:32768
  v_cvt_pk_bf16_f32 v195, v198, v199
  v_mfma_f32_16x16x32_bf16 v[216:219], a[228:231], a[148:151], v[216:219]
  s_waitcnt vmcnt(12)
  buffer_load_dwordx4 v22, s[20:23], s40 offen nt lds
  v_mfma_f32_16x16x32_bf16 v[216:219], a[232:235], a[152:155], v[216:219]
  ds_read_b64_tr_b16 a[202:203], v15 offset:36864
  v_mfma_f32_16x16x32_bf16 v[216:219], a[236:239], a[156:159], v[216:219]
  v_cvt_pk_bf16_f32 v126, v6, v7
  v_mfma_f32_16x16x32_bf16 v[200:203], a[236:239], a[140:143], 0
  ds_read_b64_tr_b16 a[204:205], v15 offset:40960
  v_cvt_pk_bf16_f32 v127, v8, v9
  v_mfma_f32_16x16x32_bf16 v[200:203], a[232:235], a[136:139], v[200:203]
  v_exp_f32 v209, v209
  v_mfma_f32_16x16x32_bf16 v[200:203], a[228:231], a[132:135], v[200:203]
  ds_read_b64_tr_b16 a[206:207], v15 offset:45056
  v_cvt_pk_bf16_f32 v208, v208, v209
  v_mfma_f32_16x16x32_bf16 v[200:203], a[224:227], a[128:131], v[200:203]
  v_exp_f32 v210, v210
  v_mfma_f32_16x16x32_bf16 v[204:207], a[240:243], a[128:131], 0
  ds_read_b64_tr_b16 a[208:209], v16 offset:32768
  v_mfma_f32_16x16x32_bf16 v[204:207], a[244:247], a[132:135], v[204:207]
  v_exp_f32 v211, v211
  v_mfma_f32_16x16x32_bf16 v[204:207], a[248:251], a[136:139], v[204:207]
  ds_read_b64_tr_b16 a[210:211], v16 offset:36864
  v_cvt_pk_bf16_f32 v209, v210, v211
  v_mfma_f32_16x16x32_bf16 v[204:207], a[252:255], a[140:143], v[204:207]
  s_waitcnt vmcnt(8)
  v_readfirstlane_b32 s44, v252
  v_mfma_f32_16x16x32_bf16 v[220:223], a[252:255], a[156:159], 0
  ds_read_b64_tr_b16 a[212:213], v16 offset:40960
  v_mfma_f32_16x16x32_bf16 v[220:223], a[248:251], a[152:155], v[220:223]
  s_sub_u32 s44, s44, s49
  s_add_u32 s49, s49, 64
  s_sub_i32 s8, s44, s98
  s_sub_i32 s9, s44, s99
  s_sub_i32 s10, s44, s100
  s_sub_i32 s11, s44, s101
  v_exp_f32 v212, v212
  v_mfma_f32_16x16x32_bf16 v[220:223], a[244:247], a[148:151], v[220:223]
  ds_read_b64_tr_b16 a[214:215], v16 offset:45056
  v_mfma_f32_16x16x32_bf16 v[220:223], a[240:243], a[144:147], v[220:223]
  v_exp_f32 v213, v213
  v_mfma_f32_16x16x32_bf16 v[236:239], a[240:243], a[160:163], 0
  s_add_u32 m0, s30, 115712
  s_xor_b32 s40, s32, 0x11000
  ds_read_b64_tr_b16 a[216:217], v17 offset:32768
  v_cvt_pk_bf16_f32 v210, v212, v213
  v_mfma_f32_16x16x32_bf16 v[236:239], a[244:247], a[164:167], v[236:239]
  s_waitcnt vmcnt(12)
  buffer_load_dwordx4 v23, s[20:23], s40 offen nt lds
  v_mfma_f32_16x16x32_bf16 v[236:239], a[248:251], a[168:171], v[236:239]
  ds_read_b64_tr_b16 a[218:219], v17 offset:36864
  v_mfma_f32_16x16x32_bf16 v[236:239], a[252:255], a[172:175], v[236:239]
  v_exp_f32 v214, v214
  v_mfma_f32_16x16x32_bf16 v[252:255], a[252:255], a[188:191], 0
  ds_read_b64_tr_b16 a[220:221], v17 offset:40960
  v_mfma_f32_16x16x32_bf16 v[252:255], a[248:251], a[184:187], v[252:255]
  v_exp_f32 v215, v215
  v_mfma_f32_16x16x32_bf16 v[252:255], a[244:247], a[180:183], v[252:255]
  ds_read_b64_tr_b16 a[222:223], v17 offset:45056
  v_cvt_pk_bf16_f32 v211, v214, v215
  v_mfma_f32_16x16x32_bf16 v[252:255], a[240:243], a[176:179], v[252:255]
  v_exp_f32 v224, v224
  v_mfma_f32_16x16x32_bf16 v[48:51], v[44:47], v[128:131], v[48:51]
  ds_read_b64_tr_b16 a[224:225], v18 offset:32768
  v_accvgpr_write_b32 a128, v64
  v_mfma_f32_16x16x32_bf16 v[48:51], v[44:47], v[136:139], v[48:51]
  v_accvgpr_write_b32 a129, v65
  v_mfma_f32_16x16x32_bf16 v[52:55], v[44:47], v[144:147], v[52:55]
  ds_read_b64_tr_b16 a[226:227], v18 offset:36864
  v_accvgpr_write_b32 a130, v66
  v_mfma_f32_16x16x32_bf16 v[52:55], v[44:47], v[152:155], v[52:55]
  v_accvgpr_write_b32 a131, v67
  v_exp_f32 v225, v225
  v_mfma_f32_16x16x32_bf16 v[56:59], v[44:47], v[160:163], v[56:59]
  ds_read_b64_tr_b16 a[228:229], v18 offset:40960
  v_accvgpr_write_b32 a132, v68
  v_mfma_f32_16x16x32_bf16 v[56:59], v[44:47], v[168:171], v[56:59]
  v_accvgpr_write_b32 a133, v69
  v_exp_f32 v226, v226
  v_mfma_f32_16x16x32_bf16 v[60:63], v[44:47], v[176:179], v[60:63]
  ds_read_b64_tr_b16 a[230:231], v18 offset:45056
  v_accvgpr_write_b32 a134, v70
  v_mfma_f32_16x16x32_bf16 v[60:63], v[44:47], v[184:187], v[60:63]
  s_waitcnt lgkmcnt(4)
  v_accvgpr_write_b32 a135, v71
  v_cvt_pk_bf16_f32 v224, v224, v225
  v_mfma_f32_16x16x32_bf16 a[96:99], v[184:187], a[196:199], a[96:99]
  s_add_u32 m0, s30, 116736
  s_xor_b32 s40, s32, 0x1800
  ds_read_b64_tr_b16 a[232:233], v19 offset:32768
  v_accvgpr_write_b32 a136, v72
  v_mfma_f32_16x16x32_bf16 a[96:99], v[176:179], a[192:195], a[96:99]
  s_waitcnt vmcnt(12)
  buffer_load_dwordx4 v24, s[20:23], s40 offen nt lds
  v_mfma_f32_16x16x32_bf16 a[64:67], v[160:163], a[192:195], a[64:67]
  ds_read_b64_tr_b16 a[234:235], v19 offset:36864
  v_accvgpr_write_b32 a137, v73
  v_mfma_f32_16x16x32_bf16 a[64:67], v[168:171], a[196:199], a[64:67]
  v_accvgpr_write_b32 a138, v74
  v_exp_f32 v227, v227
  v_mfma_f32_16x16x32_bf16 a[32:35], v[152:155], a[196:199], a[32:35]
  ds_read_b64_tr_b16 a[236:237], v19 offset:40960
  v_accvgpr_write_b32 a139, v75
  v_mfma_f32_16x16x32_bf16 a[32:35], v[144:147], a[192:195], a[32:35]
  v_accvgpr_write_b32 a140, v76
  v_cvt_pk_bf16_f32 v225, v226, v227
  v_mfma_f32_16x16x32_bf16 a[0:3], v[128:131], a[192:195], a[0:3]
  ds_read_b64_tr_b16 a[238:239], v19 offset:45056
  v_accvgpr_write_b32 a141, v77
  v_mfma_f32_16x16x32_bf16 a[0:3], v[136:139], a[196:199], a[0:3]
  v_accvgpr_write_b32 a142, v78
  v_exp_f32 v228, v228
  v_mfma_f32_16x16x32_bf16 a[4:7], v[136:139], a[204:207], a[4:7]
  ds_read_b64_tr_b16 a[240:241], v20 offset:32768
  v_accvgpr_write_b32 a143, v79
  v_mfma_f32_16x16x32_bf16 a[4:7], v[128:131], a[200:203], a[4:7]
  v_accvgpr_write_b32 a144, v80
  v_exp_f32 v229, v229
  v_mfma_f32_16x16x32_bf16 a[36:39], v[144:147], a[200:203], a[36:39]
  ds_read_b64_tr_b16 a[242:243], v20 offset:36864
  v_accvgpr_write_b32 a145, v81
  v_mfma_f32_16x16x32_bf16 a[36:39], v[152:155], a[204:207], a[36:39]
  v_accvgpr_write_b32 a146, v82
  v_cvt_pk_bf16_f32 v226, v228, v229
  v_mfma_f32_16x16x32_bf16 a[68:71], v[168:171], a[204:207], a[68:71]
  ds_read_b64_tr_b16 a[244:245], v20 offset:40960
  v_accvgpr_write_b32 a147, v83
  v_mfma_f32_16x16x32_bf16 a[68:71], v[160:163], a[200:203], a[68:71]
  v_accvgpr_write_b32 a148, v84
  v_exp_f32 v230, v230
  v_mfma_f32_16x16x32_bf16 a[100:103], v[176:179], a[200:203], a[100:103]
  s_add_u32 m0, s30, 117760
  s_xor_b32 s40, s32, 0x1400
  ds_read_b64_tr_b16 a[246:247], v20 offset:45056
  v_accvgpr_write_b32 a149, v85
  v_mfma_f32_16x16x32_bf16 a[100:103], v[184:187], a[204:207], a[100:103]
  s_waitcnt vmcnt(12)
  buffer_load_dwordx4 v25, s[20:23], s40 offen nt lds
  v_mfma_f32_16x16x32_bf16 a[104:107], v[184:187], a[212:215], a[104:107]
  ds_read_b64_tr_b16 a[248:249], v21 offset:32768
  v_accvgpr_write_b32 a150, v86
  v_mfma_f32_16x16x32_bf16 a[104:107], v[176:179], a[208:211], a[104:107]
  v_accvgpr_write_b32 a151, v87
  v_mfma_f32_16x16x32_bf16 a[72:75], v[160:163], a[208:211], a[72:75]
  ds_read_b64_tr_b16 a[250:251], v21 offset:36864
  v_accvgpr_write_b32 a152, v88
  v_mfma_f32_16x16x32_bf16 a[72:75], v[168:171], a[212:215], a[72:75]
  v_accvgpr_write_b32 a153, v89
  v_exp_f32 v231, v231
  v_mfma_f32_16x16x32_bf16 a[40:43], v[152:155], a[212:215], a[40:43]
  ds_read_b64_tr_b16 a[252:253], v21 offset:40960
  v_accvgpr_write_b32 a154, v90
  v_mfma_f32_16x16x32_bf16 a[40:43], v[144:147], a[208:211], a[40:43]
  v_accvgpr_write_b32 a155, v91
  v_exp_f32 v240, v240
  v_mfma_f32_16x16x32_bf16 a[8:11], v[128:131], a[208:211], a[8:11]
  ds_read_b64_tr_b16 a[254:255], v21 offset:45056
  v_accvgpr_write_b32 a156, v92
  v_mfma_f32_16x16x32_bf16 a[8:11], v[136:139], a[212:215], a[8:11]
  v_accvgpr_write_b32 a157, v93
  v_cvt_pk_bf16_f32 v227, v230, v231
  v_mfma_f32_16x16x32_bf16 a[12:15], v[136:139], a[220:223], a[12:15]
  v_accvgpr_write_b32 a158, v94
  v_exp_f32 v241, v241
  v_mfma_f32_16x16x32_bf16 a[12:15], v[128:131], a[216:219], a[12:15]
  v_accvgpr_write_b32 a159, v95
  v_cvt_pk_bf16_f32 v240, v240, v241
  v_mfma_f32_16x16x32_bf16 a[44:47], v[144:147], a[216:219], a[44:47]
  v_accvgpr_write_b32 a160, v96
  v_mfma_f32_16x16x32_bf16 a[44:47], v[152:155], a[220:223], a[44:47]
  s_waitcnt vmcnt(4) lgkmcnt(0)
  s_cmpk_lt_i32 s9, 0x0
  s_cbranch_scc0 L_fb2_13
  s_waitcnt vmcnt(4)
L_fb2_13:
  s_barrier
  v_mfma_f32_16x16x32_bf16 a[76:79], v[168:171], a[220:223], a[76:79]
  ds_read_b128 a[192:195], v10
  v_accvgpr_write_b32 a161, v97
  v_mfma_f32_16x16x32_bf16 a[76:79], v[160:163], a[216:219], a[76:79]
  s_add_u32 m0, s30, 16384
  s_xor_b32 s40, s33, 0x400
  v_accvgpr_write_b32 a162, v98
  v_exp_f32 v242, v242
  v_mfma_f32_16x16x32_bf16 a[108:111], v[176:179], a[216:219], a[108:111]
  s_waitcnt vmcnt(12)
  buffer_load_dwordx4 v22, s[16:19], s40 offen nt lds
  v_mfma_f32_16x16x32_bf16 a[108:111], v[184:187], a[220:223], a[108:111]
  v_accvgpr_write_b32 a163, v99
  v_mfma_f32_16x16x32_bf16 a[112:115], v[184:187], a[228:231], a[112:115]
  ds_read_b128 a[196:199], v11
  v_accvgpr_write_b32 a164, v100
  v_mfma_f32_16x16x32_bf16 a[112:115], v[176:179], a[224:227], a[112:115]
  v_accvgpr_write_b32 a165, v101
  v_exp_f32 v243, v243
  v_mfma_f32_16x16x32_bf16 a[80:83], v[160:163], a[224:227], a[80:83]
  v_accvgpr_write_b32 a166, v102
  v_cvt_pk_bf16_f32 v241, v242, v243
L_pg17:
  s_cbranch_execz L_rt3
  v_mfma_f32_16x16x32_bf16 a[80:83], v[168:171], a[228:231], a[80:83]
  v_accvgpr_write_b32 a167, v103
  v_exp_f32 v244, v244
  v_mfma_f32_16x16x32_bf16 a[48:51], v[152:155], a[228:231], a[48:51]
  ds_read_b128 a[200:203], v12
  v_accvgpr_write_b32 a168, v104
  v_mfma_f32_16x16x32_bf16 a[48:51], v[144:147], a[224:227], a[48:51]
  v_accvgpr_write_b32 a169, v105
  v_mfma_f32_16x16x32_bf16 a[16:19], v[128:131], a[224:227], a[16:19]
  v_accvgpr_write_b32 a170, v106
  v_exp_f32 v245, v245
  v_mfma_f32_16x16x32_bf16 a[16:19], v[136:139], a[228:231], a[16:19]
  v_accvgpr_write_b32 a171, v107
  v_cvt_pk_bf16_f32 v242, v244, v245
  v_mfma_f32_16x16x32_bf16 a[20:23], v[136:139], a[236:239], a[20:23]
  ds_read_b128 a[204:207], v13
  v_accvgpr_write_b32 a172, v108
  v_mfma_f32_16x16x32_bf16 a[20:23], v[128:131], a[232:235], a[20:23]
  v_accvgpr_write_b32 a173, v109
  v_exp_f32 v246, v246
  v_mfma_f32_16x16x32_bf16 a[52:55], v[144:147], a[232:235], a[52:55]
  v_accvgpr_write_b32 a174, v110
  v_mfma_f32_16x16x32_bf16 a[52:55], v[152:155], a[236:239], a[52:55]
  v_accvgpr_write_b32 a175, v111
  v_exp_f32 v247, v247
  v_mfma_f32_16x16x32_bf16 a[84:87], v[168:171], a[236:239], a[84:87]
  s_add_u32 m0, s30, 17408
  s_xor_b32 s40, s33, 0x800
  ds_read_b128 a[208:211], v10 offset:4096
  v_accvgpr_write_b32 a176, v112
  v_mfma_f32_16x16x32_bf16 a[84:87], v[160:163], a[232:235], a[84:87]
  s_waitcnt vmcnt(12)
  buffer_load_dwordx4 v23, s[16:19], s40 offen nt lds
  v_mfma_f32_16x16x32_bf16 a[116:119], v[176:179], a[232:235], a[116:119]
  v_accvgpr_write_b32 a177, v113
  v_cvt_pk_bf16_f32 v243, v246, v247
  v_mfma_f32_16x16x32_bf16 a[116:119], v[184:187], a[236:239], a[116:119]
  v_accvgpr_write_b32 a178, v114
  v_mfma_f32_16x16x32_bf16 a[120:123], v[184:187], a[244:247], a[120:123]
  ds_read_b128 a[212:215], v11 offset:4096
  v_accvgpr_write_b32 a179, v115
  v_mfma_f32_16x16x32_bf16 a[120:123], v[176:179], a[240:243], a[120:123]
  v_accvgpr_write_b32 a180, v116
  v_exp_f32 v200, v200
  v_mfma_f32_16x16x32_bf16 a[88:91], v[160:163], a[240:243], a[88:91]
  v_accvgpr_write_b32 a181, v117
  v_mfma_f32_16x16x32_bf16 a[88:91], v[168:171], a[244:247], a[88:91]
  v_accvgpr_write_b32 a182, v118
  v_exp_f32 v201, v201
  v_mfma_f32_16x16x32_bf16 a[56:59], v[152:155], a[244:247], a[56:59]
  ds_read_b128 a[216:219], v12 offset:4096
  v_accvgpr_write_b32 a183, v119
  v_mfma_f32_16x16x32_bf16 a[56:59], v[144:147], a[240:243], a[56:59]
  v_accvgpr_write_b32 a184, v120
  v_exp_f32 v202, v202
  v_mfma_f32_16x16x32_bf16 a[24:27], v[128:131], a[240:243], a[24:27]
  v_accvgpr_write_b32 a185, v121
  v_cvt_pk_bf16_f32 v200, v200, v201
  v_mfma_f32_16x16x32_bf16 a[24:27], v[136:139], a[244:247], a[24:27]
  v_accvgpr_write_b32 a186, v122
  v_mfma_f32_16x16x32_bf16 a[28:31], v[136:139], a[252:255], a[28:31]
  ds_read_b128 a[220:223], v13 offset:4096
  v_accvgpr_write_b32 a187, v123
  v_mfma_f32_16x16x32_bf16 a[28:31], v[128:131], a[248:251], a[28:31]
  v_accvgpr_write_b32 a188, v124
  v_exp_f32 v203, v203
  v_mfma_f32_16x16x32_bf16 a[60:63], v[144:147], a[248:251], a[60:63]
  v_accvgpr_write_b32 a189, v125
  v_cvt_pk_bf16_f32 v201, v202, v203
  v_mfma_f32_16x16x32_bf16 a[60:63], v[152:155], a[252:255], a[60:63]
  s_add_u32 m0, s30, 18432
  s_xor_b32 s40, s33, 0x10000
  v_accvgpr_write_b32 a190, v126
  v_exp_f32 v204, v204
  v_mfma_f32_16x16x32_bf16 a[92:95], v[168:171], a[252:255], a[92:95]
  s_waitcnt vmcnt(12)
  buffer_load_dwordx4 v24, s[16:19], s40 offen nt lds
  v_mfma_f32_16x16x32_bf16 a[92:95], v[160:163], a[248:251], a[92:95]
  v_accvgpr_write_b32 a191, v127
  v_mfma_f32_16x16x32_bf16 a[124:127], v[176:179], a[248:251], a[124:127]
  v_exp_f32 v205, v205
  v_mfma_f32_16x16x32_bf16 a[124:127], v[184:187], a[252:255], a[124:127]
  s_waitcnt lgkmcnt(0)
  v_exp_f32 v206, v206
  v_cvt_pk_bf16_f32 v202, v204, v205
  v_mfma_f32_16x16x32_bf16 v[176:179], a[192:195], a[176:179], 0
  v_exp_f32 v207, v207
  v_mfma_f32_16x16x32_bf16 v[176:179], a[196:199], a[180:183], v[176:179]
  ds_read_b128 a[224:227], v10 offset:8192
  v_exp_f32 v216, v216
  v_mfma_f32_16x16x32_bf16 v[176:179], a[200:203], a[184:187], v[176:179]
  v_exp_f32 v217, v217
  v_mfma_f32_16x16x32_bf16 v[176:179], a[204:207], a[188:191], v[176:179]
  v_exp_f32 v218, v218
  v_mfma_f32_16x16x32_bf16 v[160:163], a[204:207], a[172:175], 0
  ds_read_b128 a[228:231], v11 offset:8192
  v_exp_f32 v219, v219
  v_mfma_f32_16x16x32_bf16 v[160:163], a[200:203], a[168:171], v[160:163]
  v_exp_f32 v220, v220
  v_mfma_f32_16x16x32_bf16 v[160:163], a[196:199], a[164:167], v[160:163]
  v_exp_f32 v221, v221
  v_mfma_f32_16x16x32_bf16 v[160:163], a[192:195], a[160:163], v[160:163]
  ds_read_b128 a[232:235], v12 offset:8192
  v_exp_f32 v222, v222
  v_mfma_f32_16x16x32_bf16 v[144:147], a[192:195], a[144:147], 0
  v_exp_f32 v223, v223
  v_mfma_f32_16x16x32_bf16 v[144:147], a[196:199], a[148:151], v[144:147]
  v_exp_f32 v232, v232
  v_mfma_f32_16x16x32_bf16 v[144:147], a[200:203], a[152:155], v[144:147]
  ds_read_b128 a[236:239], v13 offset:8192
  v_exp_f32 v233, v233
  v_mfma_f32_16x16x32_bf16 v[144:147], a[204:207], a[156:159], v[144:147]
  s_add_u32 m0, s30, 19456
  s_xor_b32 s40, s33, 0x10c00
  v_exp_f32 v234, v234
  v_mfma_f32_16x16x32_bf16 v[128:131], a[204:207], a[140:143], 0
  s_waitcnt vmcnt(12)
  buffer_load_dwordx4 v25, s[16:19], s40 offen nt lds
  v_mfma_f32_16x16x32_bf16 v[128:131], a[200:203], a[136:139], v[128:131]
  ds_read_b128 a[240:243], v10 offset:12288
  v_cvt_pk_bf16_f32 v203, v206, v207
  v_mfma_f32_16x16x32_bf16 v[128:131], a[196:199], a[132:135], v[128:131]
  v_exp_f32 v235, v235
  v_mfma_f32_16x16x32_bf16 v[128:131], a[192:195], a[128:131], v[128:131]
  v_exp_f32 v236, v236
  v_mfma_f32_16x16x32_bf16 v[132:135], a[208:211], a[128:131], 0
  ds_read_b128 a[244:247], v11 offset:12288
  v_exp_f32 v237, v237
  v_mfma_f32_16x16x32_bf16 v[132:135], a[212:215], a[132:135], v[132:135]
  v_exp_f32 v238, v238
  v_mfma_f32_16x16x32_bf16 v[132:135], a[216:219], a[136:139], v[132:135]
  v_exp_f32 v239, v239
  v_mfma_f32_16x16x32_bf16 v[132:135], a[220:223], a[140:143], v[132:135]
  ds_read_b128 a[248:251], v12 offset:12288
  v_cvt_pk_bf16_f32 v216, v216, v217
  v_cvt_pk_bf16_f32 v217, v218, v219
  v_mfma_f32_16x16x32_bf16 v[148:151], a[220:223], a[156:159], 0
  v_exp_f32 v248, v248
  v_mfma_f32_16x16x32_bf16 v[148:151], a[216:219], a[152:155], v[148:151]
  v_exp_f32 v249, v249
  v_mfma_f32_16x16x32_bf16 v[148:151], a[212:215], a[148:151], v[148:151]
  ds_read_b128 a[252:255], v13 offset:12288
  v_exp_f32 v250, v250
  v_mfma_f32_16x16x32_bf16 v[148:151], a[208:211], a[144:147], v[148:151]
  v_exp_f32 v251, v251
  v_mfma_f32_16x16x32_bf16 v[164:167], a[208:211], a[160:163], 0
  v_exp_f32 v252, v252
  v_mfma_f32_16x16x32_bf16 v[164:167], a[212:215], a[164:167], v[164:167]
  v_cvt_pk_bf16_f32 v218, v220, v221
  v_exp_f32 v253, v253
  v_mfma_f32_16x16x32_bf16 v[164:167], a[216:219], a[168:171], v[164:167]
  v_exp_f32 v254, v254
  v_mfma_f32_16x16x32_bf16 v[164:167], a[220:223], a[172:175], v[164:167]
  v_cvt_pk_bf16_f32 v219, v222, v223
  v_cvt_pk_bf16_f32 v232, v232, v233
  v_mfma_f32_16x16x32_bf16 v[180:183], a[220:223], a[188:191], 0
  v_exp_f32 v255, v255
  v_cvt_pk_bf16_f32 v233, v234, v235
  v_mfma_f32_16x16x32_bf16 v[180:183], a[216:219], a[184:187], v[180:183]
  s_add_u32 m0, s30, 65536
  s_xor_b32 s40, s33, 0x0
  v_exp_f32 v128, v128
  v_mfma_f32_16x16x32_bf16 v[180:183], a[212:215], a[180:183], v[180:183]
  s_waitcnt vmcnt(12)
  buffer_load_dwordx4 v22, s[20:23], s40 offen nt lds
  v_mfma_f32_16x16x32_bf16 v[180:183], a[208:211], a[176:179], v[180:183]
  s_waitcnt vmcnt(5) lgkmcnt(0)
  s_cmpk_lt_i32 s10, 0x0
  s_cbranch_scc0 L_fb2_14
  s_waitcnt vmcnt(4)
L_fb2_14:
  s_barrier
  v_mfma_f32_16x16x32_bf16 v[184:187], a[224:227], a[176:179], 0
  ds_read_b64_tr_b16 a[192:193], v14 offset:49152
  v_cvt_pk_bf16_f32 v234, v236, v237
  v_mfma_f32_16x16x32_bf16 v[184:187], a[228:231], a[180:183], v[184:187]
  v_exp_f32 v129, v129
  v_cvt_pk_bf16_f32 v235, v238, v239
  v_mfma_f32_16x16x32_bf16 v[184:187], a[232:235], a[184:187], v[184:187]
  ds_read_b64_tr_b16 a[194:195], v14 offset:53248
  v_cvt_pk_bf16_f32 v248, v248, v249
  v_mfma_f32_16x16x32_bf16 v[184:187], a[236:239], a[188:191], v[184:187]
  v_exp_f32 v130, v130
  v_mfma_f32_16x16x32_bf16 v[168:171], a[236:239], a[172:175], 0
  ds_read_b64_tr_b16 a[196:197], v14 offset:57344
  v_exp_f32 v131, v131
  v_mfma_f32_16x16x32_bf16 v[168:171], a[232:235], a[168:171], v[168:171]
  v_exp_f32 v132, v132
  v_mfma_f32_16x16x32_bf16 v[168:171], a[228:231], a[164:167], v[168:171]
  ds_read_b64_tr_b16 a[198:199], v14 offset:61440
  v_cvt_pk_bf16_f32 v249, v250, v251
  v_mfma_f32_16x16x32_bf16 v[168:171], a[224:227], a[160:163], v[168:171]
  v_exp_f32 v133, v133
  v_cvt_pk_bf16_f32 v250, v252, v253
  v_mfma_f32_16x16x32_bf16 v[152:155], a[224:227], a[144:147], 0
  ds_read_b64_tr_b16 a[200:201], v15 offset:49152
  v_cvt_pk_bf16_f32 v251, v254, v255
  v_mfma_f32_16x16x32_bf16 v[152:155], a[228:231], a[148:151], v[152:155]
  v_exp_f32 v134, v134
  v_mfma_f32_16x16x32_bf16 v[152:155], a[232:235], a[152:155], v[152:155]
  ds_read_b64_tr_b16 a[202:203], v15 offset:53248
  v_exp_f32 v135, v135
  v_mfma_f32_16x16x32_bf16 v[152:155], a[236:239], a[156:159], v[152:155]
  v_exp_f32 v144, v144
  v_mfma_f32_16x16x32_bf16 v[136:139], a[236:239], a[140:143], 0
  ds_read_b64_tr_b16 a[204:205], v15 offset:57344
  v_cvt_pk_bf16_f32 v128, v128, v129
  v_mfma_f32_16x16x32_bf16 v[136:139], a[232:235], a[136:139], v[136:139]
  v_exp_f32 v145, v145
  v_cvt_pk_bf16_f32 v129, v130, v131
  v_mfma_f32_16x16x32_bf16 v[136:139], a[228:231], a[132:135], v[136:139]
  s_add_u32 m0, s30, 66560
  s_xor_b32 s40, s33, 0xc00
  ds_read_b64_tr_b16 a[206:207], v15 offset:61440
  v_cvt_pk_bf16_f32 v130, v132, v133
  v_mfma_f32_16x16x32_bf16 v[136:139], a[224:227], a[128:131], v[136:139]
  s_waitcnt vmcnt(12)
  buffer_load_dwordx4 v23, s[20:23], s40 offen nt lds
  v_mfma_f32_16x16x32_bf16 v[140:143], a[240:243], a[128:131], 0
  ds_read_b64_tr_b16 a[208:209], v16 offset:49152
  v_cvt_pk_bf16_f32 v131, v134, v135
  v_mfma_f32_16x16x32_bf16 v[140:143], a[244:247], a[132:135], v[140:143]
  v_exp_f32 v146, v146
  v_mfma_f32_16x16x32_bf16 v[140:143], a[248:251], a[136:139], v[140:143]
  ds_read_b64_tr_b16 a[210:211], v16 offset:53248
  v_cvt_pk_bf16_f32 v144, v144, v145
  v_mfma_f32_16x16x32_bf16 v[140:143], a[252:255], a[140:143], v[140:143]
  v_exp_f32 v147, v147
  v_mfma_f32_16x16x32_bf16 v[156:159], a[252:255], a[156:159], 0
  ds_read_b64_tr_b16 a[212:213], v16 offset:57344
  v_exp_f32 v148, v148
  v_mfma_f32_16x16x32_bf16 v[156:159], a[248:251], a[152:155], v[156:159]
  v_exp_f32 v149, v149
  v_mfma_f32_16x16x32_bf16 v[156:159], a[244:247], a[148:151], v[156:159]
  ds_read_b64_tr_b16 a[214:215], v16 offset:61440
  v_exp_f32 v150, v150
  v_mfma_f32_16x16x32_bf16 v[156:159], a[240:243], a[144:147], v[156:159]
  v_exp_f32 v151, v151
  v_mfma_f32_16x16x32_bf16 v[172:175], a[240:243], a[160:163], 0
  ds_read_b64_tr_b16 a[216:217], v17 offset:49152
  v_cvt_pk_bf16_f32 v145, v146, v147
  v_mfma_f32_16x16x32_bf16 v[172:175], a[244:247], a[164:167], v[172:175]
  v_exp_f32 v160, v160
  v_cvt_pk_bf16_f32 v146, v148, v149
  v_mfma_f32_16x16x32_bf16 v[172:175], a[248:251], a[168:171], v[172:175]
  ds_read_b64_tr_b16 a[218:219], v17 offset:53248
  v_cvt_pk_bf16_f32 v147, v150, v151
  v_mfma_f32_16x16x32_bf16 v[172:175], a[252:255], a[172:175], v[172:175]
  v_exp_f32 v161, v161
  v_mfma_f32_16x16x32_bf16 v[188:191], a[252:255], a[188:191], 0
  ds_read_b64_tr_b16 a[220:221], v17 offset:57344
  v_exp_f32 v162, v162
  v_mfma_f32_16x16x32_bf16 v[188:191], a[248:251], a[184:187], v[188:191]
  v_exp_f32 v163, v163
  v_mfma_f32_16x16x32_bf16 v[188:191], a[244:247], a[180:183], v[188:191]
  ds_read_b64_tr_b16 a[222:223], v17 offset:61440
  v_cvt_pk_bf16_f32 v160, v160, v161
  v_mfma_f32_16x16x32_bf16 v[188:191], a[240:243], a[176:179], v[188:191]
  v_exp_f32 v164, v164
  v_cvt_pk_bf16_f32 v161, v162, v163
  v_mfma_f32_16x16x32_bf16 v[48:51], v[44:47], v[192:195], v[48:51]
  ds_read_b64_tr_b16 a[224:225], v18 offset:49152
  v_mfma_f32_16x16x32_bf16 v[48:51], v[44:47], v[200:203], v[48:51]
  v_lshrrev_b32 v120, 8, v26
  v_exp_f32 v165, v165
  v_mfma_f32_16x16x32_bf16 v[52:55], v[44:47], v[208:211], v[52:55]
  s_add_u32 m0, s30, 67584
  s_xor_b32 s40, s33, 0x10400
  ds_read_b64_tr_b16 a[226:227], v18 offset:53248
  v_lshl_add_u32 v120, v120, 5, s31
  v_mfma_f32_16x16x32_bf16 v[52:55], v[44:47], v[216:219], v[52:55]
  s_waitcnt vmcnt(12)
  buffer_load_dwordx4 v24, s[20:23], s40 offen nt lds
  v_mfma_f32_16x16x32_bf16 v[56:59], v[44:47], v[224:227], v[56:59]
  ds_read_b64_tr_b16 a[228:229], v18 offset:57344
  v_cvt_pk_bf16_f32 v162, v164, v165
  v_mfma_f32_16x16x32_bf16 v[56:59], v[44:47], v[232:235], v[56:59]
  v_exp_f32 v166, v166
  v_mfma_f32_16x16x32_bf16 v[60:63], v[44:47], v[240:243], v[60:63]
  ds_read_b64_tr_b16 a[230:231], v18 offset:61440
  v_exp_f32 v167, v167
  v_mfma_f32_16x16x32_bf16 v[60:63], v[44:47], v[248:251], v[60:63]
  s_waitcnt lgkmcnt(4)
  v_exp_f32 v176, v176
  v_mfma_f32_16x16x32_bf16 a[12:15], v[200:203], a[220:223], a[12:15]
  ds_read_b64_tr_b16 a[232:233], v19 offset:49152
  v_rcp_f32 v112, v48
  v_mfma_f32_16x16x32_bf16 a[12:15], v[192:195], a[216:219], a[12:15]
  v_exp_f32 v177, v177
  v_mfma_f32_16x16x32_bf16 a[8:11], v[192:195], a[208:211], a[8:11]
  ds_read_b64_tr_b16 a[234:235], v19 offset:53248
  v_rcp_f32 v113, v52
  v_mfma_f32_16x16x32_bf16 a[8:11], v[200:203], a[212:215], a[8:11]
  s_nop 0
  ds_write_b64 v27, v[112:113] offset:6208
  v_mfma_f32_16x16x32_bf16 a[4:7], v[200:203], a[204:207], a[4:7]
  ds_read_b64_tr_b16 a[236:237], v19 offset:57344
  ds_read_b128 v[112:115], v120 offset:6208
  v_mfma_f32_16x16x32_bf16 a[4:7], v[192:195], a[200:203], a[4:7]
  v_cvt_pk_bf16_f32 v163, v166, v167
  v_mfma_f32_16x16x32_bf16 a[0:3], v[192:195], a[192:195], a[0:3]
  ds_read_b64_tr_b16 a[238:239], v19 offset:61440
  ds_read_b128 v[116:119], v120 offset:6224
  v_cvt_pk_bf16_f32 v176, v176, v177
  v_mfma_f32_16x16x32_bf16 a[0:3], v[200:203], a[196:199], a[0:3]
  v_exp_f32 v178, v178
  v_mfma_f32_16x16x32_bf16 a[32:35], v[216:219], a[196:199], a[32:35]
  s_add_u32 m0, s30, 68608
  s_xor_b32 s40, s33, 0x10800
  ds_read_b64_tr_b16 a[240:241], v20 offset:49152
  v_mfma_f32_16x16x32_bf16 a[32:35], v[208:211], a[192:195], a[32:35]
  s_waitcnt vmcnt(12)
  buffer_load_dwordx4 v25, s[20:23], s40 offen nt lds
  v_mfma_f32_16x16x32_bf16 a[36:39], v[208:211], a[200:203], a[36:39]
  ds_read_b64_tr_b16 a[242:243], v20 offset:53248
  v_mfma_f32_16x16x32_bf16 a[36:39], v[216:219], a[204:207], a[36:39]
  v_accvgpr_read_b32 v36, a0
  v_accvgpr_read_b32 v37, a4
  v_accvgpr_read_b32 v38, a8
  v_accvgpr_read_b32 v39, a12
  v_mfma_f32_16x16x32_bf16 a[40:43], v[216:219], a[212:215], a[40:43]
  ds_read_b64_tr_b16 a[244:245], v20 offset:57344
  v_exp_f32 v179, v179
  v_mfma_f32_16x16x32_bf16 a[40:43], v[208:211], a[208:211], a[40:43]
  v_exp_f32 v180, v180
  v_mfma_f32_16x16x32_bf16 a[44:47], v[208:211], a[216:219], a[44:47]
  ds_read_b64_tr_b16 a[246:247], v20 offset:61440
  v_exp_f32 v181, v181
  v_mfma_f32_16x16x32_bf16 a[44:47], v[216:219], a[220:223], a[44:47]
  v_accvgpr_read_b32 v40, a1
  v_accvgpr_read_b32 v41, a5
  v_accvgpr_read_b32 v42, a9
  s_waitcnt lgkmcnt(6)
  v_pk_mul_f32 v[36:37], v[36:37], v[112:113] op_sel:[0,0] op_sel_hi:[1,0]
  v_pk_mul_f32 v[38:39], v[38:39], v[112:113] op_sel:[0,0] op_sel_hi:[1,0]
  v_accvgpr_read_b32 v43, a13
  v_mfma_f32_16x16x32_bf16 a[76:79], v[232:235], a[220:223], a[76:79]
  ds_read_b64_tr_b16 a[248:249], v21 offset:49152
  v_cvt_pk_bf16_f32 v177, v178, v179
  v_mfma_f32_16x16x32_bf16 a[76:79], v[224:227], a[216:219], a[76:79]
  v_exp_f32 v182, v182
  v_mfma_f32_16x16x32_bf16 a[72:75], v[224:227], a[208:211], a[72:75]
  ds_read_b64_tr_b16 a[250:251], v21 offset:53248
  v_exp_f32 v183, v183
  v_mfma_f32_16x16x32_bf16 a[72:75], v[232:235], a[212:215], a[72:75]
  v_accvgpr_read_b32 v124, a2
  v_accvgpr_read_b32 v125, a6
  v_accvgpr_read_b32 v126, a10
  v_accvgpr_read_b32 v127, a14
  v_cvt_pk_bf16_f32 v64, v36, v37
  v_pk_mul_f32 v[40:41], v[40:41], v[114:115] op_sel:[0,0] op_sel_hi:[1,0]
  v_pk_mul_f32 v[42:43], v[42:43], v[114:115] op_sel:[0,0] op_sel_hi:[1,0]
  v_cvt_pk_bf16_f32 v65, v38, v39
  v_mfma_f32_16x16x32_bf16 a[68:71], v[232:235], a[204:207], a[68:71]
  s_add_u32 m0, s30, 32768
  s_xor_b32 s40, s33, 0x3800
  ds_read_b64_tr_b16 a[252:253], v21 offset:57344
  v_cvt_pk_bf16_f32 v178, v180, v181
  v_mfma_f32_16x16x32_bf16 a[68:71], v[224:227], a[200:203], a[68:71]
  s_waitcnt vmcnt(12)
  buffer_load_dwordx4 v22, s[16:19], s40 offen nt lds
  v_mfma_f32_16x16x32_bf16 a[64:67], v[224:227], a[192:195], a[64:67]
  ds_read_b64_tr_b16 a[254:255], v21 offset:61440
  v_cvt_pk_bf16_f32 v179, v182, v183
  v_mfma_f32_16x16x32_bf16 a[64:67], v[232:235], a[196:199], a[64:67]
  ds_write_b64 v27, v[64:65] offset:2080
  v_accvgpr_read_b32 v36, a3
  v_accvgpr_read_b32 v37, a7
  v_accvgpr_read_b32 v38, a11
  v_accvgpr_read_b32 v39, a15
  v_cvt_pk_bf16_f32 v68, v40, v41
  s_waitcnt lgkmcnt(9)
  v_pk_mul_f32 v[124:125], v[124:125], v[116:117] op_sel:[0,0] op_sel_hi:[1,0]
  v_pk_mul_f32 v[126:127], v[126:127], v[116:117] op_sel:[0,0] op_sel_hi:[1,0]
  v_cvt_pk_bf16_f32 v69, v42, v43
  v_mfma_f32_16x16x32_bf16 a[96:99], v[248:251], a[196:199], a[96:99]
  v_subrev_u32 v50, 0x37800000, v48
  v_subrev_u32 v54, 0x37800000, v52
  v_mfma_f32_16x16x32_bf16 a[96:99], v[240:243], a[192:195], a[96:99]
  v_exp_f32 v136, v136
  v_mfma_f32_16x16x32_bf16 a[100:103], v[240:243], a[200:203], a[100:103]
  ds_write_b64 v27, v[68:69] offset:2592
  v_accvgpr_read_b32 v40, a32
  v_accvgpr_read_b32 v41, a36
  v_accvgpr_read_b32 v42, a40
  v_accvgpr_read_b32 v43, a44
  v_cvt_pk_bf16_f32 v72, v124, v125
  v_pk_mul_f32 v[36:37], v[36:37], v[118:119] op_sel:[0,0] op_sel_hi:[1,0]
  v_pk_mul_f32 v[38:39], v[38:39], v[118:119] op_sel:[0,0] op_sel_hi:[1,0]
  v_cvt_pk_bf16_f32 v73, v126, v127
  v_mfma_f32_16x16x32_bf16 a[100:103], v[248:251], a[204:207], a[100:103]
  s_waitcnt vmcnt(5) lgkmcnt(0)
  s_barrier
  v_exp_f32 v137, v137
  v_mfma_f32_16x16x32_bf16 a[104:107], v[248:251], a[212:215], a[104:107]
  ds_read_b128 a[192:195], v10 offset:16384
  v_subrev_u32 v58, 0x37800000, v56
  v_mfma_f32_16x16x32_bf16 a[104:107], v[240:243], a[208:211], a[104:107]
  v_exp_f32 v138, v138
  v_mfma_f32_16x16x32_bf16 a[108:111], v[240:243], a[216:219], a[108:111]
  ds_write_b64 v27, v[72:73] offset:3104
  v_accvgpr_read_b32 v124, a33
  v_accvgpr_read_b32 v125, a37
  v_accvgpr_read_b32 v126, a41
  v_accvgpr_read_b32 v127, a45
  v_cvt_pk_bf16_f32 v76, v36, v37
  v_pk_mul_f32 v[40:41], v[40:41], v[112:113] op_sel:[0,1] op_sel_hi:[1,1]
  v_pk_mul_f32 v[42:43], v[42:43], v[112:113] op_sel:[0,1] op_sel_hi:[1,1]
  v_cvt_pk_bf16_f32 v77, v38, v39
  v_mfma_f32_16x16x32_bf16 a[108:111], v[248:251], a[220:223], a[108:111]
  v_exp_f32 v139, v139
  v_subrev_u32 v62, 0x37800000, v60
  v_mfma_f32_16x16x32_bf16 a[28:31], v[200:203], a[252:255], a[28:31]
  s_add_u32 m0, s30, 33792
  s_xor_b32 s40, s33, 0x3400
  ds_read_b128 a[196:199], v11 offset:16384
  v_rcp_f32 v2, v56
  v_mfma_f32_16x16x32_bf16 a[28:31], v[192:195], a[248:251], a[28:31]
  s_waitcnt vmcnt(12)
  buffer_load_dwordx4 v23, s[16:19], s40 offen nt lds
  v_mfma_f32_16x16x32_bf16 a[24:27], v[192:195], a[240:243], a[24:27]
  ds_write_b64 v27, v[76:77] offset:3616
  v_accvgpr_read_b32 v36, a34
  v_accvgpr_read_b32 v37, a38
  v_accvgpr_read_b32 v38, a42
  v_accvgpr_read_b32 v39, a46
  v_cvt_pk_bf16_f32 v80, v40, v41
  v_pk_mul_f32 v[124:125], v[124:125], v[114:115] op_sel:[0,1] op_sel_hi:[1,1]
  v_pk_mul_f32 v[126:127], v[126:127], v[114:115] op_sel:[0,1] op_sel_hi:[1,1]
  v_cvt_pk_bf16_f32 v81, v42, v43
  v_mfma_f32_16x16x32_bf16 a[24:27], v[200:203], a[244:247], a[24:27]
  v_max3_u32 v51, v50, v54, v58
  v_mfma_f32_16x16x32_bf16 a[20:23], v[200:203], a[236:239], a[20:23]
  ds_read_b128 a[200:203], v12 offset:16384
  v_rcp_f32 v3, v60
  v_mfma_f32_16x16x32_bf16 a[20:23], v[192:195], a[232:235], a[20:23]
  s_nop 0
  ds_write_b64 v27, v[2:3] offset:6720
  v_mfma_f32_16x16x32_bf16 a[16:19], v[192:195], a[224:227], a[16:19]
  ds_write_b64 v27, v[80:81]
  v_accvgpr_read_b32 v40, a35
  v_accvgpr_read_b32 v41, a39
  v_accvgpr_read_b32 v42, a43
  v_accvgpr_read_b32 v43, a47
  v_cvt_pk_bf16_f32 v84, v124, v125
  v_pk_mul_f32 v[36:37], v[36:37], v[116:117] op_sel:[0,1] op_sel_hi:[1,1]
  v_pk_mul_f32 v[38:39], v[38:39], v[116:117] op_sel:[0,1] op_sel_hi:[1,1]
  v_cvt_pk_bf16_f32 v85, v126, v127
  v_mfma_f32_16x16x32_bf16 a[16:19], v[200:203], a[228:231], a[16:19]
  v_max_u32 v51, v51, v62
  v_mfma_f32_16x16x32_bf16 a[48:51], v[216:219], a[228:231], a[48:51]
  ds_read_b128 a[204:207], v13 offset:16384
  ds_read_b128 v[2:5], v120 offset:6720
  v_mfma_f32_16x16x32_bf16 a[48:51], v[208:211], a[224:227], a[48:51]
  v_exp_f32 v140, v140
  v_cmp_gt_u32 vcc, 0x18000000, v51
  v_mfma_f32_16x16x32_bf16 a[52:55], v[208:211], a[232:235], a[52:55]
  s_add_u32 m0, s30, 34816
  s_xor_b32 s40, s33, 0x13c00
  ds_write_b64 v27, v[84:85] offset:512
  v_accvgpr_read_b32 v124, a16
  v_accvgpr_read_b32 v125, a20
  v_accvgpr_read_b32 v126, a24
  v_accvgpr_read_b32 v127, a28
  v_cvt_pk_bf16_f32 v88, v36, v37
  v_pk_mul_f32 v[40:41], v[40:41], v[118:119] op_sel:[0,1] op_sel_hi:[1,1]
  v_pk_mul_f32 v[42:43], v[42:43], v[118:119] op_sel:[0,1] op_sel_hi:[1,1]
  v_cvt_pk_bf16_f32 v89, v38, v39
  v_mfma_f32_16x16x32_bf16 a[52:55], v[216:219], a[236:239], a[52:55]
  s_waitcnt vmcnt(12)
  buffer_load_dwordx4 v24, s[16:19], s40 offen nt lds
  v_mfma_f32_16x16x32_bf16 a[56:59], v[216:219], a[244:247], a[56:59]
  ds_read_b128 a[208:211], v10 offset:20480
  ds_read_b128 v[6:9], v120 offset:6736
  v_mfma_f32_16x16x32_bf16 a[56:59], v[208:211], a[240:243], a[56:59]
  v_exp_f32 v141, v141
  v_mfma_f32_16x16x32_bf16 a[60:63], v[208:211], a[248:251], a[60:63]
  ds_write_b64 v27, v[88:89] offset:1024
  v_accvgpr_read_b32 v36, a17
  v_accvgpr_read_b32 v37, a21
  v_accvgpr_read_b32 v38, a25
  v_accvgpr_read_b32 v39, a29
  v_cvt_pk_bf16_f32 v92, v40, v41
  v_pk_mul_f32 v[124:125], v[124:125], v[112:113] op_sel:[0,0] op_sel_hi:[1,0]
  v_pk_mul_f32 v[126:127], v[126:127], v[112:113] op_sel:[0,0] op_sel_hi:[1,0]
  v_cvt_pk_bf16_f32 v93, v42, v43
  v_mfma_f32_16x16x32_bf16 a[60:63], v[216:219], a[252:255], a[60:63]
  v_exp_f32 v142, v142
  v_mfma_f32_16x16x32_bf16 a[92:95], v[232:235], a[252:255], a[92:95]
  ds_read_b128 a[212:215], v11 offset:20480
  v_cvt_pk_bf16_f32 v136, v136, v137
  v_mfma_f32_16x16x32_bf16 a[92:95], v[224:227], a[248:251], a[92:95]
  v_exp_f32 v143, v143
  v_cvt_pk_bf16_f32 v137, v138, v139
  v_mfma_f32_16x16x32_bf16 a[88:91], v[224:227], a[240:243], a[88:91]
  ds_write_b64 v27, v[92:93] offset:1536
  v_accvgpr_read_b32 v40, a18
  v_accvgpr_read_b32 v41, a22
  v_accvgpr_read_b32 v42, a26
  v_accvgpr_read_b32 v43, a30
  v_cvt_pk_bf16_f32 v66, v124, v125
  v_pk_mul_f32 v[36:37], v[36:37], v[114:115] op_sel:[0,0] op_sel_hi:[1,0]
  v_pk_mul_f32 v[38:39], v[38:39], v[114:115] op_sel:[0,0] op_sel_hi:[1,0]
  v_cvt_pk_bf16_f32 v67, v126, v127
  v_mfma_f32_16x16x32_bf16 a[88:91], v[232:235], a[244:247], a[88:91]
  v_exp_f32 v152, v152
  v_mfma_f32_16x16x32_bf16 a[84:87], v[232:235], a[236:239], a[84:87]
  ds_read_b128 a[216:219], v12 offset:20480
  v_cvt_pk_bf16_f32 v138, v140, v141
  v_mfma_f32_16x16x32_bf16 a[84:87], v[224:227], a[232:235], a[84:87]
  v_exp_f32 v153, v153
  v_cvt_pk_bf16_f32 v139, v142, v143
  v_mfma_f32_16x16x32_bf16 a[80:83], v[224:227], a[224:227], a[80:83]
  ds_write_b64 v27, v[66:67] offset:4160
  v_accvgpr_read_b32 v124, a19
  v_accvgpr_read_b32 v125, a23
  v_accvgpr_read_b32 v126, a27
  v_accvgpr_read_b32 v127, a31
  v_cvt_pk_bf16_f32 v70, v36, v37
  v_pk_mul_f32 v[40:41], v[40:41], v[116:117] op_sel:[0,0] op_sel_hi:[1,0]
  v_pk_mul_f32 v[42:43], v[42:43], v[116:117] op_sel:[0,0] op_sel_hi:[1,0]
  v_cvt_pk_bf16_f32 v71, v38, v39
  v_mfma_f32_16x16x32_bf16 a[80:83], v[232:235], a[228:231], a[80:83]
  ds_read_b64_tr_b16 v[64:65], v0 offset:2080
  ds_read_b64_tr_b16 v[66:67], v0 offset:2112
  v_mfma_f32_16x16x32_bf16 a[112:115], v[248:251], a[228:231], a[112:115]
  s_add_u32 m0, s30, 35840
  s_xor_b32 s40, s33, 0x13000
  ds_read_b128 a[220:223], v13 offset:20480
  v_cvt_pk_bf16_f32 v152, v152, v153
  v_mfma_f32_16x16x32_bf16 a[112:115], v[240:243], a[224:227], a[112:115]
  s_waitcnt vmcnt(12)
  buffer_load_dwordx4 v25, s[16:19], s40 offen nt lds
  v_mfma_f32_16x16x32_bf16 a[116:119], v[240:243], a[232:235], a[116:119]
  ds_write_b64 v27, v[70:71] offset:4672
  v_accvgpr_read_b32 v36, a48
  v_accvgpr_read_b32 v37, a52
  v_accvgpr_read_b32 v38, a56
  v_accvgpr_read_b32 v39, a60
  v_cvt_pk_bf16_f32 v74, v40, v41
  v_pk_mul_f32 v[124:125], v[124:125], v[118:119] op_sel:[0,0] op_sel_hi:[1,0]
  v_pk_mul_f32 v[126:127], v[126:127], v[118:119] op_sel:[0,0] op_sel_hi:[1,0]
  v_cvt_pk_bf16_f32 v75, v42, v43
  v_mfma_f32_16x16x32_bf16 a[116:119], v[248:251], a[236:239], a[116:119]
  ds_read_b64_tr_b16 v[68:69], v0 offset:2592
  ds_read_b64_tr_b16 v[70:71], v0 offset:2624
  v_mfma_f32_16x16x32_bf16 a[120:123], v[248:251], a[244:247], a[120:123]
  v_exp_f32 v154, v154
  v_mfma_f32_16x16x32_bf16 a[120:123], v[240:243], a[240:243], a[120:123]
  v_exp_f32 v155, v155
  v_mfma_f32_16x16x32_bf16 a[124:127], v[240:243], a[248:251], a[124:127]
  ds_write_b64 v27, v[74:75] offset:5184
  v_accvgpr_read_b32 v40, a49
  v_accvgpr_read_b32 v41, a53
  v_accvgpr_read_b32 v42, a57
  v_accvgpr_read_b32 v43, a61
  v_cvt_pk_bf16_f32 v78, v124, v125
  v_pk_mul_f32 v[36:37], v[36:37], v[112:113] op_sel:[0,1] op_sel_hi:[1,1]
  v_pk_mul_f32 v[38:39], v[38:39], v[112:113] op_sel:[0,1] op_sel_hi:[1,1]
  v_cvt_pk_bf16_f32 v79, v126, v127
  v_mfma_f32_16x16x32_bf16 a[124:127], v[248:251], a[252:255], a[124:127]
  s_waitcnt lgkmcnt(4)
  v_exp_f32 v156, v156
  v_cvt_pk_bf16_f32 v153, v154, v155
  s_nop 4
  s_cmp_eq_u64 vcc, -1
  s_cselect_b32 s41, 0, s37
  s_or_b32 s36, s36, s41
  v_exp_f32 v157, v157
  v_exp_f32 v158, v158
  v_cvt_pk_bf16_f32 v154, v156, v157
  v_exp_f32 v159, v159
  s_nop 0
L_pg18:
  s_cbranch_execz L_rt3
  v_cvt_pk_bf16_f32 v155, v158, v159
  s_mov_b32 s48, s35
  s_lshl_b32 s37, s37, 1
  s_mov_b32 s32, s33
  s_mov_b32 s35, s34
L_blk3:
  v_mfma_f32_16x16x32_bf16 v[240:243], a[192:195], a[176:179], 0
  ds_read_b64_tr_b16 v[72:73], v0 offset:3104
  ds_read_b64_tr_b16 v[74:75], v0 offset:3136
  v_mfma_f32_16x16x32_bf16 v[240:243], a[196:199], a[180:183], v[240:243]
  ds_read_b128 a[224:227], v10 offset:24576
  v_mfma_f32_16x16x32_bf16 v[240:243], a[200:203], a[184:187], v[240:243]
  ds_write_b64 v27, v[78:79] offset:5696
  v_accvgpr_read_b32 v124, a50
  v_accvgpr_read_b32 v125, a54
  v_accvgpr_read_b32 v126, a58
  v_accvgpr_read_b32 v127, a62
  v_cvt_pk_bf16_f32 v82, v36, v37
  v_pk_mul_f32 v[40:41], v[40:41], v[114:115] op_sel:[0,1] op_sel_hi:[1,1]
  v_pk_mul_f32 v[42:43], v[42:43], v[114:115] op_sel:[0,1] op_sel_hi:[1,1]
  v_cvt_pk_bf16_f32 v83, v38, v39
  v_mfma_f32_16x16x32_bf16 v[240:243], a[204:207], a[188:191], v[240:243]
  ds_read_b64_tr_b16 v[76:77], v0 offset:3616
  ds_read_b64_tr_b16 v[78:79], v0 offset:3648
  v_mfma_f32_16x16x32_bf16 v[224:227], a[204:207], a[172:175], 0
  s_add_u32 m0, s30, 81920
  s_xor_b32 s40, s32, 0x400
  ds_read_b128 a[228:231], v11 offset:24576
  v_exp_f32 v168, v168
  v_mfma_f32_16x16x32_bf16 v[224:227], a[200:203], a[168:171], v[224:227]
  s_waitcnt vmcnt(12)
  buffer_load_dwordx4 v22, s[20:23], s40 offen nt lds
  v_mfma_f32_16x16x32_bf16 v[224:227], a[196:199], a[164:167], v[224:227]
  ds_write_b64 v27, v[82:83] offset:2080
  v_accvgpr_read_b32 v36, a51
  v_accvgpr_read_b32 v37, a55
  v_accvgpr_read_b32 v38, a59
  v_accvgpr_read_b32 v39, a63
  v_cvt_pk_bf16_f32 v86, v40, v41
  v_pk_mul_f32 v[124:125], v[124:125], v[116:117] op_sel:[0,1] op_sel_hi:[1,1]
  v_pk_mul_f32 v[126:127], v[126:127], v[116:117] op_sel:[0,1] op_sel_hi:[1,1]
  v_cvt_pk_bf16_f32 v87, v42, v43
  v_mfma_f32_16x16x32_bf16 v[224:227], a[192:195], a[160:163], v[224:227]
  ds_read_b128 a[232:235], v12 offset:24576
  ds_read_b64_tr_b16 v[80:81], v0
  v_mfma_f32_16x16x32_bf16 v[208:211], a[192:195], a[144:147], 0
  ds_read_b64_tr_b16 v[82:83], v0 offset:32
  v_mfma_f32_16x16x32_bf16 v[208:211], a[196:199], a[148:151], v[208:211]
  v_exp_f32 v169, v169
  v_mfma_f32_16x16x32_bf16 v[208:211], a[200:203], a[152:155], v[208:211]
  ds_read_b128 a[236:239], v13 offset:24576
  v_cvt_pk_bf16_f32 v168, v168, v169
  v_mfma_f32_16x16x32_bf16 v[208:211], a[204:207], a[156:159], v[208:211]
  ds_write_b64 v27, v[86:87] offset:2592
  v_accvgpr_read_b32 v40, a64
  v_accvgpr_read_b32 v41, a68
  v_accvgpr_read_b32 v42, a72
  v_accvgpr_read_b32 v43, a76
  v_cvt_pk_bf16_f32 v90, v124, v125
  v_pk_mul_f32 v[36:37], v[36:37], v[118:119] op_sel:[0,1] op_sel_hi:[1,1]
  v_pk_mul_f32 v[38:39], v[38:39], v[118:119] op_sel:[0,1] op_sel_hi:[1,1]
  v_cvt_pk_bf16_f32 v91, v126, v127
  v_mfma_f32_16x16x32_bf16 v[192:195], a[204:207], a[140:143], 0
  ds_read_b64_tr_b16 v[84:85], v0 offset:512
  ds_read_b64_tr_b16 v[86:87], v0 offset:544
  v_mfma_f32_16x16x32_bf16 v[192:195], a[200:203], a[136:139], v[192:195]
  s_add_u32 m0, s30, 82944
  s_xor_b32 s40, s32, 0x800
  ds_read_b128 a[240:243], v10 offset:28672
  v_mfma_f32_16x16x32_bf16 v[192:195], a[196:199], a[132:135], v[192:195]
  s_waitcnt vmcnt(12)
  buffer_load_dwordx4 v23, s[20:23], s40 offen nt lds
  v_mfma_f32_16x16x32_bf16 v[192:195], a[192:195], a[128:131], v[192:195]
  v_exp_f32 v170, v170
  v_mfma_f32_16x16x32_bf16 v[196:199], a[208:211], a[128:131], 0
  ds_read_b128 a[244:247], v11 offset:28672
  v_mfma_f32_16x16x32_bf16 v[196:199], a[212:215], a[132:135], v[196:199]
  ds_write_b64 v27, v[90:91] offset:3104
  v_accvgpr_read_b32 v124, a65
  v_accvgpr_read_b32 v125, a69
  v_accvgpr_read_b32 v126, a73
  v_accvgpr_read_b32 v127, a77
  v_cvt_pk_bf16_f32 v94, v36, v37
  v_pk_mul_f32 v[40:41], v[40:41], v[2:3] op_sel:[0,0] op_sel_hi:[1,0]
  v_pk_mul_f32 v[42:43], v[42:43], v[2:3] op_sel:[0,0] op_sel_hi:[1,0]
  v_cvt_pk_bf16_f32 v95, v38, v39
  v_mfma_f32_16x16x32_bf16 v[196:199], a[216:219], a[136:139], v[196:199]
  ds_read_b64_tr_b16 v[88:89], v0 offset:1024
  ds_read_b64_tr_b16 v[90:91], v0 offset:1056
  v_mfma_f32_16x16x32_bf16 v[196:199], a[220:223], a[140:143], v[196:199]
  ds_read_b128 a[248:251], v12 offset:28672
  v_exp_f32 v171, v171
  v_mfma_f32_16x16x32_bf16 v[212:215], a[220:223], a[156:159], 0
  v_exp_f32 v172, v172
  v_mfma_f32_16x16x32_bf16 v[212:215], a[216:219], a[152:155], v[212:215]
  ds_write_b64 v27, v[94:95] offset:3616
  v_accvgpr_read_b32 v36, a66
  v_accvgpr_read_b32 v37, a70
  v_accvgpr_read_b32 v38, a74
  v_accvgpr_read_b32 v39, a78
  v_cvt_pk_bf16_f32 v96, v40, v41
  v_pk_mul_f32 v[124:125], v[124:125], v[4:5] op_sel:[0,0] op_sel_hi:[1,0]
  v_pk_mul_f32 v[126:127], v[126:127], v[4:5] op_sel:[0,0] op_sel_hi:[1,0]
  v_cvt_pk_bf16_f32 v97, v42, v43
  v_mfma_f32_16x16x32_bf16 v[212:215], a[212:215], a[148:151], v[212:215]
  ds_read_b128 a[252:255], v13 offset:28672
  ds_read_b64_tr_b16 v[92:93], v0 offset:1536
  v_mfma_f32_16x16x32_bf16 v[212:215], a[208:211], a[144:147], v[212:215]
  s_add_u32 m0, s30, 83968
  s_xor_b32 s40, s32, 0x10000
  ds_read_b64_tr_b16 v[94:95], v0 offset:1568
  v_cvt_pk_bf16_f32 v169, v170, v171
  v_mfma_f32_16x16x32_bf16 v[228:231], a[208:211], a[160:163], 0
  s_waitcnt vmcnt(12)
  buffer_load_dwordx4 v24, s[20:23], s40 offen nt lds
  v_mfma_f32_16x16x32_bf16 v[228:231], a[212:215], a[164:167], v[228:231]
  v_mfma_f32_16x16x32_bf16 v[228:231], a[216:219], a[168:171], v[228:231]
  ds_write_b64 v27, v[96:97] offset:2080
  v_accvgpr_read_b32 v40, a67
  v_accvgpr_read_b32 v41, a71
  v_accvgpr_read_b32 v42, a75
  v_accvgpr_read_b32 v43, a79
  v_cvt_pk_bf16_f32 v100, v124, v125
  v_pk_mul_f32 v[36:37], v[36:37], v[6:7] op_sel:[0,0] op_sel_hi:[1,0]
  v_pk_mul_f32 v[38:39], v[38:39], v[6:7] op_sel:[0,0] op_sel_hi:[1,0]
  v_cvt_pk_bf16_f32 v101, v126, v127
  v_mfma_f32_16x16x32_bf16 v[228:231], a[220:223], a[172:175], v[228:231]
  v_exp_f32 v173, v173
  v_mfma_f32_16x16x32_bf16 v[244:247], a[220:223], a[188:191], 0
  v_exp_f32 v174, v174
  v_cvt_pk_bf16_f32 v170, v172, v173
  v_mfma_f32_16x16x32_bf16 v[244:247], a[216:219], a[184:187], v[244:247]
  v_exp_f32 v175, v175
  v_mfma_f32_16x16x32_bf16 v[244:247], a[212:215], a[180:183], v[244:247]
  v_exp_f32 v184, v184
  v_mfma_f32_16x16x32_bf16 v[244:247], a[208:211], a[176:179], v[244:247]
  s_waitcnt vmcnt(7) lgkmcnt(0)
  s_barrier
  v_cvt_pk_bf16_f32 v171, v174, v175
  v_mfma_f32_16x16x32_bf16 v[248:251], a[224:227], a[176:179], 0
  ds_read_b64_tr_b16 a[192:193], v14
  v_mfma_f32_16x16x32_bf16 v[248:251], a[228:231], a[180:183], v[248:251]
  ds_write_b64 v27, v[100:101] offset:2592
  v_accvgpr_read_b32 v132, a96
  v_accvgpr_read_b32 v133, a100
  v_accvgpr_read_b32 v134, a104
  v_accvgpr_read_b32 v135, a108
  v_cvt_pk_bf16_f32 v104, v36, v37
  v_pk_mul_f32 v[40:41], v[40:41], v[8:9] op_sel:[0,0] op_sel_hi:[1,0]
  v_pk_mul_f32 v[42:43], v[42:43], v[8:9] op_sel:[0,0] op_sel_hi:[1,0]
  v_cvt_pk_bf16_f32 v105, v38, v39
  v_mfma_f32_16x16x32_bf16 v[248:251], a[232:235], a[184:187], v[248:251]
  s_add_u32 m0, s30, 84992
  s_xor_b32 s40, s32, 0x10c00
  ds_read_b64_tr_b16 a[194:195], v14 offset:4096
  v_exp_f32 v185, v185
  v_mfma_f32_16x16x32_bf16 v[248:251], a[236:239], a[188:191], v[248:251]
  s_waitcnt vmcnt(12)
  buffer_load_dwordx4 v25, s[20:23], s40 offen nt lds
  v_mfma_f32_16x16x32_bf16 v[232:235], a[236:239], a[172:175], 0
  ds_read_b64_tr_b16 a[196:197], v14 offset:8192
  v_mfma_f32_16x16x32_bf16 v[232:235], a[232:235], a[168:171], v[232:235]
  ds_write_b64 v27, v[104:105] offset:3104
  v_accvgpr_read_b32 v36, a97
  v_accvgpr_read_b32 v37, a101
  v_accvgpr_read_b32 v38, a105
  v_accvgpr_read_b32 v39, a109
  v_cvt_pk_bf16_f32 v108, v40, v41
  v_pk_mul_f32 v[132:133], v[132:133], v[2:3] op_sel:[0,1] op_sel_hi:[1,1]
  v_pk_mul_f32 v[134:135], v[134:135], v[2:3] op_sel:[0,1] op_sel_hi:[1,1]
  v_cvt_pk_bf16_f32 v109, v42, v43
  v_mfma_f32_16x16x32_bf16 v[232:235], a[228:231], a[164:167], v[232:235]
  ds_read_b64_tr_b16 a[198:199], v14 offset:12288
  v_cvt_pk_bf16_f32 v184, v184, v185
  v_mfma_f32_16x16x32_bf16 v[232:235], a[224:227], a[160:163], v[232:235]
  v_exp_f32 v186, v186
  v_mfma_f32_16x16x32_bf16 v[216:219], a[224:227], a[144:147], 0
  ds_read_b64_tr_b16 a[200:201], v15
  v_mfma_f32_16x16x32_bf16 v[216:219], a[228:231], a[148:151], v[216:219]
  ds_write_b64 v27, v[108:109] offset:3616
  v_accvgpr_read_b32 v40, a98
  v_accvgpr_read_b32 v41, a102
  v_accvgpr_read_b32 v42, a106
  v_accvgpr_read_b32 v43, a110
  v_cvt_pk_bf16_f32 v112, v132, v133
  v_pk_mul_f32 v[36:37], v[36:37], v[4:5] op_sel:[0,1] op_sel_hi:[1,1]
  v_pk_mul_f32 v[38:39], v[38:39], v[4:5] op_sel:[0,1] op_sel_hi:[1,1]
  v_cvt_pk_bf16_f32 v113, v134, v135
  v_mfma_f32_16x16x32_bf16 v[216:219], a[232:235], a[152:155], v[216:219]
  s_xor_b32 s43, s48, 0x0
  ds_read_b64_tr_b16 a[202:203], v15 offset:4096
  v_exp_f32 v187, v187
  v_mfma_f32_16x16x32_bf16 v[216:219], a[236:239], a[156:159], v[216:219]
  s_waitcnt vmcnt(12)
  buffer_store_dwordx4 v[64:67], v26, s[24:27], s43 offen sc1
  v_mfma_f32_16x16x32_bf16 v[200:203], a[236:239], a[140:143], 0
  ds_read_b64_tr_b16 a[204:205], v15 offset:8192
  v_mfma_f32_16x16x32_bf16 v[200:203], a[232:235], a[136:139], v[200:203]
  v_exp_f32 v188, v188
  v_mfma_f32_16x16x32_bf16 v[200:203], a[228:231], a[132:135], v[200:203]
  ds_read_b64_tr_b16 a[206:207], v15 offset:12288
  v_cvt_pk_bf16_f32 v185, v186, v187
  v_mfma_f32_16x16x32_bf16 v[200:203], a[224:227], a[128:131], v[200:203]
  ds_write_b64 v27, v[112:113]
  v_accvgpr_read_b32 v132, a99
  v_accvgpr_read_b32 v133, a103
  v_accvgpr_read_b32 v134, a107
  v_accvgpr_read_b32 v135, a111
  v_cvt_pk_bf16_f32 v116, v36, v37
  v_pk_mul_f32 v[40:41], v[40:41], v[6:7] op_sel:[0,1] op_sel_hi:[1,1]
  v_pk_mul_f32 v[42:43], v[42:43], v[6:7] op_sel:[0,1] op_sel_hi:[1,1]
  v_cvt_pk_bf16_f32 v117, v38, v39
  v_mfma_f32_16x16x32_bf16 v[204:207], a[240:243], a[128:131], 0
  ds_read_b64_tr_b16 a[208:209], v16
  v_mfma_f32_16x16x32_bf16 v[204:207], a[244:247], a[132:135], v[204:207]
  v_exp_f32 v189, v189
  v_mfma_f32_16x16x32_bf16 v[204:207], a[248:251], a[136:139], v[204:207]
  ds_read_b64_tr_b16 a[210:211], v16 offset:4096
  v_exp_f32 v190, v190
  v_mfma_f32_16x16x32_bf16 v[204:207], a[252:255], a[140:143], v[204:207]
  ds_write_b64 v27, v[116:117] offset:512
  v_accvgpr_read_b32 v36, a80
  v_accvgpr_read_b32 v37, a84
  v_accvgpr_read_b32 v38, a88
  v_accvgpr_read_b32 v39, a92
  v_cvt_pk_bf16_f32 v120, v40, v41
  v_pk_mul_f32 v[132:133], v[132:133], v[8:9] op_sel:[0,1] op_sel_hi:[1,1]
  v_pk_mul_f32 v[134:135], v[134:135], v[8:9] op_sel:[0,1] op_sel_hi:[1,1]
  v_cvt_pk_bf16_f32 v121, v42, v43
  v_mfma_f32_16x16x32_bf16 v[220:223], a[252:255], a[156:159], 0
  ds_read_b64_tr_b16 a[212:213], v16 offset:8192
  v_cvt_pk_bf16_f32 v186, v188, v189
  v_mfma_f32_16x16x32_bf16 v[220:223], a[248:251], a[152:155], v[220:223]
  v_exp_f32 v191, v191
  v_mfma_f32_16x16x32_bf16 v[220:223], a[244:247], a[148:151], v[220:223]
  s_add_u32 m0, s30, 49152
  s_xor_b32 s40, s32, 0x3c00
  ds_read_b64_tr_b16 a[214:215], v16 offset:12288
  v_cvt_pk_bf16_f32 v187, v190, v191
  v_mfma_f32_16x16x32_bf16 v[220:223], a[240:243], a[144:147], v[220:223]
  s_waitcnt vmcnt(12)
  buffer_load_dwordx4 v22, s[16:19], s40 offen nt lds
  v_mfma_f32_16x16x32_bf16 v[236:239], a[240:243], a[160:163], 0
  ds_read_b64_tr_b16 a[216:217], v17
  v_mfma_f32_16x16x32_bf16 v[236:239], a[244:247], a[164:167], v[236:239]
  ds_write_b64 v27, v[120:121] offset:1024
  v_accvgpr_read_b32 v40, a81
  v_accvgpr_read_b32 v41, a85
  v_accvgpr_read_b32 v42, a89
  v_accvgpr_read_b32 v43, a93
  v_cvt_pk_bf16_f32 v124, v132, v133
  v_pk_mul_f32 v[36:37], v[36:37], v[2:3] op_sel:[0,0] op_sel_hi:[1,0]
  v_pk_mul_f32 v[38:39], v[38:39], v[2:3] op_sel:[0,0] op_sel_hi:[1,0]
  v_cvt_pk_bf16_f32 v125, v134, v135
  v_mfma_f32_16x16x32_bf16 v[236:239], a[248:251], a[168:171], v[236:239]
  ds_read_b64_tr_b16 a[218:219], v17 offset:4096
  v_mfma_f32_16x16x32_bf16 v[236:239], a[252:255], a[172:175], v[236:239]
  v_exp_f32 v192, v192
  v_mfma_f32_16x16x32_bf16 v[252:255], a[252:255], a[188:191], 0
  ds_read_b64_tr_b16 a[220:221], v17 offset:8192
  v_exp_f32 v193, v193
  v_mfma_f32_16x16x32_bf16 v[252:255], a[248:251], a[184:187], v[252:255]
  ds_write_b64 v27, v[124:125] offset:1536
  v_accvgpr_read_b32 v132, a82
  v_accvgpr_read_b32 v133, a86
  v_accvgpr_read_b32 v134, a90
  v_accvgpr_read_b32 v135, a94
  v_cvt_pk_bf16_f32 v98, v36, v37
  v_pk_mul_f32 v[40:41], v[40:41], v[4:5] op_sel:[0,0] op_sel_hi:[1,0]
  v_pk_mul_f32 v[42:43], v[42:43], v[4:5] op_sel:[0,0] op_sel_hi:[1,0]
  v_cvt_pk_bf16_f32 v99, v38, v39
  v_mfma_f32_16x16x32_bf16 v[252:255], a[244:247], a[180:183], v[252:255]
  ds_read_b64_tr_b16 a[222:223], v17 offset:12288
  v_cvt_pk_bf16_f32 v192, v192, v193
  v_mfma_f32_16x16x32_bf16 v[252:255], a[240:243], a[176:179], v[252:255]
  v_exp_f32 v194, v194
  v_mfma_f32_16x16x32_bf16 v[48:51], v[44:47], v[128:131], 0
  s_add_u32 m0, s30, 50176
  s_xor_b32 s40, s32, 0x3000
  ds_read_b64_tr_b16 a[224:225], v18
  v_mfma_f32_16x16x32_bf16 v[48:51], v[44:47], v[136:139], v[48:51]
  s_waitcnt vmcnt(12)
  buffer_load_dwordx4 v23, s[16:19], s40 offen nt lds
  v_mfma_f32_16x16x32_bf16 v[52:55], v[44:47], v[144:147], 0
  ds_read_b64_tr_b16 a[226:227], v18 offset:4096
  v_mfma_f32_16x16x32_bf16 v[52:55], v[44:47], v[152:155], v[52:55]
  ds_write_b64 v27, v[98:99] offset:4160
  v_accvgpr_read_b32 v36, a83
  v_accvgpr_read_b32 v37, a87
  v_accvgpr_read_b32 v38, a91
  v_accvgpr_read_b32 v39, a95
  v_cvt_pk_bf16_f32 v102, v40, v41
  v_pk_mul_f32 v[132:133], v[132:133], v[6:7] op_sel:[0,0] op_sel_hi:[1,0]
  v_pk_mul_f32 v[134:135], v[134:135], v[6:7] op_sel:[0,0] op_sel_hi:[1,0]
  v_cvt_pk_bf16_f32 v103, v42, v43
  v_mfma_f32_16x16x32_bf16 v[56:59], v[44:47], v[160:163], 0
  ds_read_b64_tr_b16 a[228:229], v18 offset:8192
  ds_read_b64_tr_b16 v[96:97], v0 offset:2080
  v_mfma_f32_16x16x32_bf16 v[56:59], v[44:47], v[168:171], v[56:59]
  ds_read_b64_tr_b16 v[98:99], v0 offset:2112
  v_exp_f32 v195, v195
  v_mfma_f32_16x16x32_bf16 v[60:63], v[44:47], v[176:179], 0
  ds_read_b64_tr_b16 a[230:231], v18 offset:12288
  v_cvt_pk_bf16_f32 v193, v194, v195
  v_mfma_f32_16x16x32_bf16 v[60:63], v[44:47], v[184:187], v[60:63]
  s_waitcnt lgkmcnt(7)
  ds_write_b64 v27, v[102:103] offset:4672
  v_accvgpr_read_b32 v40, a112
  v_accvgpr_read_b32 v41, a116
  v_accvgpr_read_b32 v42, a120
  v_accvgpr_read_b32 v43, a124
  v_cvt_pk_bf16_f32 v106, v132, v133
  v_pk_mul_f32 v[36:37], v[36:37], v[8:9] op_sel:[0,0] op_sel_hi:[1,0]
  v_pk_mul_f32 v[38:39], v[38:39], v[8:9] op_sel:[0,0] op_sel_hi:[1,0]
  v_cvt_pk_bf16_f32 v107, v134, v135
  v_mfma_f32_16x16x32_bf16 a[12:15], v[136:139], a[220:223], 0
  ds_read_b64_tr_b16 a[232:233], v19
  ds_read_b64_tr_b16 v[100:101], v0 offset:2592
  v_mfma_f32_16x16x32_bf16 a[12:15], v[128:131], a[216:219], a[12:15]
  ds_read_b64_tr_b16 v[102:103], v0 offset:2624
  v_mfma_f32_16x16x32_bf16 a[8:11], v[128:131], a[208:211], 0
  s_add_u32 m0, s30, 51200
  s_xor_b32 s40, s32, 0x13800
  ds_read_b64_tr_b16 a[234:235], v19 offset:4096
  v_exp_f32 v196, v196
  v_mfma_f32_16x16x32_bf16 a[8:11], v[136:139], a[212:215], a[8:11]
  s_waitcnt vmcnt(12)
  buffer_load_dwordx4 v24, s[16:19], s40 offen nt lds
  v_mfma_f32_16x16x32_bf16 a[4:7], v[136:139], a[204:207], 0
  ds_read_b64_tr_b16 a[236:237], v19 offset:8192
  v_mfma_f32_16x16x32_bf16 a[4:7], v[128:131], a[200:203], a[4:7]
  ds_write_b64 v27, v[106:107] offset:5184
  v_accvgpr_read_b32 v132, a113
  v_accvgpr_read_b32 v133, a117
  v_accvgpr_read_b32 v134, a121
  v_accvgpr_read_b32 v135, a125
  v_cvt_pk_bf16_f32 v110, v36, v37
  v_pk_mul_f32 v[40:41], v[40:41], v[2:3] op_sel:[0,1] op_sel_hi:[1,1]
  v_pk_mul_f32 v[42:43], v[42:43], v[2:3] op_sel:[0,1] op_sel_hi:[1,1]
  v_cvt_pk_bf16_f32 v111, v38, v39
  v_mfma_f32_16x16x32_bf16 a[0:3], v[128:131], a[192:195], 0
  ds_read_b64_tr_b16 a[238:239], v19 offset:12288
  ds_read_b64_tr_b16 v[104:105], v0 offset:3104
  v_mfma_f32_16x16x32_bf16 a[0:3], v[136:139], a[196:199], a[0:3]
  ds_read_b64_tr_b16 v[106:107], v0 offset:3136
  v_mfma_f32_16x16x32_bf16 a[32:35], v[152:155], a[196:199], 0
  ds_read_b64_tr_b16 a[240:241], v20
  v_exp_f32 v197, v197
  v_mfma_f32_16x16x32_bf16 a[32:35], v[144:147], a[192:195], a[32:35]
  ds_write_b64 v27, v[110:111] offset:5696
  v_accvgpr_read_b32 v36, a114
  v_accvgpr_read_b32 v37, a118
  v_accvgpr_read_b32 v38, a122
  v_accvgpr_read_b32 v39, a126
  v_cvt_pk_bf16_f32 v114, v40, v41
  v_pk_mul_f32 v[132:133], v[132:133], v[4:5] op_sel:[0,1] op_sel_hi:[1,1]
  v_pk_mul_f32 v[134:135], v[134:135], v[4:5] op_sel:[0,1] op_sel_hi:[1,1]
  v_cvt_pk_bf16_f32 v115, v42, v43
  v_mfma_f32_16x16x32_bf16 a[36:39], v[144:147], a[200:203], 0
  ds_read_b64_tr_b16 a[242:243], v20 offset:4096
  ds_read_b64_tr_b16 v[108:109], v0 offset:3616
  v_mfma_f32_16x16x32_bf16 a[36:39], v[152:155], a[204:207], a[36:39]
  ds_read_b64_tr_b16 v[110:111], v0 offset:3648
  v_cvt_pk_bf16_f32 v194, v196, v197
  v_mfma_f32_16x16x32_bf16 a[40:43], v[152:155], a[212:215], 0
  s_add_u32 m0, s30, 52224
  s_xor_b32 s40, s32, 0x13400
  ds_read_b64_tr_b16 a[244:245], v20 offset:8192
  v_mfma_f32_16x16x32_bf16 a[40:43], v[144:147], a[208:211], a[40:43]
  s_waitcnt vmcnt(12)
  buffer_load_dwordx4 v25, s[16:19], s40 offen nt lds
  v_mfma_f32_16x16x32_bf16 a[44:47], v[144:147], a[216:219], 0
  ds_read_b64_tr_b16 a[246:247], v20 offset:12288
  v_mfma_f32_16x16x32_bf16 a[44:47], v[152:155], a[220:223], a[44:47]
  ds_write_b64 v27, v[114:115] offset:2080
  v_accvgpr_read_b32 v40, a115
  v_accvgpr_read_b32 v41, a119
  v_accvgpr_read_b32 v42, a123
  v_accvgpr_read_b32 v43, a127
  v_cvt_pk_bf16_f32 v118, v132, v133
  v_pk_mul_f32 v[36:37], v[36:37], v[6:7] op_sel:[0,1] op_sel_hi:[1,1]
  v_pk_mul_f32 v[38:39], v[38:39], v[6:7] op_sel:[0,1] op_sel_hi:[1,1]
  v_cvt_pk_bf16_f32 v119, v134, v135
  v_mfma_f32_16x16x32_bf16 a[76:79], v[168:171], a[220:223], 0
  ds_read_b64_tr_b16 a[248:249], v21
  ds_read_b64_tr_b16 v[112:113], v0
  v_mfma_f32_16x16x32_bf16 a[76:79], v[160:163], a[216:219], a[76:79]
  ds_read_b64_tr_b16 v[114:115], v0 offset:32
  v_exp_f32 v198, v198
  v_mfma_f32_16x16x32_bf16 a[72:75], v[160:163], a[208:211], 0
  ds_read_b64_tr_b16 a[250:251], v21 offset:4096
  v_mfma_f32_16x16x32_bf16 a[72:75], v[168:171], a[212:215], a[72:75]
  ds_write_b64 v27, v[118:119] offset:2592
  v_cvt_pk_bf16_f32 v122, v36, v37
  v_pk_mul_f32 v[40:41], v[40:41], v[8:9] op_sel:[0,1] op_sel_hi:[1,1]
  v_pk_mul_f32 v[42:43], v[42:43], v[8:9] op_sel:[0,1] op_sel_hi:[1,1]
  v_cvt_pk_bf16_f32 v123, v38, v39
  v_mfma_f32_16x16x32_bf16 a[68:71], v[168:171], a[204:207], 0
  ds_read_b64_tr_b16 a[252:253], v21 offset:8192
  ds_read_b64_tr_b16 v[116:117], v0 offset:512
  v_mfma_f32_16x16x32_bf16 a[68:71], v[160:163], a[200:203], a[68:71]
  ds_read_b64_tr_b16 v[118:119], v0 offset:544
  v_exp_f32 v199, v199
  v_mfma_f32_16x16x32_bf16 a[64:67], v[160:163], a[192:195], 0
  s_xor_b32 s43, s48, 0x6000
  ds_read_b64_tr_b16 a[254:255], v21 offset:12288
  v_cvt_pk_bf16_f32 v195, v198, v199
  v_mfma_f32_16x16x32_bf16 a[64:67], v[168:171], a[196:199], a[64:67]
  s_waitcnt vmcnt(12)
  buffer_store_dwordx4 v[68:71], v26, s[24:27], s43 offen sc1
  v_mfma_f32_16x16x32_bf16 a[96:99], v[184:187], a[196:199], 0
  ds_write_b64 v27, v[122:123] offset:3104
  v_cvt_pk_bf16_f32 v126, v40, v41
  v_cvt_pk_bf16_f32 v127, v42, v43
  v_mfma_f32_16x16x32_bf16 a[96:99], v[176:179], a[192:195], a[96:99]
  ds_read_b64_tr_b16 v[120:121], v0 offset:1024
  ds_read_b64_tr_b16 v[122:123], v0 offset:1056
  v_mfma_f32_16x16x32_bf16 a[100:103], v[176:179], a[200:203], 0
  v_mfma_f32_16x16x32_bf16 a[100:103], v[184:187], a[204:207], a[100:103]
  s_waitcnt vmcnt(7) lgkmcnt(0)
  s_cmpk_lt_i32 s9, 0x0
  s_cbranch_scc0 L_fb3_1
  s_waitcnt vmcnt(4)
L_fb3_1:
  s_barrier
  v_mfma_f32_16x16x32_bf16 a[104:107], v[184:187], a[212:215], 0
  ds_read_b128 a[192:195], v10 offset:32768
  v_exp_f32 v208, v208
  v_mfma_f32_16x16x32_bf16 a[104:107], v[176:179], a[208:211], a[104:107]
  ds_write_b64 v27, v[126:127] offset:3616
  v_mfma_f32_16x16x32_bf16 a[108:111], v[176:179], a[216:219], 0
  ds_read_b64_tr_b16 v[124:125], v0 offset:1536
  ds_read_b64_tr_b16 v[126:127], v0 offset:1568
  v_mfma_f32_16x16x32_bf16 a[108:111], v[184:187], a[220:223], a[108:111]
  v_exp_f32 v209, v209
  v_mfma_f32_16x16x32_bf16 a[28:31], v[136:139], a[252:255], 0
  s_add_u32 m0, s30, 98304
  s_xor_b32 s40, s32, 0x3800
  ds_read_b128 a[196:199], v11 offset:32768
  v_cvt_pk_bf16_f32 v208, v208, v209
  v_mfma_f32_16x16x32_bf16 a[28:31], v[128:131], a[248:251], a[28:31]
  s_waitcnt vmcnt(12)
  buffer_load_dwordx4 v22, s[20:23], s40 offen nt lds
  v_mfma_f32_16x16x32_bf16 a[24:27], v[128:131], a[240:243], 0
  v_mfma_f32_16x16x32_bf16 a[24:27], v[136:139], a[244:247], a[24:27]
  v_exp_f32 v210, v210
  v_mfma_f32_16x16x32_bf16 a[20:23], v[136:139], a[236:239], 0
  s_waitcnt lgkmcnt(1)
  ds_read_b128 a[200:203], v12 offset:32768
  v_exp_f32 v211, v211
  v_mfma_f32_16x16x32_bf16 a[20:23], v[128:131], a[232:235], a[20:23]
  v_exp_f32 v212, v212
  v_mfma_f32_16x16x32_bf16 a[16:19], v[128:131], a[224:227], 0
  v_exp_f32 v213, v213
  v_mfma_f32_16x16x32_bf16 a[16:19], v[136:139], a[228:231], a[16:19]
  v_exp_f32 v214, v214
  v_mfma_f32_16x16x32_bf16 a[48:51], v[152:155], a[228:231], 0
  ds_read_b128 a[204:207], v13 offset:32768
  v_cvt_pk_bf16_f32 v209, v210, v211
  v_mfma_f32_16x16x32_bf16 a[48:51], v[144:147], a[224:227], a[48:51]
  v_exp_f32 v215, v215
  v_mfma_f32_16x16x32_bf16 a[52:55], v[144:147], a[232:235], 0
  v_exp_f32 v224, v224
  v_mfma_f32_16x16x32_bf16 a[52:55], v[152:155], a[236:239], a[52:55]
  v_exp_f32 v225, v225
  v_mfma_f32_16x16x32_bf16 a[56:59], v[152:155], a[244:247], 0
  ds_read_b128 a[208:211], v10 offset:36864
  v_cvt_pk_bf16_f32 v210, v212, v213
  v_mfma_f32_16x16x32_bf16 a[56:59], v[144:147], a[240:243], a[56:59]
  v_exp_f32 v226, v226
  v_mfma_f32_16x16x32_bf16 a[60:63], v[144:147], a[248:251], 0
  s_add_u32 m0, s30, 99328
  s_xor_b32 s40, s32, 0x3400
  v_exp_f32 v227, v227
  v_mfma_f32_16x16x32_bf16 a[60:63], v[152:155], a[252:255], a[60:63]
  s_waitcnt vmcnt(12)
  buffer_load_dwordx4 v23, s[20:23], s40 offen nt lds
  v_mfma_f32_16x16x32_bf16 a[92:95], v[168:171], a[252:255], 0
  ds_read_b128 a[212:215], v11 offset:36864
  v_mfma_f32_16x16x32_bf16 a[92:95], v[160:163], a[248:251], a[92:95]
  v_exp_f32 v228, v228
  v_mfma_f32_16x16x32_bf16 a[88:91], v[160:163], a[240:243], 0
  v_exp_f32 v229, v229
  v_mfma_f32_16x16x32_bf16 a[88:91], v[168:171], a[244:247], a[88:91]
  v_exp_f32 v230, v230
  v_mfma_f32_16x16x32_bf16 a[84:87], v[168:171], a[236:239], 0
  ds_read_b128 a[216:219], v12 offset:36864
  v_cvt_pk_bf16_f32 v211, v214, v215
  v_mfma_f32_16x16x32_bf16 a[84:87], v[160:163], a[232:235], a[84:87]
  v_exp_f32 v231, v231
  v_mfma_f32_16x16x32_bf16 a[80:83], v[160:163], a[224:227], 0
  v_exp_f32 v240, v240
  v_mfma_f32_16x16x32_bf16 a[80:83], v[168:171], a[228:231], a[80:83]
  v_exp_f32 v241, v241
  v_mfma_f32_16x16x32_bf16 a[112:115], v[184:187], a[228:231], 0
  ds_read_b128 a[220:223], v13 offset:36864
  v_cvt_pk_bf16_f32 v224, v224, v225
  v_mfma_f32_16x16x32_bf16 a[112:115], v[176:179], a[224:227], a[112:115]
  v_exp_f32 v242, v242
  v_mfma_f32_16x16x32_bf16 a[116:119], v[176:179], a[232:235], 0
  v_exp_f32 v243, v243
  v_mfma_f32_16x16x32_bf16 a[116:119], v[184:187], a[236:239], a[116:119]
  s_add_u32 m0, s30, 100352
  s_xor_b32 s40, s32, 0x13c00
  v_exp_f32 v244, v244
  v_mfma_f32_16x16x32_bf16 a[120:123], v[184:187], a[244:247], 0
  s_waitcnt vmcnt(12)
  buffer_load_dwordx4 v24, s[20:23], s40 offen nt lds
  v_mfma_f32_16x16x32_bf16 a[120:123], v[176:179], a[240:243], a[120:123]
  v_cvt_pk_bf16_f32 v225, v226, v227
  v_mfma_f32_16x16x32_bf16 a[124:127], v[176:179], a[248:251], 0
  v_exp_f32 v245, v245
  v_mfma_f32_16x16x32_bf16 a[124:127], v[184:187], a[252:255], a[124:127]
  s_waitcnt lgkmcnt(0)
  v_exp_f32 v246, v246
  v_mfma_f32_16x16x32_bf16 v[176:179], a[192:195], a[176:179], 0
  v_exp_f32 v247, v247
  v_mfma_f32_16x16x32_bf16 v[176:179], a[196:199], a[180:183], v[176:179]
  ds_read_b128 a[224:227], v10 offset:40960
  v_cvt_pk_bf16_f32 v226, v228, v229
  v_mfma_f32_16x16x32_bf16 v[176:179], a[200:203], a[184:187], v[176:179]
  v_exp_f32 v200, v200
  v_mfma_f32_16x16x32_bf16 v[176:179], a[204:207], a[188:191], v[176:179]
  v_exp_f32 v201, v201
  v_mfma_f32_16x16x32_bf16 v[160:163], a[204:207], a[172:175], 0
  ds_read_b128 a[228:231], v11 offset:40960
  v_cvt_pk_bf16_f32 v227, v230, v231
  v_mfma_f32_16x16x32_bf16 v[160:163], a[200:203], a[168:171], v[160:163]
  v_exp_f32 v202, v202
  v_mfma_f32_16x16x32_bf16 v[160:163], a[196:199], a[164:167], v[160:163]
  v_exp_f32 v203, v203
  v_mfma_f32_16x16x32_bf16 v[160:163], a[192:195], a[160:163], v[160:163]
  ds_read_b128 a[232:235], v12 offset:40960
  v_cvt_pk_bf16_f32 v240, v240, v241
  v_mfma_f32_16x16x32_bf16 v[144:147], a[192:195], a[144:147], 0
  v_exp_f32 v204, v204
  v_mfma_f32_16x16x32_bf16 v[144:147], a[196:199], a[148:151], v[144:147]
  v_exp_f32 v205, v205
  v_mfma_f32_16x16x32_bf16 v[144:147], a[200:203], a[152:155], v[144:147]
  s_add_u32 m0, s30, 101376
  s_xor_b32 s40, s32, 0x13000
  ds_read_b128 a[236:239], v13 offset:40960
  v_cvt_pk_bf16_f32 v241, v242, v243
  v_mfma_f32_16x16x32_bf16 v[144:147], a[204:207], a[156:159], v[144:147]
  s_waitcnt vmcnt(12)
  buffer_load_dwordx4 v25, s[20:23], s40 offen nt lds
  v_mfma_f32_16x16x32_bf16 v[128:131], a[204:207], a[140:143], 0
  v_cvt_pk_bf16_f32 v242, v244, v245
  v_mfma_f32_16x16x32_bf16 v[128:131], a[200:203], a[136:139], v[128:131]
  ds_read_b128 a[240:243], v10 offset:45056
  v_cvt_pk_bf16_f32 v243, v246, v247
  v_mfma_f32_16x16x32_bf16 v[128:131], a[196:199], a[132:135], v[128:131]
  v_exp_f32 v206, v206
  v_mfma_f32_16x16x32_bf16 v[128:131], a[192:195], a[128:131], v[128:131]
  v_exp_f32 v207, v207
  v_mfma_f32_16x16x32_bf16 v[132:135], a[208:211], a[128:131], 0
L_pg19:
  s_cbranch_execz L_rt3
  ds_read_b128 a[244:247], v11 offset:45056
  v_cvt_pk_bf16_f32 v200, v200, v201
  v_mfma_f32_16x16x32_bf16 v[132:135], a[212:215], a[132:135], v[132:135]
  v_exp_f32 v216, v216
  v_mfma_f32_16x16x32_bf16 v[132:135], a[216:219], a[136:139], v[132:135]
  v_exp_f32 v217, v217
  v_mfma_f32_16x16x32_bf16 v[132:135], a[220:223], a[140:143], v[132:135]
  ds_read_b128 a[248:251], v12 offset:45056
  v_cvt_pk_bf16_f32 v201, v202, v203
  v_mfma_f32_16x16x32_bf16 v[148:151], a[220:223], a[156:159], 0
  v_exp_f32 v218, v218
  v_mfma_f32_16x16x32_bf16 v[148:151], a[216:219], a[152:155], v[148:151]
  v_exp_f32 v219, v219
  v_mfma_f32_16x16x32_bf16 v[148:151], a[212:215], a[148:151], v[148:151]
  s_xor_b32 s43, s48, 0x400
  ds_read_b128 a[252:255], v13 offset:45056
  v_cvt_pk_bf16_f32 v202, v204, v205
  v_mfma_f32_16x16x32_bf16 v[148:151], a[208:211], a[144:147], v[148:151]
  s_waitcnt vmcnt(12)
  buffer_store_dwordx4 v[72:75], v26, s[24:27], s43 offen sc1
  v_mfma_f32_16x16x32_bf16 v[164:167], a[208:211], a[160:163], 0
  v_cvt_pk_bf16_f32 v203, v206, v207
  v_mfma_f32_16x16x32_bf16 v[164:167], a[212:215], a[164:167], v[164:167]
  v_exp_f32 v220, v220
  v_mfma_f32_16x16x32_bf16 v[164:167], a[216:219], a[168:171], v[164:167]
  v_exp_f32 v221, v221
  v_mfma_f32_16x16x32_bf16 v[164:167], a[220:223], a[172:175], v[164:167]
  v_exp_f32 v222, v222
  v_mfma_f32_16x16x32_bf16 v[180:183], a[220:223], a[188:191], 0
  v_exp_f32 v223, v223
  v_mfma_f32_16x16x32_bf16 v[180:183], a[216:219], a[184:187], v[180:183]
  v_exp_f32 v232, v232
  v_mfma_f32_16x16x32_bf16 v[180:183], a[212:215], a[180:183], v[180:183]
  v_exp_f32 v233, v233
  v_mfma_f32_16x16x32_bf16 v[180:183], a[208:211], a[176:179], v[180:183]
  s_waitcnt vmcnt(7) lgkmcnt(0)
  s_cmpk_lt_i32 s10, 0x0
  s_cbranch_scc0 L_fb3_2
  s_waitcnt vmcnt(4)
L_fb3_2:
  s_barrier
  v_mfma_f32_16x16x32_bf16 v[184:187], a[224:227], a[176:179], 0
  ds_read_b64_tr_b16 a[192:193], v14 offset:16384
  v_cvt_pk_bf16_f32 v216, v216, v217
  v_mfma_f32_16x16x32_bf16 v[184:187], a[228:231], a[180:183], v[184:187]
  v_exp_f32 v234, v234
  v_mfma_f32_16x16x32_bf16 v[184:187], a[232:235], a[184:187], v[184:187]
  ds_read_b64_tr_b16 a[194:195], v14 offset:20480
  v_cvt_pk_bf16_f32 v217, v218, v219
  v_mfma_f32_16x16x32_bf16 v[184:187], a[236:239], a[188:191], v[184:187]
  v_exp_f32 v235, v235
  v_mfma_f32_16x16x32_bf16 v[168:171], a[236:239], a[172:175], 0
  s_add_u32 m0, s30, 0
  s_xor_b32 s40, s32, 0x12000
  ds_read_b64_tr_b16 a[196:197], v14 offset:24576
  v_cvt_pk_bf16_f32 v218, v220, v221
  v_mfma_f32_16x16x32_bf16 v[168:171], a[232:235], a[168:171], v[168:171]
  s_waitcnt vmcnt(12)
  buffer_load_dwordx4 v22, s[16:19], s40 offen nt lds
  v_mfma_f32_16x16x32_bf16 v[168:171], a[228:231], a[164:167], v[168:171]
  ds_read_b64_tr_b16 a[198:199], v14 offset:28672
  v_mfma_f32_16x16x32_bf16 v[168:171], a[224:227], a[160:163], v[168:171]
  v_exp_f32 v236, v236
  v_mfma_f32_16x16x32_bf16 v[152:155], a[224:227], a[144:147], 0
  ds_read_b64_tr_b16 a[200:201], v15 offset:16384
  v_cvt_pk_bf16_f32 v219, v222, v223
  v_mfma_f32_16x16x32_bf16 v[152:155], a[228:231], a[148:151], v[152:155]
  v_exp_f32 v237, v237
  v_mfma_f32_16x16x32_bf16 v[152:155], a[232:235], a[152:155], v[152:155]
  ds_read_b64_tr_b16 a[202:203], v15 offset:20480
  v_cvt_pk_bf16_f32 v232, v232, v233
  v_mfma_f32_16x16x32_bf16 v[152:155], a[236:239], a[156:159], v[152:155]
  v_exp_f32 v238, v238
  v_mfma_f32_16x16x32_bf16 v[136:139], a[236:239], a[140:143], 0
  ds_read_b64_tr_b16 a[204:205], v15 offset:24576
  v_cvt_pk_bf16_f32 v233, v234, v235
  v_mfma_f32_16x16x32_bf16 v[136:139], a[232:235], a[136:139], v[136:139]
  v_exp_f32 v239, v239
  v_mfma_f32_16x16x32_bf16 v[136:139], a[228:231], a[132:135], v[136:139]
  ds_read_b64_tr_b16 a[206:207], v15 offset:28672
  v_cvt_pk_bf16_f32 v234, v236, v237
  v_mfma_f32_16x16x32_bf16 v[136:139], a[224:227], a[128:131], v[136:139]
  v_exp_f32 v248, v248
  v_mfma_f32_16x16x32_bf16 v[140:143], a[240:243], a[128:131], 0
  ds_read_b64_tr_b16 a[208:209], v16 offset:16384
  v_cvt_pk_bf16_f32 v235, v238, v239
  v_mfma_f32_16x16x32_bf16 v[140:143], a[244:247], a[132:135], v[140:143]
  v_exp_f32 v249, v249
  v_mfma_f32_16x16x32_bf16 v[140:143], a[248:251], a[136:139], v[140:143]
  s_add_u32 m0, s30, 1024
  s_xor_b32 s40, s32, 0x12c00
  ds_read_b64_tr_b16 a[210:211], v16 offset:20480
  v_cvt_pk_bf16_f32 v248, v248, v249
  v_mfma_f32_16x16x32_bf16 v[140:143], a[252:255], a[140:143], v[140:143]
  s_waitcnt vmcnt(12)
  buffer_load_dwordx4 v23, s[16:19], s40 offen nt lds
  v_mfma_f32_16x16x32_bf16 v[156:159], a[252:255], a[156:159], 0
  ds_read_b64_tr_b16 a[212:213], v16 offset:24576
  v_mfma_f32_16x16x32_bf16 v[156:159], a[248:251], a[152:155], v[156:159]
  v_exp_f32 v250, v250
  v_mfma_f32_16x16x32_bf16 v[156:159], a[244:247], a[148:151], v[156:159]
  ds_read_b64_tr_b16 a[214:215], v16 offset:28672
  v_mfma_f32_16x16x32_bf16 v[156:159], a[240:243], a[144:147], v[156:159]
  v_exp_f32 v251, v251
  v_mfma_f32_16x16x32_bf16 v[172:175], a[240:243], a[160:163], 0
  ds_read_b64_tr_b16 a[216:217], v17 offset:16384
  v_exp_f32 v252, v252
  v_mfma_f32_16x16x32_bf16 v[172:175], a[244:247], a[164:167], v[172:175]
  v_exp_f32 v253, v253
  v_mfma_f32_16x16x32_bf16 v[172:175], a[248:251], a[168:171], v[172:175]
  ds_read_b64_tr_b16 a[218:219], v17 offset:20480
  v_cvt_pk_bf16_f32 v249, v250, v251
  v_mfma_f32_16x16x32_bf16 v[172:175], a[252:255], a[172:175], v[172:175]
  v_exp_f32 v254, v254
  v_mfma_f32_16x16x32_bf16 v[188:191], a[252:255], a[188:191], 0
  ds_read_b64_tr_b16 a[220:221], v17 offset:24576
  v_cvt_pk_bf16_f32 v250, v252, v253
  v_mfma_f32_16x16x32_bf16 v[188:191], a[248:251], a[184:187], v[188:191]
  v_exp_f32 v255, v255
  v_mfma_f32_16x16x32_bf16 v[188:191], a[244:247], a[180:183], v[188:191]
  s_add_u32 m0, s30, 2048
  s_xor_b32 s40, s32, 0x2400
  ds_read_b64_tr_b16 a[222:223], v17 offset:28672
  v_cvt_pk_bf16_f32 v251, v254, v255
  v_mfma_f32_16x16x32_bf16 v[188:191], a[240:243], a[176:179], v[188:191]
  s_waitcnt vmcnt(12)
  buffer_load_dwordx4 v24, s[16:19], s40 offen nt lds
  v_mfma_f32_16x16x32_bf16 v[48:51], v[44:47], v[192:195], v[48:51]
  ds_read_b64_tr_b16 a[224:225], v18 offset:16384
  v_mfma_f32_16x16x32_bf16 v[48:51], v[44:47], v[200:203], v[48:51]
  v_exp_f32 v128, v128
  v_mfma_f32_16x16x32_bf16 v[52:55], v[44:47], v[208:211], v[52:55]
  ds_read_b64_tr_b16 a[226:227], v18 offset:20480
  v_mfma_f32_16x16x32_bf16 v[52:55], v[44:47], v[216:219], v[52:55]
  v_mov_b32 v252, 1
  v_mfma_f32_16x16x32_bf16 v[56:59], v[44:47], v[224:227], v[56:59]
  ds_read_b64_tr_b16 a[228:229], v18 offset:24576
  v_mfma_f32_16x16x32_bf16 v[56:59], v[44:47], v[232:235], v[56:59]
  s_waitcnt vmcnt(12)
  buffer_atomic_add v252, v26, s[4:7], 0 offen sc0 sc1
  v_mfma_f32_16x16x32_bf16 v[60:63], v[44:47], v[240:243], v[60:63]
  ds_read_b64_tr_b16 a[230:231], v18 offset:28672
  v_mfma_f32_16x16x32_bf16 v[60:63], v[44:47], v[248:251], v[60:63]
  s_waitcnt lgkmcnt(4)
  v_exp_f32 v129, v129
  v_mfma_f32_16x16x32_bf16 a[96:99], v[248:251], a[196:199], a[96:99]
  ds_read_b64_tr_b16 a[232:233], v19 offset:16384
  v_cvt_pk_bf16_f32 v128, v128, v129
  v_mfma_f32_16x16x32_bf16 a[96:99], v[240:243], a[192:195], a[96:99]
  v_exp_f32 v130, v130
  v_mfma_f32_16x16x32_bf16 a[64:67], v[224:227], a[192:195], a[64:67]
  ds_read_b64_tr_b16 a[234:235], v19 offset:20480
  v_mfma_f32_16x16x32_bf16 a[64:67], v[232:235], a[196:199], a[64:67]
  v_exp_f32 v131, v131
  v_mfma_f32_16x16x32_bf16 a[32:35], v[216:219], a[196:199], a[32:35]
  s_xor_b32 s43, s48, 0x6400
  ds_read_b64_tr_b16 a[236:237], v19 offset:24576
  v_cvt_pk_bf16_f32 v129, v130, v131
  v_mfma_f32_16x16x32_bf16 a[32:35], v[208:211], a[192:195], a[32:35]
  s_waitcnt vmcnt(12)
  buffer_store_dwordx4 v[76:79], v26, s[24:27], s43 offen sc1
  v_mfma_f32_16x16x32_bf16 a[0:3], v[192:195], a[192:195], a[0:3]
  ds_read_b64_tr_b16 a[238:239], v19 offset:28672
  v_mfma_f32_16x16x32_bf16 a[0:3], v[200:203], a[196:199], a[0:3]
  v_exp_f32 v132, v132
  v_mfma_f32_16x16x32_bf16 a[4:7], v[200:203], a[204:207], a[4:7]
  ds_read_b64_tr_b16 a[240:241], v20 offset:16384
  v_mfma_f32_16x16x32_bf16 a[4:7], v[192:195], a[200:203], a[4:7]
  v_exp_f32 v133, v133
  v_mfma_f32_16x16x32_bf16 a[36:39], v[208:211], a[200:203], a[36:39]
  ds_read_b64_tr_b16 a[242:243], v20 offset:20480
  v_cvt_pk_bf16_f32 v130, v132, v133
  v_mfma_f32_16x16x32_bf16 a[36:39], v[216:219], a[204:207], a[36:39]
  v_exp_f32 v134, v134
  v_mfma_f32_16x16x32_bf16 a[68:71], v[232:235], a[204:207], a[68:71]
  ds_read_b64_tr_b16 a[244:245], v20 offset:24576
  v_mfma_f32_16x16x32_bf16 a[68:71], v[224:227], a[200:203], a[68:71]
  v_exp_f32 v135, v135
  v_mfma_f32_16x16x32_bf16 a[100:103], v[240:243], a[200:203], a[100:103]
  ds_read_b64_tr_b16 a[246:247], v20 offset:28672
  v_cvt_pk_bf16_f32 v131, v134, v135
  v_mfma_f32_16x16x32_bf16 a[100:103], v[248:251], a[204:207], a[100:103]
  v_exp_f32 v144, v144
  v_mfma_f32_16x16x32_bf16 a[104:107], v[248:251], a[212:215], a[104:107]
  ds_read_b64_tr_b16 a[248:249], v21 offset:16384
  v_mfma_f32_16x16x32_bf16 a[104:107], v[240:243], a[208:211], a[104:107]
  v_exp_f32 v145, v145
  v_mfma_f32_16x16x32_bf16 a[72:75], v[224:227], a[208:211], a[72:75]
  s_add_u32 m0, s30, 3072
  s_xor_b32 s40, s32, 0x2800
  ds_read_b64_tr_b16 a[250:251], v21 offset:20480
  v_cvt_pk_bf16_f32 v144, v144, v145
  v_mfma_f32_16x16x32_bf16 a[72:75], v[232:235], a[212:215], a[72:75]
  s_waitcnt vmcnt(12)
  buffer_load_dwordx4 v25, s[16:19], s40 offen nt lds
  v_mfma_f32_16x16x32_bf16 a[40:43], v[216:219], a[212:215], a[40:43]
  ds_read_b64_tr_b16 a[252:253], v21 offset:24576
  v_mfma_f32_16x16x32_bf16 a[40:43], v[208:211], a[208:211], a[40:43]
  v_exp_f32 v146, v146
  v_mfma_f32_16x16x32_bf16 a[8:11], v[192:195], a[208:211], a[8:11]
  ds_read_b64_tr_b16 a[254:255], v21 offset:28672
  v_mfma_f32_16x16x32_bf16 a[8:11], v[200:203], a[212:215], a[8:11]
  v_exp_f32 v147, v147
  v_mfma_f32_16x16x32_bf16 a[12:15], v[200:203], a[220:223], a[12:15]
  v_exp_f32 v148, v148
  v_mfma_f32_16x16x32_bf16 a[12:15], v[192:195], a[216:219], a[12:15]
  v_exp_f32 v149, v149
  v_mfma_f32_16x16x32_bf16 a[44:47], v[208:211], a[216:219], a[44:47]
  v_exp_f32 v150, v150
  v_mfma_f32_16x16x32_bf16 a[44:47], v[216:219], a[220:223], a[44:47]
  s_waitcnt vmcnt(7) lgkmcnt(0)
  s_cmpk_lt_i32 s11, 0x0
  s_cbranch_scc0 L_fb3_3
  s_waitcnt vmcnt(5)
L_fb3_3:
  s_barrier
  v_mfma_f32_16x16x32_bf16 a[76:79], v[232:235], a[220:223], a[76:79]
  ds_read_b128 a[192:195], v10 offset:49152
  v_cvt_pk_bf16_f32 v145, v146, v147
  v_mfma_f32_16x16x32_bf16 a[76:79], v[224:227], a[216:219], a[76:79]
  v_exp_f32 v151, v151
  v_mfma_f32_16x16x32_bf16 a[108:111], v[240:243], a[216:219], a[108:111]
  s_add_u32 m0, s30, 114688
  s_xor_b32 s40, s32, 0x3c00
  v_exp_f32 v160, v160
  v_mfma_f32_16x16x32_bf16 a[108:111], v[248:251], a[220:223], a[108:111]
  s_waitcnt vmcnt(12)
  buffer_load_dwordx4 v22, s[20:23], s40 offen nt lds
  v_mfma_f32_16x16x32_bf16 a[112:115], v[248:251], a[228:231], a[112:115]
  ds_read_b128 a[196:199], v11 offset:49152
  v_cvt_pk_bf16_f32 v146, v148, v149
  v_mfma_f32_16x16x32_bf16 a[112:115], v[240:243], a[224:227], a[112:115]
  v_exp_f32 v161, v161
  v_mfma_f32_16x16x32_bf16 a[80:83], v[224:227], a[224:227], a[80:83]
  v_exp_f32 v162, v162
  v_mfma_f32_16x16x32_bf16 a[80:83], v[232:235], a[228:231], a[80:83]
  v_exp_f32 v163, v163
  v_mfma_f32_16x16x32_bf16 a[48:51], v[216:219], a[228:231], a[48:51]
  ds_read_b128 a[200:203], v12 offset:49152
  v_cvt_pk_bf16_f32 v147, v150, v151
  v_mfma_f32_16x16x32_bf16 a[48:51], v[208:211], a[224:227], a[48:51]
  v_exp_f32 v164, v164
  v_mfma_f32_16x16x32_bf16 a[16:19], v[192:195], a[224:227], a[16:19]
  v_exp_f32 v165, v165
  v_mfma_f32_16x16x32_bf16 a[16:19], v[200:203], a[228:231], a[16:19]
  v_exp_f32 v166, v166
  v_mfma_f32_16x16x32_bf16 a[20:23], v[200:203], a[236:239], a[20:23]
  ds_read_b128 a[204:207], v13 offset:49152
  v_cvt_pk_bf16_f32 v160, v160, v161
  v_mfma_f32_16x16x32_bf16 a[20:23], v[192:195], a[232:235], a[20:23]
  v_exp_f32 v167, v167
  v_mfma_f32_16x16x32_bf16 a[52:55], v[208:211], a[232:235], a[52:55]
  v_exp_f32 v176, v176
  v_mfma_f32_16x16x32_bf16 a[52:55], v[216:219], a[236:239], a[52:55]
  v_exp_f32 v177, v177
  v_mfma_f32_16x16x32_bf16 a[84:87], v[232:235], a[236:239], a[84:87]
  s_add_u32 m0, s30, 115712
  s_xor_b32 s40, s32, 0x3000
  ds_read_b128 a[208:211], v10 offset:53248
  v_cvt_pk_bf16_f32 v161, v162, v163
  v_mfma_f32_16x16x32_bf16 a[84:87], v[224:227], a[232:235], a[84:87]
  s_waitcnt vmcnt(12)
  buffer_load_dwordx4 v23, s[20:23], s40 offen nt lds
  v_mfma_f32_16x16x32_bf16 a[116:119], v[240:243], a[232:235], a[116:119]
  v_exp_f32 v178, v178
  v_mfma_f32_16x16x32_bf16 a[116:119], v[248:251], a[236:239], a[116:119]
  v_exp_f32 v179, v179
  v_mfma_f32_16x16x32_bf16 a[120:123], v[248:251], a[244:247], a[120:123]
  ds_read_b128 a[212:215], v11 offset:53248
  v_cvt_pk_bf16_f32 v162, v164, v165
  v_mfma_f32_16x16x32_bf16 a[120:123], v[240:243], a[240:243], a[120:123]
  v_exp_f32 v180, v180
  v_mfma_f32_16x16x32_bf16 a[88:91], v[224:227], a[240:243], a[88:91]
  v_exp_f32 v181, v181
  v_mfma_f32_16x16x32_bf16 a[88:91], v[232:235], a[244:247], a[88:91]
  v_exp_f32 v182, v182
  v_mfma_f32_16x16x32_bf16 a[56:59], v[216:219], a[244:247], a[56:59]
  ds_read_b128 a[216:219], v12 offset:53248
  v_cvt_pk_bf16_f32 v163, v166, v167
  v_mfma_f32_16x16x32_bf16 a[56:59], v[208:211], a[240:243], a[56:59]
  v_exp_f32 v183, v183
  v_mfma_f32_16x16x32_bf16 a[24:27], v[192:195], a[240:243], a[24:27]
  v_exp_f32 v136, v136
  v_mfma_f32_16x16x32_bf16 a[24:27], v[200:203], a[244:247], a[24:27]
  v_exp_f32 v137, v137
  v_mfma_f32_16x16x32_bf16 a[28:31], v[200:203], a[252:255], a[28:31]
  ds_read_b128 a[220:223], v13 offset:53248
  v_cvt_pk_bf16_f32 v176, v176, v177
  v_mfma_f32_16x16x32_bf16 a[28:31], v[192:195], a[248:251], a[28:31]
  s_add_u32 m0, s30, 116736
  s_xor_b32 s40, s32, 0x13800
  v_exp_f32 v138, v138
  v_mfma_f32_16x16x32_bf16 a[60:63], v[208:211], a[248:251], a[60:63]
  s_waitcnt vmcnt(12)
  buffer_load_dwordx4 v24, s[20:23], s40 offen nt lds
  v_mfma_f32_16x16x32_bf16 a[60:63], v[216:219], a[252:255], a[60:63]
  v_exp_f32 v139, v139
  v_mfma_f32_16x16x32_bf16 a[92:95], v[232:235], a[252:255], a[92:95]
  v_exp_f32 v140, v140
  v_mfma_f32_16x16x32_bf16 a[92:95], v[224:227], a[248:251], a[92:95]
  v_exp_f32 v141, v141
  v_mfma_f32_16x16x32_bf16 a[124:127], v[240:243], a[248:251], a[124:127]
  v_exp_f32 v142, v142
  v_mfma_f32_16x16x32_bf16 a[124:127], v[248:251], a[252:255], a[124:127]
  s_waitcnt lgkmcnt(0)
  v_exp_f32 v143, v143
  v_mfma_f32_16x16x32_bf16 v[240:243], a[192:195], a[176:179], 0
  v_exp_f32 v152, v152
  v_mfma_f32_16x16x32_bf16 v[240:243], a[196:199], a[180:183], v[240:243]
  ds_read_b128 a[224:227], v10 offset:57344
  v_cvt_pk_bf16_f32 v177, v178, v179
  v_mfma_f32_16x16x32_bf16 v[240:243], a[200:203], a[184:187], v[240:243]
  v_exp_f32 v153, v153
  v_mfma_f32_16x16x32_bf16 v[240:243], a[204:207], a[188:191], v[240:243]
  v_exp_f32 v154, v154
  v_mfma_f32_16x16x32_bf16 v[224:227], a[204:207], a[172:175], 0
  ds_read_b128 a[228:231], v11 offset:57344
  v_cvt_pk_bf16_f32 v178, v180, v181
  v_mfma_f32_16x16x32_bf16 v[224:227], a[200:203], a[168:171], v[224:227]
  v_exp_f32 v155, v155
  v_mfma_f32_16x16x32_bf16 v[224:227], a[196:199], a[164:167], v[224:227]
  v_exp_f32 v156, v156
  v_mfma_f32_16x16x32_bf16 v[224:227], a[192:195], a[160:163], v[224:227]
  s_xor_b32 s43, s48, 0x5000
  ds_read_b128 a[232:235], v12 offset:57344
  v_cvt_pk_bf16_f32 v179, v182, v183
  v_mfma_f32_16x16x32_bf16 v[208:211], a[192:195], a[144:147], 0
  s_waitcnt vmcnt(12)
  buffer_store_dwordx4 v[80:83], v26, s[24:27], s43 offen sc1
  v_mfma_f32_16x16x32_bf16 v[208:211], a[196:199], a[148:151], v[208:211]
  v_exp_f32 v157, v157
  v_mfma_f32_16x16x32_bf16 v[208:211], a[200:203], a[152:155], v[208:211]
  ds_read_b128 a[236:239], v13 offset:57344
  v_cvt_pk_bf16_f32 v136, v136, v137
  v_mfma_f32_16x16x32_bf16 v[208:211], a[204:207], a[156:159], v[208:211]
  v_exp_f32 v158, v158
  v_mfma_f32_16x16x32_bf16 v[192:195], a[204:207], a[140:143], 0
  v_exp_f32 v159, v159
  v_mfma_f32_16x16x32_bf16 v[192:195], a[200:203], a[136:139], v[192:195]
  ds_read_b128 a[240:243], v10 offset:61440
  v_cvt_pk_bf16_f32 v137, v138, v139
  v_mfma_f32_16x16x32_bf16 v[192:195], a[196:199], a[132:135], v[192:195]
  v_exp_f32 v168, v168
  v_mfma_f32_16x16x32_bf16 v[192:195], a[192:195], a[128:131], v[192:195]
  v_exp_f32 v169, v169
  v_mfma_f32_16x16x32_bf16 v[196:199], a[208:211], a[128:131], 0
  ds_read_b128 a[244:247], v11 offset:61440
  v_cvt_pk_bf16_f32 v138, v140, v141
  v_mfma_f32_16x16x32_bf16 v[196:199], a[212:215], a[132:135], v[196:199]
  v_exp_f32 v170, v170
  v_mfma_f32_16x16x32_bf16 v[196:199], a[216:219], a[136:139], v[196:199]
  v_exp_f32 v171, v171
  v_mfma_f32_16x16x32_bf16 v[196:199], a[220:223], a[140:143], v[196:199]
  ds_read_b128 a[248:251], v12 offset:61440
  v_cvt_pk_bf16_f32 v139, v142, v143
  v_mfma_f32_16x16x32_bf16 v[212:215], a[220:223], a[156:159], 0
  s_add_u32 m0, s30, 117760
  s_xor_b32 s40, s32, 0x13400
  v_exp_f32 v172, v172
  v_mfma_f32_16x16x32_bf16 v[212:215], a[216:219], a[152:155], v[212:215]
  s_waitcnt vmcnt(12)
  buffer_load_dwordx4 v25, s[20:23], s40 offen nt lds
  v_mfma_f32_16x16x32_bf16 v[212:215], a[212:215], a[148:151], v[212:215]
  ds_read_b128 a[252:255], v13 offset:61440
  v_cvt_pk_bf16_f32 v152, v152, v153
  v_mfma_f32_16x16x32_bf16 v[212:215], a[208:211], a[144:147], v[212:215]
  v_exp_f32 v173, v173
  v_mfma_f32_16x16x32_bf16 v[228:231], a[208:211], a[160:163], 0
  v_exp_f32 v174, v174
  v_mfma_f32_16x16x32_bf16 v[228:231], a[212:215], a[164:167], v[228:231]
  v_exp_f32 v175, v175
  v_mfma_f32_16x16x32_bf16 v[228:231], a[216:219], a[168:171], v[228:231]
  v_exp_f32 v184, v184
  v_mfma_f32_16x16x32_bf16 v[228:231], a[220:223], a[172:175], v[228:231]
  v_exp_f32 v185, v185
  v_mfma_f32_16x16x32_bf16 v[244:247], a[220:223], a[188:191], 0
  v_exp_f32 v186, v186
  v_mfma_f32_16x16x32_bf16 v[244:247], a[216:219], a[184:187], v[244:247]
  v_cvt_pk_bf16_f32 v153, v154, v155
  v_cvt_pk_bf16_f32 v154, v156, v157
  v_mfma_f32_16x16x32_bf16 v[244:247], a[212:215], a[180:183], v[244:247]
  v_exp_f32 v187, v187
  v_mfma_f32_16x16x32_bf16 v[244:247], a[208:211], a[176:179], v[244:247]
  s_waitcnt vmcnt(7) lgkmcnt(0)
  s_cmpk_lt_i32 s8, 0x0
  s_cbranch_scc0 L_fb3_4
  s_waitcnt vmcnt(4)
L_fb3_4:
  s_barrier
  v_mfma_f32_16x16x32_bf16 v[248:251], a[224:227], a[176:179], 0
  ds_read_b64_tr_b16 a[192:193], v14 offset:32768
  v_cvt_pk_bf16_f32 v155, v158, v159
  v_mfma_f32_16x16x32_bf16 v[248:251], a[228:231], a[180:183], v[248:251]
  v_exp_f32 v188, v188
  v_mfma_f32_16x16x32_bf16 v[248:251], a[232:235], a[184:187], v[248:251]
  s_add_u32 m0, s30, 16384
  s_xor_b32 s40, s32, 0x12400
  ds_read_b64_tr_b16 a[194:195], v14 offset:36864
  v_cvt_pk_bf16_f32 v168, v168, v169
  v_mfma_f32_16x16x32_bf16 v[248:251], a[236:239], a[188:191], v[248:251]
  s_waitcnt vmcnt(12)
  buffer_load_dwordx4 v22, s[16:19], s40 offen nt lds
  v_mfma_f32_16x16x32_bf16 v[232:235], a[236:239], a[172:175], 0
  ds_read_b64_tr_b16 a[196:197], v14 offset:40960
  v_cvt_pk_bf16_f32 v169, v170, v171
  v_mfma_f32_16x16x32_bf16 v[232:235], a[232:235], a[168:171], v[232:235]
  v_exp_f32 v189, v189
  v_mfma_f32_16x16x32_bf16 v[232:235], a[228:231], a[164:167], v[232:235]
  ds_read_b64_tr_b16 a[198:199], v14 offset:45056
  v_cvt_pk_bf16_f32 v170, v172, v173
  v_mfma_f32_16x16x32_bf16 v[232:235], a[224:227], a[160:163], v[232:235]
  v_exp_f32 v190, v190
  v_mfma_f32_16x16x32_bf16 v[216:219], a[224:227], a[144:147], 0
  ds_read_b64_tr_b16 a[200:201], v15 offset:32768
  v_cvt_pk_bf16_f32 v171, v174, v175
  v_mfma_f32_16x16x32_bf16 v[216:219], a[228:231], a[148:151], v[216:219]
  v_exp_f32 v191, v191
  v_mfma_f32_16x16x32_bf16 v[216:219], a[232:235], a[152:155], v[216:219]
  ds_read_b64_tr_b16 a[202:203], v15 offset:36864
  v_cvt_pk_bf16_f32 v184, v184, v185
  v_mfma_f32_16x16x32_bf16 v[216:219], a[236:239], a[156:159], v[216:219]
  v_exp_f32 v192, v192
  v_mfma_f32_16x16x32_bf16 v[200:203], a[236:239], a[140:143], 0
  ds_read_b64_tr_b16 a[204:205], v15 offset:40960
  v_cvt_pk_bf16_f32 v185, v186, v187
  v_mfma_f32_16x16x32_bf16 v[200:203], a[232:235], a[136:139], v[200:203]
  v_exp_f32 v193, v193
  v_mfma_f32_16x16x32_bf16 v[200:203], a[228:231], a[132:135], v[200:203]
  ds_read_b64_tr_b16 a[206:207], v15 offset:45056
  v_cvt_pk_bf16_f32 v186, v188, v189
  v_mfma_f32_16x16x32_bf16 v[200:203], a[224:227], a[128:131], v[200:203]
  v_exp_f32 v194, v194
  v_mfma_f32_16x16x32_bf16 v[204:207], a[240:243], a[128:131], 0
  s_add_u32 m0, s30, 17408
  s_xor_b32 s40, s32, 0x12800
  ds_read_b64_tr_b16 a[208:209], v16 offset:32768
  v_cvt_pk_bf16_f32 v187, v190, v191
  v_mfma_f32_16x16x32_bf16 v[204:207], a[244:247], a[132:135], v[204:207]
  s_waitcnt vmcnt(12)
  buffer_load_dwordx4 v23, s[16:19], s40 offen nt lds
  v_mfma_f32_16x16x32_bf16 v[204:207], a[248:251], a[136:139], v[204:207]
  ds_read_b64_tr_b16 a[210:211], v16 offset:36864
  v_cvt_pk_bf16_f32 v192, v192, v193
  v_mfma_f32_16x16x32_bf16 v[204:207], a[252:255], a[140:143], v[204:207]
  s_waitcnt vmcnt(9)
  v_readfirstlane_b32 s44, v252
  v_mfma_f32_16x16x32_bf16 v[220:223], a[252:255], a[156:159], 0
  ds_read_b64_tr_b16 a[212:213], v16 offset:40960
  v_mfma_f32_16x16x32_bf16 v[220:223], a[248:251], a[152:155], v[220:223]
  s_sub_u32 s44, s44, s49
  s_add_u32 s49, s49, 64
  s_sub_i32 s8, s44, s98
  s_sub_i32 s9, s44, s99
  s_sub_i32 s10, s44, s100
  s_sub_i32 s11, s44, s101
  v_exp_f32 v195, v195
  v_mfma_f32_16x16x32_bf16 v[220:223], a[244:247], a[148:151], v[220:223]
  ds_read_b64_tr_b16 a[214:215], v16 offset:45056
  v_cvt_pk_bf16_f32 v193, v194, v195
  v_mfma_f32_16x16x32_bf16 v[220:223], a[240:243], a[144:147], v[220:223]
  v_exp_f32 v196, v196
  v_mfma_f32_16x16x32_bf16 v[236:239], a[240:243], a[160:163], 0
  ds_read_b64_tr_b16 a[216:217], v17 offset:32768
  v_mfma_f32_16x16x32_bf16 v[236:239], a[244:247], a[164:167], v[236:239]
  v_exp_f32 v197, v197
  v_mfma_f32_16x16x32_bf16 v[236:239], a[248:251], a[168:171], v[236:239]
  ds_read_b64_tr_b16 a[218:219], v17 offset:36864
  v_cvt_pk_bf16_f32 v194, v196, v197
  v_mfma_f32_16x16x32_bf16 v[236:239], a[252:255], a[172:175], v[236:239]
  v_exp_f32 v198, v198
  v_mfma_f32_16x16x32_bf16 v[252:255], a[252:255], a[188:191], 0
  s_add_u32 m0, s30, 18432
  s_xor_b32 s40, s32, 0x2000
  ds_read_b64_tr_b16 a[220:221], v17 offset:40960
  v_mfma_f32_16x16x32_bf16 v[252:255], a[248:251], a[184:187], v[252:255]
  s_waitcnt vmcnt(12)
  buffer_load_dwordx4 v24, s[16:19], s40 offen nt lds
  v_mfma_f32_16x16x32_bf16 v[252:255], a[244:247], a[180:183], v[252:255]
  ds_read_b64_tr_b16 a[222:223], v17 offset:45056
  v_mfma_f32_16x16x32_bf16 v[252:255], a[240:243], a[176:179], v[252:255]
  v_exp_f32 v199, v199
  v_mfma_f32_16x16x32_bf16 v[48:51], v[44:47], v[128:131], v[48:51]
  ds_read_b64_tr_b16 a[224:225], v18 offset:32768
  v_cvt_pk_bf16_f32 v195, v198, v199
  v_mfma_f32_16x16x32_bf16 v[48:51], v[44:47], v[136:139], v[48:51]
  v_exp_f32 v208, v208
  v_mfma_f32_16x16x32_bf16 v[52:55], v[44:47], v[144:147], v[52:55]
  ds_read_b64_tr_b16 a[226:227], v18 offset:36864
  v_mfma_f32_16x16x32_bf16 v[52:55], v[44:47], v[152:155], v[52:55]
  v_exp_f32 v209, v209
  v_mfma_f32_16x16x32_bf16 v[56:59], v[44:47], v[160:163], v[56:59]
  ds_read_b64_tr_b16 a[228:229], v18 offset:40960
  v_cvt_pk_bf16_f32 v208, v208, v209
  v_mfma_f32_16x16x32_bf16 v[56:59], v[44:47], v[168:171], v[56:59]
  v_exp_f32 v210, v210
  v_mfma_f32_16x16x32_bf16 v[60:63], v[44:47], v[176:179], v[60:63]
  ds_read_b64_tr_b16 a[230:231], v18 offset:45056
  v_mfma_f32_16x16x32_bf16 v[60:63], v[44:47], v[184:187], v[60:63]
  s_waitcnt lgkmcnt(4)
  v_exp_f32 v211, v211
  v_mfma_f32_16x16x32_bf16 a[96:99], v[184:187], a[196:199], a[96:99]
  ds_read_b64_tr_b16 a[232:233], v19 offset:32768
  v_cvt_pk_bf16_f32 v209, v210, v211
  v_mfma_f32_16x16x32_bf16 a[96:99], v[176:179], a[192:195], a[96:99]
  v_exp_f32 v212, v212
  v_mfma_f32_16x16x32_bf16 a[64:67], v[160:163], a[192:195], a[64:67]
  s_xor_b32 s43, s48, 0x3000
  ds_read_b64_tr_b16 a[234:235], v19 offset:36864
  v_mfma_f32_16x16x32_bf16 a[64:67], v[168:171], a[196:199], a[64:67]
  s_waitcnt vmcnt(12)
  buffer_store_dwordx4 v[84:87], v26, s[24:27], s43 offen sc1
  v_mfma_f32_16x16x32_bf16 a[32:35], v[152:155], a[196:199], a[32:35]
  ds_read_b64_tr_b16 a[236:237], v19 offset:40960
  v_mfma_f32_16x16x32_bf16 a[32:35], v[144:147], a[192:195], a[32:35]
  v_exp_f32 v213, v213
  v_mfma_f32_16x16x32_bf16 a[0:3], v[128:131], a[192:195], a[0:3]
  ds_read_b64_tr_b16 a[238:239], v19 offset:45056
  v_cvt_pk_bf16_f32 v210, v212, v213
  v_mfma_f32_16x16x32_bf16 a[0:3], v[136:139], a[196:199], a[0:3]
  v_exp_f32 v214, v214
  v_mfma_f32_16x16x32_bf16 a[4:7], v[136:139], a[204:207], a[4:7]
  ds_read_b64_tr_b16 a[240:241], v20 offset:32768
  v_mfma_f32_16x16x32_bf16 a[4:7], v[128:131], a[200:203], a[4:7]
  v_exp_f32 v215, v215
  v_mfma_f32_16x16x32_bf16 a[36:39], v[144:147], a[200:203], a[36:39]
  ds_read_b64_tr_b16 a[242:243], v20 offset:36864
  v_cvt_pk_bf16_f32 v211, v214, v215
  v_mfma_f32_16x16x32_bf16 a[36:39], v[152:155], a[204:207], a[36:39]
  v_exp_f32 v224, v224
  v_mfma_f32_16x16x32_bf16 a[68:71], v[168:171], a[204:207], a[68:71]
  ds_read_b64_tr_b16 a[244:245], v20 offset:40960
  v_mfma_f32_16x16x32_bf16 a[68:71], v[160:163], a[200:203], a[68:71]
  v_exp_f32 v225, v225
  v_mfma_f32_16x16x32_bf16 a[100:103], v[176:179], a[200:203], a[100:103]
  ds_read_b64_tr_b16 a[246:247], v20 offset:45056
  v_cvt_pk_bf16_f32 v224, v224, v225
  v_mfma_f32_16x16x32_bf16 a[100:103], v[184:187], a[204:207], a[100:103]
  v_exp_f32 v226, v226
  v_mfma_f32_16x16x32_bf16 a[104:107], v[184:187], a[212:215], a[104:107]
  s_add_u32 m0, s30, 19456
  s_xor_b32 s40, s32, 0x2c00
  ds_read_b64_tr_b16 a[248:249], v21 offset:32768
  v_mfma_f32_16x16x32_bf16 a[104:107], v[176:179], a[208:211], a[104:107]
  s_waitcnt vmcnt(12)
  buffer_load_dwordx4 v25, s[16:19], s40 offen nt lds
  v_mfma_f32_16x16x32_bf16 a[72:75], v[160:163], a[208:211], a[72:75]
  ds_read_b64_tr_b16 a[250:251], v21 offset:36864
  v_mfma_f32_16x16x32_bf16 a[72:75], v[168:171], a[212:215], a[72:75]
  v_exp_f32 v227, v227
  v_mfma_f32_16x16x32_bf16 a[40:43], v[152:155], a[212:215], a[40:43]
  ds_read_b64_tr_b16 a[252:253], v21 offset:40960
  v_cvt_pk_bf16_f32 v225, v226, v227
  v_mfma_f32_16x16x32_bf16 a[40:43], v[144:147], a[208:211], a[40:43]
  v_exp_f32 v228, v228
  v_mfma_f32_16x16x32_bf16 a[8:11], v[128:131], a[208:211], a[8:11]
  ds_read_b64_tr_b16 a[254:255], v21 offset:45056
  v_mfma_f32_16x16x32_bf16 a[8:11], v[136:139], a[212:215], a[8:11]
  v_exp_f32 v229, v229
  v_mfma_f32_16x16x32_bf16 a[12:15], v[136:139], a[220:223], a[12:15]
  v_exp_f32 v230, v230
  v_mfma_f32_16x16x32_bf16 a[12:15], v[128:131], a[216:219], a[12:15]
  v_exp_f32 v231, v231
  v_mfma_f32_16x16x32_bf16 a[44:47], v[144:147], a[216:219], a[44:47]
  v_exp_f32 v240, v240
  v_mfma_f32_16x16x32_bf16 a[44:47], v[152:155], a[220:223], a[44:47]
  s_waitcnt vmcnt(7) lgkmcnt(0)
  s_cmpk_lt_i32 s9, 0x0
  s_cbranch_scc0 L_fb3_5
  s_waitcnt vmcnt(3)
L_fb3_5:
  s_barrier
  v_mfma_f32_16x16x32_bf16 a[76:79], v[168:171], a[220:223], a[76:79]
  s_add_u32 m0, s30, 65536
  s_xor_b32 s40, s32, 0x12000
  ds_read_b128 a[192:195], v10
  v_cvt_pk_bf16_f32 v226, v228, v229
  v_mfma_f32_16x16x32_bf16 a[76:79], v[160:163], a[216:219], a[76:79]
  s_waitcnt vmcnt(12)
  buffer_load_dwordx4 v22, s[20:23], s40 offen nt lds
  v_mfma_f32_16x16x32_bf16 a[108:111], v[176:179], a[216:219], a[108:111]
  v_exp_f32 v241, v241
  v_mfma_f32_16x16x32_bf16 a[108:111], v[184:187], a[220:223], a[108:111]
  v_exp_f32 v242, v242
  v_mfma_f32_16x16x32_bf16 a[112:115], v[184:187], a[228:231], a[112:115]
  ds_read_b128 a[196:199], v11
  v_cvt_pk_bf16_f32 v227, v230, v231
  v_mfma_f32_16x16x32_bf16 a[112:115], v[176:179], a[224:227], a[112:115]
  v_exp_f32 v243, v243
  v_mfma_f32_16x16x32_bf16 a[80:83], v[160:163], a[224:227], a[80:83]
  v_exp_f32 v244, v244
  v_mfma_f32_16x16x32_bf16 a[80:83], v[168:171], a[228:231], a[80:83]
  v_exp_f32 v245, v245
  v_mfma_f32_16x16x32_bf16 a[48:51], v[152:155], a[228:231], a[48:51]
  ds_read_b128 a[200:203], v12
  v_cvt_pk_bf16_f32 v240, v240, v241
  v_mfma_f32_16x16x32_bf16 a[48:51], v[144:147], a[224:227], a[48:51]
  v_exp_f32 v246, v246
  v_mfma_f32_16x16x32_bf16 a[16:19], v[128:131], a[224:227], a[16:19]
  v_exp_f32 v247, v247
  v_mfma_f32_16x16x32_bf16 a[16:19], v[136:139], a[228:231], a[16:19]
  v_exp_f32 v200, v200
  v_mfma_f32_16x16x32_bf16 a[20:23], v[136:139], a[236:239], a[20:23]
L_pg20:
  s_cbranch_execz L_rt4
  ds_read_b128 a[204:207], v13
  v_cvt_pk_bf16_f32 v241, v242, v243
  v_mfma_f32_16x16x32_bf16 a[20:23], v[128:131], a[232:235], a[20:23]
  v_exp_f32 v201, v201
  v_mfma_f32_16x16x32_bf16 a[52:55], v[144:147], a[232:235], a[52:55]
  s_add_u32 m0, s30, 66560
  s_xor_b32 s40, s32, 0x12c00
  v_exp_f32 v202, v202
  v_mfma_f32_16x16x32_bf16 a[52:55], v[152:155], a[236:239], a[52:55]
  s_waitcnt vmcnt(12)
  buffer_load_dwordx4 v23, s[20:23], s40 offen nt lds
  v_mfma_f32_16x16x32_bf16 a[84:87], v[168:171], a[236:239], a[84:87]
  ds_read_b128 a[208:211], v10 offset:4096
  v_cvt_pk_bf16_f32 v242, v244, v245
  v_mfma_f32_16x16x32_bf16 a[84:87], v[160:163], a[232:235], a[84:87]
  v_exp_f32 v203, v203
  v_mfma_f32_16x16x32_bf16 a[116:119], v[176:179], a[232:235], a[116:119]
  v_exp_f32 v204, v204
  v_mfma_f32_16x16x32_bf16 a[116:119], v[184:187], a[236:239], a[116:119]
  v_exp_f32 v205, v205
  v_mfma_f32_16x16x32_bf16 a[120:123], v[184:187], a[244:247], a[120:123]
  ds_read_b128 a[212:215], v11 offset:4096
  v_cvt_pk_bf16_f32 v243, v246, v247
  v_mfma_f32_16x16x32_bf16 a[120:123], v[176:179], a[240:243], a[120:123]
  v_exp_f32 v206, v206
  v_mfma_f32_16x16x32_bf16 a[88:91], v[160:163], a[240:243], a[88:91]
  v_exp_f32 v207, v207
  v_mfma_f32_16x16x32_bf16 a[88:91], v[168:171], a[244:247], a[88:91]
  v_exp_f32 v216, v216
  v_mfma_f32_16x16x32_bf16 a[56:59], v[152:155], a[244:247], a[56:59]
  ds_read_b128 a[216:219], v12 offset:4096
  v_cvt_pk_bf16_f32 v200, v200, v201
  v_mfma_f32_16x16x32_bf16 a[56:59], v[144:147], a[240:243], a[56:59]
  v_exp_f32 v217, v217
  v_mfma_f32_16x16x32_bf16 a[24:27], v[128:131], a[240:243], a[24:27]
  v_exp_f32 v218, v218
  v_mfma_f32_16x16x32_bf16 a[24:27], v[136:139], a[244:247], a[24:27]
  v_exp_f32 v219, v219
  v_mfma_f32_16x16x32_bf16 a[28:31], v[136:139], a[252:255], a[28:31]
  s_xor_b32 s43, s48, 0x5400
  ds_read_b128 a[220:223], v13 offset:4096
  v_cvt_pk_bf16_f32 v201, v202, v203
  v_mfma_f32_16x16x32_bf16 a[28:31], v[128:131], a[248:251], a[28:31]
  s_waitcnt vmcnt(12)
  buffer_store_dwordx4 v[88:91], v26, s[24:27], s43 offen sc1
  v_mfma_f32_16x16x32_bf16 a[60:63], v[144:147], a[248:251], a[60:63]
  v_exp_f32 v220, v220
  v_mfma_f32_16x16x32_bf16 a[60:63], v[152:155], a[252:255], a[60:63]
  v_exp_f32 v221, v221
  v_mfma_f32_16x16x32_bf16 a[92:95], v[168:171], a[252:255], a[92:95]
  v_exp_f32 v222, v222
  v_mfma_f32_16x16x32_bf16 a[92:95], v[160:163], a[248:251], a[92:95]
  v_exp_f32 v223, v223
  v_mfma_f32_16x16x32_bf16 a[124:127], v[176:179], a[248:251], a[124:127]
  v_exp_f32 v232, v232
  v_mfma_f32_16x16x32_bf16 a[124:127], v[184:187], a[252:255], a[124:127]
  s_waitcnt lgkmcnt(0)
  v_exp_f32 v233, v233
  v_mfma_f32_16x16x32_bf16 v[176:179], a[192:195], a[176:179], 0
  v_exp_f32 v234, v234
  v_mfma_f32_16x16x32_bf16 v[176:179], a[196:199], a[180:183], v[176:179]
  ds_read_b128 a[224:227], v10 offset:8192
  v_cvt_pk_bf16_f32 v202, v204, v205
  v_mfma_f32_16x16x32_bf16 v[176:179], a[200:203], a[184:187], v[176:179]
  v_exp_f32 v235, v235
  v_mfma_f32_16x16x32_bf16 v[176:179], a[204:207], a[188:191], v[176:179]
  v_exp_f32 v236, v236
  v_mfma_f32_16x16x32_bf16 v[160:163], a[204:207], a[172:175], 0
  ds_read_b128 a[228:231], v11 offset:8192
  v_cvt_pk_bf16_f32 v203, v206, v207
  v_mfma_f32_16x16x32_bf16 v[160:163], a[200:203], a[168:171], v[160:163]
  s_add_u32 m0, s30, 67584
  s_xor_b32 s40, s32, 0x2400
  v_exp_f32 v237, v237
  v_mfma_f32_16x16x32_bf16 v[160:163], a[196:199], a[164:167], v[160:163]
  s_waitcnt vmcnt(12)
  buffer_load_dwordx4 v24, s[20:23], s40 offen nt lds
  v_mfma_f32_16x16x32_bf16 v[160:163], a[192:195], a[160:163], v[160:163]
  ds_read_b128 a[232:235], v12 offset:8192
  v_cvt_pk_bf16_f32 v216, v216, v217
  v_mfma_f32_16x16x32_bf16 v[144:147], a[192:195], a[144:147], 0
  v_exp_f32 v238, v238
  v_mfma_f32_16x16x32_bf16 v[144:147], a[196:199], a[148:151], v[144:147]
  v_exp_f32 v239, v239
  v_mfma_f32_16x16x32_bf16 v[144:147], a[200:203], a[152:155], v[144:147]
  ds_read_b128 a[236:239], v13 offset:8192
  v_cvt_pk_bf16_f32 v217, v218, v219
  v_mfma_f32_16x16x32_bf16 v[144:147], a[204:207], a[156:159], v[144:147]
  v_exp_f32 v248, v248
  v_mfma_f32_16x16x32_bf16 v[128:131], a[204:207], a[140:143], 0
  v_exp_f32 v249, v249
  v_mfma_f32_16x16x32_bf16 v[128:131], a[200:203], a[136:139], v[128:131]
  ds_read_b128 a[240:243], v10 offset:12288
  v_cvt_pk_bf16_f32 v218, v220, v221
  v_mfma_f32_16x16x32_bf16 v[128:131], a[196:199], a[132:135], v[128:131]
  v_exp_f32 v250, v250
  v_mfma_f32_16x16x32_bf16 v[128:131], a[192:195], a[128:131], v[128:131]
  v_exp_f32 v251, v251
  v_mfma_f32_16x16x32_bf16 v[132:135], a[208:211], a[128:131], 0
  ds_read_b128 a[244:247], v11 offset:12288
  v_cvt_pk_bf16_f32 v219, v222, v223
  v_mfma_f32_16x16x32_bf16 v[132:135], a[212:215], a[132:135], v[132:135]
  v_exp_f32 v252, v252
  v_mfma_f32_16x16x32_bf16 v[132:135], a[216:219], a[136:139], v[132:135]
  v_exp_f32 v253, v253
  v_mfma_f32_16x16x32_bf16 v[132:135], a[220:223], a[140:143], v[132:135]
  s_add_u32 m0, s30, 68608
  s_xor_b32 s40, s32, 0x2800
  ds_read_b128 a[248:251], v12 offset:12288
  v_cvt_pk_bf16_f32 v232, v232, v233
  v_mfma_f32_16x16x32_bf16 v[148:151], a[220:223], a[156:159], 0
  s_waitcnt vmcnt(12)
  buffer_load_dwordx4 v25, s[20:23], s40 offen nt lds
  v_mfma_f32_16x16x32_bf16 v[148:151], a[216:219], a[152:155], v[148:151]
  v_exp_f32 v254, v254
  v_mfma_f32_16x16x32_bf16 v[148:151], a[212:215], a[148:151], v[148:151]
  ds_read_b128 a[252:255], v13 offset:12288
  v_cvt_pk_bf16_f32 v233, v234, v235
  v_mfma_f32_16x16x32_bf16 v[148:151], a[208:211], a[144:147], v[148:151]
  v_exp_f32 v255, v255
  v_mfma_f32_16x16x32_bf16 v[164:167], a[208:211], a[160:163], 0
  v_exp_f32 v128, v128
  v_mfma_f32_16x16x32_bf16 v[164:167], a[212:215], a[164:167], v[164:167]
  v_exp_f32 v129, v129
  v_mfma_f32_16x16x32_bf16 v[164:167], a[216:219], a[168:171], v[164:167]
  v_exp_f32 v130, v130
  v_mfma_f32_16x16x32_bf16 v[164:167], a[220:223], a[172:175], v[164:167]
  v_exp_f32 v131, v131
  v_mfma_f32_16x16x32_bf16 v[180:183], a[220:223], a[188:191], 0
  v_exp_f32 v132, v132
  v_mfma_f32_16x16x32_bf16 v[180:183], a[216:219], a[184:187], v[180:183]
  v_cvt_pk_bf16_f32 v234, v236, v237
  v_cvt_pk_bf16_f32 v235, v238, v239
  v_mfma_f32_16x16x32_bf16 v[180:183], a[212:215], a[180:183], v[180:183]
  v_exp_f32 v133, v133
  v_mfma_f32_16x16x32_bf16 v[180:183], a[208:211], a[176:179], v[180:183]
  s_waitcnt vmcnt(7) lgkmcnt(0)
  s_cmpk_lt_i32 s10, 0x0
  s_cbranch_scc0 L_fb3_6
  s_waitcnt vmcnt(4)
L_fb3_6:
  s_barrier
  v_mfma_f32_16x16x32_bf16 v[184:187], a[224:227], a[176:179], 0
  s_add_u32 m0, s30, 32768
  s_xor_b32 s40, s32, 0x11800
  ds_read_b64_tr_b16 a[192:193], v14 offset:49152
  v_cvt_pk_bf16_f32 v248, v248, v249
  v_mfma_f32_16x16x32_bf16 v[184:187], a[228:231], a[180:183], v[184:187]
  s_waitcnt vmcnt(12)
  buffer_load_dwordx4 v22, s[16:19], s40 offen nt lds
  v_mfma_f32_16x16x32_bf16 v[184:187], a[232:235], a[184:187], v[184:187]
  ds_read_b64_tr_b16 a[194:195], v14 offset:53248
  v_cvt_pk_bf16_f32 v249, v250, v251
  v_mfma_f32_16x16x32_bf16 v[184:187], a[236:239], a[188:191], v[184:187]
  v_exp_f32 v134, v134
  v_mfma_f32_16x16x32_bf16 v[168:171], a[236:239], a[172:175], 0
  ds_read_b64_tr_b16 a[196:197], v14 offset:57344
  v_cvt_pk_bf16_f32 v250, v252, v253
  v_mfma_f32_16x16x32_bf16 v[168:171], a[232:235], a[168:171], v[168:171]
  v_exp_f32 v135, v135
  v_mfma_f32_16x16x32_bf16 v[168:171], a[228:231], a[164:167], v[168:171]
  ds_read_b64_tr_b16 a[198:199], v14 offset:61440
  v_cvt_pk_bf16_f32 v251, v254, v255
  v_mfma_f32_16x16x32_bf16 v[168:171], a[224:227], a[160:163], v[168:171]
  v_exp_f32 v144, v144
  v_mfma_f32_16x16x32_bf16 v[152:155], a[224:227], a[144:147], 0
  ds_read_b64_tr_b16 a[200:201], v15 offset:49152
  v_cvt_pk_bf16_f32 v128, v128, v129
  v_mfma_f32_16x16x32_bf16 v[152:155], a[228:231], a[148:151], v[152:155]
  v_exp_f32 v145, v145
  v_mfma_f32_16x16x32_bf16 v[152:155], a[232:235], a[152:155], v[152:155]
  ds_read_b64_tr_b16 a[202:203], v15 offset:53248
  v_cvt_pk_bf16_f32 v129, v130, v131
  v_mfma_f32_16x16x32_bf16 v[152:155], a[236:239], a[156:159], v[152:155]
  v_exp_f32 v146, v146
  v_mfma_f32_16x16x32_bf16 v[136:139], a[236:239], a[140:143], 0
  ds_read_b64_tr_b16 a[204:205], v15 offset:57344
  v_cvt_pk_bf16_f32 v130, v132, v133
  v_mfma_f32_16x16x32_bf16 v[136:139], a[232:235], a[136:139], v[136:139]
  v_exp_f32 v147, v147
  v_mfma_f32_16x16x32_bf16 v[136:139], a[228:231], a[132:135], v[136:139]
  s_add_u32 m0, s30, 33792
  s_xor_b32 s40, s32, 0x11400
  ds_read_b64_tr_b16 a[206:207], v15 offset:61440
  v_cvt_pk_bf16_f32 v131, v134, v135
  v_mfma_f32_16x16x32_bf16 v[136:139], a[224:227], a[128:131], v[136:139]
  s_waitcnt vmcnt(12)
  buffer_load_dwordx4 v23, s[16:19], s40 offen nt lds
  v_mfma_f32_16x16x32_bf16 v[140:143], a[240:243], a[128:131], 0
  ds_read_b64_tr_b16 a[208:209], v16 offset:49152
  v_cvt_pk_bf16_f32 v144, v144, v145
  v_mfma_f32_16x16x32_bf16 v[140:143], a[244:247], a[132:135], v[140:143]
  v_exp_f32 v148, v148
  v_mfma_f32_16x16x32_bf16 v[140:143], a[248:251], a[136:139], v[140:143]
  ds_read_b64_tr_b16 a[210:211], v16 offset:53248
  v_cvt_pk_bf16_f32 v145, v146, v147
  v_mfma_f32_16x16x32_bf16 v[140:143], a[252:255], a[140:143], v[140:143]
  v_exp_f32 v149, v149
  v_mfma_f32_16x16x32_bf16 v[156:159], a[252:255], a[156:159], 0
  ds_read_b64_tr_b16 a[212:213], v16 offset:57344
  v_cvt_pk_bf16_f32 v146, v148, v149
  v_mfma_f32_16x16x32_bf16 v[156:159], a[248:251], a[152:155], v[156:159]
  v_exp_f32 v150, v150
  v_mfma_f32_16x16x32_bf16 v[156:159], a[244:247], a[148:151], v[156:159]
  ds_read_b64_tr_b16 a[214:215], v16 offset:61440
  v_mfma_f32_16x16x32_bf16 v[156:159], a[240:243], a[144:147], v[156:159]
  v_exp_f32 v151, v151
  v_mfma_f32_16x16x32_bf16 v[172:175], a[240:243], a[160:163], 0
  ds_read_b64_tr_b16 a[216:217], v17 offset:49152
  v_cvt_pk_bf16_f32 v147, v150, v151
  v_mfma_f32_16x16x32_bf16 v[172:175], a[244:247], a[164:167], v[172:175]
  v_exp_f32 v160, v160
  v_mfma_f32_16x16x32_bf16 v[172:175], a[248:251], a[168:171], v[172:175]
  s_xor_b32 s43, s48, 0x3400
  ds_read_b64_tr_b16 a[218:219], v17 offset:53248
  v_mfma_f32_16x16x32_bf16 v[172:175], a[252:255], a[172:175], v[172:175]
  s_waitcnt vmcnt(12)
  buffer_store_dwordx4 v[92:95], v26, s[24:27], s43 offen sc1
  v_mfma_f32_16x16x32_bf16 v[188:191], a[252:255], a[188:191], 0
  ds_read_b64_tr_b16 a[220:221], v17 offset:57344
  v_mfma_f32_16x16x32_bf16 v[188:191], a[248:251], a[184:187], v[188:191]
  v_exp_f32 v161, v161
  v_mfma_f32_16x16x32_bf16 v[188:191], a[244:247], a[180:183], v[188:191]
  ds_read_b64_tr_b16 a[222:223], v17 offset:61440
  v_cvt_pk_bf16_f32 v160, v160, v161
  v_mfma_f32_16x16x32_bf16 v[188:191], a[240:243], a[176:179], v[188:191]
  v_exp_f32 v162, v162
  v_mfma_f32_16x16x32_bf16 v[48:51], v[44:47], v[192:195], v[48:51]
  ds_read_b64_tr_b16 a[224:225], v18 offset:49152
  v_mfma_f32_16x16x32_bf16 v[48:51], v[44:47], v[200:203], v[48:51]
  v_exp_f32 v163, v163
  v_mfma_f32_16x16x32_bf16 v[52:55], v[44:47], v[208:211], v[52:55]
  ds_read_b64_tr_b16 a[226:227], v18 offset:53248
  v_cvt_pk_bf16_f32 v161, v162, v163
  v_mfma_f32_16x16x32_bf16 v[52:55], v[44:47], v[216:219], v[52:55]
  v_exp_f32 v164, v164
  v_mfma_f32_16x16x32_bf16 v[56:59], v[44:47], v[224:227], v[56:59]
  ds_read_b64_tr_b16 a[228:229], v18 offset:57344
  v_mfma_f32_16x16x32_bf16 v[56:59], v[44:47], v[232:235], v[56:59]
  v_exp_f32 v165, v165
  v_mfma_f32_16x16x32_bf16 v[60:63], v[44:47], v[240:243], v[60:63]
  ds_read_b64_tr_b16 a[230:231], v18 offset:61440
  v_cvt_pk_bf16_f32 v162, v164, v165
  v_mfma_f32_16x16x32_bf16 v[60:63], v[44:47], v[248:251], v[60:63]
  s_waitcnt lgkmcnt(4)
  v_exp_f32 v166, v166
  v_mfma_f32_16x16x32_bf16 a[96:99], v[248:251], a[196:199], a[96:99]
  s_add_u32 m0, s30, 34816
  s_xor_b32 s40, s32, 0x1c00
  ds_read_b64_tr_b16 a[232:233], v19 offset:49152
  v_mfma_f32_16x16x32_bf16 a[96:99], v[240:243], a[192:195], a[96:99]
  s_waitcnt vmcnt(12)
  buffer_load_dwordx4 v24, s[16:19], s40 offen nt lds
  v_mfma_f32_16x16x32_bf16 a[64:67], v[224:227], a[192:195], a[64:67]
  ds_read_b64_tr_b16 a[234:235], v19 offset:53248
  v_mfma_f32_16x16x32_bf16 a[64:67], v[232:235], a[196:199], a[64:67]
  v_exp_f32 v167, v167
  v_mfma_f32_16x16x32_bf16 a[32:35], v[216:219], a[196:199], a[32:35]
  ds_read_b64_tr_b16 a[236:237], v19 offset:57344
  v_cvt_pk_bf16_f32 v163, v166, v167
  v_mfma_f32_16x16x32_bf16 a[32:35], v[208:211], a[192:195], a[32:35]
  v_exp_f32 v176, v176
  v_mfma_f32_16x16x32_bf16 a[0:3], v[192:195], a[192:195], a[0:3]
  ds_read_b64_tr_b16 a[238:239], v19 offset:61440
  v_mfma_f32_16x16x32_bf16 a[0:3], v[200:203], a[196:199], a[0:3]
  v_exp_f32 v177, v177
  v_mfma_f32_16x16x32_bf16 a[4:7], v[200:203], a[204:207], a[4:7]
  ds_read_b64_tr_b16 a[240:241], v20 offset:49152
  v_cvt_pk_bf16_f32 v176, v176, v177
  v_mfma_f32_16x16x32_bf16 a[4:7], v[192:195], a[200:203], a[4:7]
  v_exp_f32 v178, v178
  v_mfma_f32_16x16x32_bf16 a[36:39], v[208:211], a[200:203], a[36:39]
  ds_read_b64_tr_b16 a[242:243], v20 offset:53248
  v_mfma_f32_16x16x32_bf16 a[36:39], v[216:219], a[204:207], a[36:39]
  v_exp_f32 v179, v179
  v_mfma_f32_16x16x32_bf16 a[68:71], v[232:235], a[204:207], a[68:71]
  ds_read_b64_tr_b16 a[244:245], v20 offset:57344
  v_cvt_pk_bf16_f32 v177, v178, v179
  v_mfma_f32_16x16x32_bf16 a[68:71], v[224:227], a[200:203], a[68:71]
  v_exp_f32 v180, v180
  v_mfma_f32_16x16x32_bf16 a[100:103], v[240:243], a[200:203], a[100:103]
  s_add_u32 m0, s30, 35840
  s_xor_b32 s40, s32, 0x1000
  ds_read_b64_tr_b16 a[246:247], v20 offset:61440
  v_mfma_f32_16x16x32_bf16 a[100:103], v[248:251], a[204:207], a[100:103]
  s_waitcnt vmcnt(12)
  buffer_load_dwordx4 v25, s[16:19], s40 offen nt lds
  v_mfma_f32_16x16x32_bf16 a[104:107], v[248:251], a[212:215], a[104:107]
  ds_read_b64_tr_b16 a[248:249], v21 offset:49152
  v_mfma_f32_16x16x32_bf16 a[104:107], v[240:243], a[208:211], a[104:107]
  v_exp_f32 v181, v181
  v_mfma_f32_16x16x32_bf16 a[72:75], v[224:227], a[208:211], a[72:75]
  ds_read_b64_tr_b16 a[250:251], v21 offset:53248
  v_cvt_pk_bf16_f32 v178, v180, v181
  v_mfma_f32_16x16x32_bf16 a[72:75], v[232:235], a[212:215], a[72:75]
  v_exp_f32 v182, v182
  v_mfma_f32_16x16x32_bf16 a[40:43], v[216:219], a[212:215], a[40:43]
  ds_read_b64_tr_b16 a[252:253], v21 offset:57344
  v_mfma_f32_16x16x32_bf16 a[40:43], v[208:211], a[208:211], a[40:43]
  v_exp_f32 v183, v183
  v_mfma_f32_16x16x32_bf16 a[8:11], v[192:195], a[208:211], a[8:11]
  ds_read_b64_tr_b16 a[254:255], v21 offset:61440
  v_cvt_pk_bf16_f32 v179, v182, v183
  v_mfma_f32_16x16x32_bf16 a[8:11], v[200:203], a[212:215], a[8:11]
  v_exp_f32 v136, v136
  v_mfma_f32_16x16x32_bf16 a[12:15], v[200:203], a[220:223], a[12:15]
  v_exp_f32 v137, v137
  v_mfma_f32_16x16x32_bf16 a[12:15], v[192:195], a[216:219], a[12:15]
  v_exp_f32 v138, v138
  v_mfma_f32_16x16x32_bf16 a[44:47], v[208:211], a[216:219], a[44:47]
  v_exp_f32 v139, v139
  v_mfma_f32_16x16x32_bf16 a[44:47], v[216:219], a[220:223], a[44:47]
  s_waitcnt vmcnt(7) lgkmcnt(0)
  s_cmpk_lt_i32 s11, 0x0
  s_cbranch_scc0 L_fb3_7
  s_waitcnt vmcnt(3)
L_fb3_7:
  s_barrier
  v_mfma_f32_16x16x32_bf16 a[76:79], v[232:235], a[220:223], a[76:79]
  s_add_u32 m0, s30, 81920
  s_xor_b32 s40, s32, 0x12400
  ds_read_b128 a[192:195], v10 offset:16384
  v_cvt_pk_bf16_f32 v136, v136, v137
  v_mfma_f32_16x16x32_bf16 a[76:79], v[224:227], a[216:219], a[76:79]
  s_waitcnt vmcnt(12)
  buffer_load_dwordx4 v22, s[20:23], s40 offen nt lds
  v_mfma_f32_16x16x32_bf16 a[108:111], v[240:243], a[216:219], a[108:111]
  v_exp_f32 v140, v140
  v_mfma_f32_16x16x32_bf16 a[108:111], v[248:251], a[220:223], a[108:111]
  v_exp_f32 v141, v141
  v_mfma_f32_16x16x32_bf16 a[112:115], v[248:251], a[228:231], a[112:115]
  ds_read_b128 a[196:199], v11 offset:16384
  v_cvt_pk_bf16_f32 v137, v138, v139
  v_mfma_f32_16x16x32_bf16 a[112:115], v[240:243], a[224:227], a[112:115]
  v_exp_f32 v142, v142
  v_mfma_f32_16x16x32_bf16 a[80:83], v[224:227], a[224:227], a[80:83]
  v_exp_f32 v143, v143
  v_mfma_f32_16x16x32_bf16 a[80:83], v[232:235], a[228:231], a[80:83]
  v_exp_f32 v152, v152
  v_mfma_f32_16x16x32_bf16 a[48:51], v[216:219], a[228:231], a[48:51]
  ds_read_b128 a[200:203], v12 offset:16384
  v_cvt_pk_bf16_f32 v138, v140, v141
  v_mfma_f32_16x16x32_bf16 a[48:51], v[208:211], a[224:227], a[48:51]
  v_exp_f32 v153, v153
  v_mfma_f32_16x16x32_bf16 a[16:19], v[192:195], a[224:227], a[16:19]
  v_exp_f32 v154, v154
  v_mfma_f32_16x16x32_bf16 a[16:19], v[200:203], a[228:231], a[16:19]
  v_exp_f32 v155, v155
  v_mfma_f32_16x16x32_bf16 a[20:23], v[200:203], a[236:239], a[20:23]
  s_add_u32 m0, s30, 82944
  s_xor_b32 s40, s32, 0x12800
  ds_read_b128 a[204:207], v13 offset:16384
  v_cvt_pk_bf16_f32 v139, v142, v143
  v_mfma_f32_16x16x32_bf16 a[20:23], v[192:195], a[232:235], a[20:23]
  s_waitcnt vmcnt(12)
  buffer_load_dwordx4 v23, s[20:23], s40 offen nt lds
  v_mfma_f32_16x16x32_bf16 a[52:55], v[208:211], a[232:235], a[52:55]
  v_exp_f32 v156, v156
  v_mfma_f32_16x16x32_bf16 a[52:55], v[216:219], a[236:239], a[52:55]
  v_exp_f32 v157, v157
  v_mfma_f32_16x16x32_bf16 a[84:87], v[232:235], a[236:239], a[84:87]
  ds_read_b128 a[208:211], v10 offset:20480
  v_cvt_pk_bf16_f32 v152, v152, v153
  v_mfma_f32_16x16x32_bf16 a[84:87], v[224:227], a[232:235], a[84:87]
  v_exp_f32 v158, v158
  v_mfma_f32_16x16x32_bf16 a[116:119], v[240:243], a[232:235], a[116:119]
  v_exp_f32 v159, v159
  v_mfma_f32_16x16x32_bf16 a[116:119], v[248:251], a[236:239], a[116:119]
  v_exp_f32 v168, v168
  v_mfma_f32_16x16x32_bf16 a[120:123], v[248:251], a[244:247], a[120:123]
  ds_read_b128 a[212:215], v11 offset:20480
  v_cvt_pk_bf16_f32 v153, v154, v155
  v_mfma_f32_16x16x32_bf16 a[120:123], v[240:243], a[240:243], a[120:123]
  v_exp_f32 v169, v169
  v_mfma_f32_16x16x32_bf16 a[88:91], v[224:227], a[240:243], a[88:91]
  v_exp_f32 v170, v170
  v_mfma_f32_16x16x32_bf16 a[88:91], v[232:235], a[244:247], a[88:91]
  v_exp_f32 v171, v171
  v_mfma_f32_16x16x32_bf16 a[56:59], v[216:219], a[244:247], a[56:59]
  ds_read_b128 a[216:219], v12 offset:20480
  v_cvt_pk_bf16_f32 v154, v156, v157
  v_mfma_f32_16x16x32_bf16 a[56:59], v[208:211], a[240:243], a[56:59]
  s_xor_b32 s43, s48, 0xe800
  v_exp_f32 v172, v172
  v_mfma_f32_16x16x32_bf16 a[24:27], v[192:195], a[240:243], a[24:27]
  s_waitcnt vmcnt(12)
  buffer_store_dwordx4 v[96:99], v26, s[24:27], s43 offen sc1
  v_mfma_f32_16x16x32_bf16 a[24:27], v[200:203], a[244:247], a[24:27]
  v_exp_f32 v173, v173
  v_mfma_f32_16x16x32_bf16 a[28:31], v[200:203], a[252:255], a[28:31]
  ds_read_b128 a[220:223], v13 offset:20480
  v_cvt_pk_bf16_f32 v155, v158, v159
  v_mfma_f32_16x16x32_bf16 a[28:31], v[192:195], a[248:251], a[28:31]
  v_exp_f32 v174, v174
  v_mfma_f32_16x16x32_bf16 a[60:63], v[208:211], a[248:251], a[60:63]
  v_exp_f32 v175, v175
  v_mfma_f32_16x16x32_bf16 a[60:63], v[216:219], a[252:255], a[60:63]
  v_exp_f32 v184, v184
  v_mfma_f32_16x16x32_bf16 a[92:95], v[232:235], a[252:255], a[92:95]
  v_exp_f32 v185, v185
  v_mfma_f32_16x16x32_bf16 a[92:95], v[224:227], a[248:251], a[92:95]
  v_exp_f32 v186, v186
  v_mfma_f32_16x16x32_bf16 a[124:127], v[240:243], a[248:251], a[124:127]
  v_exp_f32 v187, v187
  v_mfma_f32_16x16x32_bf16 a[124:127], v[248:251], a[252:255], a[124:127]
  s_waitcnt lgkmcnt(0)
  v_exp_f32 v188, v188
  v_mfma_f32_16x16x32_bf16 v[240:243], a[192:195], a[176:179], 0
  v_exp_f32 v189, v189
  v_mfma_f32_16x16x32_bf16 v[240:243], a[196:199], a[180:183], v[240:243]
  ds_read_b128 a[224:227], v10 offset:24576
  v_cvt_pk_bf16_f32 v168, v168, v169
  v_mfma_f32_16x16x32_bf16 v[240:243], a[200:203], a[184:187], v[240:243]
  v_exp_f32 v190, v190
  v_mfma_f32_16x16x32_bf16 v[240:243], a[204:207], a[188:191], v[240:243]
  v_exp_f32 v191, v191
  v_mfma_f32_16x16x32_bf16 v[224:227], a[204:207], a[172:175], 0
  s_add_u32 m0, s30, 83968
  s_xor_b32 s40, s32, 0x2000
  ds_read_b128 a[228:231], v11 offset:24576
  v_cvt_pk_bf16_f32 v169, v170, v171
  v_mfma_f32_16x16x32_bf16 v[224:227], a[200:203], a[168:171], v[224:227]
  s_waitcnt vmcnt(12)
  buffer_load_dwordx4 v24, s[20:23], s40 offen nt lds
  v_mfma_f32_16x16x32_bf16 v[224:227], a[196:199], a[164:167], v[224:227]
  v_cvt_pk_bf16_f32 v170, v172, v173
  v_cvt_pk_bf16_f32 v171, v174, v175
  v_mfma_f32_16x16x32_bf16 v[224:227], a[192:195], a[160:163], v[224:227]
  ds_read_b128 a[232:235], v12 offset:24576
  v_cvt_pk_bf16_f32 v184, v184, v185
  v_mfma_f32_16x16x32_bf16 v[208:211], a[192:195], a[144:147], 0
  v_cvt_pk_bf16_f32 v185, v186, v187
  v_cvt_pk_bf16_f32 v186, v188, v189
  v_mfma_f32_16x16x32_bf16 v[208:211], a[196:199], a[148:151], v[208:211]
  v_cvt_pk_bf16_f32 v187, v190, v191
  v_mfma_f32_16x16x32_bf16 v[208:211], a[200:203], a[152:155], v[208:211]
  ds_read_b128 a[236:239], v13 offset:24576
  v_mfma_f32_16x16x32_bf16 v[208:211], a[204:207], a[156:159], v[208:211]
  v_mfma_f32_16x16x32_bf16 v[192:195], a[204:207], a[140:143], 0
  v_mfma_f32_16x16x32_bf16 v[192:195], a[200:203], a[136:139], v[192:195]
  ds_read_b128 a[240:243], v10 offset:28672
  v_mfma_f32_16x16x32_bf16 v[192:195], a[196:199], a[132:135], v[192:195]
  v_mfma_f32_16x16x32_bf16 v[192:195], a[192:195], a[128:131], v[192:195]
  v_mfma_f32_16x16x32_bf16 v[196:199], a[208:211], a[128:131], 0
  s_add_u32 m0, s30, 84992
  s_xor_b32 s40, s32, 0x2c00
  ds_read_b128 a[244:247], v11 offset:28672
  v_mfma_f32_16x16x32_bf16 v[196:199], a[212:215], a[132:135], v[196:199]
  s_waitcnt vmcnt(12)
  buffer_load_dwordx4 v25, s[20:23], s40 offen nt lds
  v_mfma_f32_16x16x32_bf16 v[196:199], a[216:219], a[136:139], v[196:199]
  v_mfma_f32_16x16x32_bf16 v[196:199], a[220:223], a[140:143], v[196:199]
  ds_read_b128 a[248:251], v12 offset:28672
  v_mfma_f32_16x16x32_bf16 v[212:215], a[220:223], a[156:159], 0
  v_mfma_f32_16x16x32_bf16 v[212:215], a[216:219], a[152:155], v[212:215]
  v_mfma_f32_16x16x32_bf16 v[212:215], a[212:215], a[148:151], v[212:215]
  ds_read_b128 a[252:255], v13 offset:28672
  v_mfma_f32_16x16x32_bf16 v[212:215], a[208:211], a[144:147], v[212:215]
  v_mfma_f32_16x16x32_bf16 v[228:231], a[208:211], a[160:163], 0
  v_exp_f32 v192, v192
  v_mfma_f32_16x16x32_bf16 v[228:231], a[212:215], a[164:167], v[228:231]
  v_exp_f32 v193, v193
  v_mfma_f32_16x16x32_bf16 v[228:231], a[216:219], a[168:171], v[228:231]
  v_exp_f32 v194, v194
  v_mfma_f32_16x16x32_bf16 v[228:231], a[220:223], a[172:175], v[228:231]
  v_exp_f32 v195, v195
  v_mfma_f32_16x16x32_bf16 v[244:247], a[220:223], a[188:191], 0
  v_exp_f32 v196, v196
  v_mfma_f32_16x16x32_bf16 v[244:247], a[216:219], a[184:187], v[244:247]
  s_add_u32 m0, s30, 49152
  s_xor_b32 s40, s32, 0x11c00
  v_exp_f32 v197, v197
  v_mfma_f32_16x16x32_bf16 v[244:247], a[212:215], a[180:183], v[244:247]
  s_waitcnt vmcnt(12)
  buffer_load_dwordx4 v22, s[16:19], s40 offen nt lds
  v_mfma_f32_16x16x32_bf16 v[244:247], a[208:211], a[176:179], v[244:247]
  s_waitcnt vmcnt(7) lgkmcnt(0)
  s_cmpk_lt_i32 s8, 0x0
  s_cbranch_scc0 L_fb3_8
  s_waitcnt vmcnt(4)
L_fb3_8:
  s_barrier
  v_mfma_f32_16x16x32_bf16 v[248:251], a[224:227], a[176:179], 0
  ds_read_b64_tr_b16 a[192:193], v14
  v_cvt_pk_bf16_f32 v192, v192, v193
  v_mfma_f32_16x16x32_bf16 v[248:251], a[228:231], a[180:183], v[248:251]
  v_exp_f32 v198, v198
  v_mfma_f32_16x16x32_bf16 v[248:251], a[232:235], a[184:187], v[248:251]
  ds_read_b64_tr_b16 a[194:195], v14 offset:4096
  v_cvt_pk_bf16_f32 v193, v194, v195
  v_mfma_f32_16x16x32_bf16 v[248:251], a[236:239], a[188:191], v[248:251]
  v_exp_f32 v199, v199
  v_mfma_f32_16x16x32_bf16 v[232:235], a[236:239], a[172:175], 0
  ds_read_b64_tr_b16 a[196:197], v14 offset:8192
  v_cvt_pk_bf16_f32 v194, v196, v197
  v_mfma_f32_16x16x32_bf16 v[232:235], a[232:235], a[168:171], v[232:235]
  v_exp_f32 v208, v208
  v_mfma_f32_16x16x32_bf16 v[232:235], a[228:231], a[164:167], v[232:235]
  ds_read_b64_tr_b16 a[198:199], v14 offset:12288
  v_cvt_pk_bf16_f32 v195, v198, v199
  v_mfma_f32_16x16x32_bf16 v[232:235], a[224:227], a[160:163], v[232:235]
  v_exp_f32 v209, v209
  v_mfma_f32_16x16x32_bf16 v[216:219], a[224:227], a[144:147], 0
  ds_read_b64_tr_b16 a[200:201], v15
  v_cvt_pk_bf16_f32 v208, v208, v209
  v_mfma_f32_16x16x32_bf16 v[216:219], a[228:231], a[148:151], v[216:219]
  v_exp_f32 v210, v210
  v_mfma_f32_16x16x32_bf16 v[216:219], a[232:235], a[152:155], v[216:219]
  ds_read_b64_tr_b16 a[202:203], v15 offset:4096
  v_mfma_f32_16x16x32_bf16 v[216:219], a[236:239], a[156:159], v[216:219]
  v_exp_f32 v211, v211
  v_mfma_f32_16x16x32_bf16 v[200:203], a[236:239], a[140:143], 0
  s_add_u32 m0, s30, 50176
  s_xor_b32 s40, s32, 0x11000
  ds_read_b64_tr_b16 a[204:205], v15 offset:8192
  v_cvt_pk_bf16_f32 v209, v210, v211
  v_mfma_f32_16x16x32_bf16 v[200:203], a[232:235], a[136:139], v[200:203]
  s_waitcnt vmcnt(12)
  buffer_load_dwordx4 v23, s[16:19], s40 offen nt lds
  v_mfma_f32_16x16x32_bf16 v[200:203], a[228:231], a[132:135], v[200:203]
  ds_read_b64_tr_b16 a[206:207], v15 offset:12288
  v_mfma_f32_16x16x32_bf16 v[200:203], a[224:227], a[128:131], v[200:203]
  v_exp_f32 v212, v212
  v_mfma_f32_16x16x32_bf16 v[204:207], a[240:243], a[128:131], 0
  ds_read_b64_tr_b16 a[208:209], v16
  v_mfma_f32_16x16x32_bf16 v[204:207], a[244:247], a[132:135], v[204:207]
  v_exp_f32 v213, v213
  v_mfma_f32_16x16x32_bf16 v[204:207], a[248:251], a[136:139], v[204:207]
  ds_read_b64_tr_b16 a[210:211], v16 offset:4096
  v_cvt_pk_bf16_f32 v210, v212, v213
  v_mfma_f32_16x16x32_bf16 v[204:207], a[252:255], a[140:143], v[204:207]
  v_exp_f32 v214, v214
  v_mfma_f32_16x16x32_bf16 v[220:223], a[252:255], a[156:159], 0
  ds_read_b64_tr_b16 a[212:213], v16 offset:8192
  v_mfma_f32_16x16x32_bf16 v[220:223], a[248:251], a[152:155], v[220:223]
  v_exp_f32 v215, v215
  v_mfma_f32_16x16x32_bf16 v[220:223], a[244:247], a[148:151], v[220:223]
  ds_read_b64_tr_b16 a[214:215], v16 offset:12288
  v_cvt_pk_bf16_f32 v211, v214, v215
  v_mfma_f32_16x16x32_bf16 v[220:223], a[240:243], a[144:147], v[220:223]
  v_exp_f32 v224, v224
  v_mfma_f32_16x16x32_bf16 v[236:239], a[240:243], a[160:163], 0
  s_xor_b32 s43, s48, 0x8800
  ds_read_b64_tr_b16 a[216:217], v17
  v_mfma_f32_16x16x32_bf16 v[236:239], a[244:247], a[164:167], v[236:239]
  s_waitcnt vmcnt(12)
  buffer_store_dwordx4 v[100:103], v26, s[24:27], s43 offen sc1
  v_mfma_f32_16x16x32_bf16 v[236:239], a[248:251], a[168:171], v[236:239]
  ds_read_b64_tr_b16 a[218:219], v17 offset:4096
  v_mfma_f32_16x16x32_bf16 v[236:239], a[252:255], a[172:175], v[236:239]
  v_exp_f32 v225, v225
  v_mfma_f32_16x16x32_bf16 v[252:255], a[252:255], a[188:191], 0
  ds_read_b64_tr_b16 a[220:221], v17 offset:8192
  v_cvt_pk_bf16_f32 v224, v224, v225
  v_mfma_f32_16x16x32_bf16 v[252:255], a[248:251], a[184:187], v[252:255]
  v_exp_f32 v226, v226
  v_mfma_f32_16x16x32_bf16 v[252:255], a[244:247], a[180:183], v[252:255]
  ds_read_b64_tr_b16 a[222:223], v17 offset:12288
  v_mfma_f32_16x16x32_bf16 v[252:255], a[240:243], a[176:179], v[252:255]
  v_exp_f32 v227, v227
  v_mfma_f32_16x16x32_bf16 v[48:51], v[44:47], v[128:131], v[48:51]
  ds_read_b64_tr_b16 a[224:225], v18
  v_cvt_pk_bf16_f32 v225, v226, v227
  v_mfma_f32_16x16x32_bf16 v[48:51], v[44:47], v[136:139], v[48:51]
  v_exp_f32 v228, v228
  v_mfma_f32_16x16x32_bf16 v[52:55], v[44:47], v[144:147], v[52:55]
  ds_read_b64_tr_b16 a[226:227], v18 offset:4096
  v_mfma_f32_16x16x32_bf16 v[52:55], v[44:47], v[152:155], v[52:55]
  v_exp_f32 v229, v229
  v_mfma_f32_16x16x32_bf16 v[56:59], v[44:47], v[160:163], v[56:59]
  ds_read_b64_tr_b16 a[228:229], v18 offset:8192
  v_cvt_pk_bf16_f32 v226, v228, v229
  v_mfma_f32_16x16x32_bf16 v[56:59], v[44:47], v[168:171], v[56:59]
  v_exp_f32 v230, v230
  v_mfma_f32_16x16x32_bf16 v[60:63], v[44:47], v[176:179], v[60:63]
  s_add_u32 m0, s30, 51200
  s_xor_b32 s40, s32, 0x1800
  ds_read_b64_tr_b16 a[230:231], v18 offset:12288
  v_mfma_f32_16x16x32_bf16 v[60:63], v[44:47], v[184:187], v[60:63]
  s_waitcnt lgkmcnt(4)
  s_waitcnt vmcnt(12)
  buffer_load_dwordx4 v24, s[16:19], s40 offen nt lds
  v_mfma_f32_16x16x32_bf16 a[96:99], v[184:187], a[196:199], a[96:99]
  ds_read_b64_tr_b16 a[232:233], v19
  v_mfma_f32_16x16x32_bf16 a[96:99], v[176:179], a[192:195], a[96:99]
  v_exp_f32 v231, v231
  v_mfma_f32_16x16x32_bf16 a[64:67], v[160:163], a[192:195], a[64:67]
  ds_read_b64_tr_b16 a[234:235], v19 offset:4096
  v_cvt_pk_bf16_f32 v227, v230, v231
  v_mfma_f32_16x16x32_bf16 a[64:67], v[168:171], a[196:199], a[64:67]
  v_exp_f32 v240, v240
  v_mfma_f32_16x16x32_bf16 a[32:35], v[152:155], a[196:199], a[32:35]
  ds_read_b64_tr_b16 a[236:237], v19 offset:8192
L_pg21:
  s_cbranch_execz L_rt4
  v_mfma_f32_16x16x32_bf16 a[32:35], v[144:147], a[192:195], a[32:35]
  v_exp_f32 v241, v241
  v_mfma_f32_16x16x32_bf16 a[0:3], v[128:131], a[192:195], a[0:3]
  ds_read_b64_tr_b16 a[238:239], v19 offset:12288
  v_cvt_pk_bf16_f32 v240, v240, v241
  v_mfma_f32_16x16x32_bf16 a[0:3], v[136:139], a[196:199], a[0:3]
  v_exp_f32 v242, v242
  v_mfma_f32_16x16x32_bf16 a[4:7], v[136:139], a[204:207], a[4:7]
  ds_read_b64_tr_b16 a[240:241], v20
  v_mfma_f32_16x16x32_bf16 a[4:7], v[128:131], a[200:203], a[4:7]
  v_exp_f32 v243, v243
  v_mfma_f32_16x16x32_bf16 a[36:39], v[144:147], a[200:203], a[36:39]
  ds_read_b64_tr_b16 a[242:243], v20 offset:4096
  v_cvt_pk_bf16_f32 v241, v242, v243
  v_mfma_f32_16x16x32_bf16 a[36:39], v[152:155], a[204:207], a[36:39]
  v_exp_f32 v244, v244
  v_mfma_f32_16x16x32_bf16 a[68:71], v[168:171], a[204:207], a[68:71]
  s_add_u32 m0, s30, 52224
  s_xor_b32 s40, s32, 0x1400
  ds_read_b64_tr_b16 a[244:245], v20 offset:8192
  v_mfma_f32_16x16x32_bf16 a[68:71], v[160:163], a[200:203], a[68:71]
  s_waitcnt vmcnt(12)
  buffer_load_dwordx4 v25, s[16:19], s40 offen nt lds
  v_mfma_f32_16x16x32_bf16 a[100:103], v[176:179], a[200:203], a[100:103]
  ds_read_b64_tr_b16 a[246:247], v20 offset:12288
  v_mfma_f32_16x16x32_bf16 a[100:103], v[184:187], a[204:207], a[100:103]
  v_exp_f32 v245, v245
  v_mfma_f32_16x16x32_bf16 a[104:107], v[184:187], a[212:215], a[104:107]
  ds_read_b64_tr_b16 a[248:249], v21
  v_cvt_pk_bf16_f32 v242, v244, v245
  v_mfma_f32_16x16x32_bf16 a[104:107], v[176:179], a[208:211], a[104:107]
  v_exp_f32 v246, v246
  v_mfma_f32_16x16x32_bf16 a[72:75], v[160:163], a[208:211], a[72:75]
  ds_read_b64_tr_b16 a[250:251], v21 offset:4096
  v_mfma_f32_16x16x32_bf16 a[72:75], v[168:171], a[212:215], a[72:75]
  v_exp_f32 v247, v247
  v_mfma_f32_16x16x32_bf16 a[40:43], v[152:155], a[212:215], a[40:43]
  ds_read_b64_tr_b16 a[252:253], v21 offset:8192
  v_cvt_pk_bf16_f32 v243, v246, v247
  v_mfma_f32_16x16x32_bf16 a[40:43], v[144:147], a[208:211], a[40:43]
  v_exp_f32 v200, v200
  v_mfma_f32_16x16x32_bf16 a[8:11], v[128:131], a[208:211], a[8:11]
  ds_read_b64_tr_b16 a[254:255], v21 offset:12288
  v_mfma_f32_16x16x32_bf16 a[8:11], v[136:139], a[212:215], a[8:11]
  v_exp_f32 v201, v201
  v_mfma_f32_16x16x32_bf16 a[12:15], v[136:139], a[220:223], a[12:15]
  s_add_u32 m0, s30, 98304
  s_xor_b32 s40, s32, 0x11800
  v_exp_f32 v202, v202
  v_mfma_f32_16x16x32_bf16 a[12:15], v[128:131], a[216:219], a[12:15]
  s_waitcnt vmcnt(12)
  buffer_load_dwordx4 v22, s[20:23], s40 offen nt lds
  v_mfma_f32_16x16x32_bf16 a[44:47], v[144:147], a[216:219], a[44:47]
  v_exp_f32 v203, v203
  v_mfma_f32_16x16x32_bf16 a[44:47], v[152:155], a[220:223], a[44:47]
  s_waitcnt vmcnt(11) lgkmcnt(0)
  s_barrier
  v_cvt_pk_bf16_f32 v200, v200, v201
  v_mfma_f32_16x16x32_bf16 a[76:79], v[168:171], a[220:223], a[76:79]
  ds_read_b128 a[192:195], v10 offset:32768
  v_cvt_pk_bf16_f32 v201, v202, v203
  v_mfma_f32_16x16x32_bf16 a[76:79], v[160:163], a[216:219], a[76:79]
  v_exp_f32 v204, v204
  v_mfma_f32_16x16x32_bf16 a[108:111], v[176:179], a[216:219], a[108:111]
  v_exp_f32 v205, v205
  v_mfma_f32_16x16x32_bf16 a[108:111], v[184:187], a[220:223], a[108:111]
  v_exp_f32 v206, v206
  v_mfma_f32_16x16x32_bf16 a[112:115], v[184:187], a[228:231], a[112:115]
  ds_read_b128 a[196:199], v11 offset:32768
  v_cvt_pk_bf16_f32 v202, v204, v205
  v_mfma_f32_16x16x32_bf16 a[112:115], v[176:179], a[224:227], a[112:115]
  v_exp_f32 v207, v207
  v_mfma_f32_16x16x32_bf16 a[80:83], v[160:163], a[224:227], a[80:83]
  v_exp_f32 v216, v216
  v_mfma_f32_16x16x32_bf16 a[80:83], v[168:171], a[228:231], a[80:83]
  v_exp_f32 v217, v217
  v_mfma_f32_16x16x32_bf16 a[48:51], v[152:155], a[228:231], a[48:51]
  ds_read_b128 a[200:203], v12 offset:32768
  v_cvt_pk_bf16_f32 v203, v206, v207
  v_mfma_f32_16x16x32_bf16 a[48:51], v[144:147], a[224:227], a[48:51]
  v_exp_f32 v218, v218
  v_mfma_f32_16x16x32_bf16 a[16:19], v[128:131], a[224:227], a[16:19]
  s_add_u32 m0, s30, 99328
  s_xor_b32 s40, s32, 0x11400
  v_exp_f32 v219, v219
  v_mfma_f32_16x16x32_bf16 a[16:19], v[136:139], a[228:231], a[16:19]
  s_waitcnt vmcnt(12)
  buffer_load_dwordx4 v23, s[20:23], s40 offen nt lds
  v_mfma_f32_16x16x32_bf16 a[20:23], v[136:139], a[236:239], a[20:23]
  ds_read_b128 a[204:207], v13 offset:32768
  v_cvt_pk_bf16_f32 v216, v216, v217
  v_mfma_f32_16x16x32_bf16 a[20:23], v[128:131], a[232:235], a[20:23]
  v_exp_f32 v220, v220
  v_mfma_f32_16x16x32_bf16 a[52:55], v[144:147], a[232:235], a[52:55]
  v_exp_f32 v221, v221
  v_mfma_f32_16x16x32_bf16 a[52:55], v[152:155], a[236:239], a[52:55]
  v_exp_f32 v222, v222
  v_mfma_f32_16x16x32_bf16 a[84:87], v[168:171], a[236:239], a[84:87]
  ds_read_b128 a[208:211], v10 offset:36864
  v_cvt_pk_bf16_f32 v217, v218, v219
  v_mfma_f32_16x16x32_bf16 a[84:87], v[160:163], a[232:235], a[84:87]
  v_exp_f32 v223, v223
  v_mfma_f32_16x16x32_bf16 a[116:119], v[176:179], a[232:235], a[116:119]
  v_exp_f32 v232, v232
  v_mfma_f32_16x16x32_bf16 a[116:119], v[184:187], a[236:239], a[116:119]
  v_exp_f32 v233, v233
  v_mfma_f32_16x16x32_bf16 a[120:123], v[184:187], a[244:247], a[120:123]
  ds_read_b128 a[212:215], v11 offset:36864
  v_cvt_pk_bf16_f32 v218, v220, v221
  v_mfma_f32_16x16x32_bf16 a[120:123], v[176:179], a[240:243], a[120:123]
  v_exp_f32 v234, v234
  v_mfma_f32_16x16x32_bf16 a[88:91], v[160:163], a[240:243], a[88:91]
  v_exp_f32 v235, v235
  v_mfma_f32_16x16x32_bf16 a[88:91], v[168:171], a[244:247], a[88:91]
  v_exp_f32 v236, v236
  v_mfma_f32_16x16x32_bf16 a[56:59], v[152:155], a[244:247], a[56:59]
  s_add_u32 m0, s30, 100352
  s_xor_b32 s40, s32, 0x1c00
  ds_read_b128 a[216:219], v12 offset:36864
  v_cvt_pk_bf16_f32 v219, v222, v223
  v_mfma_f32_16x16x32_bf16 a[56:59], v[144:147], a[240:243], a[56:59]
  s_waitcnt vmcnt(12)
  buffer_load_dwordx4 v24, s[20:23], s40 offen nt lds
  v_mfma_f32_16x16x32_bf16 a[24:27], v[128:131], a[240:243], a[24:27]
  v_exp_f32 v237, v237
  v_mfma_f32_16x16x32_bf16 a[24:27], v[136:139], a[244:247], a[24:27]
  v_exp_f32 v238, v238
  v_mfma_f32_16x16x32_bf16 a[28:31], v[136:139], a[252:255], a[28:31]
  ds_read_b128 a[220:223], v13 offset:36864
  v_cvt_pk_bf16_f32 v232, v232, v233
  v_mfma_f32_16x16x32_bf16 a[28:31], v[128:131], a[248:251], a[28:31]
  v_exp_f32 v239, v239
  v_mfma_f32_16x16x32_bf16 a[60:63], v[144:147], a[248:251], a[60:63]
  v_exp_f32 v248, v248
  v_mfma_f32_16x16x32_bf16 a[60:63], v[152:155], a[252:255], a[60:63]
  v_exp_f32 v249, v249
  v_mfma_f32_16x16x32_bf16 a[92:95], v[168:171], a[252:255], a[92:95]
  v_exp_f32 v250, v250
  v_mfma_f32_16x16x32_bf16 a[92:95], v[160:163], a[248:251], a[92:95]
  v_exp_f32 v251, v251
  v_mfma_f32_16x16x32_bf16 a[124:127], v[176:179], a[248:251], a[124:127]
  v_exp_f32 v252, v252
  v_mfma_f32_16x16x32_bf16 a[124:127], v[184:187], a[252:255], a[124:127]
  s_waitcnt lgkmcnt(0)
  v_exp_f32 v253, v253
  v_mfma_f32_16x16x32_bf16 v[176:179], a[192:195], a[176:179], 0
  v_exp_f32 v254, v254
  v_mfma_f32_16x16x32_bf16 v[176:179], a[196:199], a[180:183], v[176:179]
  s_add_u32 m0, s30, 101376
  s_xor_b32 s40, s32, 0x1000
  ds_read_b128 a[224:227], v10 offset:40960
  v_cvt_pk_bf16_f32 v233, v234, v235
  v_mfma_f32_16x16x32_bf16 v[176:179], a[200:203], a[184:187], v[176:179]
  s_waitcnt vmcnt(12)
  buffer_load_dwordx4 v25, s[20:23], s40 offen nt lds
  v_mfma_f32_16x16x32_bf16 v[176:179], a[204:207], a[188:191], v[176:179]
  v_exp_f32 v255, v255
  v_mfma_f32_16x16x32_bf16 v[160:163], a[204:207], a[172:175], 0
  ds_read_b128 a[228:231], v11 offset:40960
  v_cvt_pk_bf16_f32 v234, v236, v237
  v_mfma_f32_16x16x32_bf16 v[160:163], a[200:203], a[168:171], v[160:163]
  v_cvt_pk_bf16_f32 v235, v238, v239
  v_cvt_pk_bf16_f32 v248, v248, v249
  v_mfma_f32_16x16x32_bf16 v[160:163], a[196:199], a[164:167], v[160:163]
  v_cvt_pk_bf16_f32 v249, v250, v251
  v_cvt_pk_bf16_f32 v250, v252, v253
  v_mfma_f32_16x16x32_bf16 v[160:163], a[192:195], a[160:163], v[160:163]
  ds_read_b128 a[232:235], v12 offset:40960
  v_cvt_pk_bf16_f32 v251, v254, v255
  v_mfma_f32_16x16x32_bf16 v[144:147], a[192:195], a[144:147], 0
  v_mfma_f32_16x16x32_bf16 v[144:147], a[196:199], a[148:151], v[144:147]
  v_mfma_f32_16x16x32_bf16 v[144:147], a[200:203], a[152:155], v[144:147]
  ds_read_b128 a[236:239], v13 offset:40960
  v_mfma_f32_16x16x32_bf16 v[144:147], a[204:207], a[156:159], v[144:147]
  v_mfma_f32_16x16x32_bf16 v[128:131], a[204:207], a[140:143], 0
  v_mfma_f32_16x16x32_bf16 v[128:131], a[200:203], a[136:139], v[128:131]
  ds_read_b128 a[240:243], v10 offset:45056
  v_mfma_f32_16x16x32_bf16 v[128:131], a[196:199], a[132:135], v[128:131]
  s_add_u32 m0, s30, 114688
  s_xor_b32 s40, s32, 0x11c00
  v_mfma_f32_16x16x32_bf16 v[128:131], a[192:195], a[128:131], v[128:131]
  s_waitcnt vmcnt(12)
  buffer_load_dwordx4 v22, s[20:23], s40 offen nt lds
  v_mfma_f32_16x16x32_bf16 v[132:135], a[208:211], a[128:131], 0
  ds_read_b128 a[244:247], v11 offset:45056
  v_mfma_f32_16x16x32_bf16 v[132:135], a[212:215], a[132:135], v[132:135]
  v_mfma_f32_16x16x32_bf16 v[132:135], a[216:219], a[136:139], v[132:135]
  v_mfma_f32_16x16x32_bf16 v[132:135], a[220:223], a[140:143], v[132:135]
  ds_read_b128 a[248:251], v12 offset:45056
  v_mfma_f32_16x16x32_bf16 v[148:151], a[220:223], a[156:159], 0
  v_mfma_f32_16x16x32_bf16 v[148:151], a[216:219], a[152:155], v[148:151]
  v_mfma_f32_16x16x32_bf16 v[148:151], a[212:215], a[148:151], v[148:151]
  ds_read_b128 a[252:255], v13 offset:45056
  v_mfma_f32_16x16x32_bf16 v[148:151], a[208:211], a[144:147], v[148:151]
  v_mfma_f32_16x16x32_bf16 v[164:167], a[208:211], a[160:163], 0
  v_exp_f32 v128, v128
  v_mfma_f32_16x16x32_bf16 v[164:167], a[212:215], a[164:167], v[164:167]
  v_exp_f32 v129, v129
  v_mfma_f32_16x16x32_bf16 v[164:167], a[216:219], a[168:171], v[164:167]
  v_exp_f32 v130, v130
  v_mfma_f32_16x16x32_bf16 v[164:167], a[220:223], a[172:175], v[164:167]
  v_exp_f32 v131, v131
  v_mfma_f32_16x16x32_bf16 v[180:183], a[220:223], a[188:191], 0
  s_add_u32 m0, s30, 115712
  s_xor_b32 s40, s32, 0x11000
  v_exp_f32 v132, v132
  v_mfma_f32_16x16x32_bf16 v[180:183], a[216:219], a[184:187], v[180:183]
  s_waitcnt vmcnt(12)
  buffer_load_dwordx4 v23, s[20:23], s40 offen nt lds
  v_mfma_f32_16x16x32_bf16 v[180:183], a[212:215], a[180:183], v[180:183]
  v_exp_f32 v133, v133
  v_mfma_f32_16x16x32_bf16 v[180:183], a[208:211], a[176:179], v[180:183]
  s_waitcnt vmcnt(11) lgkmcnt(0)
  s_barrier
  v_cvt_pk_bf16_f32 v128, v128, v129
  v_mfma_f32_16x16x32_bf16 v[184:187], a[224:227], a[176:179], 0
  ds_read_b64_tr_b16 a[192:193], v14 offset:16384
  v_cvt_pk_bf16_f32 v129, v130, v131
  v_mfma_f32_16x16x32_bf16 v[184:187], a[228:231], a[180:183], v[184:187]
  v_exp_f32 v134, v134
  v_mfma_f32_16x16x32_bf16 v[184:187], a[232:235], a[184:187], v[184:187]
  ds_read_b64_tr_b16 a[194:195], v14 offset:20480
  v_cvt_pk_bf16_f32 v130, v132, v133
  v_mfma_f32_16x16x32_bf16 v[184:187], a[236:239], a[188:191], v[184:187]
  v_exp_f32 v135, v135
  v_mfma_f32_16x16x32_bf16 v[168:171], a[236:239], a[172:175], 0
  ds_read_b64_tr_b16 a[196:197], v14 offset:24576
  v_cvt_pk_bf16_f32 v131, v134, v135
  v_mfma_f32_16x16x32_bf16 v[168:171], a[232:235], a[168:171], v[168:171]
  v_exp_f32 v144, v144
  v_mfma_f32_16x16x32_bf16 v[168:171], a[228:231], a[164:167], v[168:171]
  ds_read_b64_tr_b16 a[198:199], v14 offset:28672
  v_mfma_f32_16x16x32_bf16 v[168:171], a[224:227], a[160:163], v[168:171]
  v_exp_f32 v145, v145
  v_mfma_f32_16x16x32_bf16 v[152:155], a[224:227], a[144:147], 0
  ds_read_b64_tr_b16 a[200:201], v15 offset:16384
  v_cvt_pk_bf16_f32 v144, v144, v145
  v_mfma_f32_16x16x32_bf16 v[152:155], a[228:231], a[148:151], v[152:155]
  v_exp_f32 v146, v146
  v_mfma_f32_16x16x32_bf16 v[152:155], a[232:235], a[152:155], v[152:155]
  s_add_u32 m0, s30, 116736
  s_xor_b32 s40, s32, 0x1800
  ds_read_b64_tr_b16 a[202:203], v15 offset:20480
  v_mfma_f32_16x16x32_bf16 v[152:155], a[236:239], a[156:159], v[152:155]
  s_waitcnt vmcnt(12)
  buffer_load_dwordx4 v24, s[20:23], s40 offen nt lds
  v_mfma_f32_16x16x32_bf16 v[136:139], a[236:239], a[140:143], 0
  ds_read_b64_tr_b16 a[204:205], v15 offset:24576
  v_mfma_f32_16x16x32_bf16 v[136:139], a[232:235], a[136:139], v[136:139]
  v_exp_f32 v147, v147
  v_mfma_f32_16x16x32_bf16 v[136:139], a[228:231], a[132:135], v[136:139]
  ds_read_b64_tr_b16 a[206:207], v15 offset:28672
  v_cvt_pk_bf16_f32 v145, v146, v147
  v_mfma_f32_16x16x32_bf16 v[136:139], a[224:227], a[128:131], v[136:139]
  v_exp_f32 v148, v148
  v_mfma_f32_16x16x32_bf16 v[140:143], a[240:243], a[128:131], 0
  ds_read_b64_tr_b16 a[208:209], v16 offset:16384
  v_mfma_f32_16x16x32_bf16 v[140:143], a[244:247], a[132:135], v[140:143]
  v_exp_f32 v149, v149
  v_mfma_f32_16x16x32_bf16 v[140:143], a[248:251], a[136:139], v[140:143]
  ds_read_b64_tr_b16 a[210:211], v16 offset:20480
  v_cvt_pk_bf16_f32 v146, v148, v149
  v_mfma_f32_16x16x32_bf16 v[140:143], a[252:255], a[140:143], v[140:143]
  v_exp_f32 v150, v150
  v_mfma_f32_16x16x32_bf16 v[156:159], a[252:255], a[156:159], 0
  ds_read_b64_tr_b16 a[212:213], v16 offset:24576
  v_mfma_f32_16x16x32_bf16 v[156:159], a[248:251], a[152:155], v[156:159]
  v_exp_f32 v151, v151
  v_mfma_f32_16x16x32_bf16 v[156:159], a[244:247], a[148:151], v[156:159]
  s_add_u32 m0, s30, 117760
  s_xor_b32 s40, s32, 0x1400
  ds_read_b64_tr_b16 a[214:215], v16 offset:28672
  v_cvt_pk_bf16_f32 v147, v150, v151
  v_mfma_f32_16x16x32_bf16 v[156:159], a[240:243], a[144:147], v[156:159]
  s_waitcnt vmcnt(12)
  buffer_load_dwordx4 v25, s[20:23], s40 offen nt lds
  v_mfma_f32_16x16x32_bf16 v[172:175], a[240:243], a[160:163], 0
  ds_read_b64_tr_b16 a[216:217], v17 offset:16384
  v_mfma_f32_16x16x32_bf16 v[172:175], a[244:247], a[164:167], v[172:175]
  v_exp_f32 v160, v160
  v_mfma_f32_16x16x32_bf16 v[172:175], a[248:251], a[168:171], v[172:175]
  ds_read_b64_tr_b16 a[218:219], v17 offset:20480
  v_mfma_f32_16x16x32_bf16 v[172:175], a[252:255], a[172:175], v[172:175]
  v_exp_f32 v161, v161
  v_mfma_f32_16x16x32_bf16 v[188:191], a[252:255], a[188:191], 0
  ds_read_b64_tr_b16 a[220:221], v17 offset:24576
  v_cvt_pk_bf16_f32 v160, v160, v161
  v_mfma_f32_16x16x32_bf16 v[188:191], a[248:251], a[184:187], v[188:191]
  v_exp_f32 v162, v162
  v_mfma_f32_16x16x32_bf16 v[188:191], a[244:247], a[180:183], v[188:191]
  ds_read_b64_tr_b16 a[222:223], v17 offset:28672
  v_mfma_f32_16x16x32_bf16 v[188:191], a[240:243], a[176:179], v[188:191]
  v_exp_f32 v163, v163
  v_mfma_f32_16x16x32_bf16 v[48:51], v[44:47], v[192:195], v[48:51]
  ds_read_b64_tr_b16 a[224:225], v18 offset:16384
  v_cvt_pk_bf16_f32 v161, v162, v163
  v_mfma_f32_16x16x32_bf16 v[48:51], v[44:47], v[200:203], v[48:51]
  v_exp_f32 v164, v164
  v_mfma_f32_16x16x32_bf16 v[52:55], v[44:47], v[208:211], v[52:55]
  ds_read_b64_tr_b16 a[226:227], v18 offset:20480
  v_mfma_f32_16x16x32_bf16 v[52:55], v[44:47], v[216:219], v[52:55]
  v_exp_f32 v165, v165
  v_mfma_f32_16x16x32_bf16 v[56:59], v[44:47], v[224:227], v[56:59]
  ds_read_b64_tr_b16 a[228:229], v18 offset:24576
  v_cvt_pk_bf16_f32 v162, v164, v165
  v_mfma_f32_16x16x32_bf16 v[56:59], v[44:47], v[232:235], v[56:59]
  v_exp_f32 v166, v166
  v_mfma_f32_16x16x32_bf16 v[60:63], v[44:47], v[240:243], v[60:63]
  ds_read_b64_tr_b16 a[230:231], v18 offset:28672
  v_mfma_f32_16x16x32_bf16 v[60:63], v[44:47], v[248:251], v[60:63]
  s_waitcnt lgkmcnt(4)
  v_exp_f32 v167, v167
  v_mfma_f32_16x16x32_bf16 a[96:99], v[248:251], a[196:199], a[96:99]
  s_xor_b32 s43, s48, 0xec00
  ds_read_b64_tr_b16 a[232:233], v19 offset:16384
  v_cvt_pk_bf16_f32 v163, v166, v167
  v_mfma_f32_16x16x32_bf16 a[96:99], v[240:243], a[192:195], a[96:99]
  s_waitcnt vmcnt(63)
  buffer_store_dwordx4 v[104:107], v26, s[24:27], s43 offen sc1
  v_mfma_f32_16x16x32_bf16 a[64:67], v[224:227], a[192:195], a[64:67]
  ds_read_b64_tr_b16 a[234:235], v19 offset:20480
  v_mfma_f32_16x16x32_bf16 a[64:67], v[232:235], a[196:199], a[64:67]
  v_exp_f32 v176, v176
  v_mfma_f32_16x16x32_bf16 a[32:35], v[216:219], a[196:199], a[32:35]
  ds_read_b64_tr_b16 a[236:237], v19 offset:24576
  v_mfma_f32_16x16x32_bf16 a[32:35], v[208:211], a[192:195], a[32:35]
  v_exp_f32 v177, v177
  v_mfma_f32_16x16x32_bf16 a[0:3], v[192:195], a[192:195], a[0:3]
  ds_read_b64_tr_b16 a[238:239], v19 offset:28672
  v_cvt_pk_bf16_f32 v176, v176, v177
  v_mfma_f32_16x16x32_bf16 a[0:3], v[200:203], a[196:199], a[0:3]
  v_exp_f32 v178, v178
  v_mfma_f32_16x16x32_bf16 a[4:7], v[200:203], a[204:207], a[4:7]
  ds_read_b64_tr_b16 a[240:241], v20 offset:16384
  v_mfma_f32_16x16x32_bf16 a[4:7], v[192:195], a[200:203], a[4:7]
  v_exp_f32 v179, v179
  v_mfma_f32_16x16x32_bf16 a[36:39], v[208:211], a[200:203], a[36:39]
  ds_read_b64_tr_b16 a[242:243], v20 offset:20480
  v_cvt_pk_bf16_f32 v177, v178, v179
  v_mfma_f32_16x16x32_bf16 a[36:39], v[216:219], a[204:207], a[36:39]
  v_exp_f32 v180, v180
  v_mfma_f32_16x16x32_bf16 a[68:71], v[232:235], a[204:207], a[68:71]
  ds_read_b64_tr_b16 a[244:245], v20 offset:24576
  v_mfma_f32_16x16x32_bf16 a[68:71], v[224:227], a[200:203], a[68:71]
  v_exp_f32 v181, v181
  v_mfma_f32_16x16x32_bf16 a[100:103], v[240:243], a[200:203], a[100:103]
  ds_read_b64_tr_b16 a[246:247], v20 offset:28672
  v_cvt_pk_bf16_f32 v178, v180, v181
  v_mfma_f32_16x16x32_bf16 a[100:103], v[248:251], a[204:207], a[100:103]
  v_exp_f32 v182, v182
  v_mfma_f32_16x16x32_bf16 a[104:107], v[248:251], a[212:215], a[104:107]
  ds_read_b64_tr_b16 a[248:249], v21 offset:16384
  v_mfma_f32_16x16x32_bf16 a[104:107], v[240:243], a[208:211], a[104:107]
  v_exp_f32 v183, v183
  v_mfma_f32_16x16x32_bf16 a[72:75], v[224:227], a[208:211], a[72:75]
  ds_read_b64_tr_b16 a[250:251], v21 offset:20480
  v_cvt_pk_bf16_f32 v179, v182, v183
  v_mfma_f32_16x16x32_bf16 a[72:75], v[232:235], a[212:215], a[72:75]
  v_exp_f32 v136, v136
  v_mfma_f32_16x16x32_bf16 a[40:43], v[216:219], a[212:215], a[40:43]
  ds_read_b64_tr_b16 a[252:253], v21 offset:24576
  v_mfma_f32_16x16x32_bf16 a[40:43], v[208:211], a[208:211], a[40:43]
  v_exp_f32 v137, v137
  v_mfma_f32_16x16x32_bf16 a[8:11], v[192:195], a[208:211], a[8:11]
  s_xor_b32 s43, s48, 0x8c00
  ds_read_b64_tr_b16 a[254:255], v21 offset:28672
  v_cvt_pk_bf16_f32 v136, v136, v137
  v_mfma_f32_16x16x32_bf16 a[8:11], v[200:203], a[212:215], a[8:11]
  s_waitcnt vmcnt(63)
  buffer_store_dwordx4 v[108:111], v26, s[24:27], s43 offen sc1
  v_mfma_f32_16x16x32_bf16 a[12:15], v[200:203], a[220:223], a[12:15]
  v_exp_f32 v138, v138
  v_mfma_f32_16x16x32_bf16 a[12:15], v[192:195], a[216:219], a[12:15]
  v_exp_f32 v139, v139
  v_mfma_f32_16x16x32_bf16 a[44:47], v[208:211], a[216:219], a[44:47]
  v_exp_f32 v140, v140
  v_mfma_f32_16x16x32_bf16 a[44:47], v[216:219], a[220:223], a[44:47]
  s_waitcnt vmcnt(10) lgkmcnt(0)
  s_barrier
  v_cvt_pk_bf16_f32 v137, v138, v139
  v_mfma_f32_16x16x32_bf16 a[76:79], v[232:235], a[220:223], a[76:79]
  ds_read_b128 a[192:195], v10 offset:49152
  v_mfma_f32_16x16x32_bf16 a[76:79], v[224:227], a[216:219], a[76:79]
  v_exp_f32 v141, v141
  v_mfma_f32_16x16x32_bf16 a[108:111], v[240:243], a[216:219], a[108:111]
  v_exp_f32 v142, v142
  v_mfma_f32_16x16x32_bf16 a[108:111], v[248:251], a[220:223], a[108:111]
  v_exp_f32 v143, v143
  v_mfma_f32_16x16x32_bf16 a[112:115], v[248:251], a[228:231], a[112:115]
  ds_read_b128 a[196:199], v11 offset:49152
  v_cvt_pk_bf16_f32 v138, v140, v141
  v_mfma_f32_16x16x32_bf16 a[112:115], v[240:243], a[224:227], a[112:115]
  v_exp_f32 v152, v152
  v_mfma_f32_16x16x32_bf16 a[80:83], v[224:227], a[224:227], a[80:83]
  v_exp_f32 v153, v153
  v_mfma_f32_16x16x32_bf16 a[80:83], v[232:235], a[228:231], a[80:83]
  v_exp_f32 v154, v154
  v_mfma_f32_16x16x32_bf16 a[48:51], v[216:219], a[228:231], a[48:51]
  ds_read_b128 a[200:203], v12 offset:49152
  v_cvt_pk_bf16_f32 v139, v142, v143
  v_mfma_f32_16x16x32_bf16 a[48:51], v[208:211], a[224:227], a[48:51]
  v_exp_f32 v155, v155
  v_mfma_f32_16x16x32_bf16 a[16:19], v[192:195], a[224:227], a[16:19]
  v_exp_f32 v156, v156
  v_mfma_f32_16x16x32_bf16 a[16:19], v[200:203], a[228:231], a[16:19]
  v_exp_f32 v157, v157
  v_mfma_f32_16x16x32_bf16 a[20:23], v[200:203], a[236:239], a[20:23]
  ds_read_b128 a[204:207], v13 offset:49152
  v_cvt_pk_bf16_f32 v152, v152, v153
  v_mfma_f32_16x16x32_bf16 a[20:23], v[192:195], a[232:235], a[20:23]
  v_exp_f32 v158, v158
  v_mfma_f32_16x16x32_bf16 a[52:55], v[208:211], a[232:235], a[52:55]
  v_exp_f32 v159, v159
  v_mfma_f32_16x16x32_bf16 a[52:55], v[216:219], a[236:239], a[52:55]
  v_exp_f32 v168, v168
  v_mfma_f32_16x16x32_bf16 a[84:87], v[232:235], a[236:239], a[84:87]
  s_xor_b32 s43, s48, 0xb800
  ds_read_b128 a[208:211], v10 offset:53248
  v_cvt_pk_bf16_f32 v153, v154, v155
  v_mfma_f32_16x16x32_bf16 a[84:87], v[224:227], a[232:235], a[84:87]
  s_waitcnt vmcnt(63)
  buffer_store_dwordx4 v[112:115], v26, s[24:27], s43 offen sc1
  v_mfma_f32_16x16x32_bf16 a[116:119], v[240:243], a[232:235], a[116:119]
  v_exp_f32 v169, v169
  v_mfma_f32_16x16x32_bf16 a[116:119], v[248:251], a[236:239], a[116:119]
  v_exp_f32 v170, v170
  v_mfma_f32_16x16x32_bf16 a[120:123], v[248:251], a[244:247], a[120:123]
  ds_read_b128 a[212:215], v11 offset:53248
  v_cvt_pk_bf16_f32 v154, v156, v157
  v_mfma_f32_16x16x32_bf16 a[120:123], v[240:243], a[240:243], a[120:123]
  v_exp_f32 v171, v171
  v_mfma_f32_16x16x32_bf16 a[88:91], v[224:227], a[240:243], a[88:91]
  v_exp_f32 v172, v172
  v_mfma_f32_16x16x32_bf16 a[88:91], v[232:235], a[244:247], a[88:91]
  v_exp_f32 v173, v173
  v_mfma_f32_16x16x32_bf16 a[56:59], v[216:219], a[244:247], a[56:59]
  ds_read_b128 a[216:219], v12 offset:53248
  v_cvt_pk_bf16_f32 v155, v158, v159
  v_mfma_f32_16x16x32_bf16 a[56:59], v[208:211], a[240:243], a[56:59]
  v_exp_f32 v174, v174
  v_mfma_f32_16x16x32_bf16 a[24:27], v[192:195], a[240:243], a[24:27]
  v_exp_f32 v175, v175
  v_mfma_f32_16x16x32_bf16 a[24:27], v[200:203], a[244:247], a[24:27]
  v_exp_f32 v184, v184
  v_mfma_f32_16x16x32_bf16 a[28:31], v[200:203], a[252:255], a[28:31]
  ds_read_b128 a[220:223], v13 offset:53248
  v_cvt_pk_bf16_f32 v168, v168, v169
  v_mfma_f32_16x16x32_bf16 a[28:31], v[192:195], a[248:251], a[28:31]
  v_exp_f32 v185, v185
  v_mfma_f32_16x16x32_bf16 a[60:63], v[208:211], a[248:251], a[60:63]
  v_exp_f32 v186, v186
  v_mfma_f32_16x16x32_bf16 a[60:63], v[216:219], a[252:255], a[60:63]
  v_exp_f32 v187, v187
  v_mfma_f32_16x16x32_bf16 a[92:95], v[232:235], a[252:255], a[92:95]
  v_exp_f32 v188, v188
  v_mfma_f32_16x16x32_bf16 a[92:95], v[224:227], a[248:251], a[92:95]
  v_exp_f32 v189, v189
  v_mfma_f32_16x16x32_bf16 a[124:127], v[240:243], a[248:251], a[124:127]
  v_exp_f32 v190, v190
  v_mfma_f32_16x16x32_bf16 a[124:127], v[248:251], a[252:255], a[124:127]
  s_waitcnt lgkmcnt(0)
  v_exp_f32 v191, v191
  v_mfma_f32_16x16x32_bf16 v[240:243], a[192:195], a[176:179], 0
  v_cvt_pk_bf16_f32 v169, v170, v171
  v_cvt_pk_bf16_f32 v170, v172, v173
  v_mfma_f32_16x16x32_bf16 v[240:243], a[196:199], a[180:183], v[240:243]
  ds_read_b128 a[224:227], v10 offset:57344
  v_cvt_pk_bf16_f32 v171, v174, v175
  v_mfma_f32_16x16x32_bf16 v[240:243], a[200:203], a[184:187], v[240:243]
  s_xor_b32 s43, s48, 0xd800
  v_cvt_pk_bf16_f32 v184, v184, v185
  v_cvt_pk_bf16_f32 v185, v186, v187
  v_mfma_f32_16x16x32_bf16 v[240:243], a[204:207], a[188:191], v[240:243]
  s_waitcnt vmcnt(63)
  buffer_store_dwordx4 v[116:119], v26, s[24:27], s43 offen sc1
  v_mfma_f32_16x16x32_bf16 v[224:227], a[204:207], a[172:175], 0
  s_waitcnt vmcnt(8) lgkmcnt(0)
  s_barrier
  ds_read_b128 a[228:231], v11 offset:57344
  v_mfma_f32_16x16x32_bf16 v[224:227], a[200:203], a[168:171], v[224:227]
  ds_read_b64_tr_b16 v[64:65], v18 offset:32768
  v_cvt_pk_bf16_f32 v186, v188, v189
  v_mfma_f32_16x16x32_bf16 v[224:227], a[196:199], a[164:167], v[224:227]
  ds_read_b64_tr_b16 v[66:67], v18 offset:36864
  v_cvt_pk_bf16_f32 v187, v190, v191
  v_mfma_f32_16x16x32_bf16 v[224:227], a[192:195], a[160:163], v[224:227]
  ds_read_b128 a[232:235], v12 offset:57344
  v_mfma_f32_16x16x32_bf16 v[208:211], a[192:195], a[144:147], 0
  ds_read_b64_tr_b16 v[68:69], v18 offset:40960
  v_mfma_f32_16x16x32_bf16 v[208:211], a[196:199], a[148:151], v[208:211]
  ds_read_b64_tr_b16 v[70:71], v18 offset:45056
  v_mfma_f32_16x16x32_bf16 v[208:211], a[200:203], a[152:155], v[208:211]
  ds_read_b128 a[236:239], v13 offset:57344
  v_mfma_f32_16x16x32_bf16 v[208:211], a[204:207], a[156:159], v[208:211]
  ds_read_b64_tr_b16 v[72:73], v19 offset:32768
  v_mfma_f32_16x16x32_bf16 v[192:195], a[204:207], a[140:143], 0
  ds_read_b64_tr_b16 v[74:75], v19 offset:36864
  v_mfma_f32_16x16x32_bf16 v[192:195], a[200:203], a[136:139], v[192:195]
  ds_read_b128 a[240:243], v10 offset:61440
  v_mfma_f32_16x16x32_bf16 v[192:195], a[196:199], a[132:135], v[192:195]
  ds_read_b64_tr_b16 v[76:77], v19 offset:40960
  v_mfma_f32_16x16x32_bf16 v[192:195], a[192:195], a[128:131], v[192:195]
  ds_read_b64_tr_b16 v[78:79], v19 offset:45056
  v_mfma_f32_16x16x32_bf16 v[196:199], a[208:211], a[128:131], 0
  ds_read_b128 a[244:247], v11 offset:61440
  v_mfma_f32_16x16x32_bf16 v[196:199], a[212:215], a[132:135], v[196:199]
  ds_read_b64_tr_b16 v[80:81], v20 offset:32768
  v_mfma_f32_16x16x32_bf16 v[196:199], a[216:219], a[136:139], v[196:199]
  ds_read_b64_tr_b16 v[82:83], v20 offset:36864
  v_mfma_f32_16x16x32_bf16 v[196:199], a[220:223], a[140:143], v[196:199]
  ds_read_b128 a[248:251], v12 offset:61440
  v_mfma_f32_16x16x32_bf16 v[212:215], a[220:223], a[156:159], 0
  ds_read_b64_tr_b16 v[84:85], v20 offset:40960
  v_mfma_f32_16x16x32_bf16 v[212:215], a[216:219], a[152:155], v[212:215]
  ds_read_b64_tr_b16 v[86:87], v20 offset:45056
  v_mfma_f32_16x16x32_bf16 v[212:215], a[212:215], a[148:151], v[212:215]
  ds_read_b128 a[252:255], v13 offset:61440
  v_mfma_f32_16x16x32_bf16 v[212:215], a[208:211], a[144:147], v[212:215]
  ds_read_b64_tr_b16 v[88:89], v21 offset:32768
  v_mfma_f32_16x16x32_bf16 v[228:231], a[208:211], a[160:163], 0
  ds_read_b64_tr_b16 v[90:91], v21 offset:36864
  v_mfma_f32_16x16x32_bf16 v[228:231], a[212:215], a[164:167], v[228:231]
  ds_read_b64_tr_b16 v[92:93], v21 offset:40960
  v_mfma_f32_16x16x32_bf16 v[228:231], a[216:219], a[168:171], v[228:231]
  s_xor_b32 s43, s48, 0xbc00
  ds_read_b64_tr_b16 v[94:95], v21 offset:45056
  v_mfma_f32_16x16x32_bf16 v[228:231], a[220:223], a[172:175], v[228:231]
  s_waitcnt vmcnt(63)
  buffer_store_dwordx4 v[120:123], v26, s[24:27], s43 offen sc1
  v_mfma_f32_16x16x32_bf16 v[244:247], a[220:223], a[188:191], 0
  v_exp_f32 v192, v192
  v_mfma_f32_16x16x32_bf16 v[244:247], a[216:219], a[184:187], v[244:247]
  v_exp_f32 v193, v193
  v_mfma_f32_16x16x32_bf16 v[244:247], a[212:215], a[180:183], v[244:247]
  v_exp_f32 v194, v194
  v_mfma_f32_16x16x32_bf16 v[244:247], a[208:211], a[176:179], v[244:247]
  v_exp_f32 v195, v195
  v_mfma_f32_16x16x32_bf16 v[248:251], a[224:227], a[176:179], 0
  ds_read_b64_tr_b16 a[192:193], v14 offset:32768
  v_cvt_pk_bf16_f32 v192, v192, v193
  s_waitcnt lgkmcnt(15)
  v_mfma_f32_16x16x32_bf16 v[248:251], a[228:231], a[180:183], v[248:251]
  v_exp_f32 v196, v196
  v_mfma_f32_16x16x32_bf16 v[248:251], a[232:235], a[184:187], v[248:251]
  ds_read_b64_tr_b16 a[194:195], v14 offset:36864
  v_cvt_pk_bf16_f32 v193, v194, v195
  v_mfma_f32_16x16x32_bf16 v[248:251], a[236:239], a[188:191], v[248:251]
  v_exp_f32 v197, v197
  v_mfma_f32_16x16x32_bf16 v[232:235], a[236:239], a[172:175], 0
  ds_read_b64_tr_b16 a[196:197], v14 offset:40960
  v_cvt_pk_bf16_f32 v194, v196, v197
  v_mfma_f32_16x16x32_bf16 v[232:235], a[232:235], a[168:171], v[232:235]
  v_exp_f32 v198, v198
  v_mfma_f32_16x16x32_bf16 v[232:235], a[228:231], a[164:167], v[232:235]
  ds_read_b64_tr_b16 a[198:199], v14 offset:45056
  v_mfma_f32_16x16x32_bf16 v[232:235], a[224:227], a[160:163], v[232:235]
  v_exp_f32 v199, v199
  v_mfma_f32_16x16x32_bf16 v[216:219], a[224:227], a[144:147], 0
  ds_read_b64_tr_b16 a[200:201], v15 offset:32768
  v_cvt_pk_bf16_f32 v195, v198, v199
  v_mfma_f32_16x16x32_bf16 v[216:219], a[228:231], a[148:151], v[216:219]
  v_exp_f32 v208, v208
  v_mfma_f32_16x16x32_bf16 v[216:219], a[232:235], a[152:155], v[216:219]
  ds_read_b64_tr_b16 a[202:203], v15 offset:36864
  v_mfma_f32_16x16x32_bf16 v[216:219], a[236:239], a[156:159], v[216:219]
  v_exp_f32 v209, v209
  v_mfma_f32_16x16x32_bf16 v[200:203], a[236:239], a[140:143], 0
  ds_read_b64_tr_b16 a[204:205], v15 offset:40960
  v_cvt_pk_bf16_f32 v208, v208, v209
  v_mfma_f32_16x16x32_bf16 v[200:203], a[232:235], a[136:139], v[200:203]
  v_exp_f32 v210, v210
  v_mfma_f32_16x16x32_bf16 v[200:203], a[228:231], a[132:135], v[200:203]
  ds_read_b64_tr_b16 a[206:207], v15 offset:45056
  v_mfma_f32_16x16x32_bf16 v[200:203], a[224:227], a[128:131], v[200:203]
  v_exp_f32 v211, v211
  s_waitcnt lgkmcnt(15)
  v_mfma_f32_16x16x32_bf16 v[204:207], a[240:243], a[128:131], 0
  s_xor_b32 s43, s48, 0xdc00
  ds_read_b64_tr_b16 a[208:209], v16 offset:32768
  v_cvt_pk_bf16_f32 v209, v210, v211
  v_mfma_f32_16x16x32_bf16 v[204:207], a[244:247], a[132:135], v[204:207]
  s_waitcnt vmcnt(63)
  buffer_store_dwordx4 v[124:127], v26, s[24:27], s43 offen sc1
L_pg22:
  s_cbranch_execz L_rt4
  v_mfma_f32_16x16x32_bf16 v[204:207], a[248:251], a[136:139], v[204:207]
  ds_read_b64_tr_b16 a[210:211], v16 offset:36864
  s_waitcnt lgkmcnt(14)
  v_mfma_f32_16x16x32_bf16 v[204:207], a[252:255], a[140:143], v[204:207]
  v_exp_f32 v212, v212
  v_mfma_f32_16x16x32_bf16 v[220:223], a[252:255], a[156:159], 0
  ds_read_b64_tr_b16 a[212:213], v16 offset:40960
  v_mfma_f32_16x16x32_bf16 v[220:223], a[248:251], a[152:155], v[220:223]
  v_exp_f32 v213, v213
  v_mfma_f32_16x16x32_bf16 v[220:223], a[244:247], a[148:151], v[220:223]
  ds_read_b64_tr_b16 a[214:215], v16 offset:45056
  v_cvt_pk_bf16_f32 v210, v212, v213
  v_mfma_f32_16x16x32_bf16 v[220:223], a[240:243], a[144:147], v[220:223]
  v_exp_f32 v214, v214
  v_mfma_f32_16x16x32_bf16 v[236:239], a[240:243], a[160:163], 0
  ds_read_b64_tr_b16 a[216:217], v17 offset:32768
  v_mfma_f32_16x16x32_bf16 v[236:239], a[244:247], a[164:167], v[236:239]
  v_exp_f32 v215, v215
  v_mfma_f32_16x16x32_bf16 v[236:239], a[248:251], a[168:171], v[236:239]
  ds_read_b64_tr_b16 a[218:219], v17 offset:36864
  v_cvt_pk_bf16_f32 v211, v214, v215
  v_mfma_f32_16x16x32_bf16 v[236:239], a[252:255], a[172:175], v[236:239]
  v_exp_f32 v224, v224
  v_mfma_f32_16x16x32_bf16 v[252:255], a[252:255], a[188:191], 0
  ds_read_b64_tr_b16 a[220:221], v17 offset:40960
  v_mfma_f32_16x16x32_bf16 v[252:255], a[248:251], a[184:187], v[252:255]
  v_exp_f32 v225, v225
  v_mfma_f32_16x16x32_bf16 v[252:255], a[244:247], a[180:183], v[252:255]
  ds_read_b64_tr_b16 a[222:223], v17 offset:45056
  v_cvt_pk_bf16_f32 v224, v224, v225
  v_mfma_f32_16x16x32_bf16 v[252:255], a[240:243], a[176:179], v[252:255]
  v_exp_f32 v226, v226
L_tail:
  v_mfma_f32_16x16x32_bf16 v[48:51], v[44:47], v[128:131], v[48:51]
  v_exp_f32 v200, v200
  v_mfma_f32_16x16x32_bf16 v[48:51], v[44:47], v[136:139], v[48:51]
  v_exp_f32 v201, v201
  s_waitcnt lgkmcnt(14)
  v_mfma_f32_16x16x32_bf16 a[0:3], v[128:131], a[192:195], a[0:3]
  v_lshrrev_b32 v28, 8, v26
  v_lshl_add_u32 v28, v28, 5, s31
  v_add_u32 v28, 6208, v28
  s_waitcnt lgkmcnt(12)
  v_mfma_f32_16x16x32_bf16 a[0:3], v[136:139], a[196:199], a[0:3]
  v_exp_f32 v202, v202
  v_cvt_pk_bf16_f32 v200, v200, v201
  s_waitcnt lgkmcnt(10)
  v_mfma_f32_16x16x32_bf16 a[4:7], v[128:131], a[200:203], a[4:7]
  v_exp_f32 v203, v203
  s_waitcnt lgkmcnt(8)
  v_mfma_f32_16x16x32_bf16 a[4:7], v[136:139], a[204:207], a[4:7]
  v_exp_f32 v204, v204
  v_cvt_pk_bf16_f32 v201, v202, v203
  s_waitcnt lgkmcnt(6)
  v_mfma_f32_16x16x32_bf16 a[8:11], v[128:131], a[208:211], a[8:11]
  v_exp_f32 v205, v205
  s_waitcnt lgkmcnt(4)
  v_mfma_f32_16x16x32_bf16 a[8:11], v[136:139], a[212:215], a[8:11]
  v_exp_f32 v206, v206
  v_cvt_pk_bf16_f32 v202, v204, v205
  s_waitcnt lgkmcnt(2)
  v_mfma_f32_16x16x32_bf16 a[12:15], v[128:131], a[216:219], a[12:15]
  v_exp_f32 v207, v207
  s_waitcnt lgkmcnt(0)
  v_mfma_f32_16x16x32_bf16 a[12:15], v[136:139], a[220:223], a[12:15]
  v_exp_f32 v216, v216
  v_cvt_pk_bf16_f32 v203, v206, v207
  v_mfma_f32_16x16x32_bf16 a[16:19], v[128:131], v[64:67], a[16:19]
  v_exp_f32 v217, v217
  v_mfma_f32_16x16x32_bf16 a[16:19], v[136:139], v[68:71], a[16:19]
  v_exp_f32 v218, v218
  v_cvt_pk_bf16_f32 v216, v216, v217
  v_mfma_f32_16x16x32_bf16 a[20:23], v[128:131], v[72:75], a[20:23]
  v_exp_f32 v219, v219
  v_mfma_f32_16x16x32_bf16 a[20:23], v[136:139], v[76:79], a[20:23]
  v_exp_f32 v220, v220
  v_cvt_pk_bf16_f32 v217, v218, v219
  v_mfma_f32_16x16x32_bf16 a[24:27], v[128:131], v[80:83], a[24:27]
  s_waitcnt vmcnt(6) lgkmcnt(0)
  s_barrier
  v_exp_f32 v221, v221
  v_mfma_f32_16x16x32_bf16 a[24:27], v[136:139], v[84:87], a[24:27]
  ds_read_b64_tr_b16 v[132:133], v14 offset:49152
  v_cvt_pk_bf16_f32 v218, v220, v221
  v_mfma_f32_16x16x32_bf16 a[28:31], v[128:131], v[88:91], a[28:31]
  ds_read_b64_tr_b16 v[134:135], v14 offset:53248
  v_exp_f32 v222, v222
  v_mfma_f32_16x16x32_bf16 a[28:31], v[136:139], v[92:95], a[28:31]
  ds_read_b64_tr_b16 v[140:141], v14 offset:57344
  v_exp_f32 v223, v223
  v_mfma_f32_16x16x32_bf16 v[52:55], v[44:47], v[144:147], v[52:55]
  ds_read_b64_tr_b16 v[142:143], v14 offset:61440
  v_cvt_pk_bf16_f32 v219, v222, v223
  v_mfma_f32_16x16x32_bf16 v[52:55], v[44:47], v[152:155], v[52:55]
  ds_read_b64_tr_b16 v[148:149], v15 offset:49152
  v_exp_f32 v227, v227
  v_mfma_f32_16x16x32_bf16 a[32:35], v[144:147], a[192:195], a[32:35]
  ds_read_b64_tr_b16 v[150:151], v15 offset:53248
  v_exp_f32 v228, v228
  v_mfma_f32_16x16x32_bf16 a[32:35], v[152:155], a[196:199], a[32:35]
  ds_read_b64_tr_b16 v[156:157], v15 offset:57344
  v_cvt_pk_bf16_f32 v225, v226, v227
  v_mfma_f32_16x16x32_bf16 a[36:39], v[144:147], a[200:203], a[36:39]
  ds_read_b64_tr_b16 v[158:159], v15 offset:61440
  v_exp_f32 v229, v229
  v_mfma_f32_16x16x32_bf16 a[36:39], v[152:155], a[204:207], a[36:39]
  ds_read_b64_tr_b16 v[164:165], v16 offset:49152
  v_exp_f32 v230, v230
  v_mfma_f32_16x16x32_bf16 a[40:43], v[144:147], a[208:211], a[40:43]
  ds_read_b64_tr_b16 v[166:167], v16 offset:53248
  v_cvt_pk_bf16_f32 v226, v228, v229
  v_mfma_f32_16x16x32_bf16 a[40:43], v[152:155], a[212:215], a[40:43]
  ds_read_b64_tr_b16 v[172:173], v16 offset:57344
  v_exp_f32 v231, v231
  v_mfma_f32_16x16x32_bf16 a[44:47], v[144:147], a[216:219], a[44:47]
  ds_read_b64_tr_b16 v[174:175], v16 offset:61440
  v_exp_f32 v232, v232
  v_mfma_f32_16x16x32_bf16 a[44:47], v[152:155], a[220:223], a[44:47]
  ds_read_b64_tr_b16 v[180:181], v17 offset:49152
  v_cvt_pk_bf16_f32 v227, v230, v231
  v_mfma_f32_16x16x32_bf16 a[48:51], v[144:147], v[64:67], a[48:51]
  ds_read_b64_tr_b16 v[182:183], v17 offset:53248
  v_exp_f32 v233, v233
  v_mfma_f32_16x16x32_bf16 a[48:51], v[152:155], v[68:71], a[48:51]
  ds_read_b64_tr_b16 v[188:189], v17 offset:57344
  v_exp_f32 v234, v234
  v_mfma_f32_16x16x32_bf16 a[52:55], v[144:147], v[72:75], a[52:55]
  ds_read_b64_tr_b16 v[190:191], v17 offset:61440
  v_cvt_pk_bf16_f32 v232, v232, v233
  v_mfma_f32_16x16x32_bf16 a[52:55], v[152:155], v[76:79], a[52:55]
  ds_read_b64_tr_b16 a[224:225], v18 offset:49152
  v_exp_f32 v235, v235
  v_mfma_f32_16x16x32_bf16 a[56:59], v[144:147], v[80:83], a[56:59]
  ds_read_b64_tr_b16 a[226:227], v18 offset:53248
  v_exp_f32 v236, v236
  v_mfma_f32_16x16x32_bf16 a[56:59], v[152:155], v[84:87], a[56:59]
  ds_read_b64_tr_b16 a[228:229], v18 offset:57344
  v_cvt_pk_bf16_f32 v233, v234, v235
  v_mfma_f32_16x16x32_bf16 a[60:63], v[144:147], v[88:91], a[60:63]
  ds_read_b64_tr_b16 a[230:231], v18 offset:61440
  v_exp_f32 v237, v237
  v_mfma_f32_16x16x32_bf16 a[60:63], v[152:155], v[92:95], a[60:63]
  ds_read_b64_tr_b16 a[232:233], v19 offset:49152
  v_exp_f32 v238, v238
  v_mfma_f32_16x16x32_bf16 v[48:51], v[44:47], v[192:195], v[48:51]
  ds_read_b64_tr_b16 a[234:235], v19 offset:53248
  v_cvt_pk_bf16_f32 v234, v236, v237
  v_mfma_f32_16x16x32_bf16 v[48:51], v[44:47], v[200:203], v[48:51]
  ds_read_b64_tr_b16 a[236:237], v19 offset:57344
  v_exp_f32 v239, v239
  s_waitcnt lgkmcnt(15)
  v_mfma_f32_16x16x32_bf16 a[0:3], v[192:195], v[132:135], a[0:3]
  ds_read_b64_tr_b16 a[238:239], v19 offset:61440
  v_exp_f32 v240, v240
  v_mfma_f32_16x16x32_bf16 a[0:3], v[200:203], v[140:143], a[0:3]
  ds_read_b64_tr_b16 a[240:241], v20 offset:49152
  v_cvt_pk_bf16_f32 v235, v238, v239
  v_mfma_f32_16x16x32_bf16 a[4:7], v[192:195], v[148:151], a[4:7]
  ds_read_b64_tr_b16 a[242:243], v20 offset:53248
  v_exp_f32 v241, v241
  v_mfma_f32_16x16x32_bf16 a[4:7], v[200:203], v[156:159], a[4:7]
  ds_read_b64_tr_b16 a[244:245], v20 offset:57344
  v_rcp_f32 v2, v48
  s_waitcnt lgkmcnt(15)
  v_mfma_f32_16x16x32_bf16 a[8:11], v[192:195], v[164:167], a[8:11]
  ds_read_b64_tr_b16 a[246:247], v20 offset:61440
  v_accvgpr_read_b32 v96, a0
  v_accvgpr_read_b32 v97, a1
  v_accvgpr_read_b32 v98, a2
  v_accvgpr_read_b32 v99, a3
  v_mfma_f32_16x16x32_bf16 a[8:11], v[200:203], v[172:175], a[8:11]
  ds_read_b64_tr_b16 a[248:249], v21 offset:49152
  ds_write_b32 v27, v2 offset:6208
  ds_read2_b32 v[2:3], v28 offset0:0 offset1:2
  ds_read2_b32 v[4:5], v28 offset0:4 offset1:6
  s_waitcnt lgkmcnt(15)
  v_mfma_f32_16x16x32_bf16 a[12:15], v[192:195], v[180:183], a[12:15]
  ds_read_b64_tr_b16 a[250:251], v21 offset:53248
  v_mfma_f32_16x16x32_bf16 a[12:15], v[200:203], v[188:191], a[12:15]
  ds_read_b64_tr_b16 a[252:253], v21 offset:57344
  v_accvgpr_read_b32 v100, a4
  v_accvgpr_read_b32 v101, a5
  v_accvgpr_read_b32 v102, a6
  v_accvgpr_read_b32 v103, a7
  s_waitcnt lgkmcnt(15)
  v_mfma_f32_16x16x32_bf16 a[16:19], v[192:195], a[224:227], a[16:19]
  ds_read_b64_tr_b16 a[254:255], v21 offset:61440
  v_exp_f32 v242, v242
  s_waitcnt lgkmcnt(15)
  v_mfma_f32_16x16x32_bf16 a[16:19], v[200:203], a[228:231], a[16:19]
  v_exp_f32 v243, v243
  s_waitcnt lgkmcnt(13)
  v_mfma_f32_16x16x32_bf16 a[20:23], v[192:195], a[232:235], a[20:23]
  v_accvgpr_read_b32 v104, a8
  v_accvgpr_read_b32 v105, a9
  v_accvgpr_read_b32 v106, a10
  v_accvgpr_read_b32 v107, a11
  s_waitcnt lgkmcnt(4)
  v_pk_mul_f32 v[96:97], v[96:97], v[2:3]
  s_waitcnt lgkmcnt(3)
  v_pk_mul_f32 v[98:99], v[98:99], v[4:5]
  v_pk_mul_f32 v[100:101], v[100:101], v[2:3]
  v_pk_mul_f32 v[102:103], v[102:103], v[4:5]
  v_pk_mul_f32 v[104:105], v[104:105], v[2:3]
  v_pk_mul_f32 v[106:107], v[106:107], v[4:5]
  v_mfma_f32_16x16x32_bf16 a[20:23], v[200:203], a[236:239], a[20:23]
  v_cvt_pk_bf16_f32 v96, v96, v100
  v_exp_f32 v244, v244
  v_mfma_f32_16x16x32_bf16 a[24:27], v[192:195], a[240:243], a[24:27]
  v_exp_f32 v245, v245
  v_cvt_pk_bf16_f32 v240, v240, v241
  v_mfma_f32_16x16x32_bf16 a[24:27], v[200:203], a[244:247], a[24:27]
  v_cvt_pk_bf16_f32 v100, v97, v101
  v_accvgpr_read_b32 v108, a12
  v_accvgpr_read_b32 v109, a13
  v_accvgpr_read_b32 v110, a14
  v_accvgpr_read_b32 v111, a15
  v_pk_mul_f32 v[108:109], v[108:109], v[2:3]
  v_pk_mul_f32 v[110:111], v[110:111], v[4:5]
  s_waitcnt lgkmcnt(2)
  v_mfma_f32_16x16x32_bf16 a[28:31], v[192:195], a[248:251], a[28:31]
  v_cvt_pk_bf16_f32 v98, v98, v102
  v_cvt_pk_bf16_f32 v241, v242, v243
  s_waitcnt lgkmcnt(0)
  v_mfma_f32_16x16x32_bf16 a[28:31], v[200:203], a[252:255], a[28:31]
  v_exp_f32 v246, v246
  v_cvt_pk_bf16_f32 v242, v244, v245
  v_mfma_f32_16x16x32_bf16 v[52:55], v[44:47], v[208:211], v[52:55]
  v_cvt_pk_bf16_f32 v102, v99, v103
  v_accvgpr_read_b32 v112, a16
  v_accvgpr_read_b32 v113, a17
  v_accvgpr_read_b32 v114, a18
  v_accvgpr_read_b32 v115, a19
  v_pk_mul_f32 v[112:113], v[112:113], v[2:3]
  v_pk_mul_f32 v[114:115], v[114:115], v[4:5]
  v_mfma_f32_16x16x32_bf16 v[52:55], v[44:47], v[216:219], v[52:55]
  v_cvt_pk_bf16_f32 v97, v104, v108
  v_exp_f32 v247, v247
  v_mfma_f32_16x16x32_bf16 a[32:35], v[208:211], v[132:135], a[32:35]
  ds_write_b64 v27, v[96:97] offset:2080
  v_mfma_f32_16x16x32_bf16 a[32:35], v[216:219], v[140:143], a[32:35]
  v_cvt_pk_bf16_f32 v101, v105, v109
  v_accvgpr_read_b32 v116, a20
  v_accvgpr_read_b32 v117, a21
  v_accvgpr_read_b32 v118, a22
  v_accvgpr_read_b32 v119, a23
  v_pk_mul_f32 v[116:117], v[116:117], v[2:3]
  v_pk_mul_f32 v[118:119], v[118:119], v[4:5]
  v_mfma_f32_16x16x32_bf16 a[36:39], v[208:211], v[148:151], a[36:39]
  v_cvt_pk_bf16_f32 v99, v106, v110
  v_cvt_pk_bf16_f32 v243, v246, v247
  v_mfma_f32_16x16x32_bf16 a[36:39], v[216:219], v[156:159], a[36:39]
  ds_write_b64 v27, v[100:101] offset:2592
  v_mfma_f32_16x16x32_bf16 a[40:43], v[208:211], v[164:167], a[40:43]
  v_cvt_pk_bf16_f32 v103, v107, v111
  v_accvgpr_read_b32 v120, a24
  v_accvgpr_read_b32 v121, a25
  v_accvgpr_read_b32 v122, a26
  v_accvgpr_read_b32 v123, a27
  v_pk_mul_f32 v[120:121], v[120:121], v[2:3]
  v_pk_mul_f32 v[122:123], v[122:123], v[4:5]
  v_mfma_f32_16x16x32_bf16 a[40:43], v[216:219], v[172:175], a[40:43]
  v_rcp_f32 v6, v52
  v_cvt_pk_bf16_f32 v112, v112, v116
  v_mfma_f32_16x16x32_bf16 a[44:47], v[208:211], v[180:183], a[44:47]
  ds_write_b64 v27, v[98:99] offset:3104
  v_mfma_f32_16x16x32_bf16 a[44:47], v[216:219], v[188:191], a[44:47]
  v_cvt_pk_bf16_f32 v116, v113, v117
  v_accvgpr_read_b32 v124, a28
  v_accvgpr_read_b32 v125, a29
  v_accvgpr_read_b32 v126, a30
  v_accvgpr_read_b32 v127, a31
  v_pk_mul_f32 v[124:125], v[124:125], v[2:3]
  v_pk_mul_f32 v[126:127], v[126:127], v[4:5]
  v_mfma_f32_16x16x32_bf16 a[48:51], v[208:211], a[224:227], a[48:51]
  ds_write_b32 v27, v6 offset:6208
  ds_read2_b32 v[6:7], v28 offset0:0 offset1:2
  ds_read2_b32 v[8:9], v28 offset0:4 offset1:6
  v_cvt_pk_bf16_f32 v114, v114, v118
  v_mfma_f32_16x16x32_bf16 a[48:51], v[216:219], a[228:231], a[48:51]
  ds_write_b64 v27, v[102:103] offset:3616
  v_mfma_f32_16x16x32_bf16 a[52:55], v[208:211], a[232:235], a[52:55]
  v_cvt_pk_bf16_f32 v118, v115, v119
  v_accvgpr_read_b32 v96, a32
  v_accvgpr_read_b32 v97, a33
  v_accvgpr_read_b32 v98, a34
  v_accvgpr_read_b32 v99, a35
  v_mfma_f32_16x16x32_bf16 a[52:55], v[216:219], a[236:239], a[52:55]
  v_cvt_pk_bf16_f32 v113, v120, v124
  v_mfma_f32_16x16x32_bf16 a[56:59], v[208:211], a[240:243], a[56:59]
  ds_write_b64 v27, v[112:113] offset:4160
  ds_read_b64_tr_b16 v[192:193], v0 offset:2080
  ds_read_b64_tr_b16 v[194:195], v0 offset:2112
  v_mfma_f32_16x16x32_bf16 a[56:59], v[216:219], a[244:247], a[56:59]
  v_cvt_pk_bf16_f32 v117, v121, v125
  v_accvgpr_read_b32 v100, a36
  v_accvgpr_read_b32 v101, a37
  v_accvgpr_read_b32 v102, a38
  v_accvgpr_read_b32 v103, a39
  s_waitcnt lgkmcnt(5)
  v_pk_mul_f32 v[96:97], v[96:97], v[6:7]
  s_waitcnt lgkmcnt(4)
  v_pk_mul_f32 v[98:99], v[98:99], v[8:9]
  v_pk_mul_f32 v[100:101], v[100:101], v[6:7]
  v_pk_mul_f32 v[102:103], v[102:103], v[8:9]
  v_mfma_f32_16x16x32_bf16 a[60:63], v[208:211], a[248:251], a[60:63]
  v_cvt_pk_bf16_f32 v115, v122, v126
  v_exp_f32 v248, v248
  v_mfma_f32_16x16x32_bf16 a[60:63], v[216:219], a[252:255], a[60:63]
  ds_write_b64 v27, v[116:117] offset:4672
  ds_read_b64_tr_b16 v[196:197], v0 offset:2592
  ds_read_b64_tr_b16 v[198:199], v0 offset:2624
  v_mfma_f32_16x16x32_bf16 v[56:59], v[44:47], v[160:163], v[56:59]
  v_cvt_pk_bf16_f32 v119, v123, v127
  v_accvgpr_read_b32 v104, a40
  v_accvgpr_read_b32 v105, a41
  v_accvgpr_read_b32 v106, a42
  v_accvgpr_read_b32 v107, a43
  v_pk_mul_f32 v[104:105], v[104:105], v[6:7]
  v_pk_mul_f32 v[106:107], v[106:107], v[8:9]
  v_mfma_f32_16x16x32_bf16 v[56:59], v[44:47], v[168:171], v[56:59]
  s_xor_b32 s43, s35, 0x0
  s_waitcnt lgkmcnt(3)
  buffer_store_dwordx4 v[192:195], v26, s[24:27], s43 offen sc1
  v_cvt_pk_bf16_f32 v96, v96, v100
  v_mfma_f32_16x16x32_bf16 v[56:59], v[44:47], v[224:227], v[56:59]
  ds_write_b64 v27, v[114:115] offset:5184
  ds_read_b64_tr_b16 v[200:201], v0 offset:3104
  ds_read_b64_tr_b16 v[202:203], v0 offset:3136
  v_mfma_f32_16x16x32_bf16 v[56:59], v[44:47], v[232:235], v[56:59]
  v_cvt_pk_bf16_f32 v100, v97, v101
  v_accvgpr_read_b32 v108, a44
  v_accvgpr_read_b32 v109, a45
  v_accvgpr_read_b32 v110, a46
  v_accvgpr_read_b32 v111, a47
  v_pk_mul_f32 v[108:109], v[108:109], v[6:7]
  v_pk_mul_f32 v[110:111], v[110:111], v[8:9]
  v_mfma_f32_16x16x32_bf16 a[64:67], v[160:163], a[192:195], a[64:67]
  s_xor_b32 s43, s35, 0x6000
  s_waitcnt lgkmcnt(3)
  buffer_store_dwordx4 v[196:199], v26, s[24:27], s43 offen sc1
  v_cvt_pk_bf16_f32 v98, v98, v102
  v_mfma_f32_16x16x32_bf16 a[64:67], v[168:171], a[196:199], a[64:67]
  ds_write_b64 v27, v[118:119] offset:5696
  ds_read_b64_tr_b16 v[204:205], v0 offset:3616
  ds_read_b64_tr_b16 v[206:207], v0 offset:3648
  v_mfma_f32_16x16x32_bf16 a[64:67], v[224:227], v[132:135], a[64:67]
  v_cvt_pk_bf16_f32 v102, v99, v103
  v_accvgpr_read_b32 v112, a48
  v_accvgpr_read_b32 v113, a49
  v_accvgpr_read_b32 v114, a50
  v_accvgpr_read_b32 v115, a51
  v_pk_mul_f32 v[112:113], v[112:113], v[6:7]
  v_pk_mul_f32 v[114:115], v[114:115], v[8:9]
  v_mfma_f32_16x16x32_bf16 a[64:67], v[232:235], v[140:143], a[64:67]
  v_rcp_f32 v36, v56
  v_cvt_pk_bf16_f32 v97, v104, v108
  v_mfma_f32_16x16x32_bf16 a[68:71], v[160:163], a[200:203], a[68:71]
  ds_write_b64 v27, v[96:97]
  v_mfma_f32_16x16x32_bf16 a[68:71], v[168:171], a[204:207], a[68:71]
  v_cvt_pk_bf16_f32 v101, v105, v109
  v_accvgpr_read_b32 v116, a52
  v_accvgpr_read_b32 v117, a53
  v_accvgpr_read_b32 v118, a54
  v_accvgpr_read_b32 v119, a55
  v_pk_mul_f32 v[116:117], v[116:117], v[6:7]
  v_pk_mul_f32 v[118:119], v[118:119], v[8:9]
  v_mfma_f32_16x16x32_bf16 a[68:71], v[224:227], v[148:151], a[68:71]
  ds_write_b32 v27, v36 offset:6208
  ds_read2_b32 v[36:37], v28 offset0:0 offset1:2
  ds_read2_b32 v[38:39], v28 offset0:4 offset1:6
  v_cvt_pk_bf16_f32 v99, v106, v110
  v_mfma_f32_16x16x32_bf16 a[68:71], v[232:235], v[156:159], a[68:71]
  ds_write_b64 v27, v[100:101] offset:512
  v_mfma_f32_16x16x32_bf16 a[72:75], v[160:163], a[208:211], a[72:75]
  v_cvt_pk_bf16_f32 v103, v107, v111
  v_accvgpr_read_b32 v120, a56
  v_accvgpr_read_b32 v121, a57
  v_accvgpr_read_b32 v122, a58
  v_accvgpr_read_b32 v123, a59
  v_pk_mul_f32 v[120:121], v[120:121], v[6:7]
  v_pk_mul_f32 v[122:123], v[122:123], v[8:9]
  v_mfma_f32_16x16x32_bf16 a[72:75], v[168:171], a[212:215], a[72:75]
  s_xor_b32 s43, s35, 0x400
  s_waitcnt lgkmcnt(8)
  buffer_store_dwordx4 v[200:203], v26, s[24:27], s43 offen sc1
  v_cvt_pk_bf16_f32 v112, v112, v116
  v_mfma_f32_16x16x32_bf16 a[72:75], v[224:227], v[164:167], a[72:75]
  ds_write_b64 v27, v[98:99] offset:1024
  v_mfma_f32_16x16x32_bf16 a[72:75], v[232:235], v[172:175], a[72:75]
  v_cvt_pk_bf16_f32 v116, v113, v117
  v_accvgpr_read_b32 v124, a60
  v_accvgpr_read_b32 v125, a61
  v_accvgpr_read_b32 v126, a62
  v_accvgpr_read_b32 v127, a63
  v_pk_mul_f32 v[124:125], v[124:125], v[6:7]
  v_pk_mul_f32 v[126:127], v[126:127], v[8:9]
  v_mfma_f32_16x16x32_bf16 a[76:79], v[160:163], a[216:219], a[76:79]
  s_xor_b32 s43, s35, 0x6400
  s_waitcnt lgkmcnt(6)
  buffer_store_dwordx4 v[204:207], v26, s[24:27], s43 offen sc1
  v_cvt_pk_bf16_f32 v114, v114, v118
  v_mfma_f32_16x16x32_bf16 a[76:79], v[168:171], a[220:223], a[76:79]
  ds_write_b64 v27, v[102:103] offset:1536
  v_mfma_f32_16x16x32_bf16 a[76:79], v[224:227], v[180:183], a[76:79]
  v_cvt_pk_bf16_f32 v118, v115, v119
  v_accvgpr_read_b32 v96, a64
  v_accvgpr_read_b32 v97, a65
  v_accvgpr_read_b32 v98, a66
  v_accvgpr_read_b32 v99, a67
  s_waitcnt lgkmcnt(4)
  v_pk_mul_f32 v[96:97], v[96:97], v[36:37]
  s_waitcnt lgkmcnt(3)
  v_pk_mul_f32 v[98:99], v[98:99], v[38:39]
  v_mfma_f32_16x16x32_bf16 a[76:79], v[232:235], v[188:191], a[76:79]
  v_cvt_pk_bf16_f32 v113, v120, v124
  v_mfma_f32_16x16x32_bf16 a[80:83], v[160:163], v[64:67], a[80:83]
  ds_write_b64 v27, v[112:113] offset:2080
  ds_read_b64_tr_b16 v[208:209], v0
  ds_read_b64_tr_b16 v[210:211], v0 offset:32
  v_mfma_f32_16x16x32_bf16 a[80:83], v[168:171], v[68:71], a[80:83]
  v_cvt_pk_bf16_f32 v117, v121, v125
  v_accvgpr_read_b32 v100, a68
  v_accvgpr_read_b32 v101, a69
  v_accvgpr_read_b32 v102, a70
  v_accvgpr_read_b32 v103, a71
  v_pk_mul_f32 v[100:101], v[100:101], v[36:37]
  v_pk_mul_f32 v[102:103], v[102:103], v[38:39]
  v_mfma_f32_16x16x32_bf16 a[80:83], v[224:227], a[224:227], a[80:83]
  v_cvt_pk_bf16_f32 v115, v122, v126
  v_exp_f32 v249, v249
  v_mfma_f32_16x16x32_bf16 a[80:83], v[232:235], a[228:231], a[80:83]
  ds_write_b64 v27, v[116:117] offset:2592
  ds_read_b64_tr_b16 v[212:213], v0 offset:512
  ds_read_b64_tr_b16 v[214:215], v0 offset:544
  v_mfma_f32_16x16x32_bf16 a[84:87], v[160:163], v[72:75], a[84:87]
  v_cvt_pk_bf16_f32 v119, v123, v127
  v_accvgpr_read_b32 v104, a72
  v_accvgpr_read_b32 v105, a73
  v_accvgpr_read_b32 v106, a74
  v_accvgpr_read_b32 v107, a75
  v_pk_mul_f32 v[104:105], v[104:105], v[36:37]
  v_pk_mul_f32 v[106:107], v[106:107], v[38:39]
  v_mfma_f32_16x16x32_bf16 a[84:87], v[168:171], v[76:79], a[84:87]
  s_xor_b32 s43, s35, 0x5000
  s_waitcnt lgkmcnt(3)
  buffer_store_dwordx4 v[208:211], v26, s[24:27], s43 offen sc1
  v_cvt_pk_bf16_f32 v96, v96, v100
  v_mfma_f32_16x16x32_bf16 a[84:87], v[224:227], a[232:235], a[84:87]
  ds_write_b64 v27, v[114:115] offset:3104
  ds_read_b64_tr_b16 v[216:217], v0 offset:1024
  ds_read_b64_tr_b16 v[218:219], v0 offset:1056
  v_mfma_f32_16x16x32_bf16 a[84:87], v[232:235], a[236:239], a[84:87]
  v_cvt_pk_bf16_f32 v100, v97, v101
  v_accvgpr_read_b32 v108, a76
  v_accvgpr_read_b32 v109, a77
  v_accvgpr_read_b32 v110, a78
  v_accvgpr_read_b32 v111, a79
  v_pk_mul_f32 v[108:109], v[108:109], v[36:37]
  v_pk_mul_f32 v[110:111], v[110:111], v[38:39]
  v_mfma_f32_16x16x32_bf16 a[88:91], v[160:163], v[80:83], a[88:91]
  s_xor_b32 s43, s35, 0x3000
  s_waitcnt lgkmcnt(3)
  buffer_store_dwordx4 v[212:215], v26, s[24:27], s43 offen sc1
  v_cvt_pk_bf16_f32 v98, v98, v102
  v_mfma_f32_16x16x32_bf16 a[88:91], v[168:171], v[84:87], a[88:91]
  ds_write_b64 v27, v[118:119] offset:3616
  ds_read_b64_tr_b16 v[220:221], v0 offset:1536
  ds_read_b64_tr_b16 v[222:223], v0 offset:1568
  v_mfma_f32_16x16x32_bf16 a[88:91], v[224:227], a[240:243], a[88:91]
  v_cvt_pk_bf16_f32 v102, v99, v103
  v_accvgpr_read_b32 v112, a80
  v_accvgpr_read_b32 v113, a81
  v_accvgpr_read_b32 v114, a82
  v_accvgpr_read_b32 v115, a83
  v_pk_mul_f32 v[112:113], v[112:113], v[36:37]
  v_pk_mul_f32 v[114:115], v[114:115], v[38:39]
  v_mfma_f32_16x16x32_bf16 a[88:91], v[232:235], a[244:247], a[88:91]
  s_xor_b32 s43, s35, 0x5400
  s_waitcnt lgkmcnt(3)
  buffer_store_dwordx4 v[216:219], v26, s[24:27], s43 offen sc1
  v_cvt_pk_bf16_f32 v97, v104, v108
  v_mfma_f32_16x16x32_bf16 a[92:95], v[160:163], v[88:91], a[92:95]
  ds_write_b64 v27, v[96:97] offset:2080
  v_mfma_f32_16x16x32_bf16 a[92:95], v[168:171], v[92:95], a[92:95]
  v_cvt_pk_bf16_f32 v101, v105, v109
  v_accvgpr_read_b32 v116, a84
  v_accvgpr_read_b32 v117, a85
  v_accvgpr_read_b32 v118, a86
  v_accvgpr_read_b32 v119, a87
  v_pk_mul_f32 v[116:117], v[116:117], v[36:37]
  v_pk_mul_f32 v[118:119], v[118:119], v[38:39]
  v_mfma_f32_16x16x32_bf16 a[92:95], v[224:227], a[248:251], a[92:95]
  s_xor_b32 s43, s35, 0x3400
  s_waitcnt lgkmcnt(1)
  buffer_store_dwordx4 v[220:223], v26, s[24:27], s43 offen sc1
  v_cvt_pk_bf16_f32 v99, v106, v110
  v_mfma_f32_16x16x32_bf16 a[92:95], v[232:235], a[252:255], a[92:95]
  ds_write_b64 v27, v[100:101] offset:2592
  v_mfma_f32_16x16x32_bf16 v[60:63], v[44:47], v[176:179], v[60:63]
  v_cvt_pk_bf16_f32 v103, v107, v111
  v_accvgpr_read_b32 v120, a88
  v_accvgpr_read_b32 v121, a89
  v_accvgpr_read_b32 v122, a90
  v_accvgpr_read_b32 v123, a91
  v_pk_mul_f32 v[120:121], v[120:121], v[36:37]
  v_pk_mul_f32 v[122:123], v[122:123], v[38:39]
  v_exp_f32 v250, v250
  v_cvt_pk_bf16_f32 v248, v248, v249
  v_exp_f32 v251, v251
  v_exp_f32 v252, v252
  v_cvt_pk_bf16_f32 v249, v250, v251
  v_exp_f32 v253, v253
  v_exp_f32 v254, v254
  v_cvt_pk_bf16_f32 v250, v252, v253
  v_exp_f32 v255, v255
  s_nop 0
  v_cvt_pk_bf16_f32 v251, v254, v255
  v_mfma_f32_16x16x32_bf16 v[60:63], v[44:47], v[184:187], v[60:63]
  v_cvt_pk_bf16_f32 v112, v112, v116
  v_mfma_f32_16x16x32_bf16 v[60:63], v[44:47], v[240:243], v[60:63]
  ds_write_b64 v27, v[98:99] offset:3104
  v_mfma_f32_16x16x32_bf16 v[60:63], v[44:47], v[248:251], v[60:63]
  v_cvt_pk_bf16_f32 v116, v113, v117
  v_accvgpr_read_b32 v124, a92
  v_accvgpr_read_b32 v125, a93
  v_accvgpr_read_b32 v126, a94
  v_accvgpr_read_b32 v127, a95
  v_pk_mul_f32 v[124:125], v[124:125], v[36:37]
  v_pk_mul_f32 v[126:127], v[126:127], v[38:39]
  v_mfma_f32_16x16x32_bf16 a[96:99], v[176:179], a[192:195], a[96:99]
  v_cvt_pk_bf16_f32 v114, v114, v118
  v_mfma_f32_16x16x32_bf16 a[96:99], v[184:187], a[196:199], a[96:99]
  ds_write_b64 v27, v[102:103] offset:3616
  v_mfma_f32_16x16x32_bf16 a[96:99], v[240:243], v[132:135], a[96:99]
  v_cvt_pk_bf16_f32 v118, v115, v119
  v_cvt_pk_bf16_f32 v113, v120, v124
  v_mfma_f32_16x16x32_bf16 a[96:99], v[248:251], v[140:143], a[96:99]
  v_rcp_f32 v40, v60
  v_mfma_f32_16x16x32_bf16 a[100:103], v[176:179], a[200:203], a[100:103]
  s_nop 0
  ds_write_b32 v27, v40 offset:6208
  ds_read2_b32 v[40:41], v28 offset0:0 offset1:2
  ds_read2_b32 v[42:43], v28 offset0:4 offset1:6
  v_mfma_f32_16x16x32_bf16 a[100:103], v[184:187], a[204:207], a[100:103]
  ds_write_b64 v27, v[112:113] offset:4160
  ds_read_b64_tr_b16 v[224:225], v0 offset:2080
  ds_read_b64_tr_b16 v[226:227], v0 offset:2112
  v_mfma_f32_16x16x32_bf16 a[100:103], v[240:243], v[148:151], a[100:103]
  v_cvt_pk_bf16_f32 v117, v121, v125
  v_accvgpr_read_b32 v96, a96
  v_accvgpr_read_b32 v97, a97
  v_accvgpr_read_b32 v98, a98
  v_accvgpr_read_b32 v99, a99
  v_mfma_f32_16x16x32_bf16 a[100:103], v[248:251], v[156:159], a[100:103]
  v_cvt_pk_bf16_f32 v115, v122, v126
  v_mfma_f32_16x16x32_bf16 a[104:107], v[176:179], a[208:211], a[104:107]
  ds_write_b64 v27, v[116:117] offset:4672
  ds_read_b64_tr_b16 v[228:229], v0 offset:2592
L_pg23:
  s_cbranch_execz L_rt4
  ds_read_b64_tr_b16 v[230:231], v0 offset:2624
  v_mfma_f32_16x16x32_bf16 a[104:107], v[184:187], a[212:215], a[104:107]
  ds_write_b64 v27, v[114:115] offset:5184
  ds_read_b64_tr_b16 v[232:233], v0 offset:3104
  ds_read_b64_tr_b16 v[234:235], v0 offset:3136
  v_mfma_f32_16x16x32_bf16 a[104:107], v[240:243], v[164:167], a[104:107]
  v_cvt_pk_bf16_f32 v119, v123, v127
  v_accvgpr_read_b32 v100, a100
  v_accvgpr_read_b32 v101, a101
  v_accvgpr_read_b32 v102, a102
  v_accvgpr_read_b32 v103, a103
  s_waitcnt lgkmcnt(10)
  v_pk_mul_f32 v[96:97], v[96:97], v[40:41]
  s_waitcnt lgkmcnt(9)
  v_pk_mul_f32 v[98:99], v[98:99], v[42:43]
  v_pk_mul_f32 v[100:101], v[100:101], v[40:41]
  v_pk_mul_f32 v[102:103], v[102:103], v[42:43]
  v_mfma_f32_16x16x32_bf16 a[104:107], v[248:251], v[172:175], a[104:107]
  s_xor_b32 s43, s35, 0xe800
  s_waitcnt lgkmcnt(6)
  buffer_store_dwordx4 v[224:227], v26, s[24:27], s43 offen sc1
  v_cvt_pk_bf16_f32 v96, v96, v100
  v_mfma_f32_16x16x32_bf16 a[108:111], v[176:179], a[216:219], a[108:111]
  ds_write_b64 v27, v[118:119] offset:5696
  ds_read_b64_tr_b16 v[236:237], v0 offset:3616
  ds_read_b64_tr_b16 v[238:239], v0 offset:3648
  v_mfma_f32_16x16x32_bf16 a[108:111], v[184:187], a[220:223], a[108:111]
  v_cvt_pk_bf16_f32 v100, v97, v101
  v_cvt_pk_bf16_f32 v98, v98, v102
  v_mfma_f32_16x16x32_bf16 a[108:111], v[240:243], v[180:183], a[108:111]
  v_cvt_pk_bf16_f32 v102, v99, v103
  v_accvgpr_read_b32 v104, a104
  v_accvgpr_read_b32 v105, a105
  v_accvgpr_read_b32 v106, a106
  v_accvgpr_read_b32 v107, a107
  v_pk_mul_f32 v[104:105], v[104:105], v[40:41]
  v_pk_mul_f32 v[106:107], v[106:107], v[42:43]
  v_mfma_f32_16x16x32_bf16 a[108:111], v[248:251], v[188:191], a[108:111]
  s_xor_b32 s43, s35, 0x8800
  s_waitcnt lgkmcnt(6)
  buffer_store_dwordx4 v[228:231], v26, s[24:27], s43 offen sc1
  v_mfma_f32_16x16x32_bf16 a[112:115], v[176:179], v[64:67], a[112:115]
  s_xor_b32 s43, s35, 0xec00
  s_waitcnt lgkmcnt(3)
  buffer_store_dwordx4 v[232:235], v26, s[24:27], s43 offen sc1
  v_mfma_f32_16x16x32_bf16 a[112:115], v[184:187], v[68:71], a[112:115]
  s_xor_b32 s43, s35, 0x8c00
  s_waitcnt lgkmcnt(0)
  buffer_store_dwordx4 v[236:239], v26, s[24:27], s43 offen sc1
  v_mfma_f32_16x16x32_bf16 a[112:115], v[240:243], a[224:227], a[112:115]
  v_accvgpr_read_b32 v108, a108
  v_accvgpr_read_b32 v109, a109
  v_accvgpr_read_b32 v110, a110
  v_accvgpr_read_b32 v111, a111
  v_pk_mul_f32 v[108:109], v[108:109], v[40:41]
  v_pk_mul_f32 v[110:111], v[110:111], v[42:43]
  v_mfma_f32_16x16x32_bf16 a[112:115], v[248:251], a[228:231], a[112:115]
  v_cvt_pk_bf16_f32 v97, v104, v108
  v_mfma_f32_16x16x32_bf16 a[116:119], v[176:179], v[72:75], a[116:119]
  ds_write_b64 v27, v[96:97]
  v_mfma_f32_16x16x32_bf16 a[116:119], v[184:187], v[76:79], a[116:119]
  v_cvt_pk_bf16_f32 v101, v105, v109
  v_cvt_pk_bf16_f32 v99, v106, v110
  v_mfma_f32_16x16x32_bf16 a[116:119], v[240:243], a[232:235], a[116:119]
  v_cvt_pk_bf16_f32 v103, v107, v111
  v_accvgpr_read_b32 v112, a112
  v_accvgpr_read_b32 v113, a113
  v_accvgpr_read_b32 v114, a114
  v_accvgpr_read_b32 v115, a115
  v_pk_mul_f32 v[112:113], v[112:113], v[40:41]
  v_pk_mul_f32 v[114:115], v[114:115], v[42:43]
  v_mfma_f32_16x16x32_bf16 a[116:119], v[248:251], a[236:239], a[116:119]
  v_mfma_f32_16x16x32_bf16 a[120:123], v[176:179], v[80:83], a[120:123]
  ds_write_b64 v27, v[100:101] offset:512
  v_mfma_f32_16x16x32_bf16 a[120:123], v[184:187], v[84:87], a[120:123]
  ds_write_b64 v27, v[98:99] offset:1024
  v_mfma_f32_16x16x32_bf16 a[120:123], v[240:243], a[240:243], a[120:123]
  s_nop 2
  v_accvgpr_read_b32 v116, a116
  v_accvgpr_read_b32 v117, a117
  v_accvgpr_read_b32 v118, a118
  v_accvgpr_read_b32 v119, a119
  v_pk_mul_f32 v[116:117], v[116:117], v[40:41]
  v_pk_mul_f32 v[118:119], v[118:119], v[42:43]
  v_mfma_f32_16x16x32_bf16 a[120:123], v[248:251], a[244:247], a[120:123]
  v_cvt_pk_bf16_f32 v112, v112, v116
  v_mfma_f32_16x16x32_bf16 a[124:127], v[176:179], v[88:91], a[124:127]
  ds_write_b64 v27, v[102:103] offset:1536
  v_mfma_f32_16x16x32_bf16 a[124:127], v[184:187], v[92:95], a[124:127]
  v_cvt_pk_bf16_f32 v116, v113, v117
  v_cvt_pk_bf16_f32 v114, v114, v118
  v_mfma_f32_16x16x32_bf16 a[124:127], v[240:243], a[248:251], a[124:127]
  v_cvt_pk_bf16_f32 v118, v115, v119
  v_accvgpr_read_b32 v120, a120
  v_accvgpr_read_b32 v121, a121
  v_accvgpr_read_b32 v122, a122
  v_accvgpr_read_b32 v123, a123
  v_pk_mul_f32 v[120:121], v[120:121], v[40:41]
  v_pk_mul_f32 v[122:123], v[122:123], v[42:43]
  v_mfma_f32_16x16x32_bf16 a[124:127], v[248:251], a[252:255], a[124:127]
  s_nop 7
  v_accvgpr_read_b32 v124, a124
  v_accvgpr_read_b32 v125, a125
  v_accvgpr_read_b32 v126, a126
  v_accvgpr_read_b32 v127, a127
  v_pk_mul_f32 v[124:125], v[124:125], v[40:41]
  v_pk_mul_f32 v[126:127], v[126:127], v[42:43]
  v_cvt_pk_bf16_f32 v113, v120, v124
  ds_write_b64 v27, v[112:113] offset:2080
  ds_read_b64_tr_b16 v[240:241], v0
  ds_read_b64_tr_b16 v[242:243], v0 offset:32
  v_cvt_pk_bf16_f32 v117, v121, v125
  ds_write_b64 v27, v[116:117] offset:2592
  ds_read_b64_tr_b16 v[244:245], v0 offset:512
  ds_read_b64_tr_b16 v[246:247], v0 offset:544
  v_cvt_pk_bf16_f32 v115, v122, v126
  ds_write_b64 v27, v[114:115] offset:3104
  ds_read_b64_tr_b16 v[248:249], v0 offset:1024
  ds_read_b64_tr_b16 v[250:251], v0 offset:1056
  v_cvt_pk_bf16_f32 v119, v123, v127
  ds_write_b64 v27, v[118:119] offset:3616
  ds_read_b64_tr_b16 v[252:253], v0 offset:1536
  ds_read_b64_tr_b16 v[254:255], v0 offset:1568
  s_xor_b32 s43, s35, 0xb800
  s_waitcnt lgkmcnt(9)
  buffer_store_dwordx4 v[240:243], v26, s[24:27], s43 offen sc1
  s_xor_b32 s43, s35, 0xd800
  s_waitcnt lgkmcnt(6)
  buffer_store_dwordx4 v[244:247], v26, s[24:27], s43 offen sc1
  s_xor_b32 s43, s35, 0xbc00
  s_waitcnt lgkmcnt(3)
  buffer_store_dwordx4 v[248:251], v26, s[24:27], s43 offen sc1
  s_xor_b32 s43, s35, 0xdc00
  s_waitcnt lgkmcnt(0)
  buffer_store_dwordx4 v[252:255], v26, s[24:27], s43 offen sc1
  v_subrev_u32 v50, 0x37800000, v48
  v_subrev_u32 v54, 0x37800000, v52
  v_subrev_u32 v58, 0x37800000, v56
  v_subrev_u32 v62, 0x37800000, v60
  v_max3_u32 v51, v50, v54, v58
  v_max_u32 v51, v51, v62
  v_cmp_gt_u32 vcc, 0x18000000, v51
  s_nop 4
  s_cmp_eq_u64 vcc, -1
  s_cselect_b32 s41, 0, s37
  s_or_b32 s36, s36, s41
  s_cmp_lg_u32 s36, 0
  s_cbranch_scc1 SLOW0
L_done:
  s_endpgm
SLOW0:
  s_waitcnt vmcnt(0) lgkmcnt(0)
  s_barrier
  v_mbcnt_lo_u32_b32 v0, -1, 0
  v_mbcnt_hi_u32_b32 v0, -1, v0
  v_lshl_add_u32 v0, s45, 6, v0
  s_nop 1
  v_and_b32 v1, 63, v0
  v_and_b32 v5, 15, v0
  v_bfe_u32 v6, v0, 4, 2
  v_and_b32 v7, 3, v5
  v_lshlrev_b32 v7, 1, v7
  v_lshrrev_b32 v8, 3, v5
  v_bfe_u32 v9, v5, 2, 1
  v_xor_b32 v9, v9, v8
  v_lshl_or_b32 v7, v9, 3, v7
  v_or_b32 v7, v7, v8
  v_xor_b32 v8, v7, v6
  v_lshlrev_b32 v8, 4, v8
  v_lshl_add_u32 v10, v5, 8, v8
  v_xor_b32 v11, 64, v10
  v_xor_b32 v12, 128, v10
  v_xor_b32 v13, 192, v10
  v_add_u32 v28, s31, v10
  v_add_u32 v29, s31, v11
  v_add_u32 v30, s31, v12
  v_add_u32 v31, s31, v13
  v_lshrrev_b32 v8, 1, v6
  v_xor_b32 v8, v8, v7
  v_lshlrev_b32 v8, 4, v8
  v_lshl_add_u32 v8, v5, 8, v8
  v_and_b32 v9, 1, v6
  v_lshl_add_u32 v8, v9, 3, v8
  v_add_u32 v36, s31, v8
  v_xor_b32 v37, 32, v36
  v_xor_b32 v38, 64, v36
  v_xor_b32 v39, 96, v36
  v_xor_b32 v40, 128, v36
  v_xor_b32 v41, 160, v36
  v_xor_b32 v42, 192, v36
  v_xor_b32 v43, 224, v36
  s_sub_u32 s41, s31, s30
  v_lshlrev_b32 v8, 4, v1
  v_lshrrev_b32 v3, 2, v1
  v_and_b32 v7, 3, v3
  v_lshlrev_b32 v7, 1, v7
  v_lshrrev_b32 v8, 3, v3
  v_bfe_u32 v9, v3, 2, 1
  v_xor_b32 v9, v9, v8
  v_lshl_or_b32 v7, v9, 3, v7
  v_or_b32 v7, v7, v8
  v_bfe_u32 v8, v1, 1, 1
  v_xor_b32 v8, v8, v7
  v_lshlrev_b32 v8, 4, v8
  v_lshl_add_u32 v8, v3, 8, v8
  v_and_b32 v9, 1, v1
  v_lshl_add_u32 v8, v9, 3, v8
  v_add_u32 v14, 65536, v8
  v_xor_b32 v15, 32, v14
  v_xor_b32 v16, 64, v14
  v_xor_b32 v17, 96, v14
  v_xor_b32 v18, 128, v14
  v_xor_b32 v19, 160, v14
  v_xor_b32 v20, 192, v14
  v_xor_b32 v21, 224, v14
  v_and_b32 v8, 3, v5
  v_cmp_eq_u32 vcc, 0, v8
  v_mov_b32 v9, 0x3f803f80
  s_nop 1
  v_cndmask_b32 v44, 0, v9, vcc
  v_mov_b32 v45, v44
  v_mov_b32 v46, v44
  v_mov_b32 v47, v44
  v_lshlrev_b32 v26, 4, v1
  v_add_u32 v32, s31, v22
  v_add_u32 v33, s31, v23
  v_add_u32 v34, s31, v24
  v_add_u32 v35, s31, v25
  s_nop 3
SLOW:
  s_lshl_b32 s51, s45, 15
  v_add_u32 v10, s51, v10
  v_add_u32 v11, s51, v11
  v_add_u32 v12, s51, v12
  v_add_u32 v13, s51, v13
  s_sub_u32 s40, s51, 49152
  v_add_u32 v14, s40, v14
  v_add_u32 v15, s40, v15
  v_add_u32 v16, s40, v16
  v_add_u32 v17, s40, v17
  v_add_u32 v18, s40, v18
  v_add_u32 v19, s40, v19
  v_add_u32 v20, s40, v20
  v_add_u32 v21, s40, v21
  s_mov_b32 s3, 0
  v_and_b32 v76, 3, v0
  v_bfe_u32 v77, v0, 4, 2
  v_lshlrev_b32 v76, 8, v76
  v_lshl_add_u32 v76, v77, 4, v76
  v_bfe_u32 v77, v0, 2, 1
  v_mul_u32_u24 v77, 0x6000, v77
  v_xor_b32 v76, v76, v77
  v_bfe_u32 v77, v0, 3, 1
  v_mul_u32_u24 v77, 0x400, v77
  v_xor_b32 v76, v76, v77
  v_xor_b32 v84, 0x0, v76
  v_xor_b32 v85, 0x5000, v76
  v_xor_b32 v86, 0xe800, v76
  v_xor_b32 v87, 0xb800, v76
SL_blk:
  s_bitcmp1_b32 s36, s3
  s_cbranch_scc0 SL_next
  s_mov_b32 s52, s46
  s_mov_b32 s53, s47
  s_bitcmp1_b32 s3, 0
  s_cselect_b32 s40, 0x6068c00, 0
  s_cselect_b32 s41, 0x3038400, 0
  s_xor_b32 s52, s52, s40
  s_xor_b32 s53, s53, s41
  s_bitcmp1_b32 s3, 1
  s_cselect_b32 s40, 0x502e000, 0
  s_cselect_b32 s41, 0x2811400, 0
  s_xor_b32 s52, s52, s40
  s_xor_b32 s53, s53, s41
  s_and_b32 s52, s52, 0xfffe0000
  v_xor_b32 v80, s53, v84
  v_xor_b32 v81, s53, v85
  v_xor_b32 v82, s53, v86
  v_xor_b32 v83, s53, v87
  buffer_load_dwordx4 a[128:131], v80, s[12:15], 0 offen offset:0
  buffer_load_dwordx4 a[132:135], v80, s[12:15], 0 offen offset:64
  buffer_load_dwordx4 a[136:139], v80, s[12:15], 0 offen offset:128
  buffer_load_dwordx4 a[140:143], v80, s[12:15], 0 offen offset:192
  buffer_load_dwordx4 a[144:147], v81, s[12:15], 0 offen offset:0
  buffer_load_dwordx4 a[148:151], v81, s[12:15], 0 offen offset:64
  buffer_load_dwordx4 a[152:155], v81, s[12:15], 0 offen offset:128
  buffer_load_dwordx4 a[156:159], v81, s[12:15], 0 offen offset:192
  buffer_load_dwordx4 a[160:163], v82, s[12:15], 0 offen offset:0
  buffer_load_dwordx4 a[164:167], v82, s[12:15], 0 offen offset:64
  buffer_load_dwordx4 a[168:171], v82, s[12:15], 0 offen offset:128
  buffer_load_dwordx4 a[172:175], v82, s[12:15], 0 offen offset:192
  buffer_load_dwordx4 a[176:179], v83, s[12:15], 0 offen offset:0
  buffer_load_dwordx4 a[180:183], v83, s[12:15], 0 offen offset:64
  buffer_load_dwordx4 a[184:187], v83, s[12:15], 0 offen offset:128
  buffer_load_dwordx4 a[188:191], v83, s[12:15], 0 offen offset:192
  v_accvgpr_write_b32 a0, 0
  v_accvgpr_write_b32 a1, 0
  v_accvgpr_write_b32 a2, 0
  v_accvgpr_write_b32 a3, 0
  v_accvgpr_write_b32 a4, 0
  v_accvgpr_write_b32 a5, 0
  v_accvgpr_write_b32 a6, 0
  v_accvgpr_write_b32 a7, 0
  v_accvgpr_write_b32 a8, 0
  v_accvgpr_write_b32 a9, 0
  v_accvgpr_write_b32 a10, 0
  v_accvgpr_write_b32 a11, 0
  v_accvgpr_write_b32 a12, 0
  v_accvgpr_write_b32 a13, 0
  v_accvgpr_write_b32 a14, 0
  v_accvgpr_write_b32 a15, 0
  v_accvgpr_write_b32 a16, 0
  v_accvgpr_write_b32 a17, 0
  v_accvgpr_write_b32 a18, 0
  v_accvgpr_write_b32 a19, 0
  v_accvgpr_write_b32 a20, 0
  v_accvgpr_write_b32 a21, 0
  v_accvgpr_write_b32 a22, 0
  v_accvgpr_write_b32 a23, 0
  v_accvgpr_write_b32 a24, 0
  v_accvgpr_write_b32 a25, 0
  v_accvgpr_write_b32 a26, 0
  v_accvgpr_write_b32 a27, 0
  v_accvgpr_write_b32 a28, 0
  v_accvgpr_write_b32 a29, 0
  v_accvgpr_write_b32 a30, 0
  v_accvgpr_write_b32 a31, 0
  v_accvgpr_write_b32 a32, 0
  v_accvgpr_write_b32 a33, 0
  v_accvgpr_write_b32 a34, 0
  v_accvgpr_write_b32 a35, 0
  v_accvgpr_write_b32 a36, 0
  v_accvgpr_write_b32 a37, 0
  v_accvgpr_write_b32 a38, 0
  v_accvgpr_write_b32 a39, 0
  v_accvgpr_write_b32 a40, 0
  v_accvgpr_write_b32 a41, 0
  v_accvgpr_write_b32 a42, 0
  v_accvgpr_write_b32 a43, 0
  v_accvgpr_write_b32 a44, 0
  v_accvgpr_write_b32 a45, 0
  v_accvgpr_write_b32 a46, 0
  v_accvgpr_write_b32 a47, 0
  v_accvgpr_write_b32 a48, 0
  v_accvgpr_write_b32 a49, 0
  v_accvgpr_write_b32 a50, 0
  v_accvgpr_write_b32 a51, 0
  v_accvgpr_write_b32 a52, 0
  v_accvgpr_write_b32 a53, 0
  v_accvgpr_write_b32 a54, 0
  v_accvgpr_write_b32 a55, 0
  v_accvgpr_write_b32 a56, 0
  v_accvgpr_write_b32 a57, 0
  v_accvgpr_write_b32 a58, 0
  v_accvgpr_write_b32 a59, 0
  v_accvgpr_write_b32 a60, 0
  v_accvgpr_write_b32 a61, 0
  v_accvgpr_write_b32 a62, 0
  v_accvgpr_write_b32 a63, 0
  v_accvgpr_write_b32 a64, 0
  v_accvgpr_write_b32 a65, 0
  v_accvgpr_write_b32 a66, 0
  v_accvgpr_write_b32 a67, 0
  v_accvgpr_write_b32 a68, 0
  v_accvgpr_write_b32 a69, 0
  v_accvgpr_write_b32 a70, 0
  v_accvgpr_write_b32 a71, 0
  v_accvgpr_write_b32 a72, 0
  v_accvgpr_write_b32 a73, 0
  v_accvgpr_write_b32 a74, 0
  v_accvgpr_write_b32 a75, 0
  v_accvgpr_write_b32 a76, 0
  v_accvgpr_write_b32 a77, 0
  v_accvgpr_write_b32 a78, 0
  v_accvgpr_write_b32 a79, 0
  v_accvgpr_write_b32 a80, 0
  v_accvgpr_write_b32 a81, 0
  v_accvgpr_write_b32 a82, 0
  v_accvgpr_write_b32 a83, 0
  v_accvgpr_write_b32 a84, 0
  v_accvgpr_write_b32 a85, 0
  v_accvgpr_write_b32 a86, 0
  v_accvgpr_write_b32 a87, 0
  v_accvgpr_write_b32 a88, 0
  v_accvgpr_write_b32 a89, 0
  v_accvgpr_write_b32 a90, 0
  v_accvgpr_write_b32 a91, 0
  v_accvgpr_write_b32 a92, 0
  v_accvgpr_write_b32 a93, 0
  v_accvgpr_write_b32 a94, 0
  v_accvgpr_write_b32 a95, 0
  v_accvgpr_write_b32 a96, 0
  v_accvgpr_write_b32 a97, 0
  v_accvgpr_write_b32 a98, 0
  v_accvgpr_write_b32 a99, 0
  v_accvgpr_write_b32 a100, 0
  v_accvgpr_write_b32 a101, 0
  v_accvgpr_write_b32 a102, 0
  v_accvgpr_write_b32 a103, 0
  v_accvgpr_write_b32 a104, 0
  v_accvgpr_write_b32 a105, 0
  v_accvgpr_write_b32 a106, 0
  v_accvgpr_write_b32 a107, 0
  v_accvgpr_write_b32 a108, 0
  v_accvgpr_write_b32 a109, 0
  v_accvgpr_write_b32 a110, 0
  v_accvgpr_write_b32 a111, 0
  v_accvgpr_write_b32 a112, 0
  v_accvgpr_write_b32 a113, 0
  v_accvgpr_write_b32 a114, 0
  v_accvgpr_write_b32 a115, 0
  v_accvgpr_write_b32 a116, 0
  v_accvgpr_write_b32 a117, 0
  v_accvgpr_write_b32 a118, 0
  v_accvgpr_write_b32 a119, 0
  v_accvgpr_write_b32 a120, 0
  v_accvgpr_write_b32 a121, 0
  v_accvgpr_write_b32 a122, 0
  v_accvgpr_write_b32 a123, 0
  v_accvgpr_write_b32 a124, 0
  v_accvgpr_write_b32 a125, 0
  v_accvgpr_write_b32 a126, 0
  v_accvgpr_write_b32 a127, 0
  v_mov_b32 v64, 0xff800000
  v_mov_b32 v48, 0
  v_mov_b32 v49, 0
  v_mov_b32 v50, 0
  v_mov_b32 v51, 0
  v_mov_b32 v65, 0xff800000
  v_mov_b32 v52, 0
  v_mov_b32 v53, 0
  v_mov_b32 v54, 0
  v_mov_b32 v55, 0
  v_mov_b32 v66, 0xff800000
  v_mov_b32 v56, 0
  v_mov_b32 v57, 0
  v_mov_b32 v58, 0
  v_mov_b32 v59, 0
  v_mov_b32 v67, 0xff800000
  v_mov_b32 v60, 0
  v_mov_b32 v61, 0
  v_mov_b32 v62, 0
  v_mov_b32 v63, 0
  s_mov_b32 s50, 0
SL_tile:
  s_add_u32 s41, s52, s50
  s_add_u32 m0, s51, 0
  s_add_u32 s40, s41, 0
  buffer_load_dwordx4 v22, s[16:19], s40 offen lds
  buffer_load_dwordx4 v23, s[16:19], s40 offen offset:1024 lds
  buffer_load_dwordx4 v24, s[16:19], s40 offen offset:2048 lds
  buffer_load_dwordx4 v25, s[16:19], s40 offen offset:3072 lds
  s_add_u32 m0, s51, 4096
  s_add_u32 s40, s41, 4096
  buffer_load_dwordx4 v22, s[16:19], s40 offen lds
  buffer_load_dwordx4 v23, s[16:19], s40 offen offset:1024 lds
  buffer_load_dwordx4 v24, s[16:19], s40 offen offset:2048 lds
  buffer_load_dwordx4 v25, s[16:19], s40 offen offset:3072 lds
  s_add_u32 m0, s51, 8192
  s_add_u32 s40, s41, 8192
  buffer_load_dwordx4 v22, s[16:19], s40 offen lds
  buffer_load_dwordx4 v23, s[16:19], s40 offen offset:1024 lds
  buffer_load_dwordx4 v24, s[16:19], s40 offen offset:2048 lds
  buffer_load_dwordx4 v25, s[16:19], s40 offen offset:3072 lds
  s_add_u32 m0, s51, 12288
  s_add_u32 s40, s41, 12288
  buffer_load_dwordx4 v22, s[16:19], s40 offen lds
  buffer_load_dwordx4 v23, s[16:19], s40 offen offset:1024 lds
  buffer_load_dwordx4 v24, s[16:19], s40 offen offset:2048 lds
  buffer_load_dwordx4 v25, s[16:19], s40 offen offset:3072 lds
  s_add_u32 m0, s51, 16384
  s_add_u32 s40, s41, 0
  buffer_load_dwordx4 v22, s[20:23], s40 offen lds
  buffer_load_dwordx4 v23, s[20:23], s40 offen offset:1024 lds
  buffer_load_dwordx4 v24, s[20:23], s40 offen offset:2048 lds
  buffer_load_dwordx4 v25, s[20:23], s40 offen offset:3072 lds
  s_add_u32 m0, s51, 20480
  s_add_u32 s40, s41, 4096
  buffer_load_dwordx4 v22, s[20:23], s40 offen lds
  buffer_load_dwordx4 v23, s[20:23], s40 offen offset:1024 lds
  buffer_load_dwordx4 v24, s[20:23], s40 offen offset:2048 lds
  buffer_load_dwordx4 v25, s[20:23], s40 offen offset:3072 lds
  s_add_u32 m0, s51, 24576
  s_add_u32 s40, s41, 8192
  buffer_load_dwordx4 v22, s[20:23], s40 offen lds
  buffer_load_dwordx4 v23, s[20:23], s40 offen offset:1024 lds
  buffer_load_dwordx4 v24, s[20:23], s40 offen offset:2048 lds
  buffer_load_dwordx4 v25, s[20:23], s40 offen offset:3072 lds
  s_add_u32 m0, s51, 28672
  s_add_u32 s40, s41, 12288
  buffer_load_dwordx4 v22, s[20:23], s40 offen lds
  buffer_load_dwordx4 v23, s[20:23], s40 offen offset:1024 lds
  buffer_load_dwordx4 v24, s[20:23], s40 offen offset:2048 lds
  buffer_load_dwordx4 v25, s[20:23], s40 offen offset:3072 lds
  s_waitcnt vmcnt(0)
  ds_read_b128 a[192:195], v10
  ds_read_b128 a[196:199], v11
  ds_read_b128 a[200:203], v12
  ds_read_b128 a[204:207], v13
  ds_read_b128 a[208:211], v10 offset:4096
  ds_read_b128 a[212:215], v11 offset:4096
  ds_read_b128 a[216:219], v12 offset:4096
  ds_read_b128 a[220:223], v13 offset:4096
  ds_read_b128 a[224:227], v10 offset:8192
  ds_read_b128 a[228:231], v11 offset:8192
  ds_read_b128 a[232:235], v12 offset:8192
  ds_read_b128 a[236:239], v13 offset:8192
  ds_read_b128 a[240:243], v10 offset:12288
  ds_read_b128 a[244:247], v11 offset:12288
  ds_read_b128 a[248:251], v12 offset:12288
  ds_read_b128 a[252:255], v13 offset:12288
  s_waitcnt lgkmcnt(0)
  v_mfma_f32_16x16x32_bf16 v[128:131], a[192:195], a[128:131], 0
  v_mfma_f32_16x16x32_bf16 v[128:131], a[196:199], a[132:135], v[128:131]
  v_mfma_f32_16x16x32_bf16 v[128:131], a[200:203], a[136:139], v[128:131]
  v_mfma_f32_16x16x32_bf16 v[128:131], a[204:207], a[140:143], v[128:131]
  v_mfma_f32_16x16x32_bf16 v[144:147], a[192:195], a[144:147], 0
  v_mfma_f32_16x16x32_bf16 v[144:147], a[196:199], a[148:151], v[144:147]
  v_mfma_f32_16x16x32_bf16 v[144:147], a[200:203], a[152:155], v[144:147]
  v_mfma_f32_16x16x32_bf16 v[144:147], a[204:207], a[156:159], v[144:147]
  v_mfma_f32_16x16x32_bf16 v[160:163], a[192:195], a[160:163], 0
  v_mfma_f32_16x16x32_bf16 v[160:163], a[196:199], a[164:167], v[160:163]
  v_mfma_f32_16x16x32_bf16 v[160:163], a[200:203], a[168:171], v[160:163]
  v_mfma_f32_16x16x32_bf16 v[160:163], a[204:207], a[172:175], v[160:163]
  v_mfma_f32_16x16x32_bf16 v[176:179], a[192:195], a[176:179], 0
  v_mfma_f32_16x16x32_bf16 v[176:179], a[196:199], a[180:183], v[176:179]
  v_mfma_f32_16x16x32_bf16 v[176:179], a[200:203], a[184:187], v[176:179]
  v_mfma_f32_16x16x32_bf16 v[176:179], a[204:207], a[188:191], v[176:179]
  v_mfma_f32_16x16x32_bf16 v[132:135], a[208:211], a[128:131], 0
  v_mfma_f32_16x16x32_bf16 v[132:135], a[212:215], a[132:135], v[132:135]
  v_mfma_f32_16x16x32_bf16 v[132:135], a[216:219], a[136:139], v[132:135]
  v_mfma_f32_16x16x32_bf16 v[132:135], a[220:223], a[140:143], v[132:135]
  v_mfma_f32_16x16x32_bf16 v[148:151], a[208:211], a[144:147], 0
  v_mfma_f32_16x16x32_bf16 v[148:151], a[212:215], a[148:151], v[148:151]
  v_mfma_f32_16x16x32_bf16 v[148:151], a[216:219], a[152:155], v[148:151]
  v_mfma_f32_16x16x32_bf16 v[148:151], a[220:223], a[156:159], v[148:151]
  v_mfma_f32_16x16x32_bf16 v[164:167], a[208:211], a[160:163], 0
  v_mfma_f32_16x16x32_bf16 v[164:167], a[212:215], a[164:167], v[164:167]
  v_mfma_f32_16x16x32_bf16 v[164:167], a[216:219], a[168:171], v[164:167]
  v_mfma_f32_16x16x32_bf16 v[164:167], a[220:223], a[172:175], v[164:167]
  v_mfma_f32_16x16x32_bf16 v[180:183], a[208:211], a[176:179], 0
  v_mfma_f32_16x16x32_bf16 v[180:183], a[212:215], a[180:183], v[180:183]
  v_mfma_f32_16x16x32_bf16 v[180:183], a[216:219], a[184:187], v[180:183]
  v_mfma_f32_16x16x32_bf16 v[180:183], a[220:223], a[188:191], v[180:183]
  v_mfma_f32_16x16x32_bf16 v[136:139], a[224:227], a[128:131], 0
  v_mfma_f32_16x16x32_bf16 v[136:139], a[228:231], a[132:135], v[136:139]
  v_mfma_f32_16x16x32_bf16 v[136:139], a[232:235], a[136:139], v[136:139]
  v_mfma_f32_16x16x32_bf16 v[136:139], a[236:239], a[140:143], v[136:139]
  v_mfma_f32_16x16x32_bf16 v[152:155], a[224:227], a[144:147], 0
  v_mfma_f32_16x16x32_bf16 v[152:155], a[228:231], a[148:151], v[152:155]
  v_mfma_f32_16x16x32_bf16 v[152:155], a[232:235], a[152:155], v[152:155]
  v_mfma_f32_16x16x32_bf16 v[152:155], a[236:239], a[156:159], v[152:155]
  v_mfma_f32_16x16x32_bf16 v[168:171], a[224:227], a[160:163], 0
  v_mfma_f32_16x16x32_bf16 v[168:171], a[228:231], a[164:167], v[168:171]
  v_mfma_f32_16x16x32_bf16 v[168:171], a[232:235], a[168:171], v[168:171]
  v_mfma_f32_16x16x32_bf16 v[168:171], a[236:239], a[172:175], v[168:171]
  v_mfma_f32_16x16x32_bf16 v[184:187], a[224:227], a[176:179], 0
  v_mfma_f32_16x16x32_bf16 v[184:187], a[228:231], a[180:183], v[184:187]
  v_mfma_f32_16x16x32_bf16 v[184:187], a[232:235], a[184:187], v[184:187]
  v_mfma_f32_16x16x32_bf16 v[184:187], a[236:239], a[188:191], v[184:187]
  v_mfma_f32_16x16x32_bf16 v[140:143], a[240:243], a[128:131], 0
  v_mfma_f32_16x16x32_bf16 v[140:143], a[244:247], a[132:135], v[140:143]
  v_mfma_f32_16x16x32_bf16 v[140:143], a[248:251], a[136:139], v[140:143]
  v_mfma_f32_16x16x32_bf16 v[140:143], a[252:255], a[140:143], v[140:143]
  v_mfma_f32_16x16x32_bf16 v[156:159], a[240:243], a[144:147], 0
  v_mfma_f32_16x16x32_bf16 v[156:159], a[244:247], a[148:151], v[156:159]
  v_mfma_f32_16x16x32_bf16 v[156:159], a[248:251], a[152:155], v[156:159]
  v_mfma_f32_16x16x32_bf16 v[156:159], a[252:255], a[156:159], v[156:159]
  v_mfma_f32_16x16x32_bf16 v[172:175], a[240:243], a[160:163], 0
  v_mfma_f32_16x16x32_bf16 v[172:175], a[244:247], a[164:167], v[172:175]
  v_mfma_f32_16x16x32_bf16 v[172:175], a[248:251], a[168:171], v[172:175]
  v_mfma_f32_16x16x32_bf16 v[172:175], a[252:255], a[172:175], v[172:175]
  v_mfma_f32_16x16x32_bf16 v[188:191], a[240:243], a[176:179], 0
  v_mfma_f32_16x16x32_bf16 v[188:191], a[244:247], a[180:183], v[188:191]
  v_mfma_f32_16x16x32_bf16 v[188:191], a[248:251], a[184:187], v[188:191]
  v_mfma_f32_16x16x32_bf16 v[188:191], a[252:255], a[188:191], v[188:191]
  s_nop 15
  ds_read_b64_tr_b16 a[192:193], v14
  ds_read_b64_tr_b16 a[194:195], v14 offset:4096
  ds_read_b64_tr_b16 a[196:197], v14 offset:8192
  ds_read_b64_tr_b16 a[198:199], v14 offset:12288
  ds_read_b64_tr_b16 a[200:201], v15
  ds_read_b64_tr_b16 a[202:203], v15 offset:4096
  ds_read_b64_tr_b16 a[204:205], v15 offset:8192
  ds_read_b64_tr_b16 a[206:207], v15 offset:12288
  ds_read_b64_tr_b16 a[208:209], v16
  ds_read_b64_tr_b16 a[210:211], v16 offset:4096
  ds_read_b64_tr_b16 a[212:213], v16 offset:8192
  ds_read_b64_tr_b16 a[214:215], v16 offset:12288
  ds_read_b64_tr_b16 a[216:217], v17
  ds_read_b64_tr_b16 a[218:219], v17 offset:4096
  ds_read_b64_tr_b16 a[220:221], v17 offset:8192
  ds_read_b64_tr_b16 a[222:223], v17 offset:12288
  ds_read_b64_tr_b16 a[224:225], v18
  ds_read_b64_tr_b16 a[226:227], v18 offset:4096
  ds_read_b64_tr_b16 a[228:229], v18 offset:8192
  ds_read_b64_tr_b16 a[230:231], v18 offset:12288
  ds_read_b64_tr_b16 a[232:233], v19
  ds_read_b64_tr_b16 a[234:235], v19 offset:4096
  ds_read_b64_tr_b16 a[236:237], v19 offset:8192
  ds_read_b64_tr_b16 a[238:239], v19 offset:12288
  ds_read_b64_tr_b16 a[240:241], v20
  ds_read_b64_tr_b16 a[242:243], v20 offset:4096
  ds_read_b64_tr_b16 a[244:245], v20 offset:8192
  ds_read_b64_tr_b16 a[246:247], v20 offset:12288
  ds_read_b64_tr_b16 a[248:249], v21
  ds_read_b64_tr_b16 a[250:251], v21 offset:4096
  ds_read_b64_tr_b16 a[252:253], v21 offset:8192
  ds_read_b64_tr_b16 a[254:255], v21 offset:12288
  v_max3_f32 v68, v128, v129, v130
  v_max3_f32 v68, v68, v131, v132
  v_max3_f32 v68, v68, v133, v134
  v_max3_f32 v68, v68, v135, v136
  v_max3_f32 v68, v68, v137, v138
  v_max3_f32 v68, v68, v139, v140
  v_max3_f32 v68, v68, v141, v142
  v_max_f32 v68, v68, v143
  v_mov_b32 v76, v68
  s_nop 1
  v_permlane32_swap_b32 v68, v76
  v_max_f32 v68, v68, v76
  v_mov_b32 v76, v68
  s_nop 1
  v_permlane16_swap_b32 v68, v76
  v_max_f32 v68, v68, v76
  v_mul_f32 v68, s28, v68
  v_max_f32 v68, v68, v64
  v_sub_f32 v72, v64, v68
  v_exp_f32 v72, v72
  v_mov_b32 v64, v68
  v_mul_f32 v48, v48, v72
  v_max3_f32 v69, v144, v145, v146
  v_max3_f32 v69, v69, v147, v148
  v_max3_f32 v69, v69, v149, v150
  v_max3_f32 v69, v69, v151, v152
  v_max3_f32 v69, v69, v153, v154
  v_max3_f32 v69, v69, v155, v156
  v_max3_f32 v69, v69, v157, v158
  v_max_f32 v69, v69, v159
  v_mov_b32 v77, v69
  s_nop 1
  v_permlane32_swap_b32 v69, v77
  v_max_f32 v69, v69, v77
  v_mov_b32 v77, v69
  s_nop 1
  v_permlane16_swap_b32 v69, v77
  v_max_f32 v69, v69, v77
  v_mul_f32 v69, s28, v69
  v_max_f32 v69, v69, v65
  v_sub_f32 v73, v65, v69
  v_exp_f32 v73, v73
  v_mov_b32 v65, v69
  v_mul_f32 v52, v52, v73
  v_max3_f32 v70, v160, v161, v162
  v_max3_f32 v70, v70, v163, v164
  v_max3_f32 v70, v70, v165, v166
  v_max3_f32 v70, v70, v167, v168
  v_max3_f32 v70, v70, v169, v170
  v_max3_f32 v70, v70, v171, v172
  v_max3_f32 v70, v70, v173, v174
  v_max_f32 v70, v70, v175
  v_mov_b32 v78, v70
  s_nop 1
  v_permlane32_swap_b32 v70, v78
  v_max_f32 v70, v70, v78
  v_mov_b32 v78, v70
  s_nop 1
  v_permlane16_swap_b32 v70, v78
  v_max_f32 v70, v70, v78
  v_mul_f32 v70, s28, v70
  v_max_f32 v70, v70, v66
  v_sub_f32 v74, v66, v70
  v_exp_f32 v74, v74
  v_mov_b32 v66, v70
  v_mul_f32 v56, v56, v74
  v_max3_f32 v71, v176, v177, v178
  v_max3_f32 v71, v71, v179, v180
  v_max3_f32 v71, v71, v181, v182
  v_max3_f32 v71, v71, v183, v184
  v_max3_f32 v71, v71, v185, v186
  v_max3_f32 v71, v71, v187, v188
  v_max3_f32 v71, v71, v189, v190
  v_max_f32 v71, v71, v191
  v_mov_b32 v79, v71
  s_nop 1
  v_permlane32_swap_b32 v71, v79
  v_max_f32 v71, v71, v79
  v_mov_b32 v79, v71
  s_nop 1
  v_permlane16_swap_b32 v71, v79
  v_max_f32 v71, v71, v79
  v_mul_f32 v71, s28, v71
  v_max_f32 v71, v71, v67
  v_sub_f32 v75, v67, v71
  v_exp_f32 v75, v75
  v_mov_b32 v67, v71
  v_mul_f32 v60, v60, v75
  v_fma_f32 v128, v128, s28, -v64
  v_fma_f32 v129, v129, s28, -v64
  v_exp_f32 v128, v128
  v_fma_f32 v130, v130, s28, -v64
  v_exp_f32 v129, v129
  v_fma_f32 v131, v131, s28, -v64
  v_exp_f32 v130, v130
  v_fma_f32 v132, v132, s28, -v64
  v_exp_f32 v131, v131
  v_cvt_pk_bf16_f32 v128, v128, v129
  v_fma_f32 v133, v133, s28, -v64
  v_exp_f32 v132, v132
  v_cvt_pk_bf16_f32 v129, v130, v131
  v_fma_f32 v134, v134, s28, -v64
  v_exp_f32 v133, v133
  v_fma_f32 v135, v135, s28, -v64
  v_exp_f32 v134, v134
  v_cvt_pk_bf16_f32 v130, v132, v133
  v_exp_f32 v135, v135
  s_nop 0
  v_cvt_pk_bf16_f32 v131, v134, v135
  v_fma_f32 v144, v144, s28, -v65
  v_fma_f32 v145, v145, s28, -v65
  v_exp_f32 v144, v144
  v_fma_f32 v146, v146, s28, -v65
  v_exp_f32 v145, v145
  v_fma_f32 v147, v147, s28, -v65
  v_exp_f32 v146, v146
  v_fma_f32 v148, v148, s28, -v65
  v_exp_f32 v147, v147
  v_cvt_pk_bf16_f32 v144, v144, v145
  v_fma_f32 v149, v149, s28, -v65
  v_exp_f32 v148, v148
  v_cvt_pk_bf16_f32 v145, v146, v147
  v_fma_f32 v150, v150, s28, -v65
  v_exp_f32 v149, v149
  v_fma_f32 v151, v151, s28, -v65
  v_exp_f32 v150, v150
  v_cvt_pk_bf16_f32 v146, v148, v149
  v_exp_f32 v151, v151
  s_nop 0
  v_cvt_pk_bf16_f32 v147, v150, v151
  v_fma_f32 v160, v160, s28, -v66
  v_fma_f32 v161, v161, s28, -v66
  v_exp_f32 v160, v160
  v_fma_f32 v162, v162, s28, -v66
  v_exp_f32 v161, v161
  v_fma_f32 v163, v163, s28, -v66
  v_exp_f32 v162, v162
  v_fma_f32 v164, v164, s28, -v66
  v_exp_f32 v163, v163
  v_cvt_pk_bf16_f32 v160, v160, v161
  v_fma_f32 v165, v165, s28, -v66
  v_exp_f32 v164, v164
  v_cvt_pk_bf16_f32 v161, v162, v163
  v_fma_f32 v166, v166, s28, -v66
  v_exp_f32 v165, v165
  v_fma_f32 v167, v167, s28, -v66
  v_exp_f32 v166, v166
  v_cvt_pk_bf16_f32 v162, v164, v165
  v_exp_f32 v167, v167
  s_nop 0
  v_cvt_pk_bf16_f32 v163, v166, v167
  v_fma_f32 v176, v176, s28, -v67
  v_fma_f32 v177, v177, s28, -v67
  v_exp_f32 v176, v176
  v_fma_f32 v178, v178, s28, -v67
  v_exp_f32 v177, v177
  v_fma_f32 v179, v179, s28, -v67
  v_exp_f32 v178, v178
  v_fma_f32 v180, v180, s28, -v67
  v_exp_f32 v179, v179
  v_cvt_pk_bf16_f32 v176, v176, v177
  v_fma_f32 v181, v181, s28, -v67
  v_exp_f32 v180, v180
  v_cvt_pk_bf16_f32 v177, v178, v179
  v_fma_f32 v182, v182, s28, -v67
  v_exp_f32 v181, v181
  v_fma_f32 v183, v183, s28, -v67
  v_exp_f32 v182, v182
  v_cvt_pk_bf16_f32 v178, v180, v181
  v_exp_f32 v183, v183
  s_nop 0
  v_cvt_pk_bf16_f32 v179, v182, v183
  v_fma_f32 v136, v136, s28, -v64
  v_fma_f32 v137, v137, s28, -v64
  v_exp_f32 v136, v136
  v_fma_f32 v138, v138, s28, -v64
  v_exp_f32 v137, v137
  v_fma_f32 v139, v139, s28, -v64
  v_exp_f32 v138, v138
  v_fma_f32 v140, v140, s28, -v64
  v_exp_f32 v139, v139
  v_cvt_pk_bf16_f32 v136, v136, v137
  v_fma_f32 v141, v141, s28, -v64
  v_exp_f32 v140, v140
  v_cvt_pk_bf16_f32 v137, v138, v139
  v_fma_f32 v142, v142, s28, -v64
  v_exp_f32 v141, v141
  v_fma_f32 v143, v143, s28, -v64
  v_exp_f32 v142, v142
  v_cvt_pk_bf16_f32 v138, v140, v141
  v_exp_f32 v143, v143
  s_nop 0
  v_cvt_pk_bf16_f32 v139, v142, v143
  v_fma_f32 v152, v152, s28, -v65
  v_fma_f32 v153, v153, s28, -v65
  v_exp_f32 v152, v152
  v_fma_f32 v154, v154, s28, -v65
  v_exp_f32 v153, v153
  v_fma_f32 v155, v155, s28, -v65
  v_exp_f32 v154, v154
  v_fma_f32 v156, v156, s28, -v65
  v_exp_f32 v155, v155
  v_cvt_pk_bf16_f32 v152, v152, v153
  v_fma_f32 v157, v157, s28, -v65
  v_exp_f32 v156, v156
  v_cvt_pk_bf16_f32 v153, v154, v155
  v_fma_f32 v158, v158, s28, -v65
  v_exp_f32 v157, v157
  v_fma_f32 v159, v159, s28, -v65
  v_exp_f32 v158, v158
  v_cvt_pk_bf16_f32 v154, v156, v157
  v_exp_f32 v159, v159
  s_nop 0
  v_cvt_pk_bf16_f32 v155, v158, v159
  v_fma_f32 v168, v168, s28, -v66
  v_fma_f32 v169, v169, s28, -v66
  v_exp_f32 v168, v168
  v_fma_f32 v170, v170, s28, -v66
  v_exp_f32 v169, v169
  v_fma_f32 v171, v171, s28, -v66
  v_exp_f32 v170, v170
  v_fma_f32 v172, v172, s28, -v66
  v_exp_f32 v171, v171
  v_cvt_pk_bf16_f32 v168, v168, v169
  v_fma_f32 v173, v173, s28, -v66
  v_exp_f32 v172, v172
  v_cvt_pk_bf16_f32 v169, v170, v171
  v_fma_f32 v174, v174, s28, -v66
  v_exp_f32 v173, v173
  v_fma_f32 v175, v175, s28, -v66
  v_exp_f32 v174, v174
  v_cvt_pk_bf16_f32 v170, v172, v173
  v_exp_f32 v175, v175
  s_nop 0
  v_cvt_pk_bf16_f32 v171, v174, v175
  v_fma_f32 v184, v184, s28, -v67
  v_fma_f32 v185, v185, s28, -v67
  v_exp_f32 v184, v184
  v_fma_f32 v186, v186, s28, -v67
  v_exp_f32 v185, v185
  v_fma_f32 v187, v187, s28, -v67
  v_exp_f32 v186, v186
  v_fma_f32 v188, v188, s28, -v67
  v_exp_f32 v187, v187
  v_cvt_pk_bf16_f32 v184, v184, v185
  v_fma_f32 v189, v189, s28, -v67
  v_exp_f32 v188, v188
  v_cvt_pk_bf16_f32 v185, v186, v187
  v_fma_f32 v190, v190, s28, -v67
  v_exp_f32 v189, v189
  v_fma_f32 v191, v191, s28, -v67
  v_exp_f32 v190, v190
  v_cvt_pk_bf16_f32 v186, v188, v189
  v_exp_f32 v191, v191
  s_nop 0
  v_cvt_pk_bf16_f32 v187, v190, v191
  v_accvgpr_read_b32 v96, a0
  v_accvgpr_read_b32 v97, a1
  v_accvgpr_read_b32 v98, a2
  v_accvgpr_read_b32 v99, a3
  v_mul_f32 v96, v96, v72
  v_mul_f32 v97, v97, v72
  v_mul_f32 v98, v98, v72
  v_mul_f32 v99, v99, v72
  v_accvgpr_write_b32 a0, v96
  v_accvgpr_write_b32 a1, v97
  v_accvgpr_write_b32 a2, v98
  v_accvgpr_write_b32 a3, v99
  v_accvgpr_read_b32 v96, a4
  v_accvgpr_read_b32 v97, a5
  v_accvgpr_read_b32 v98, a6
  v_accvgpr_read_b32 v99, a7
  v_mul_f32 v96, v96, v72
  v_mul_f32 v97, v97, v72
  v_mul_f32 v98, v98, v72
  v_mul_f32 v99, v99, v72
  v_accvgpr_write_b32 a4, v96
  v_accvgpr_write_b32 a5, v97
  v_accvgpr_write_b32 a6, v98
  v_accvgpr_write_b32 a7, v99
  v_accvgpr_read_b32 v96, a8
  v_accvgpr_read_b32 v97, a9
  v_accvgpr_read_b32 v98, a10
  v_accvgpr_read_b32 v99, a11
  v_mul_f32 v96, v96, v72
  v_mul_f32 v97, v97, v72
  v_mul_f32 v98, v98, v72
  v_mul_f32 v99, v99, v72
  v_accvgpr_write_b32 a8, v96
  v_accvgpr_write_b32 a9, v97
  v_accvgpr_write_b32 a10, v98
  v_accvgpr_write_b32 a11, v99
  v_accvgpr_read_b32 v96, a12
  v_accvgpr_read_b32 v97, a13
  v_accvgpr_read_b32 v98, a14
  v_accvgpr_read_b32 v99, a15
  v_mul_f32 v96, v96, v72
  v_mul_f32 v97, v97, v72
  v_mul_f32 v98, v98, v72
  v_mul_f32 v99, v99, v72
  v_accvgpr_write_b32 a12, v96
  v_accvgpr_write_b32 a13, v97
  v_accvgpr_write_b32 a14, v98
  v_accvgpr_write_b32 a15, v99
  v_accvgpr_read_b32 v96, a16
  v_accvgpr_read_b32 v97, a17
  v_accvgpr_read_b32 v98, a18
  v_accvgpr_read_b32 v99, a19
  v_mul_f32 v96, v96, v72
  v_mul_f32 v97, v97, v72
  v_mul_f32 v98, v98, v72
  v_mul_f32 v99, v99, v72
  v_accvgpr_write_b32 a16, v96
  v_accvgpr_write_b32 a17, v97
  v_accvgpr_write_b32 a18, v98
  v_accvgpr_write_b32 a19, v99
  v_accvgpr_read_b32 v96, a20
  v_accvgpr_read_b32 v97, a21
  v_accvgpr_read_b32 v98, a22
  v_accvgpr_read_b32 v99, a23
  v_mul_f32 v96, v96, v72
  v_mul_f32 v97, v97, v72
  v_mul_f32 v98, v98, v72
  v_mul_f32 v99, v99, v72
  v_accvgpr_write_b32 a20, v96
  v_accvgpr_write_b32 a21, v97
  v_accvgpr_write_b32 a22, v98
  v_accvgpr_write_b32 a23, v99
  v_accvgpr_read_b32 v96, a24
  v_accvgpr_read_b32 v97, a25
  v_accvgpr_read_b32 v98, a26
  v_accvgpr_read_b32 v99, a27
  v_mul_f32 v96, v96, v72
  v_mul_f32 v97, v97, v72
  v_mul_f32 v98, v98, v72
  v_mul_f32 v99, v99, v72
  v_accvgpr_write_b32 a24, v96
  v_accvgpr_write_b32 a25, v97
  v_accvgpr_write_b32 a26, v98
  v_accvgpr_write_b32 a27, v99
  v_accvgpr_read_b32 v96, a28
  v_accvgpr_read_b32 v97, a29
  v_accvgpr_read_b32 v98, a30
  v_accvgpr_read_b32 v99, a31
  v_mul_f32 v96, v96, v72
  v_mul_f32 v97, v97, v72
  v_mul_f32 v98, v98, v72
  v_mul_f32 v99, v99, v72
  v_accvgpr_write_b32 a28, v96
  v_accvgpr_write_b32 a29, v97
  v_accvgpr_write_b32 a30, v98
  v_accvgpr_write_b32 a31, v99
  v_accvgpr_read_b32 v96, a32
  v_accvgpr_read_b32 v97, a33
  v_accvgpr_read_b32 v98, a34
  v_accvgpr_read_b32 v99, a35
  v_mul_f32 v96, v96, v73
  v_mul_f32 v97, v97, v73
  v_mul_f32 v98, v98, v73
  v_mul_f32 v99, v99, v73
  v_accvgpr_write_b32 a32, v96
  v_accvgpr_write_b32 a33, v97
  v_accvgpr_write_b32 a34, v98
  v_accvgpr_write_b32 a35, v99
  v_accvgpr_read_b32 v96, a36
  v_accvgpr_read_b32 v97, a37
  v_accvgpr_read_b32 v98, a38
  v_accvgpr_read_b32 v99, a39
  v_mul_f32 v96, v96, v73
  v_mul_f32 v97, v97, v73
  v_mul_f32 v98, v98, v73
  v_mul_f32 v99, v99, v73
  v_accvgpr_write_b32 a36, v96
  v_accvgpr_write_b32 a37, v97
  v_accvgpr_write_b32 a38, v98
  v_accvgpr_write_b32 a39, v99
  v_accvgpr_read_b32 v96, a40
  v_accvgpr_read_b32 v97, a41
  v_accvgpr_read_b32 v98, a42
  v_accvgpr_read_b32 v99, a43
  v_mul_f32 v96, v96, v73
  v_mul_f32 v97, v97, v73
  v_mul_f32 v98, v98, v73
  v_mul_f32 v99, v99, v73
  v_accvgpr_write_b32 a40, v96
  v_accvgpr_write_b32 a41, v97
  v_accvgpr_write_b32 a42, v98
  v_accvgpr_write_b32 a43, v99
  v_accvgpr_read_b32 v96, a44
  v_accvgpr_read_b32 v97, a45
  v_accvgpr_read_b32 v98, a46
  v_accvgpr_read_b32 v99, a47
  v_mul_f32 v96, v96, v73
  v_mul_f32 v97, v97, v73
  v_mul_f32 v98, v98, v73
  v_mul_f32 v99, v99, v73
  v_accvgpr_write_b32 a44, v96
  v_accvgpr_write_b32 a45, v97
  v_accvgpr_write_b32 a46, v98
  v_accvgpr_write_b32 a47, v99
  v_accvgpr_read_b32 v96, a48
  v_accvgpr_read_b32 v97, a49
  v_accvgpr_read_b32 v98, a50
  v_accvgpr_read_b32 v99, a51
  v_mul_f32 v96, v96, v73
  v_mul_f32 v97, v97, v73
  v_mul_f32 v98, v98, v73
  v_mul_f32 v99, v99, v73
  v_accvgpr_write_b32 a48, v96
  v_accvgpr_write_b32 a49, v97
  v_accvgpr_write_b32 a50, v98
  v_accvgpr_write_b32 a51, v99
  v_accvgpr_read_b32 v96, a52
  v_accvgpr_read_b32 v97, a53
  v_accvgpr_read_b32 v98, a54
  v_accvgpr_read_b32 v99, a55
  v_mul_f32 v96, v96, v73
  v_mul_f32 v97, v97, v73
  v_mul_f32 v98, v98, v73
  v_mul_f32 v99, v99, v73
  v_accvgpr_write_b32 a52, v96
  v_accvgpr_write_b32 a53, v97
  v_accvgpr_write_b32 a54, v98
  v_accvgpr_write_b32 a55, v99
  v_accvgpr_read_b32 v96, a56
  v_accvgpr_read_b32 v97, a57
  v_accvgpr_read_b32 v98, a58
  v_accvgpr_read_b32 v99, a59
  v_mul_f32 v96, v96, v73
  v_mul_f32 v97, v97, v73
  v_mul_f32 v98, v98, v73
  v_mul_f32 v99, v99, v73
  v_accvgpr_write_b32 a56, v96
  v_accvgpr_write_b32 a57, v97
  v_accvgpr_write_b32 a58, v98
  v_accvgpr_write_b32 a59, v99
  v_accvgpr_read_b32 v96, a60
  v_accvgpr_read_b32 v97, a61
  v_accvgpr_read_b32 v98, a62
  v_accvgpr_read_b32 v99, a63
  v_mul_f32 v96, v96, v73
  v_mul_f32 v97, v97, v73
  v_mul_f32 v98, v98, v73
  v_mul_f32 v99, v99, v73
  v_accvgpr_write_b32 a60, v96
  v_accvgpr_write_b32 a61, v97
  v_accvgpr_write_b32 a62, v98
  v_accvgpr_write_b32 a63, v99
  v_accvgpr_read_b32 v96, a64
  v_accvgpr_read_b32 v97, a65
  v_accvgpr_read_b32 v98, a66
  v_accvgpr_read_b32 v99, a67
  v_mul_f32 v96, v96, v74
  v_mul_f32 v97, v97, v74
  v_mul_f32 v98, v98, v74
  v_mul_f32 v99, v99, v74
  v_accvgpr_write_b32 a64, v96
  v_accvgpr_write_b32 a65, v97
  v_accvgpr_write_b32 a66, v98
  v_accvgpr_write_b32 a67, v99
  v_accvgpr_read_b32 v96, a68
  v_accvgpr_read_b32 v97, a69
  v_accvgpr_read_b32 v98, a70
  v_accvgpr_read_b32 v99, a71
  v_mul_f32 v96, v96, v74
  v_mul_f32 v97, v97, v74
  v_mul_f32 v98, v98, v74
  v_mul_f32 v99, v99, v74
  v_accvgpr_write_b32 a68, v96
  v_accvgpr_write_b32 a69, v97
  v_accvgpr_write_b32 a70, v98
  v_accvgpr_write_b32 a71, v99
  v_accvgpr_read_b32 v96, a72
  v_accvgpr_read_b32 v97, a73
  v_accvgpr_read_b32 v98, a74
  v_accvgpr_read_b32 v99, a75
  v_mul_f32 v96, v96, v74
  v_mul_f32 v97, v97, v74
  v_mul_f32 v98, v98, v74
  v_mul_f32 v99, v99, v74
  v_accvgpr_write_b32 a72, v96
  v_accvgpr_write_b32 a73, v97
  v_accvgpr_write_b32 a74, v98
  v_accvgpr_write_b32 a75, v99
  v_accvgpr_read_b32 v96, a76
  v_accvgpr_read_b32 v97, a77
  v_accvgpr_read_b32 v98, a78
  v_accvgpr_read_b32 v99, a79
  v_mul_f32 v96, v96, v74
  v_mul_f32 v97, v97, v74
  v_mul_f32 v98, v98, v74
  v_mul_f32 v99, v99, v74
  v_accvgpr_write_b32 a76, v96
  v_accvgpr_write_b32 a77, v97
  v_accvgpr_write_b32 a78, v98
  v_accvgpr_write_b32 a79, v99
  v_accvgpr_read_b32 v96, a80
  v_accvgpr_read_b32 v97, a81
  v_accvgpr_read_b32 v98, a82
  v_accvgpr_read_b32 v99, a83
  v_mul_f32 v96, v96, v74
  v_mul_f32 v97, v97, v74
  v_mul_f32 v98, v98, v74
  v_mul_f32 v99, v99, v74
  v_accvgpr_write_b32 a80, v96
  v_accvgpr_write_b32 a81, v97
  v_accvgpr_write_b32 a82, v98
  v_accvgpr_write_b32 a83, v99
  v_accvgpr_read_b32 v96, a84
  v_accvgpr_read_b32 v97, a85
  v_accvgpr_read_b32 v98, a86
  v_accvgpr_read_b32 v99, a87
  v_mul_f32 v96, v96, v74
  v_mul_f32 v97, v97, v74
  v_mul_f32 v98, v98, v74
  v_mul_f32 v99, v99, v74
  v_accvgpr_write_b32 a84, v96
  v_accvgpr_write_b32 a85, v97
  v_accvgpr_write_b32 a86, v98
  v_accvgpr_write_b32 a87, v99
  v_accvgpr_read_b32 v96, a88
  v_accvgpr_read_b32 v97, a89
  v_accvgpr_read_b32 v98, a90
  v_accvgpr_read_b32 v99, a91
  v_mul_f32 v96, v96, v74
  v_mul_f32 v97, v97, v74
  v_mul_f32 v98, v98, v74
  v_mul_f32 v99, v99, v74
  v_accvgpr_write_b32 a88, v96
  v_accvgpr_write_b32 a89, v97
  v_accvgpr_write_b32 a90, v98
  v_accvgpr_write_b32 a91, v99
  v_accvgpr_read_b32 v96, a92
  v_accvgpr_read_b32 v97, a93
  v_accvgpr_read_b32 v98, a94
  v_accvgpr_read_b32 v99, a95
  v_mul_f32 v96, v96, v74
  v_mul_f32 v97, v97, v74
  v_mul_f32 v98, v98, v74
  v_mul_f32 v99, v99, v74
  v_accvgpr_write_b32 a92, v96
  v_accvgpr_write_b32 a93, v97
  v_accvgpr_write_b32 a94, v98
  v_accvgpr_write_b32 a95, v99
  v_accvgpr_read_b32 v96, a96
  v_accvgpr_read_b32 v97, a97
  v_accvgpr_read_b32 v98, a98
  v_accvgpr_read_b32 v99, a99
  v_mul_f32 v96, v96, v75
  v_mul_f32 v97, v97, v75
  v_mul_f32 v98, v98, v75
  v_mul_f32 v99, v99, v75
  v_accvgpr_write_b32 a96, v96
  v_accvgpr_write_b32 a97, v97
  v_accvgpr_write_b32 a98, v98
  v_accvgpr_write_b32 a99, v99
  v_accvgpr_read_b32 v96, a100
  v_accvgpr_read_b32 v97, a101
  v_accvgpr_read_b32 v98, a102
  v_accvgpr_read_b32 v99, a103
  v_mul_f32 v96, v96, v75
  v_mul_f32 v97, v97, v75
  v_mul_f32 v98, v98, v75
  v_mul_f32 v99, v99, v75
  v_accvgpr_write_b32 a100, v96
  v_accvgpr_write_b32 a101, v97
  v_accvgpr_write_b32 a102, v98
  v_accvgpr_write_b32 a103, v99
  v_accvgpr_read_b32 v96, a104
  v_accvgpr_read_b32 v97, a105
  v_accvgpr_read_b32 v98, a106
  v_accvgpr_read_b32 v99, a107
  v_mul_f32 v96, v96, v75
  v_mul_f32 v97, v97, v75
  v_mul_f32 v98, v98, v75
  v_mul_f32 v99, v99, v75
  v_accvgpr_write_b32 a104, v96
  v_accvgpr_write_b32 a105, v97
  v_accvgpr_write_b32 a106, v98
  v_accvgpr_write_b32 a107, v99
  v_accvgpr_read_b32 v96, a108
  v_accvgpr_read_b32 v97, a109
  v_accvgpr_read_b32 v98, a110
  v_accvgpr_read_b32 v99, a111
  v_mul_f32 v96, v96, v75
  v_mul_f32 v97, v97, v75
  v_mul_f32 v98, v98, v75
  v_mul_f32 v99, v99, v75
  v_accvgpr_write_b32 a108, v96
  v_accvgpr_write_b32 a109, v97
  v_accvgpr_write_b32 a110, v98
  v_accvgpr_write_b32 a111, v99
  v_accvgpr_read_b32 v96, a112
  v_accvgpr_read_b32 v97, a113
  v_accvgpr_read_b32 v98, a114
  v_accvgpr_read_b32 v99, a115
  v_mul_f32 v96, v96, v75
  v_mul_f32 v97, v97, v75
  v_mul_f32 v98, v98, v75
  v_mul_f32 v99, v99, v75
  v_accvgpr_write_b32 a112, v96
  v_accvgpr_write_b32 a113, v97
  v_accvgpr_write_b32 a114, v98
  v_accvgpr_write_b32 a115, v99
  v_accvgpr_read_b32 v96, a116
  v_accvgpr_read_b32 v97, a117
  v_accvgpr_read_b32 v98, a118
  v_accvgpr_read_b32 v99, a119
  v_mul_f32 v96, v96, v75
  v_mul_f32 v97, v97, v75
  v_mul_f32 v98, v98, v75
  v_mul_f32 v99, v99, v75
  v_accvgpr_write_b32 a116, v96
  v_accvgpr_write_b32 a117, v97
  v_accvgpr_write_b32 a118, v98
  v_accvgpr_write_b32 a119, v99
  v_accvgpr_read_b32 v96, a120
  v_accvgpr_read_b32 v97, a121
  v_accvgpr_read_b32 v98, a122
  v_accvgpr_read_b32 v99, a123
  v_mul_f32 v96, v96, v75
  v_mul_f32 v97, v97, v75
  v_mul_f32 v98, v98, v75
  v_mul_f32 v99, v99, v75
  v_accvgpr_write_b32 a120, v96
  v_accvgpr_write_b32 a121, v97
  v_accvgpr_write_b32 a122, v98
  v_accvgpr_write_b32 a123, v99
  v_accvgpr_read_b32 v96, a124
  v_accvgpr_read_b32 v97, a125
  v_accvgpr_read_b32 v98, a126
  v_accvgpr_read_b32 v99, a127
  v_mul_f32 v96, v96, v75
  v_mul_f32 v97, v97, v75
  v_mul_f32 v98, v98, v75
  v_mul_f32 v99, v99, v75
  v_accvgpr_write_b32 a124, v96
  v_accvgpr_write_b32 a125, v97
  v_accvgpr_write_b32 a126, v98
  v_accvgpr_write_b32 a127, v99
  s_waitcnt lgkmcnt(0)
  s_nop 3
  v_mfma_f32_16x16x32_bf16 v[48:51], v[44:47], v[128:131], v[48:51]
  v_mfma_f32_16x16x32_bf16 v[48:51], v[44:47], v[136:139], v[48:51]
  v_mfma_f32_16x16x32_bf16 v[52:55], v[44:47], v[144:147], v[52:55]
  v_mfma_f32_16x16x32_bf16 v[52:55], v[44:47], v[152:155], v[52:55]
  v_mfma_f32_16x16x32_bf16 v[56:59], v[44:47], v[160:163], v[56:59]
  v_mfma_f32_16x16x32_bf16 v[56:59], v[44:47], v[168:171], v[56:59]
  v_mfma_f32_16x16x32_bf16 v[60:63], v[44:47], v[176:179], v[60:63]
  v_mfma_f32_16x16x32_bf16 v[60:63], v[44:47], v[184:187], v[60:63]
  v_mfma_f32_16x16x32_bf16 a[0:3], a[192:195], v[128:131], a[0:3]
  v_mfma_f32_16x16x32_bf16 a[0:3], a[196:199], v[136:139], a[0:3]
  v_mfma_f32_16x16x32_bf16 a[32:35], a[192:195], v[144:147], a[32:35]
  v_mfma_f32_16x16x32_bf16 a[32:35], a[196:199], v[152:155], a[32:35]
  v_mfma_f32_16x16x32_bf16 a[64:67], a[192:195], v[160:163], a[64:67]
  v_mfma_f32_16x16x32_bf16 a[64:67], a[196:199], v[168:171], a[64:67]
  v_mfma_f32_16x16x32_bf16 a[96:99], a[192:195], v[176:179], a[96:99]
  v_mfma_f32_16x16x32_bf16 a[96:99], a[196:199], v[184:187], a[96:99]
  v_mfma_f32_16x16x32_bf16 a[4:7], a[200:203], v[128:131], a[4:7]
  v_mfma_f32_16x16x32_bf16 a[4:7], a[204:207], v[136:139], a[4:7]
  v_mfma_f32_16x16x32_bf16 a[36:39], a[200:203], v[144:147], a[36:39]
  v_mfma_f32_16x16x32_bf16 a[36:39], a[204:207], v[152:155], a[36:39]
  v_mfma_f32_16x16x32_bf16 a[68:71], a[200:203], v[160:163], a[68:71]
  v_mfma_f32_16x16x32_bf16 a[68:71], a[204:207], v[168:171], a[68:71]
  v_mfma_f32_16x16x32_bf16 a[100:103], a[200:203], v[176:179], a[100:103]
  v_mfma_f32_16x16x32_bf16 a[100:103], a[204:207], v[184:187], a[100:103]
  v_mfma_f32_16x16x32_bf16 a[8:11], a[208:211], v[128:131], a[8:11]
  v_mfma_f32_16x16x32_bf16 a[8:11], a[212:215], v[136:139], a[8:11]
  v_mfma_f32_16x16x32_bf16 a[40:43], a[208:211], v[144:147], a[40:43]
  v_mfma_f32_16x16x32_bf16 a[40:43], a[212:215], v[152:155], a[40:43]
  v_mfma_f32_16x16x32_bf16 a[72:75], a[208:211], v[160:163], a[72:75]
  v_mfma_f32_16x16x32_bf16 a[72:75], a[212:215], v[168:171], a[72:75]
  v_mfma_f32_16x16x32_bf16 a[104:107], a[208:211], v[176:179], a[104:107]
  v_mfma_f32_16x16x32_bf16 a[104:107], a[212:215], v[184:187], a[104:107]
  v_mfma_f32_16x16x32_bf16 a[12:15], a[216:219], v[128:131], a[12:15]
  v_mfma_f32_16x16x32_bf16 a[12:15], a[220:223], v[136:139], a[12:15]
  v_mfma_f32_16x16x32_bf16 a[44:47], a[216:219], v[144:147], a[44:47]
  v_mfma_f32_16x16x32_bf16 a[44:47], a[220:223], v[152:155], a[44:47]
  v_mfma_f32_16x16x32_bf16 a[76:79], a[216:219], v[160:163], a[76:79]
  v_mfma_f32_16x16x32_bf16 a[76:79], a[220:223], v[168:171], a[76:79]
  v_mfma_f32_16x16x32_bf16 a[108:111], a[216:219], v[176:179], a[108:111]
  v_mfma_f32_16x16x32_bf16 a[108:111], a[220:223], v[184:187], a[108:111]
  v_mfma_f32_16x16x32_bf16 a[16:19], a[224:227], v[128:131], a[16:19]
  v_mfma_f32_16x16x32_bf16 a[16:19], a[228:231], v[136:139], a[16:19]
  v_mfma_f32_16x16x32_bf16 a[48:51], a[224:227], v[144:147], a[48:51]
  v_mfma_f32_16x16x32_bf16 a[48:51], a[228:231], v[152:155], a[48:51]
  v_mfma_f32_16x16x32_bf16 a[80:83], a[224:227], v[160:163], a[80:83]
  v_mfma_f32_16x16x32_bf16 a[80:83], a[228:231], v[168:171], a[80:83]
  v_mfma_f32_16x16x32_bf16 a[112:115], a[224:227], v[176:179], a[112:115]
  v_mfma_f32_16x16x32_bf16 a[112:115], a[228:231], v[184:187], a[112:115]
  v_mfma_f32_16x16x32_bf16 a[20:23], a[232:235], v[128:131], a[20:23]
  v_mfma_f32_16x16x32_bf16 a[20:23], a[236:239], v[136:139], a[20:23]
  v_mfma_f32_16x16x32_bf16 a[52:55], a[232:235], v[144:147], a[52:55]
  v_mfma_f32_16x16x32_bf16 a[52:55], a[236:239], v[152:155], a[52:55]
  v_mfma_f32_16x16x32_bf16 a[84:87], a[232:235], v[160:163], a[84:87]
  v_mfma_f32_16x16x32_bf16 a[84:87], a[236:239], v[168:171], a[84:87]
  v_mfma_f32_16x16x32_bf16 a[116:119], a[232:235], v[176:179], a[116:119]
  v_mfma_f32_16x16x32_bf16 a[116:119], a[236:239], v[184:187], a[116:119]
  v_mfma_f32_16x16x32_bf16 a[24:27], a[240:243], v[128:131], a[24:27]
  v_mfma_f32_16x16x32_bf16 a[24:27], a[244:247], v[136:139], a[24:27]
  v_mfma_f32_16x16x32_bf16 a[56:59], a[240:243], v[144:147], a[56:59]
  v_mfma_f32_16x16x32_bf16 a[56:59], a[244:247], v[152:155], a[56:59]
  v_mfma_f32_16x16x32_bf16 a[88:91], a[240:243], v[160:163], a[88:91]
  v_mfma_f32_16x16x32_bf16 a[88:91], a[244:247], v[168:171], a[88:91]
  v_mfma_f32_16x16x32_bf16 a[120:123], a[240:243], v[176:179], a[120:123]
  v_mfma_f32_16x16x32_bf16 a[120:123], a[244:247], v[184:187], a[120:123]
  v_mfma_f32_16x16x32_bf16 a[28:31], a[248:251], v[128:131], a[28:31]
  v_mfma_f32_16x16x32_bf16 a[28:31], a[252:255], v[136:139], a[28:31]
  v_mfma_f32_16x16x32_bf16 a[60:63], a[248:251], v[144:147], a[60:63]
  v_mfma_f32_16x16x32_bf16 a[60:63], a[252:255], v[152:155], a[60:63]
  v_mfma_f32_16x16x32_bf16 a[92:95], a[248:251], v[160:163], a[92:95]
  v_mfma_f32_16x16x32_bf16 a[92:95], a[252:255], v[168:171], a[92:95]
  v_mfma_f32_16x16x32_bf16 a[124:127], a[248:251], v[176:179], a[124:127]
  v_mfma_f32_16x16x32_bf16 a[124:127], a[252:255], v[184:187], a[124:127]
  s_nop 15
  s_add_u32 s50, s50, 16384
  s_cmp_lt_u32 s50, 131072
  s_cbranch_scc1 SL_tile
  v_rcp_f32 v48, v48
  v_rcp_f32 v52, v52
  v_rcp_f32 v56, v56
  v_rcp_f32 v60, v60
  v_mov_b32 v49, v48
  v_mov_b32 v53, v52
  v_mov_b32 v57, v56
  v_mov_b32 v61, v60
  s_nop 3
  v_accvgpr_read_b32 v96, a0
  v_accvgpr_read_b32 v97, a1
  v_accvgpr_read_b32 v98, a2
  v_accvgpr_read_b32 v99, a3
  v_accvgpr_read_b32 v100, a32
  v_accvgpr_read_b32 v101, a33
  v_accvgpr_read_b32 v102, a34
  v_accvgpr_read_b32 v103, a35
  v_pk_mul_f32 v[96:97], v[96:97], v[48:49]
  v_pk_mul_f32 v[98:99], v[98:99], v[48:49]
  v_cvt_pk_bf16_f32 v96, v96, v97
  v_cvt_pk_bf16_f32 v97, v98, v99
  ds_write_b64 v36, v[96:97]
  v_accvgpr_read_b32 v104, a4
  v_accvgpr_read_b32 v105, a5
  v_accvgpr_read_b32 v106, a6
  v_accvgpr_read_b32 v107, a7
  v_pk_mul_f32 v[100:101], v[100:101], v[52:53]
  v_pk_mul_f32 v[102:103], v[102:103], v[52:53]
  v_cvt_pk_bf16_f32 v100, v100, v101
  v_cvt_pk_bf16_f32 v101, v102, v103
  ds_write_b64 v36, v[100:101] offset:4096
  v_accvgpr_read_b32 v108, a36
  v_accvgpr_read_b32 v109, a37
  v_accvgpr_read_b32 v110, a38
  v_accvgpr_read_b32 v111, a39
  v_pk_mul_f32 v[104:105], v[104:105], v[48:49]
  v_pk_mul_f32 v[106:107], v[106:107], v[48:49]
  v_cvt_pk_bf16_f32 v104, v104, v105
  v_cvt_pk_bf16_f32 v105, v106, v107
  ds_write_b64 v37, v[104:105]
  v_accvgpr_read_b32 v112, a8
  v_accvgpr_read_b32 v113, a9
  v_accvgpr_read_b32 v114, a10
  v_accvgpr_read_b32 v115, a11
  v_pk_mul_f32 v[108:109], v[108:109], v[52:53]
  v_pk_mul_f32 v[110:111], v[110:111], v[52:53]
  v_cvt_pk_bf16_f32 v108, v108, v109
  v_cvt_pk_bf16_f32 v109, v110, v111
  ds_write_b64 v37, v[108:109] offset:4096
  v_accvgpr_read_b32 v116, a40
  v_accvgpr_read_b32 v117, a41
  v_accvgpr_read_b32 v118, a42
  v_accvgpr_read_b32 v119, a43
  v_pk_mul_f32 v[112:113], v[112:113], v[48:49]
  v_pk_mul_f32 v[114:115], v[114:115], v[48:49]
  v_cvt_pk_bf16_f32 v112, v112, v113
  v_cvt_pk_bf16_f32 v113, v114, v115
  ds_write_b64 v38, v[112:113]
  v_accvgpr_read_b32 v120, a12
  v_accvgpr_read_b32 v121, a13
  v_accvgpr_read_b32 v122, a14
  v_accvgpr_read_b32 v123, a15
  v_pk_mul_f32 v[116:117], v[116:117], v[52:53]
  v_pk_mul_f32 v[118:119], v[118:119], v[52:53]
  v_cvt_pk_bf16_f32 v116, v116, v117
  v_cvt_pk_bf16_f32 v117, v118, v119
  ds_write_b64 v38, v[116:117] offset:4096
  v_accvgpr_read_b32 v124, a44
  v_accvgpr_read_b32 v125, a45
  v_accvgpr_read_b32 v126, a46
  v_accvgpr_read_b32 v127, a47
  v_pk_mul_f32 v[120:121], v[120:121], v[48:49]
  v_pk_mul_f32 v[122:123], v[122:123], v[48:49]
  v_cvt_pk_bf16_f32 v120, v120, v121
  v_cvt_pk_bf16_f32 v121, v122, v123
  ds_write_b64 v39, v[120:121]
  v_accvgpr_read_b32 v96, a16
  v_accvgpr_read_b32 v97, a17
  v_accvgpr_read_b32 v98, a18
  v_accvgpr_read_b32 v99, a19
  v_pk_mul_f32 v[124:125], v[124:125], v[52:53]
  v_pk_mul_f32 v[126:127], v[126:127], v[52:53]
  v_cvt_pk_bf16_f32 v124, v124, v125
  v_cvt_pk_bf16_f32 v125, v126, v127
  ds_write_b64 v39, v[124:125] offset:4096
  v_accvgpr_read_b32 v100, a48
  v_accvgpr_read_b32 v101, a49
  v_accvgpr_read_b32 v102, a50
  v_accvgpr_read_b32 v103, a51
  v_pk_mul_f32 v[96:97], v[96:97], v[48:49]
  v_pk_mul_f32 v[98:99], v[98:99], v[48:49]
  v_cvt_pk_bf16_f32 v96, v96, v97
  v_cvt_pk_bf16_f32 v97, v98, v99
  ds_write_b64 v40, v[96:97]
  v_accvgpr_read_b32 v104, a20
  v_accvgpr_read_b32 v105, a21
  v_accvgpr_read_b32 v106, a22
  v_accvgpr_read_b32 v107, a23
  v_pk_mul_f32 v[100:101], v[100:101], v[52:53]
  v_pk_mul_f32 v[102:103], v[102:103], v[52:53]
  v_cvt_pk_bf16_f32 v100, v100, v101
  v_cvt_pk_bf16_f32 v101, v102, v103
  ds_write_b64 v40, v[100:101] offset:4096
  v_accvgpr_read_b32 v108, a52
  v_accvgpr_read_b32 v109, a53
  v_accvgpr_read_b32 v110, a54
  v_accvgpr_read_b32 v111, a55
  v_pk_mul_f32 v[104:105], v[104:105], v[48:49]
  v_pk_mul_f32 v[106:107], v[106:107], v[48:49]
  v_cvt_pk_bf16_f32 v104, v104, v105
  v_cvt_pk_bf16_f32 v105, v106, v107
  ds_write_b64 v41, v[104:105]
  v_accvgpr_read_b32 v112, a24
  v_accvgpr_read_b32 v113, a25
  v_accvgpr_read_b32 v114, a26
  v_accvgpr_read_b32 v115, a27
  v_pk_mul_f32 v[108:109], v[108:109], v[52:53]
  v_pk_mul_f32 v[110:111], v[110:111], v[52:53]
  v_cvt_pk_bf16_f32 v108, v108, v109
  v_cvt_pk_bf16_f32 v109, v110, v111
  ds_write_b64 v41, v[108:109] offset:4096
  v_accvgpr_read_b32 v116, a56
  v_accvgpr_read_b32 v117, a57
  v_accvgpr_read_b32 v118, a58
  v_accvgpr_read_b32 v119, a59
  v_pk_mul_f32 v[112:113], v[112:113], v[48:49]
  v_pk_mul_f32 v[114:115], v[114:115], v[48:49]
  v_cvt_pk_bf16_f32 v112, v112, v113
  v_cvt_pk_bf16_f32 v113, v114, v115
  ds_write_b64 v42, v[112:113]
  v_accvgpr_read_b32 v120, a28
  v_accvgpr_read_b32 v121, a29
  v_accvgpr_read_b32 v122, a30
  v_accvgpr_read_b32 v123, a31
  v_pk_mul_f32 v[116:117], v[116:117], v[52:53]
  v_pk_mul_f32 v[118:119], v[118:119], v[52:53]
  v_cvt_pk_bf16_f32 v116, v116, v117
  v_cvt_pk_bf16_f32 v117, v118, v119
  ds_write_b64 v42, v[116:117] offset:4096
  v_accvgpr_read_b32 v124, a60
  v_accvgpr_read_b32 v125, a61
  v_accvgpr_read_b32 v126, a62
  v_accvgpr_read_b32 v127, a63
  v_pk_mul_f32 v[120:121], v[120:121], v[48:49]
  v_pk_mul_f32 v[122:123], v[122:123], v[48:49]
  v_cvt_pk_bf16_f32 v120, v120, v121
  v_cvt_pk_bf16_f32 v121, v122, v123
  ds_write_b64 v43, v[120:121]
  v_pk_mul_f32 v[124:125], v[124:125], v[52:53]
  v_pk_mul_f32 v[126:127], v[126:127], v[52:53]
  v_cvt_pk_bf16_f32 v124, v124, v125
  v_cvt_pk_bf16_f32 v125, v126, v127
  ds_write_b64 v43, v[124:125] offset:4096
  ds_read_b128 v[192:195], v32
  ds_read_b128 v[196:199], v33 offset:1024
  ds_read_b128 v[200:203], v34 offset:2048
  ds_read_b128 v[204:207], v35 offset:3072
  ds_read_b128 v[208:211], v32 offset:4096
  ds_read_b128 v[212:215], v33 offset:5120
  ds_read_b128 v[216:219], v34 offset:6144
  ds_read_b128 v[220:223], v35 offset:7168
  v_accvgpr_read_b32 v96, a64
  v_accvgpr_read_b32 v97, a65
  v_accvgpr_read_b32 v98, a66
  v_accvgpr_read_b32 v99, a67
  v_accvgpr_read_b32 v100, a96
  v_accvgpr_read_b32 v101, a97
  v_accvgpr_read_b32 v102, a98
  v_accvgpr_read_b32 v103, a99
  v_pk_mul_f32 v[96:97], v[96:97], v[56:57]
  v_pk_mul_f32 v[98:99], v[98:99], v[56:57]
  v_cvt_pk_bf16_f32 v96, v96, v97
  v_cvt_pk_bf16_f32 v97, v98, v99
  ds_write_b64 v36, v[96:97]
  v_accvgpr_read_b32 v104, a68
  v_accvgpr_read_b32 v105, a69
  v_accvgpr_read_b32 v106, a70
  v_accvgpr_read_b32 v107, a71
  v_pk_mul_f32 v[100:101], v[100:101], v[60:61]
  v_pk_mul_f32 v[102:103], v[102:103], v[60:61]
  v_cvt_pk_bf16_f32 v100, v100, v101
  v_cvt_pk_bf16_f32 v101, v102, v103
  ds_write_b64 v36, v[100:101] offset:4096
  s_xor_b32 s43, s53, 0x0
  s_waitcnt lgkmcnt(9)
  buffer_store_dwordx4 v[192:195], v26, s[24:27], s43 offen sc1
  v_accvgpr_read_b32 v108, a100
  v_accvgpr_read_b32 v109, a101
  v_accvgpr_read_b32 v110, a102
  v_accvgpr_read_b32 v111, a103
  v_pk_mul_f32 v[104:105], v[104:105], v[56:57]
  v_pk_mul_f32 v[106:107], v[106:107], v[56:57]
  v_cvt_pk_bf16_f32 v104, v104, v105
  v_cvt_pk_bf16_f32 v105, v106, v107
  ds_write_b64 v37, v[104:105]
  v_accvgpr_read_b32 v112, a72
  v_accvgpr_read_b32 v113, a73
  v_accvgpr_read_b32 v114, a74
  v_accvgpr_read_b32 v115, a75
  v_pk_mul_f32 v[108:109], v[108:109], v[60:61]
  v_pk_mul_f32 v[110:111], v[110:111], v[60:61]
  v_cvt_pk_bf16_f32 v108, v108, v109
  v_cvt_pk_bf16_f32 v109, v110, v111
  ds_write_b64 v37, v[108:109] offset:4096
  s_xor_b32 s43, s53, 0x6000
  s_waitcnt lgkmcnt(10)
  buffer_store_dwordx4 v[196:199], v26, s[24:27], s43 offen sc1
  v_accvgpr_read_b32 v116, a104
  v_accvgpr_read_b32 v117, a105
  v_accvgpr_read_b32 v118, a106
  v_accvgpr_read_b32 v119, a107
  v_pk_mul_f32 v[112:113], v[112:113], v[56:57]
  v_pk_mul_f32 v[114:115], v[114:115], v[56:57]
  v_cvt_pk_bf16_f32 v112, v112, v113
  v_cvt_pk_bf16_f32 v113, v114, v115
  ds_write_b64 v38, v[112:113]
  v_accvgpr_read_b32 v120, a76
  v_accvgpr_read_b32 v121, a77
  v_accvgpr_read_b32 v122, a78
  v_accvgpr_read_b32 v123, a79
  v_pk_mul_f32 v[116:117], v[116:117], v[60:61]
  v_pk_mul_f32 v[118:119], v[118:119], v[60:61]
  v_cvt_pk_bf16_f32 v116, v116, v117
  v_cvt_pk_bf16_f32 v117, v118, v119
  ds_write_b64 v38, v[116:117] offset:4096
  s_xor_b32 s43, s53, 0x400
  s_waitcnt lgkmcnt(11)
  buffer_store_dwordx4 v[200:203], v26, s[24:27], s43 offen sc1
  v_accvgpr_read_b32 v124, a108
  v_accvgpr_read_b32 v125, a109
  v_accvgpr_read_b32 v126, a110
  v_accvgpr_read_b32 v127, a111
  v_pk_mul_f32 v[120:121], v[120:121], v[56:57]
  v_pk_mul_f32 v[122:123], v[122:123], v[56:57]
  v_cvt_pk_bf16_f32 v120, v120, v121
  v_cvt_pk_bf16_f32 v121, v122, v123
  ds_write_b64 v39, v[120:121]
  v_accvgpr_read_b32 v96, a80
  v_accvgpr_read_b32 v97, a81
  v_accvgpr_read_b32 v98, a82
  v_accvgpr_read_b32 v99, a83
  v_pk_mul_f32 v[124:125], v[124:125], v[60:61]
  v_pk_mul_f32 v[126:127], v[126:127], v[60:61]
  v_cvt_pk_bf16_f32 v124, v124, v125
  v_cvt_pk_bf16_f32 v125, v126, v127
  ds_write_b64 v39, v[124:125] offset:4096
  s_xor_b32 s43, s53, 0x6400
  s_waitcnt lgkmcnt(12)
  buffer_store_dwordx4 v[204:207], v26, s[24:27], s43 offen sc1
  v_accvgpr_read_b32 v100, a112
  v_accvgpr_read_b32 v101, a113
  v_accvgpr_read_b32 v102, a114
  v_accvgpr_read_b32 v103, a115
  v_pk_mul_f32 v[96:97], v[96:97], v[56:57]
  v_pk_mul_f32 v[98:99], v[98:99], v[56:57]
  v_cvt_pk_bf16_f32 v96, v96, v97
  v_cvt_pk_bf16_f32 v97, v98, v99
  ds_write_b64 v40, v[96:97]
  v_accvgpr_read_b32 v104, a84
  v_accvgpr_read_b32 v105, a85
  v_accvgpr_read_b32 v106, a86
  v_accvgpr_read_b32 v107, a87
  v_pk_mul_f32 v[100:101], v[100:101], v[60:61]
  v_pk_mul_f32 v[102:103], v[102:103], v[60:61]
  v_cvt_pk_bf16_f32 v100, v100, v101
  v_cvt_pk_bf16_f32 v101, v102, v103
  ds_write_b64 v40, v[100:101] offset:4096
  s_xor_b32 s43, s53, 0x5000
  s_waitcnt lgkmcnt(13)
  buffer_store_dwordx4 v[208:211], v26, s[24:27], s43 offen sc1
  v_accvgpr_read_b32 v108, a116
  v_accvgpr_read_b32 v109, a117
  v_accvgpr_read_b32 v110, a118
  v_accvgpr_read_b32 v111, a119
  v_pk_mul_f32 v[104:105], v[104:105], v[56:57]
  v_pk_mul_f32 v[106:107], v[106:107], v[56:57]
  v_cvt_pk_bf16_f32 v104, v104, v105
  v_cvt_pk_bf16_f32 v105, v106, v107
  ds_write_b64 v41, v[104:105]
  v_accvgpr_read_b32 v112, a88
  v_accvgpr_read_b32 v113, a89
  v_accvgpr_read_b32 v114, a90
  v_accvgpr_read_b32 v115, a91
  v_pk_mul_f32 v[108:109], v[108:109], v[60:61]
  v_pk_mul_f32 v[110:111], v[110:111], v[60:61]
  v_cvt_pk_bf16_f32 v108, v108, v109
  v_cvt_pk_bf16_f32 v109, v110, v111
  ds_write_b64 v41, v[108:109] offset:4096
  s_xor_b32 s43, s53, 0x3000
  s_waitcnt lgkmcnt(14)
  buffer_store_dwordx4 v[212:215], v26, s[24:27], s43 offen sc1
  v_accvgpr_read_b32 v116, a120
  v_accvgpr_read_b32 v117, a121
  v_accvgpr_read_b32 v118, a122
  v_accvgpr_read_b32 v119, a123
  v_pk_mul_f32 v[112:113], v[112:113], v[56:57]
  v_pk_mul_f32 v[114:115], v[114:115], v[56:57]
  v_cvt_pk_bf16_f32 v112, v112, v113
  v_cvt_pk_bf16_f32 v113, v114, v115
  ds_write_b64 v42, v[112:113]
  v_accvgpr_read_b32 v120, a92
  v_accvgpr_read_b32 v121, a93
  v_accvgpr_read_b32 v122, a94
  v_accvgpr_read_b32 v123, a95
  v_pk_mul_f32 v[116:117], v[116:117], v[60:61]
  v_pk_mul_f32 v[118:119], v[118:119], v[60:61]
  v_cvt_pk_bf16_f32 v116, v116, v117
  v_cvt_pk_bf16_f32 v117, v118, v119
  ds_write_b64 v42, v[116:117] offset:4096
  s_xor_b32 s43, s53, 0x5400
  s_waitcnt lgkmcnt(15)
  buffer_store_dwordx4 v[216:219], v26, s[24:27], s43 offen sc1
  v_accvgpr_read_b32 v124, a124
  v_accvgpr_read_b32 v125, a125
  v_accvgpr_read_b32 v126, a126
  v_accvgpr_read_b32 v127, a127
  v_pk_mul_f32 v[120:121], v[120:121], v[56:57]
  v_pk_mul_f32 v[122:123], v[122:123], v[56:57]
  v_cvt_pk_bf16_f32 v120, v120, v121
  v_cvt_pk_bf16_f32 v121, v122, v123
  ds_write_b64 v43, v[120:121]
  v_pk_mul_f32 v[124:125], v[124:125], v[60:61]
  v_pk_mul_f32 v[126:127], v[126:127], v[60:61]
  v_cvt_pk_bf16_f32 v124, v124, v125
  v_cvt_pk_bf16_f32 v125, v126, v127
  ds_write_b64 v43, v[124:125] offset:4096
  s_xor_b32 s43, s53, 0x3400
  s_waitcnt lgkmcnt(15)
  buffer_store_dwordx4 v[220:223], v26, s[24:27], s43 offen sc1
  ds_read_b128 v[224:227], v32
  ds_read_b128 v[228:231], v33 offset:1024
  ds_read_b128 v[232:235], v34 offset:2048
  ds_read_b128 v[236:239], v35 offset:3072
  ds_read_b128 v[240:243], v32 offset:4096
  ds_read_b128 v[244:247], v33 offset:5120
  ds_read_b128 v[248:251], v34 offset:6144
  ds_read_b128 v[252:255], v35 offset:7168
  s_xor_b32 s43, s53, 0xe800
  s_waitcnt lgkmcnt(7)
  buffer_store_dwordx4 v[224:227], v26, s[24:27], s43 offen sc1
  s_xor_b32 s43, s53, 0x8800
  s_waitcnt lgkmcnt(6)
  buffer_store_dwordx4 v[228:231], v26, s[24:27], s43 offen sc1
  s_xor_b32 s43, s53, 0xec00
  s_waitcnt lgkmcnt(5)
  buffer_store_dwordx4 v[232:235], v26, s[24:27], s43 offen sc1
  s_xor_b32 s43, s53, 0x8c00
  s_waitcnt lgkmcnt(4)
  buffer_store_dwordx4 v[236:239], v26, s[24:27], s43 offen sc1
  s_xor_b32 s43, s53, 0xb800
  s_waitcnt lgkmcnt(3)
  buffer_store_dwordx4 v[240:243], v26, s[24:27], s43 offen sc1
  s_xor_b32 s43, s53, 0xd800
  s_waitcnt lgkmcnt(2)
  buffer_store_dwordx4 v[244:247], v26, s[24:27], s43 offen sc1
  s_xor_b32 s43, s53, 0xbc00
  s_waitcnt lgkmcnt(1)
  buffer_store_dwordx4 v[248:251], v26, s[24:27], s43 offen sc1
  s_xor_b32 s43, s53, 0xdc00
  s_waitcnt lgkmcnt(0)
  buffer_store_dwordx4 v[252:255], v26, s[24:27], s43 offen sc1
  s_waitcnt vmcnt(0) lgkmcnt(0)
SL_next:
  s_add_u32 s3, s3, 1
  s_cmp_lt_u32 s3, 4
  s_cbranch_scc1 SL_blk
  s_endpgm

.section .rodata,"a"
.p2align 6
.amdhsa_kernel standalone__gqa_softmax__near_ridge_kernel
  .amdhsa_next_free_vgpr 512
  .amdhsa_next_free_sgpr 102
  .amdhsa_accum_offset 256
  .amdhsa_group_segment_fixed_size 0
  .amdhsa_kernarg_size 48
  .amdhsa_user_sgpr_count 2
  .amdhsa_user_sgpr_kernarg_segment_ptr 1
  .amdhsa_system_sgpr_workgroup_id_x 1
.end_amdhsa_kernel
```
